```python
import torch

def _softmax(x, axis=-1):
    return torch.softmax(x, dim=axis)

def _gelu(x):
    return torch.nn.functional.gelu(x, approximate='tanh')

def _silu(x):
    return torch.nn.functional.silu(x)

def _sigmoid(x):
    return torch.sigmoid(x)

def _layernorm(x, axis=-1, eps=1e-05):
    m = x.mean(dim=axis, keepdim=True)
    v = x.var(dim=axis, keepdim=True, unbiased=False)
    return (x - m) / torch.sqrt(v + eps)

def _scatter_add(tgt, idx, src, axis=0):
    return tgt.clone().index_add_(axis, idx, src)

def _segment_sum(src, seg, n):
    out = torch.zeros((n,) + src.shape[1:], dtype=src.dtype)
    return out.index_add_(0, seg, src)

def _pad(x, pw):
    flat = tuple((v for pair in reversed(pw) for v in pair))
    return torch.nn.functional.pad(x, flat)
kernel_name = 'adaLN_cond__mha_block_cached__glu_gated_swiglu__prompt'

def setup_inputs():

    _w = lambda a: (lambda t: t.to(torch.bfloat16) if t.is_floating_point() else t)(torch.as_tensor(a))

    def _A_setup():
        B, Sq, D = (1, 2048, 512)
        H, Sk, Dh = (32, 2048, 128)
        return {'x': _w((lambda *s: torch.randn(*s, dtype=torch.bfloat16) * 0.1)(B, Sq, D)), 'k_cache': _w((lambda *s: torch.randn(*s, dtype=torch.bfloat16) * 0.8)(B, H, Sk, Dh)), 'v_cache': _w((lambda *s: torch.randn(*s, dtype=torch.bfloat16) * 3.2)(B, H, Sk, Dh)), 'wq': _w((lambda *s: torch.randn(*s, dtype=torch.bfloat16) * 0.8)(D, H * Dh) * D ** (-0.5)), 'wo': _w((lambda *s: torch.randn(*s, dtype=torch.bfloat16) * 3.2)(H * Dh, D) * (H * Dh) ** (-0.5))}
    _A_in = _A_setup()

    def _B_setup():
        B, S, D, F = (1, 2048, 512, 1792)
        return {'x': _w((lambda *s: torch.randn(*s, dtype=torch.bfloat16) * 0.1)(B, S, D)), 'w1': _w((lambda *s: torch.randn(*s, dtype=torch.bfloat16) * 3.2)(D, F) * (2.0 / D) ** 0.5), 'w3': _w((lambda *s: torch.randn(*s, dtype=torch.bfloat16) * 3.2)(D, F) * (2.0 / D) ** 0.5), 'w2': _w((lambda *s: torch.randn(*s, dtype=torch.bfloat16) * 3.2)(F, D) * (2.0 / F) ** 0.5)}
    _B_in = _B_setup()
    return {'A_x': _A_in['x'], 'A_k_cache': _A_in['k_cache'], 'A_v_cache': _A_in['v_cache'], 'A_wq': _A_in['wq'], 'A_wo': _A_in['wo'], 'B_x': _B_in['x'], 'B_w1': _B_in['w1'], 'B_w3': _B_in['w3'], 'B_w2': _B_in['w2'], 'c': _w((lambda *s: torch.randn(*s, dtype=torch.bfloat16) * 0.8)(1, 512) * 8.0), 'w_mod': _w((lambda *s: torch.randn(*s, dtype=torch.bfloat16) * 0.8)(512, 6 * 512) * 512 ** (-0.5) * 8.0)}

def reference(A_x, A_k_cache, A_v_cache, A_wq, A_wo, B_x, B_w1, B_w3, B_w2, c, w_mod):

    def _A_ref(x, k_cache, v_cache, wq, wo):
        B, Sq, D = x.shape
        H, Dh = (32, 128)
        q = (lambda x, *d: x.permute(*d))((x @ wq).reshape(B, Sq, H, Dh), 0, 2, 1, 3)
        scores = torch.einsum('bhqd,bhkd->bhqk', q, k_cache) * Dh ** (-0.5)
        p = _softmax(scores, axis=-1)
        o = torch.einsum('bhqk,bhkd->bhqd', p, v_cache)
        return (lambda x, *d: x.permute(*d))(o, 0, 2, 1, 3).reshape(B, Sq, H * Dh) @ wo

    def _B_ref(x, w1, w3, w2):
        gate = torch.einsum('bsd,df->bsf', x, w1)
        up = torch.einsum('bsd,df->bsf', x, w3)
        h = _silu(gate) * up
        out = torch.einsum('bsf,fd->bsd', h, w2)
        return out
    x = A_x
    mod = (_silu(c) @ w_mod).reshape(c.shape[0], 6, 1, -1)
    sa, ca, ga, sb, cb, gb = (mod[:, 0].clone(), mod[:, 1].clone(), mod[:, 2].clone(), mod[:, 3].clone(), mod[:, 4].clone(), mod[:, 5].clone())
    h = _layernorm(x, axis=-1) * (1 + ca) + sa
    x = x + ga * _A_ref(h, A_k_cache, A_v_cache, A_wq, A_wo)
    h = _layernorm(x, axis=-1) * (1 + cb) + sb
    x = x + gb * _B_ref(h, B_w1, B_w3, B_w2)
    return x
```

```asm
; @launch kernel=pre_kernel grid=(384,1,1) block=(512,1,1) lds=18432
; @launch kernel=attn_kernel grid=(256,1,1) block=(256,1,1) lds=163840
.amdgcn_target "amdgcn-amd-amdhsa--gfx950"
.text
.globl pre_kernel
.p2align 8
.type pre_kernel,@function
pre_kernel:
  s_cmp_ge_u32 s2, 384
  s_cbranch_scc1 pre_kernel_done1
  s_cmp_ge_u32 s2, 320
  s_cbranch_scc1 pre_kernel_pf3
  v_lshrrev_b32 v60, 6, v0
  s_nop 0
  v_readfirstlane_b32 s36, v60
  s_load_dwordx2 s[8:9], s[0:1], 104
  s_cmp_ge_u32 s2, 192
  s_cbranch_scc1 pre_kernel_ln2
  s_load_dwordx4 s[4:7], s[0:1], 72
  s_and_b32 s3, s2, 3
  s_lshr_b32 s30, s2, 2
  v_and_b32 v1, 7, v0
  v_lshrrev_b32 v2, 3, v0
  s_movk_i32 s24, 12288
  v_mul_lo_u32 v3, v2, s24
  v_lshl_add_u32 v3, v1, 4, v3
  v_lshlrev_b32 v4, 2, v2
  s_mul_i32 s25, s3, 786432
  s_lshl_b32 s26, s30, 7
  s_add_u32 s25, s25, s26
  s_add_u32 s26, s25, 6144
  s_lshl_b32 s29, s3, 8
  s_waitcnt lgkmcnt(0)
  s_mov_b32 s16, s6
  s_and_b32 s17, s7, 0xffff
  s_mov_b32 s18, 0x300000
  s_mov_b32 s19, 0x20000
  buffer_load_dwordx4 v[8:11], v3, s[16:19], s25 offen
  buffer_load_dwordx4 v[12:15], v3, s[16:19], s26 offen
  s_mov_b32 s12, s4
  s_and_b32 s13, s5, 0xffff
  s_mov_b32 s14, 0x400
  s_mov_b32 s15, 0x20000
  buffer_load_dword v6, v4, s[12:15], s29 offen
  s_mov_b32 s20, s8
  s_and_b32 s21, s9, 0xffff
  s_mov_b32 s22, 0xc000
  s_mov_b32 s23, 0x20000
  v_lshlrev_b32 v5, 8, v2
  v_lshl_add_u32 v5, v1, 5, v5
  v_and_b32 v16, 63, v0
  v_lshrrev_b32 v7, 6, v0
  v_lshlrev_b32 v7, 11, v7
  v_lshl_add_u32 v7, v16, 2, v7
  v_lshlrev_b32 v17, 2, v0
  v_lshlrev_b32 v18, 4, v0
  s_lshl_b32 s25, s30, 10
  s_lshl_b32 s26, s3, 2
  s_add_u32 s25, s25, s26
  s_waitcnt vmcnt(0)
  v_lshlrev_b32 v24, 16, v6
  v_and_b32 v25, 0xffff0000, v6
  v_mul_f32 v28, 0xbfb8aa3b, v24
  v_mul_f32 v29, 0xbfb8aa3b, v25
  v_exp_f32 v28, v28
  v_exp_f32 v29, v29
  s_nop 0
  v_add_f32 v28, 1.0, v28
  v_add_f32 v29, 1.0, v29
  v_rcp_f32 v28, v28
  v_rcp_f32 v29, v29
  s_nop 0
  v_mul_f32 v24, v24, v28
  v_mul_f32 v25, v25, v29
  v_cvt_pk_bf16_f32 v28, v24, v25
  v_lshlrev_b32 v24, 16, v28
  v_and_b32 v25, 0xffff0000, v28
  v_lshlrev_b32 v40, 16, v8
  v_and_b32 v41, 0xffff0000, v8
  v_mul_f32 v32, v24, v40
  v_mul_f32 v33, v24, v41
  v_lshlrev_b32 v40, 16, v9
  v_and_b32 v41, 0xffff0000, v9
  v_mul_f32 v34, v24, v40
  v_mul_f32 v35, v24, v41
  v_lshlrev_b32 v40, 16, v10
  v_and_b32 v41, 0xffff0000, v10
  v_mul_f32 v36, v24, v40
  v_mul_f32 v37, v24, v41
  v_lshlrev_b32 v40, 16, v11
  v_and_b32 v41, 0xffff0000, v11
  v_mul_f32 v38, v24, v40
  v_mul_f32 v39, v24, v41
  v_lshlrev_b32 v40, 16, v12
  v_and_b32 v41, 0xffff0000, v12
  v_fmac_f32 v32, v25, v40
  v_fmac_f32 v33, v25, v41
  v_lshlrev_b32 v40, 16, v13
  v_and_b32 v41, 0xffff0000, v13
  v_fmac_f32 v34, v25, v40
  v_fmac_f32 v35, v25, v41
  v_lshlrev_b32 v40, 16, v14
  v_and_b32 v41, 0xffff0000, v14
  v_fmac_f32 v36, v25, v40
  v_fmac_f32 v37, v25, v41
  v_lshlrev_b32 v40, 16, v15
  v_and_b32 v41, 0xffff0000, v15
  v_fmac_f32 v38, v25, v40
  v_fmac_f32 v39, v25, v41
  ds_write_b128 v5, v[32:35]
  ds_write_b128 v5, v[36:39] offset:16
  s_waitcnt lgkmcnt(0)
  s_barrier
  ds_read_b32 v8, v7 offset:0
  ds_read_b32 v9, v7 offset:256
  ds_read_b32 v10, v7 offset:512
  ds_read_b32 v11, v7 offset:768
  ds_read_b32 v12, v7 offset:1024
  ds_read_b32 v13, v7 offset:1280
  ds_read_b32 v14, v7 offset:1536
  ds_read_b32 v15, v7 offset:1792
  s_waitcnt lgkmcnt(0)
  v_add_f32 v8, v8, v12
  v_add_f32 v9, v9, v13
  v_add_f32 v10, v10, v14
  v_add_f32 v11, v11, v15
  v_add_f32 v8, v8, v10
  v_add_f32 v9, v9, v11
  v_add_f32 v8, v8, v9
  ds_write_b32 v17, v8 offset:16384
  s_waitcnt lgkmcnt(0)
  s_barrier
  v_cmp_gt_u32 vcc, 64, v0
  s_and_saveexec_b64 s[32:33], vcc
  s_cbranch_execz pre_kernel_done1
  ds_read_b32 v8, v17 offset:16384
  ds_read_b32 v9, v17 offset:16640
  ds_read_b32 v10, v17 offset:16896
  ds_read_b32 v11, v17 offset:17152
  ds_read_b32 v12, v17 offset:17408
  ds_read_b32 v13, v17 offset:17664
  ds_read_b32 v14, v17 offset:17920
  ds_read_b32 v15, v17 offset:18176
  s_waitcnt lgkmcnt(0)
  v_add_f32 v8, v8, v12
  v_add_f32 v9, v9, v13
  v_add_f32 v10, v10, v14
  v_add_f32 v11, v11, v15
  v_add_f32 v8, v8, v10
  v_add_f32 v9, v9, v11
  v_add_f32 v8, v8, v9
  buffer_store_dword v8, v18, s[20:23], s25 offen
  s_endpgm
pre_kernel_ln2:
  s_load_dwordx2 s[4:5], s[0:1], 0
  s_sub_u32 s24, s2, 192
  v_and_b32 v1, 63, v0
  v_lshrrev_b32 v2, 6, v0
  v_lshlrev_b32 v5, 11, v2
  v_lshl_add_u32 v5, v1, 4, v5
  s_lshl_b32 s25, s24, 14
  s_waitcnt lgkmcnt(0)
  s_mov_b32 s12, s4
  s_and_b32 s13, s5, 0xffff
  s_mov_b32 s14, 0x200000
  s_mov_b32 s15, 0x20000
  buffer_load_dwordx4 v[16:19], v5, s[12:15], s25 offen
  buffer_load_dwordx4 v[20:23], v5, s[12:15], s25 offen offset:1024
  s_add_u32 s20, s8, 0x100000
  s_addc_u32 s21, s9, 0
  s_and_b32 s21, s21, 0xffff
  s_mov_b32 s22, 0x200000
  s_mov_b32 s23, 0x20000
  s_movk_i32 s26, 272
  v_mul_lo_u32 v6, v1, s26
  v_lshl_add_u32 v6, v2, 5, v6
  v_lshrrev_b32 v7, 4, v0
  v_and_b32 v8, 15, v0
  v_mul_lo_u32 v9, v7, s26
  v_lshl_add_u32 v9, v8, 4, v9
  v_lshlrev_b32 v10, 9, v7
  v_lshl_add_u32 v10, v8, 4, v10
  s_lshr_b32 s27, s24, 1
  s_lshl_b32 s27, s27, 15
  s_and_b32 s28, s24, 1
  s_lshl_b32 s28, s28, 8
  s_add_u32 s27, s27, s28
  s_add_u32 s28, s27, 0x4000
  s_waitcnt vmcnt(1)
  v_lshlrev_b32 v32, 16, v16
  v_and_b32 v33, 0xffff0000, v16
  v_lshlrev_b32 v34, 16, v17
  v_and_b32 v35, 0xffff0000, v17
  v_lshlrev_b32 v36, 16, v18
  v_and_b32 v37, 0xffff0000, v18
  v_lshlrev_b32 v38, 16, v19
  v_and_b32 v39, 0xffff0000, v19
  s_waitcnt vmcnt(0)
  v_lshlrev_b32 v40, 16, v20
  v_and_b32 v41, 0xffff0000, v20
  v_lshlrev_b32 v42, 16, v21
  v_and_b32 v43, 0xffff0000, v21
  v_lshlrev_b32 v44, 16, v22
  v_and_b32 v45, 0xffff0000, v22
  v_lshlrev_b32 v46, 16, v23
  v_and_b32 v47, 0xffff0000, v23
  v_add_f32 v12, v32, v33
  v_add_f32 v14, v34, v35
  v_add_f32 v12, v12, v36
  v_add_f32 v14, v14, v37
  v_add_f32 v12, v12, v38
  v_add_f32 v14, v14, v39
  v_add_f32 v13, v40, v41
  v_add_f32 v15, v42, v43
  v_add_f32 v13, v13, v44
  v_add_f32 v15, v15, v45
  v_add_f32 v13, v13, v46
  v_add_f32 v15, v15, v47
  v_add_f32 v12, v12, v14
  v_add_f32 v13, v13, v15
  s_nop 0
  v_add_f32_dpp v12, v12, v12 row_ror:8 row_mask:0xf bank_mask:0xf
  v_add_f32_dpp v13, v13, v13 row_ror:8 row_mask:0xf bank_mask:0xf
  s_nop 0
  v_add_f32_dpp v12, v12, v12 row_ror:4 row_mask:0xf bank_mask:0xf
  v_add_f32_dpp v13, v13, v13 row_ror:4 row_mask:0xf bank_mask:0xf
  s_nop 0
  v_add_f32_dpp v12, v12, v12 row_ror:2 row_mask:0xf bank_mask:0xf
  v_add_f32_dpp v13, v13, v13 row_ror:2 row_mask:0xf bank_mask:0xf
  s_nop 0
  v_add_f32_dpp v12, v12, v12 row_ror:1 row_mask:0xf bank_mask:0xf
  v_add_f32_dpp v13, v13, v13 row_ror:1 row_mask:0xf bank_mask:0xf
  v_mov_b32 v14, v12
  v_mov_b32 v15, v13
  s_nop 0
  v_permlane16_swap_b32 v12, v14
  v_permlane16_swap_b32 v13, v15
  v_add_f32 v12, v12, v14
  v_add_f32 v13, v13, v15
  v_mov_b32 v14, v12
  v_mov_b32 v15, v13
  s_nop 0
  v_permlane32_swap_b32 v12, v14
  v_permlane32_swap_b32 v13, v15
  v_add_f32 v12, v12, v14
  v_add_f32 v13, v13, v15
  v_mul_f32 v12, 0x3b000000, v12
  v_mul_f32 v13, 0x3b000000, v13
  v_sub_f32 v32, v32, v12
  v_sub_f32 v33, v33, v12
  v_sub_f32 v34, v34, v12
  v_sub_f32 v35, v35, v12
  v_sub_f32 v36, v36, v12
  v_sub_f32 v37, v37, v12
  v_sub_f32 v38, v38, v12
  v_sub_f32 v39, v39, v12
  v_sub_f32 v40, v40, v13
  v_sub_f32 v41, v41, v13
  v_sub_f32 v42, v42, v13
  v_sub_f32 v43, v43, v13
  v_sub_f32 v44, v44, v13
  v_sub_f32 v45, v45, v13
  v_sub_f32 v46, v46, v13
  v_sub_f32 v47, v47, v13
  v_mul_f32 v12, v32, v32
  v_mul_f32 v14, v33, v33
  v_fmac_f32 v12, v34, v34
  v_fmac_f32 v14, v35, v35
  v_fmac_f32 v12, v36, v36
  v_fmac_f32 v14, v37, v37
  v_fmac_f32 v12, v38, v38
  v_fmac_f32 v14, v39, v39
  v_mul_f32 v13, v40, v40
  v_mul_f32 v15, v41, v41
  v_fmac_f32 v13, v42, v42
  v_fmac_f32 v15, v43, v43
  v_fmac_f32 v13, v44, v44
  v_fmac_f32 v15, v45, v45
  v_fmac_f32 v13, v46, v46
  v_fmac_f32 v15, v47, v47
  v_add_f32 v12, v12, v14
  v_add_f32 v13, v13, v15
  s_nop 0
  v_add_f32_dpp v12, v12, v12 row_ror:8 row_mask:0xf bank_mask:0xf
  v_add_f32_dpp v13, v13, v13 row_ror:8 row_mask:0xf bank_mask:0xf
  s_nop 0
  v_add_f32_dpp v12, v12, v12 row_ror:4 row_mask:0xf bank_mask:0xf
  v_add_f32_dpp v13, v13, v13 row_ror:4 row_mask:0xf bank_mask:0xf
  s_nop 0
  v_add_f32_dpp v12, v12, v12 row_ror:2 row_mask:0xf bank_mask:0xf
  v_add_f32_dpp v13, v13, v13 row_ror:2 row_mask:0xf bank_mask:0xf
  s_nop 0
  v_add_f32_dpp v12, v12, v12 row_ror:1 row_mask:0xf bank_mask:0xf
  v_add_f32_dpp v13, v13, v13 row_ror:1 row_mask:0xf bank_mask:0xf
  v_mov_b32 v14, v12
  v_mov_b32 v15, v13
  s_nop 0
  v_permlane16_swap_b32 v12, v14
  v_permlane16_swap_b32 v13, v15
  v_add_f32 v12, v12, v14
  v_add_f32 v13, v13, v15
  v_mov_b32 v14, v12
  v_mov_b32 v15, v13
  s_nop 0
  v_permlane32_swap_b32 v12, v14
  v_permlane32_swap_b32 v13, v15
  v_add_f32 v12, v12, v14
  v_add_f32 v13, v13, v15
  v_mov_b32 v14, 0x3727c5ac
  v_fmac_f32 v14, 0x3b000000, v12
  v_mov_b32 v15, 0x3727c5ac
  v_fmac_f32 v15, 0x3b000000, v13
  v_rsq_f32 v14, v14
  v_rsq_f32 v15, v15
  s_nop 0
  v_mul_f32 v32, v32, v14
  v_mul_f32 v33, v33, v14
  v_mul_f32 v34, v34, v14
  v_mul_f32 v35, v35, v14
  v_mul_f32 v36, v36, v14
  v_mul_f32 v37, v37, v14
  v_mul_f32 v38, v38, v14
  v_mul_f32 v39, v39, v14
  v_cvt_pk_f16_f32 v16, v32, v33
  v_cvt_pk_f16_f32 v17, v34, v35
  v_cvt_pk_f16_f32 v18, v36, v37
  v_cvt_pk_f16_f32 v19, v38, v39
  ds_write_b128 v6, v[16:19] offset:0
  v_mul_f32 v40, v40, v15
  v_mul_f32 v41, v41, v15
  v_mul_f32 v42, v42, v15
  v_mul_f32 v43, v43, v15
  v_mul_f32 v44, v44, v15
  v_mul_f32 v45, v45, v15
  v_mul_f32 v46, v46, v15
  v_mul_f32 v47, v47, v15
  v_cvt_pk_f16_f32 v20, v40, v41
  v_cvt_pk_f16_f32 v21, v42, v43
  v_cvt_pk_f16_f32 v22, v44, v45
  v_cvt_pk_f16_f32 v23, v46, v47
  ds_write_b128 v6, v[20:23] offset:16
  s_waitcnt lgkmcnt(0)
  s_barrier
  ds_read_b128 v[24:27], v9
  ds_read_b128 v[28:31], v9 offset:8704
  s_waitcnt lgkmcnt(1)
  buffer_store_dwordx4 v[24:27], v10, s[20:23], s27 offen
  s_waitcnt lgkmcnt(0)
  buffer_store_dwordx4 v[28:31], v10, s[20:23], s28 offen
pre_kernel_done1:
  s_endpgm
pre_kernel_pf3:
  s_load_dwordx4 s[4:7], s[0:1], 8
  s_load_dwordx2 s[8:9], s[0:1], 24
  s_and_b32 s24, s2, 7
  s_sub_u32 s25, s2, 320
  s_lshr_b32 s25, s25, 3
  v_lshrrev_b32 v1, 3, v0
  v_lshlrev_b32 v1, 13, v1
  v_and_b32 v2, 7, v0
  v_lshl_add_u32 v1, v2, 7, v1
  s_lshl_b32 s26, s25, 19
  s_lshr_b32 s27, s24, 0
  s_lshl_b32 s27, s27, 10
  s_add_u32 s26, s26, s27
  v_lshlrev_b32 v2, 6, v0
  s_lshl_b32 s27, s24, 2
  s_lshr_b32 s28, s25, 1
  s_add_u32 s27, s27, s28
  s_lshl_b32 s27, s27, 19
  s_bitcmp1_b32 s25, 0
  s_waitcnt lgkmcnt(0)
  s_cselect_b32 s4, s6, s4
  s_cselect_b32 s5, s7, s5
  s_mov_b32 s12, s8
  s_and_b32 s13, s9, 0xffff
  s_mov_b32 s14, 0x400000
  s_mov_b32 s15, 0x20000
  s_mov_b32 s16, s4
  s_and_b32 s17, s5, 0xffff
  s_mov_b32 s18, 0x1000000
  s_mov_b32 s19, 0x20000
  s_load_dwordx2 s[10:11], s[0:1], 104
  v_mov_b32 v16, 0
  v_lshlrev_b32 v17, 2, v0
  s_lshl_b32 s30, s25, 11
  s_waitcnt lgkmcnt(0)
  s_add_u32 s32, s10, 0xfc000
  s_addc_u32 s33, s11, 0
  s_and_b32 s33, s33, 0xffff
  s_mov_b32 s34, 0x2000
  s_mov_b32 s35, 0x20000
  buffer_store_dword v16, v17, s[32:35], s30 offen
  s_getpc_b64 s[20:21]
pre_kernel_pc4:
  s_add_u32 s20, s20, attn_kernel-pre_kernel_pc4
  s_addc_u32 s21, s21, 0
  s_and_b32 s21, s21, 0xffff
  s_mov_b32 s22, 0x10000
  s_mov_b32 s23, 0x20000
  v_lshlrev_b32 v5, 4, v0
  s_lshl_b32 s28, s25, 13
  buffer_load_dword v6, v5, s[20:23], s28 offen
  buffer_load_dword v8, v1, s[12:15], s26 offen offset:0
  s_endpgm
.globl attn_kernel
.p2align 8
.type attn_kernel,@function
attn_kernel:
  s_cmp_ge_u32 s2, 256
  s_cbranch_scc1 attn_kernel_done1
  s_load_dwordx2 s[76:77], s[0:1], 104
  s_load_dwordx2 s[10:11], s[0:1], 104
  s_load_dwordx2 s[8:9], s[0:1], 24
  s_load_dwordx4 s[4:7], s[0:1], 8
  v_and_b32 v1, 63, v0
  v_lshrrev_b32 v2, 6, v0
  v_lshlrev_b32 v24, 5, v0
  v_readfirstlane_b32 s40, v2
  s_bfe_u32 s41, s2, 0x30000
  s_lshl_b32 s41, s41, 2
  s_bfe_u32 s42, s2, 0x20003
  s_add_u32 s41, s41, s42
  s_and_b32 s42, s2, 0
  s_lshl_b32 s42, s42, 3
  s_lshr_b32 s43, s2, 5
  s_add_u32 s42, s42, s43
  v_lshlrev_b32 v3, 4, v1
  s_lshl_b32 s43, s40, 11
  v_lshrrev_b32 v26, 4, v1
  v_and_b32 v27, 15, v1
  v_lshlrev_b32 v28, 2, v26
  v_xor_b32 v28, v28, v27
  v_lshlrev_b32 v28, 4, v28
  v_lshl_add_u32 v6, v26, 8, v28
  v_lshl_add_u32 v7, v26, 13, v28
  s_lshl_b32 s46, s42, 3
  s_lshl_b32 s47, s40, 1
  s_add_u32 s46, s46, s47
  s_lshl_b32 s48, s46, 15
  s_add_u32 s49, s48, 0x8000
  s_lshl_b32 s50, s40, 15
  s_lshl_b32 s51, s41, 8
  s_add_u32 s50, s50, s51
  s_lshl_b32 s51, s40, 10
  s_waitcnt lgkmcnt(0)
  s_add_u32 s76, s76, 0xfc000
  s_addc_u32 s77, s77, 0
  s_and_b32 s77, s77, 0xffff
  s_mov_b32 s78, 8192
  s_mov_b32 s79, 0x20000
  s_mov_b32 s32, s10
  s_and_b32 s33, s11, 0xffff
  s_mov_b32 s34, 0xc000
  s_mov_b32 s35, 0x20000
  s_movk_i32 s55, 8192
  buffer_load_dwordx4 v[32:35], v24, s[32:35], s55 offen
  buffer_load_dwordx4 v[36:39], v24, s[32:35], s55 offen offset:16
  buffer_load_dwordx4 v[40:43], v24, s[32:35], 0 offen
  buffer_load_dwordx4 v[44:47], v24, s[32:35], 0 offen offset:16
  s_mov_b32 s20, s8
  s_and_b32 s21, s9, 0xffff
  s_mov_b32 s22, 0x400000
  s_mov_b32 s23, 0x20000
  s_add_u32 s24, s10, 0x100000
  s_addc_u32 s25, s11, 0
  s_and_b32 s25, s25, 0xffff
  s_mov_b32 s26, 0x200000
  s_mov_b32 s27, 0x20000
  s_sub_u32 s50, s50, 131072
  s_add_u32 m0, s51, 32768
  s_add_u32 s50, s50, 131072
  buffer_load_dwordx4 v7, s[20:23], s50 offen lds
  buffer_load_dwordx4 v[64:67], v3, s[24:27], s48 offen offset:0
  buffer_load_dwordx4 v[68:71], v3, s[24:27], s49 offen offset:0
  s_add_u32 m0, s51, 36864
  s_add_u32 s50, s50, 131072
  buffer_load_dwordx4 v7, s[20:23], s50 offen lds
  buffer_load_dwordx4 v[72:75], v3, s[24:27], s48 offen offset:1024
  buffer_load_dwordx4 v[76:79], v3, s[24:27], s49 offen offset:1024
  s_add_u32 m0, s51, 40960
  s_add_u32 s50, s50, 131072
  buffer_load_dwordx4 v7, s[20:23], s50 offen lds
  buffer_load_dwordx4 v[80:83], v3, s[24:27], s48 offen offset:2048
  buffer_load_dwordx4 v[84:87], v3, s[24:27], s49 offen offset:2048
  s_add_u32 m0, s51, 45056
  s_add_u32 s50, s50, 131072
  buffer_load_dwordx4 v7, s[20:23], s50 offen lds
  buffer_load_dwordx4 v[88:91], v3, s[24:27], s48 offen offset:3072
  buffer_load_dwordx4 v[92:95], v3, s[24:27], s49 offen offset:3072
  s_add_u32 s48, s48, 4096
  s_add_u32 s49, s49, 4096
  s_and_b32 s44, s40, 1
  s_lshl_b32 s44, s44, 3
  v_add_u32 v28, s44, v26
  v_xor_b32 v28, v28, v27
  v_lshlrev_b32 v28, 4, v28
  v_lshl_add_u32 v4, v26, 8, v28
  v_xor_b32 v5, 64, v4
  s_lshl_b32 s45, s41, 19
  s_add_u32 s12, s4, s45
  s_addc_u32 s13, s5, 0
  s_and_b32 s13, s13, 0xffff
  s_mov_b32 s14, 0x80000
  s_mov_b32 s15, 0x20000
  s_add_u32 s16, s6, s45
  s_addc_u32 s17, s7, 0
  s_and_b32 s17, s17, 0xffff
  s_mov_b32 s18, 0x80000
  s_mov_b32 s19, 0x20000
  s_mov_b32 s52, s43
  s_mov_b32 s53, s43
  s_load_dwordx2 s[4:5], s[0:1], 32
  s_load_dwordx2 s[6:7], s[0:1], 64
  s_add_u32 m0, s51, 49152
  s_add_u32 s50, s50, 131072
  buffer_load_dwordx4 v7, s[20:23], s50 offen lds
  buffer_load_dwordx4 v[96:99], v3, s[24:27], s48 offen offset:0
  buffer_load_dwordx4 v[100:103], v3, s[24:27], s49 offen offset:0
  s_add_u32 m0, s51, 53248
  s_add_u32 s50, s50, 131072
  buffer_load_dwordx4 v7, s[20:23], s50 offen lds
  buffer_load_dwordx4 v[104:107], v3, s[24:27], s48 offen offset:1024
  buffer_load_dwordx4 v[108:111], v3, s[24:27], s49 offen offset:1024
  s_add_u32 m0, s51, 57344
  s_add_u32 s50, s50, 131072
  buffer_load_dwordx4 v7, s[20:23], s50 offen lds
  s_add_u32 m0, s51, 61440
  s_add_u32 s50, s50, 131072
  buffer_load_dwordx4 v7, s[20:23], s50 offen lds
  s_add_u32 m0, s51, 81920
  s_add_u32 s50, s50, 131072
  buffer_load_dwordx4 v7, s[20:23], s50 offen lds
  s_add_u32 m0, s51, 86016
  s_add_u32 s50, s50, 131072
  buffer_load_dwordx4 v7, s[20:23], s50 offen lds
  s_add_u32 m0, s51, 90112
  s_add_u32 s50, s50, 131072
  buffer_load_dwordx4 v7, s[20:23], s50 offen lds
  s_add_u32 m0, s51, 94208
  s_add_u32 s50, s50, 131072
  buffer_load_dwordx4 v7, s[20:23], s50 offen lds
  s_cmp_ge_u32 s2, 4
  s_cbranch_scc1 attn_kernel_nomodf2
  s_add_u32 s55, s2, 2
  s_lshl_b32 s56, s55, 11
  s_lshl_b32 s55, s55, 13
  buffer_load_dwordx4 v[48:51], v24, s[32:35], s55 offen
  buffer_load_dwordx4 v[52:55], v24, s[32:35], s55 offen offset:16
  s_add_u32 s36, s10, 0x20000
  s_addc_u32 s37, s11, 0
  s_and_b32 s37, s37, 0xffff
  s_mov_b32 s38, 0x3000
  s_mov_b32 s39, 0x20000
  v_lshlrev_b32 v25, 3, v0
  s_waitcnt vmcnt(0)
  v_add_f32 v48, v48, v49
  v_add_f32 v50, v50, v51
  v_add_f32 v52, v52, v53
  v_add_f32 v54, v54, v55
  v_add_f32 v48, v48, v50
  v_add_f32 v49, v52, v54
  v_cvt_pk_bf16_f32 v48, v48, v49
  v_and_b32 v49, 0xffff0000, v48
  v_lshlrev_b32 v48, 16, v48
  buffer_store_dwordx2 v[48:49], v25, s[36:39], s56 offen sc0 sc1
  s_waitcnt vmcnt(0)
attn_kernel_nomodf2:
  s_load_dwordx4 s[36:39], s[0:1], 48
  v_and_b32 v26, 0x13, v1
  v_bfe_u32 v27, v1, 2, 1
  v_lshl_or_b32 v26, v27, 3, v26
  v_bfe_u32 v27, v1, 3, 1
  v_lshl_or_b32 v26, v27, 2, v26
  v_and_b32 v27, 15, v26
  v_lshrrev_b32 v28, 5, v1
  v_xor_b32 v27, v27, v28
  v_lshlrev_b32 v27, 4, v27
  v_lshl_add_u32 v8, v26, 8, v27
  v_xor_b32 v9, 32, v8
  v_xor_b32 v10, 64, v8
  v_xor_b32 v11, 96, v8
  v_xor_b32 v12, 128, v8
  v_xor_b32 v13, 160, v8
  v_xor_b32 v14, 192, v8
  v_xor_b32 v15, 224, v8
  v_bfe_u32 v26, v1, 2, 2
  v_and_b32 v27, 3, v1
  v_lshrrev_b32 v28, 1, v27
  v_and_b32 v27, 1, v27
  v_lshl_or_b32 v27, v27, 1, v28
  v_lshrrev_b32 v28, 5, v1
  v_lshl_add_u32 v28, v28, 3, v26
  v_lshlrev_b32 v16, 8, v28
  v_lshl_add_u32 v16, v26, 6, v16
  v_bfe_u32 v28, v1, 4, 1
  v_lshl_add_u32 v16, v28, 5, v16
  v_lshl_add_u32 v16, v27, 3, v16
  v_xor_b32 v17, 64, v16
  v_xor_b32 v18, 128, v16
  v_xor_b32 v19, 192, v16
  v_add_u32 v20, 0x8000, v16
  v_add_u32 v21, 0x8000, v17
  v_add_u32 v22, 0x8000, v18
  v_add_u32 v23, 0x8000, v19
  v_add_u32 v16, 0x10000, v16
  v_add_u32 v17, 0x10000, v17
  v_add_u32 v18, 0x10000, v18
  v_add_u32 v19, 0x10000, v19
  v_lshrrev_b32 v2, 5, v1
  v_lshlrev_b32 v2, 5, v2
  v_add_u32 v2, 159744, v2
  v_lshlrev_b32 v25, 3, v0
  v_add_u32 v25, 159744, v25
  s_add_u32 s28, s10, 0x1000000
  s_addc_u32 s29, s11, 0
  s_and_b32 s29, s29, 0xffff
  s_mov_b32 s30, 0x1000000
  s_mov_b32 s31, 0x20000
  s_mov_b32 s54, 0x71800000
  s_waitcnt vmcnt(24)
  v_add_f32 v32, v32, v33
  v_add_f32 v34, v34, v35
  v_add_f32 v36, v36, v37
  v_add_f32 v38, v38, v39
  v_add_f32 v40, v40, v41
  v_add_f32 v42, v42, v43
  v_add_f32 v44, v44, v45
  v_add_f32 v46, v46, v47
  v_add_f32 v32, v32, v34
  v_add_f32 v36, v36, v38
  v_add_f32 v40, v40, v42
  v_add_f32 v44, v44, v46
  v_cvt_pk_bf16_f32 v32, v32, v36
  v_cvt_pk_bf16_f32 v40, v40, v44
  v_and_b32 v33, 0xffff0000, v32
  v_lshlrev_b32 v32, 16, v32
  v_and_b32 v35, 0xffff0000, v40
  v_lshlrev_b32 v34, 16, v40
  v_add_f32 v32, 1.0, v32
  v_add_f32 v33, 1.0, v33
  v_cvt_pk_bf16_f32 v32, v32, v33
  v_and_b32 v33, 0xffff0000, v32
  v_lshlrev_b32 v32, 16, v32
  v_mul_f32 v32, 0x3e0293ee, v32
  v_mul_f32 v33, 0x3e0293ee, v33
  v_mul_f32 v34, 0x3e0293ee, v34
  v_mul_f32 v35, 0x3e0293ee, v35
  ds_write_b64 v25, v[32:33]
  ds_write_b64 v25, v[34:35] offset:2048
  s_waitcnt vmcnt(18) lgkmcnt(0)
  s_barrier
  ds_read_b128 v[32:35], v2 offset:0
  ds_read_b128 v[36:39], v2 offset:16
  ds_read_b128 v[40:43], v2 offset:2048
  ds_read_b128 v[44:47], v2 offset:2064
  ds_read_b64_tr_b16 a[128:129], v20 offset:0
  ds_read_b64_tr_b16 a[130:131], v20 offset:1024
  ds_read_b64_tr_b16 a[132:133], v21 offset:0
  ds_read_b64_tr_b16 a[134:135], v21 offset:1024
  ds_read_b64_tr_b16 a[136:137], v22 offset:0
  ds_read_b64_tr_b16 a[138:139], v22 offset:1024
  ds_read_b64_tr_b16 a[140:141], v23 offset:0
  ds_read_b64_tr_b16 a[142:143], v23 offset:1024
  ds_read_b128 v[48:51], v2 offset:64
  ds_read_b128 v[52:55], v2 offset:80
  ds_read_b128 v[56:59], v2 offset:2112
  ds_read_b128 v[60:63], v2 offset:2128
  s_waitcnt lgkmcnt(13)
  v_fma_mix_f32 v24, v64, v32, v40 op_sel:[0,0,0] op_sel_hi:[1,0,0]
  v_fma_mix_f32 v25, v64, v33, v41 op_sel:[1,0,0] op_sel_hi:[1,0,0]
  v_fma_mix_f32 v26, v65, v34, v42 op_sel:[0,0,0] op_sel_hi:[1,0,0]
  v_fma_mix_f32 v27, v65, v35, v43 op_sel:[1,0,0] op_sel_hi:[1,0,0]
  s_waitcnt lgkmcnt(12)
  v_fma_mix_f32 v28, v66, v36, v44 op_sel:[0,0,0] op_sel_hi:[1,0,0]
  v_fma_mix_f32 v29, v66, v37, v45 op_sel:[1,0,0] op_sel_hi:[1,0,0]
  v_fma_mix_f32 v30, v67, v38, v46 op_sel:[0,0,0] op_sel_hi:[1,0,0]
  v_fma_mix_f32 v31, v67, v39, v47 op_sel:[1,0,0] op_sel_hi:[1,0,0]
  v_cvt_pk_bf16_f32 v64, v24, v25
  v_cvt_pk_bf16_f32 v65, v26, v27
  v_cvt_pk_bf16_f32 v66, v28, v29
  v_cvt_pk_bf16_f32 v67, v30, v31
  v_fma_mix_f32 v24, v68, v32, v40 op_sel:[0,0,0] op_sel_hi:[1,0,0]
  v_fma_mix_f32 v25, v68, v33, v41 op_sel:[1,0,0] op_sel_hi:[1,0,0]
  v_fma_mix_f32 v26, v69, v34, v42 op_sel:[0,0,0] op_sel_hi:[1,0,0]
  v_fma_mix_f32 v27, v69, v35, v43 op_sel:[1,0,0] op_sel_hi:[1,0,0]
  v_fma_mix_f32 v28, v70, v36, v44 op_sel:[0,0,0] op_sel_hi:[1,0,0]
  v_fma_mix_f32 v29, v70, v37, v45 op_sel:[1,0,0] op_sel_hi:[1,0,0]
  v_fma_mix_f32 v30, v71, v38, v46 op_sel:[0,0,0] op_sel_hi:[1,0,0]
  v_fma_mix_f32 v31, v71, v39, v47 op_sel:[1,0,0] op_sel_hi:[1,0,0]
  v_cvt_pk_bf16_f32 v68, v24, v25
  v_cvt_pk_bf16_f32 v69, v26, v27
  v_cvt_pk_bf16_f32 v70, v28, v29
  v_cvt_pk_bf16_f32 v71, v30, v31
  s_waitcnt lgkmcnt(10)
  v_mfma_f32_32x32x16_bf16 a[0:15], a[128:131], v[64:67], 0
  s_waitcnt vmcnt(12)
  s_barrier
  s_waitcnt lgkmcnt(1)
  v_fma_mix_f32 v24, v72, v48, v56 op_sel:[0,0,0] op_sel_hi:[1,0,0]
  v_mfma_f32_32x32x16_bf16 a[64:79], a[128:131], v[68:71], 0
  ds_read_b128 v[32:35], v2 offset:128
  ds_read_b128 v[36:39], v2 offset:144
  s_add_u32 m0, s51, 98304
  s_add_u32 s50, s50, 131072
  v_fma_mix_f32 v25, v72, v49, v57 op_sel:[1,0,0] op_sel_hi:[1,0,0]
  v_fma_mix_f32 v26, v73, v50, v58 op_sel:[0,0,0] op_sel_hi:[1,0,0]
  v_fma_mix_f32 v27, v73, v51, v59 op_sel:[1,0,0] op_sel_hi:[1,0,0]
  v_mfma_f32_32x32x16_bf16 a[16:31], a[132:135], v[64:67], 0
  ds_read_b128 v[40:43], v2 offset:2176
  ds_read_b128 v[44:47], v2 offset:2192
  buffer_load_dwordx4 v7, s[20:23], s50 offen lds
  buffer_load_dwordx4 v[112:115], v3, s[24:27], s48 offen offset:2048
  s_waitcnt lgkmcnt(4)
  v_fma_mix_f32 v28, v74, v52, v60 op_sel:[0,0,0] op_sel_hi:[1,0,0]
  v_fma_mix_f32 v29, v74, v53, v61 op_sel:[1,0,0] op_sel_hi:[1,0,0]
  v_mfma_f32_32x32x16_bf16 a[80:95], a[132:135], v[68:71], 0
  ds_read_b64_tr_b16 a[144:145], v20 offset:4096
  ds_read_b64_tr_b16 a[146:147], v20 offset:5120
  buffer_load_dwordx4 v[116:119], v3, s[24:27], s49 offen offset:2048
  s_add_u32 m0, s51, 102400
  v_fma_mix_f32 v30, v75, v54, v62 op_sel:[0,0,0] op_sel_hi:[1,0,0]
  v_fma_mix_f32 v31, v75, v55, v63 op_sel:[1,0,0] op_sel_hi:[1,0,0]
  v_cvt_pk_bf16_f32 v72, v24, v25
  v_mfma_f32_32x32x16_bf16 a[32:47], a[136:139], v[64:67], 0
  ds_read_b64_tr_b16 a[148:149], v21 offset:4096
  ds_read_b64_tr_b16 a[150:151], v21 offset:5120
  s_add_u32 s50, s50, 131072
  v_cvt_pk_bf16_f32 v73, v26, v27
  v_cvt_pk_bf16_f32 v74, v28, v29
  v_cvt_pk_bf16_f32 v75, v30, v31
  v_fma_mix_f32 v24, v76, v48, v56 op_sel:[0,0,0] op_sel_hi:[1,0,0]
  v_mfma_f32_32x32x16_bf16 a[96:111], a[136:139], v[68:71], 0
  ds_read_b64_tr_b16 a[152:153], v22 offset:4096
  ds_read_b64_tr_b16 a[154:155], v22 offset:5120
  buffer_load_dwordx4 v7, s[20:23], s50 offen lds
  buffer_load_dwordx4 v[120:123], v3, s[24:27], s48 offen offset:3072
  v_fma_mix_f32 v25, v76, v49, v57 op_sel:[1,0,0] op_sel_hi:[1,0,0]
  v_fma_mix_f32 v26, v77, v50, v58 op_sel:[0,0,0] op_sel_hi:[1,0,0]
  v_mfma_f32_32x32x16_bf16 a[48:63], a[140:143], v[64:67], 0
  ds_read_b64_tr_b16 a[156:157], v23 offset:4096
  ds_read_b64_tr_b16 a[158:159], v23 offset:5120
  buffer_load_dwordx4 v[124:127], v3, s[24:27], s49 offen offset:3072
  s_add_u32 s48, s48, 4096
  v_fma_mix_f32 v27, v77, v51, v59 op_sel:[1,0,0] op_sel_hi:[1,0,0]
  v_fma_mix_f32 v28, v78, v52, v60 op_sel:[0,0,0] op_sel_hi:[1,0,0]
  v_fma_mix_f32 v29, v78, v53, v61 op_sel:[1,0,0] op_sel_hi:[1,0,0]
  v_mfma_f32_32x32x16_bf16 a[112:127], a[140:143], v[68:71], 0
  s_add_u32 s49, s49, 4096
  v_fma_mix_f32 v30, v79, v54, v62 op_sel:[0,0,0] op_sel_hi:[1,0,0]
  v_fma_mix_f32 v31, v79, v55, v63 op_sel:[1,0,0] op_sel_hi:[1,0,0]
  v_cvt_pk_bf16_f32 v76, v24, v25
  v_cvt_pk_bf16_f32 v77, v26, v27
  v_cvt_pk_bf16_f32 v78, v28, v29
  v_cvt_pk_bf16_f32 v79, v30, v31
  s_waitcnt lgkmcnt(6)
  v_mfma_f32_32x32x16_bf16 a[0:15], a[144:147], v[72:75], a[0:15]
  ds_read_b128 v[48:51], v2 offset:192
  ds_read_b128 v[52:55], v2 offset:208
  v_fma_mix_f32 v24, v80, v32, v40 op_sel:[0,0,0] op_sel_hi:[1,0,0]
  v_fma_mix_f32 v25, v80, v33, v41 op_sel:[1,0,0] op_sel_hi:[1,0,0]
  v_fma_mix_f32 v26, v81, v34, v42 op_sel:[0,0,0] op_sel_hi:[1,0,0]
  v_fma_mix_f32 v27, v81, v35, v43 op_sel:[1,0,0] op_sel_hi:[1,0,0]
  v_mfma_f32_32x32x16_bf16 a[64:79], a[144:147], v[76:79], a[64:79]
  ds_read_b128 v[56:59], v2 offset:2240
  ds_read_b128 v[60:63], v2 offset:2256
  s_add_u32 m0, s51, 106496
  s_add_u32 s50, s50, 131072
  v_fma_mix_f32 v28, v82, v36, v44 op_sel:[0,0,0] op_sel_hi:[1,0,0]
  v_fma_mix_f32 v29, v82, v37, v45 op_sel:[1,0,0] op_sel_hi:[1,0,0]
  s_waitcnt lgkmcnt(8)
  v_mfma_f32_32x32x16_bf16 a[16:31], a[148:151], v[72:75], a[16:31]
  ds_read_b64_tr_b16 a[128:129], v20 offset:8192
  ds_read_b64_tr_b16 a[130:131], v20 offset:9216
  buffer_load_dwordx4 v7, s[20:23], s50 offen lds
  v_fma_mix_f32 v30, v83, v38, v46 op_sel:[0,0,0] op_sel_hi:[1,0,0]
  v_fma_mix_f32 v31, v83, v39, v47 op_sel:[1,0,0] op_sel_hi:[1,0,0]
  v_mfma_f32_32x32x16_bf16 a[80:95], a[148:151], v[76:79], a[80:95]
  ds_read_b64_tr_b16 a[132:133], v21 offset:8192
  ds_read_b64_tr_b16 a[134:135], v21 offset:9216
  buffer_load_dwordx4 v[128:131], v3, s[24:27], s48 offen offset:0
  buffer_load_dwordx4 v[132:135], v3, s[24:27], s49 offen offset:0
  v_cvt_pk_bf16_f32 v80, v24, v25
  v_cvt_pk_bf16_f32 v81, v26, v27
  s_waitcnt lgkmcnt(10)
  v_mfma_f32_32x32x16_bf16 a[32:47], a[152:155], v[72:75], a[32:47]
  ds_read_b64_tr_b16 a[136:137], v22 offset:8192
  ds_read_b64_tr_b16 a[138:139], v22 offset:9216
  s_add_u32 m0, s51, 110592
  v_cvt_pk_bf16_f32 v82, v28, v29
  v_cvt_pk_bf16_f32 v83, v30, v31
  v_fma_mix_f32 v24, v84, v32, v40 op_sel:[0,0,0] op_sel_hi:[1,0,0]
  v_mfma_f32_32x32x16_bf16 a[96:111], a[152:155], v[76:79], a[96:111]
  ds_read_b64_tr_b16 a[140:141], v23 offset:8192
  ds_read_b64_tr_b16 a[142:143], v23 offset:9216
  s_add_u32 s50, s50, 131072
  buffer_load_dwordx4 v7, s[20:23], s50 offen lds
  v_fma_mix_f32 v25, v84, v33, v41 op_sel:[1,0,0] op_sel_hi:[1,0,0]
  v_fma_mix_f32 v26, v85, v34, v42 op_sel:[0,0,0] op_sel_hi:[1,0,0]
  s_waitcnt lgkmcnt(12)
  v_mfma_f32_32x32x16_bf16 a[48:63], a[156:159], v[72:75], a[48:63]
  buffer_load_dwordx4 v[136:139], v3, s[24:27], s48 offen offset:1024
  v_fma_mix_f32 v27, v85, v35, v43 op_sel:[1,0,0] op_sel_hi:[1,0,0]
  v_fma_mix_f32 v28, v86, v36, v44 op_sel:[0,0,0] op_sel_hi:[1,0,0]
  v_fma_mix_f32 v29, v86, v37, v45 op_sel:[1,0,0] op_sel_hi:[1,0,0]
  v_fma_mix_f32 v30, v87, v38, v46 op_sel:[0,0,0] op_sel_hi:[1,0,0]
  v_mfma_f32_32x32x16_bf16 a[112:127], a[156:159], v[76:79], a[112:127]
  buffer_load_dwordx4 v[140:143], v3, s[24:27], s49 offen offset:1024
  v_fma_mix_f32 v31, v87, v39, v47 op_sel:[1,0,0] op_sel_hi:[1,0,0]
  v_cvt_pk_bf16_f32 v84, v24, v25
  v_cvt_pk_bf16_f32 v85, v26, v27
  v_cvt_pk_bf16_f32 v86, v28, v29
  v_cvt_pk_bf16_f32 v87, v30, v31
  s_waitcnt lgkmcnt(6)
  v_mfma_f32_32x32x16_bf16 a[0:15], a[128:131], v[80:83], a[0:15]
  s_waitcnt vmcnt(18)
  s_barrier
  v_fma_mix_f32 v24, v88, v48, v56 op_sel:[0,0,0] op_sel_hi:[1,0,0]
  v_mfma_f32_32x32x16_bf16 a[64:79], a[128:131], v[84:87], a[64:79]
  ds_read_b128 v[32:35], v2 offset:256
  ds_read_b128 v[36:39], v2 offset:272
  s_add_u32 m0, s51, 114688
  s_add_u32 s50, s50, 131072
  v_fma_mix_f32 v25, v88, v49, v57 op_sel:[1,0,0] op_sel_hi:[1,0,0]
  v_fma_mix_f32 v26, v89, v50, v58 op_sel:[0,0,0] op_sel_hi:[1,0,0]
  v_fma_mix_f32 v27, v89, v51, v59 op_sel:[1,0,0] op_sel_hi:[1,0,0]
  s_waitcnt lgkmcnt(6)
  v_mfma_f32_32x32x16_bf16 a[16:31], a[132:135], v[80:83], a[16:31]
  ds_read_b128 v[40:43], v2 offset:2304
  ds_read_b128 v[44:47], v2 offset:2320
  buffer_load_dwordx4 v7, s[20:23], s50 offen lds
  buffer_load_dwordx4 v[144:147], v3, s[24:27], s48 offen offset:2048
  v_fma_mix_f32 v28, v90, v52, v60 op_sel:[0,0,0] op_sel_hi:[1,0,0]
  v_fma_mix_f32 v29, v90, v53, v61 op_sel:[1,0,0] op_sel_hi:[1,0,0]
  v_mfma_f32_32x32x16_bf16 a[80:95], a[132:135], v[84:87], a[80:95]
  ds_read_b64_tr_b16 a[144:145], v20 offset:12288
  ds_read_b64_tr_b16 a[146:147], v20 offset:13312
  buffer_load_dwordx4 v[148:151], v3, s[24:27], s49 offen offset:2048
  s_add_u32 m0, s51, 118784
  v_fma_mix_f32 v30, v91, v54, v62 op_sel:[0,0,0] op_sel_hi:[1,0,0]
  v_fma_mix_f32 v31, v91, v55, v63 op_sel:[1,0,0] op_sel_hi:[1,0,0]
  v_cvt_pk_bf16_f32 v88, v24, v25
  s_waitcnt lgkmcnt(8)
  v_mfma_f32_32x32x16_bf16 a[32:47], a[136:139], v[80:83], a[32:47]
  ds_read_b64_tr_b16 a[148:149], v21 offset:12288
  ds_read_b64_tr_b16 a[150:151], v21 offset:13312
  s_add_u32 s50, s50, 131072
  v_cvt_pk_bf16_f32 v89, v26, v27
  v_cvt_pk_bf16_f32 v90, v28, v29
  v_cvt_pk_bf16_f32 v91, v30, v31
  v_fma_mix_f32 v24, v92, v48, v56 op_sel:[0,0,0] op_sel_hi:[1,0,0]
  v_mfma_f32_32x32x16_bf16 a[96:111], a[136:139], v[84:87], a[96:111]
  ds_read_b64_tr_b16 a[152:153], v22 offset:12288
  ds_read_b64_tr_b16 a[154:155], v22 offset:13312
  buffer_load_dwordx4 v7, s[20:23], s50 offen lds
  buffer_load_dwordx4 v[152:155], v3, s[24:27], s48 offen offset:3072
  v_fma_mix_f32 v25, v92, v49, v57 op_sel:[1,0,0] op_sel_hi:[1,0,0]
  v_fma_mix_f32 v26, v93, v50, v58 op_sel:[0,0,0] op_sel_hi:[1,0,0]
  s_waitcnt lgkmcnt(10)
  v_mfma_f32_32x32x16_bf16 a[48:63], a[140:143], v[80:83], a[48:63]
  ds_read_b64_tr_b16 a[156:157], v23 offset:12288
  ds_read_b64_tr_b16 a[158:159], v23 offset:13312
  buffer_load_dwordx4 v[156:159], v3, s[24:27], s49 offen offset:3072
  s_add_u32 s48, s48, 4096
  v_fma_mix_f32 v27, v93, v51, v59 op_sel:[1,0,0] op_sel_hi:[1,0,0]
  v_fma_mix_f32 v28, v94, v52, v60 op_sel:[0,0,0] op_sel_hi:[1,0,0]
  v_fma_mix_f32 v29, v94, v53, v61 op_sel:[1,0,0] op_sel_hi:[1,0,0]
  v_mfma_f32_32x32x16_bf16 a[112:127], a[140:143], v[84:87], a[112:127]
  s_add_u32 s49, s49, 4096
  v_fma_mix_f32 v30, v95, v54, v62 op_sel:[0,0,0] op_sel_hi:[1,0,0]
  v_fma_mix_f32 v31, v95, v55, v63 op_sel:[1,0,0] op_sel_hi:[1,0,0]
  v_cvt_pk_bf16_f32 v92, v24, v25
  v_cvt_pk_bf16_f32 v93, v26, v27
  v_cvt_pk_bf16_f32 v94, v28, v29
  v_cvt_pk_bf16_f32 v95, v30, v31
  s_waitcnt lgkmcnt(6)
  v_mfma_f32_32x32x16_bf16 a[0:15], a[144:147], v[88:91], a[0:15]
  ds_read_b128 v[48:51], v2 offset:320
  ds_read_b128 v[52:55], v2 offset:336
  v_fma_mix_f32 v24, v96, v32, v40 op_sel:[0,0,0] op_sel_hi:[1,0,0]
  v_fma_mix_f32 v25, v96, v33, v41 op_sel:[1,0,0] op_sel_hi:[1,0,0]
  v_fma_mix_f32 v26, v97, v34, v42 op_sel:[0,0,0] op_sel_hi:[1,0,0]
  v_fma_mix_f32 v27, v97, v35, v43 op_sel:[1,0,0] op_sel_hi:[1,0,0]
  v_mfma_f32_32x32x16_bf16 a[64:79], a[144:147], v[92:95], a[64:79]
  ds_read_b128 v[56:59], v2 offset:2368
  ds_read_b128 v[60:63], v2 offset:2384
  s_add_u32 m0, s51, 122880
  s_add_u32 s50, s50, 131072
  v_fma_mix_f32 v28, v98, v36, v44 op_sel:[0,0,0] op_sel_hi:[1,0,0]
  v_fma_mix_f32 v29, v98, v37, v45 op_sel:[1,0,0] op_sel_hi:[1,0,0]
  s_waitcnt lgkmcnt(8)
  v_mfma_f32_32x32x16_bf16 a[16:31], a[148:151], v[88:91], a[16:31]
  ds_read_b64_tr_b16 a[128:129], v20 offset:16384
  ds_read_b64_tr_b16 a[130:131], v20 offset:17408
  buffer_load_dwordx4 v7, s[20:23], s50 offen lds
  v_fma_mix_f32 v30, v99, v38, v46 op_sel:[0,0,0] op_sel_hi:[1,0,0]
  v_fma_mix_f32 v31, v99, v39, v47 op_sel:[1,0,0] op_sel_hi:[1,0,0]
  v_mfma_f32_32x32x16_bf16 a[80:95], a[148:151], v[92:95], a[80:95]
  ds_read_b64_tr_b16 a[132:133], v21 offset:16384
  ds_read_b64_tr_b16 a[134:135], v21 offset:17408
  buffer_load_dwordx4 v[160:163], v3, s[24:27], s48 offen offset:0
  buffer_load_dwordx4 v[164:167], v3, s[24:27], s49 offen offset:0
  v_cvt_pk_bf16_f32 v96, v24, v25
  v_cvt_pk_bf16_f32 v97, v26, v27
  s_waitcnt lgkmcnt(10)
  v_mfma_f32_32x32x16_bf16 a[32:47], a[152:155], v[88:91], a[32:47]
  ds_read_b64_tr_b16 a[136:137], v22 offset:16384
  ds_read_b64_tr_b16 a[138:139], v22 offset:17408
  s_add_u32 m0, s51, 126976
  v_cvt_pk_bf16_f32 v98, v28, v29
  v_cvt_pk_bf16_f32 v99, v30, v31
  v_fma_mix_f32 v24, v100, v32, v40 op_sel:[0,0,0] op_sel_hi:[1,0,0]
  v_mfma_f32_32x32x16_bf16 a[96:111], a[152:155], v[92:95], a[96:111]
  ds_read_b64_tr_b16 a[140:141], v23 offset:16384
  ds_read_b64_tr_b16 a[142:143], v23 offset:17408
  s_add_u32 s50, s50, 131072
  buffer_load_dwordx4 v7, s[20:23], s50 offen lds
  v_fma_mix_f32 v25, v100, v33, v41 op_sel:[1,0,0] op_sel_hi:[1,0,0]
  v_fma_mix_f32 v26, v101, v34, v42 op_sel:[0,0,0] op_sel_hi:[1,0,0]
  s_waitcnt lgkmcnt(12)
  v_mfma_f32_32x32x16_bf16 a[48:63], a[156:159], v[88:91], a[48:63]
  buffer_load_dwordx4 v[168:171], v3, s[24:27], s48 offen offset:1024
  v_fma_mix_f32 v27, v101, v35, v43 op_sel:[1,0,0] op_sel_hi:[1,0,0]
  v_fma_mix_f32 v28, v102, v36, v44 op_sel:[0,0,0] op_sel_hi:[1,0,0]
  v_fma_mix_f32 v29, v102, v37, v45 op_sel:[1,0,0] op_sel_hi:[1,0,0]
  v_fma_mix_f32 v30, v103, v38, v46 op_sel:[0,0,0] op_sel_hi:[1,0,0]
  v_mfma_f32_32x32x16_bf16 a[112:127], a[156:159], v[92:95], a[112:127]
  buffer_load_dwordx4 v[172:175], v3, s[24:27], s49 offen offset:1024
  v_fma_mix_f32 v31, v103, v39, v47 op_sel:[1,0,0] op_sel_hi:[1,0,0]
  v_cvt_pk_bf16_f32 v100, v24, v25
  v_cvt_pk_bf16_f32 v101, v26, v27
  v_cvt_pk_bf16_f32 v102, v28, v29
  v_cvt_pk_bf16_f32 v103, v30, v31
  s_waitcnt lgkmcnt(6)
  v_mfma_f32_32x32x16_bf16 a[0:15], a[128:131], v[96:99], a[0:15]
  s_waitcnt vmcnt(18)
  s_barrier
  v_fma_mix_f32 v24, v104, v48, v56 op_sel:[0,0,0] op_sel_hi:[1,0,0]
  v_mfma_f32_32x32x16_bf16 a[64:79], a[128:131], v[100:103], a[64:79]
  ds_read_b128 v[32:35], v2 offset:384
  ds_read_b128 v[36:39], v2 offset:400
  s_add_u32 m0, s51, 131072
  s_add_u32 s50, s50, 131072
  v_fma_mix_f32 v25, v104, v49, v57 op_sel:[1,0,0] op_sel_hi:[1,0,0]
  v_fma_mix_f32 v26, v105, v50, v58 op_sel:[0,0,0] op_sel_hi:[1,0,0]
  v_fma_mix_f32 v27, v105, v51, v59 op_sel:[1,0,0] op_sel_hi:[1,0,0]
  s_waitcnt lgkmcnt(6)
  v_mfma_f32_32x32x16_bf16 a[16:31], a[132:135], v[96:99], a[16:31]
  ds_read_b128 v[40:43], v2 offset:2432
  ds_read_b128 v[44:47], v2 offset:2448
  buffer_load_dwordx4 v7, s[20:23], s50 offen lds
  buffer_load_dwordx4 v[176:179], v3, s[24:27], s48 offen offset:2048
  v_fma_mix_f32 v28, v106, v52, v60 op_sel:[0,0,0] op_sel_hi:[1,0,0]
  v_fma_mix_f32 v29, v106, v53, v61 op_sel:[1,0,0] op_sel_hi:[1,0,0]
  v_mfma_f32_32x32x16_bf16 a[80:95], a[132:135], v[100:103], a[80:95]
  ds_read_b64_tr_b16 a[144:145], v20 offset:20480
  ds_read_b64_tr_b16 a[146:147], v20 offset:21504
  buffer_load_dwordx4 v[180:183], v3, s[24:27], s49 offen offset:2048
  s_add_u32 m0, s51, 135168
  v_fma_mix_f32 v30, v107, v54, v62 op_sel:[0,0,0] op_sel_hi:[1,0,0]
  v_fma_mix_f32 v31, v107, v55, v63 op_sel:[1,0,0] op_sel_hi:[1,0,0]
  v_cvt_pk_bf16_f32 v104, v24, v25
  s_waitcnt lgkmcnt(8)
  v_mfma_f32_32x32x16_bf16 a[32:47], a[136:139], v[96:99], a[32:47]
  ds_read_b64_tr_b16 a[148:149], v21 offset:20480
  ds_read_b64_tr_b16 a[150:151], v21 offset:21504
  s_add_u32 s50, s50, 131072
  v_cvt_pk_bf16_f32 v105, v26, v27
  v_cvt_pk_bf16_f32 v106, v28, v29
  v_cvt_pk_bf16_f32 v107, v30, v31
  v_fma_mix_f32 v24, v108, v48, v56 op_sel:[0,0,0] op_sel_hi:[1,0,0]
  v_mfma_f32_32x32x16_bf16 a[96:111], a[136:139], v[100:103], a[96:111]
  ds_read_b64_tr_b16 a[152:153], v22 offset:20480
  ds_read_b64_tr_b16 a[154:155], v22 offset:21504
  buffer_load_dwordx4 v7, s[20:23], s50 offen lds
  buffer_load_dwordx4 v[184:187], v3, s[24:27], s48 offen offset:3072
  v_fma_mix_f32 v25, v108, v49, v57 op_sel:[1,0,0] op_sel_hi:[1,0,0]
  v_fma_mix_f32 v26, v109, v50, v58 op_sel:[0,0,0] op_sel_hi:[1,0,0]
  s_waitcnt lgkmcnt(10)
  v_mfma_f32_32x32x16_bf16 a[48:63], a[140:143], v[96:99], a[48:63]
  ds_read_b64_tr_b16 a[156:157], v23 offset:20480
  ds_read_b64_tr_b16 a[158:159], v23 offset:21504
  buffer_load_dwordx4 v[188:191], v3, s[24:27], s49 offen offset:3072
  s_add_u32 s48, s48, 4096
  v_fma_mix_f32 v27, v109, v51, v59 op_sel:[1,0,0] op_sel_hi:[1,0,0]
  v_fma_mix_f32 v28, v110, v52, v60 op_sel:[0,0,0] op_sel_hi:[1,0,0]
  v_fma_mix_f32 v29, v110, v53, v61 op_sel:[1,0,0] op_sel_hi:[1,0,0]
  v_mfma_f32_32x32x16_bf16 a[112:127], a[140:143], v[100:103], a[112:127]
  s_add_u32 s49, s49, 4096
  v_fma_mix_f32 v30, v111, v54, v62 op_sel:[0,0,0] op_sel_hi:[1,0,0]
  v_fma_mix_f32 v31, v111, v55, v63 op_sel:[1,0,0] op_sel_hi:[1,0,0]
  v_cvt_pk_bf16_f32 v108, v24, v25
  v_cvt_pk_bf16_f32 v109, v26, v27
  v_cvt_pk_bf16_f32 v110, v28, v29
  v_cvt_pk_bf16_f32 v111, v30, v31
  s_waitcnt lgkmcnt(6)
  v_mfma_f32_32x32x16_bf16 a[0:15], a[144:147], v[104:107], a[0:15]
  ds_read_b128 v[48:51], v2 offset:448
  ds_read_b128 v[52:55], v2 offset:464
  v_fma_mix_f32 v24, v112, v32, v40 op_sel:[0,0,0] op_sel_hi:[1,0,0]
  v_fma_mix_f32 v25, v112, v33, v41 op_sel:[1,0,0] op_sel_hi:[1,0,0]
  v_fma_mix_f32 v26, v113, v34, v42 op_sel:[0,0,0] op_sel_hi:[1,0,0]
  v_fma_mix_f32 v27, v113, v35, v43 op_sel:[1,0,0] op_sel_hi:[1,0,0]
  v_mfma_f32_32x32x16_bf16 a[64:79], a[144:147], v[108:111], a[64:79]
  ds_read_b128 v[56:59], v2 offset:2496
  ds_read_b128 v[60:63], v2 offset:2512
  s_add_u32 m0, s51, 139264
  s_add_u32 s50, s50, 131072
  v_fma_mix_f32 v28, v114, v36, v44 op_sel:[0,0,0] op_sel_hi:[1,0,0]
  v_fma_mix_f32 v29, v114, v37, v45 op_sel:[1,0,0] op_sel_hi:[1,0,0]
  s_waitcnt lgkmcnt(8)
  v_mfma_f32_32x32x16_bf16 a[16:31], a[148:151], v[104:107], a[16:31]
  ds_read_b64_tr_b16 a[128:129], v20 offset:24576
  ds_read_b64_tr_b16 a[130:131], v20 offset:25600
  buffer_load_dwordx4 v7, s[20:23], s50 offen lds
  v_fma_mix_f32 v30, v115, v38, v46 op_sel:[0,0,0] op_sel_hi:[1,0,0]
  v_fma_mix_f32 v31, v115, v39, v47 op_sel:[1,0,0] op_sel_hi:[1,0,0]
  v_mfma_f32_32x32x16_bf16 a[80:95], a[148:151], v[108:111], a[80:95]
  ds_read_b64_tr_b16 a[132:133], v21 offset:24576
  ds_read_b64_tr_b16 a[134:135], v21 offset:25600
  buffer_load_dwordx4 v[192:195], v3, s[24:27], s48 offen offset:0
  buffer_load_dwordx4 v[196:199], v3, s[24:27], s49 offen offset:0
  v_cvt_pk_bf16_f32 v112, v24, v25
  v_cvt_pk_bf16_f32 v113, v26, v27
  s_waitcnt lgkmcnt(10)
  v_mfma_f32_32x32x16_bf16 a[32:47], a[152:155], v[104:107], a[32:47]
  ds_read_b64_tr_b16 a[136:137], v22 offset:24576
  ds_read_b64_tr_b16 a[138:139], v22 offset:25600
  s_add_u32 m0, s51, 143360
  v_cvt_pk_bf16_f32 v114, v28, v29
  v_cvt_pk_bf16_f32 v115, v30, v31
  v_fma_mix_f32 v24, v116, v32, v40 op_sel:[0,0,0] op_sel_hi:[1,0,0]
  v_mfma_f32_32x32x16_bf16 a[96:111], a[152:155], v[108:111], a[96:111]
  ds_read_b64_tr_b16 a[140:141], v23 offset:24576
  ds_read_b64_tr_b16 a[142:143], v23 offset:25600
  s_add_u32 s50, s50, 131072
  buffer_load_dwordx4 v7, s[20:23], s50 offen lds
  v_fma_mix_f32 v25, v116, v33, v41 op_sel:[1,0,0] op_sel_hi:[1,0,0]
  v_fma_mix_f32 v26, v117, v34, v42 op_sel:[0,0,0] op_sel_hi:[1,0,0]
  s_waitcnt lgkmcnt(12)
  v_mfma_f32_32x32x16_bf16 a[48:63], a[156:159], v[104:107], a[48:63]
  buffer_load_dwordx4 v[200:203], v3, s[24:27], s48 offen offset:1024
  v_fma_mix_f32 v27, v117, v35, v43 op_sel:[1,0,0] op_sel_hi:[1,0,0]
  v_fma_mix_f32 v28, v118, v36, v44 op_sel:[0,0,0] op_sel_hi:[1,0,0]
  v_fma_mix_f32 v29, v118, v37, v45 op_sel:[1,0,0] op_sel_hi:[1,0,0]
  v_fma_mix_f32 v30, v119, v38, v46 op_sel:[0,0,0] op_sel_hi:[1,0,0]
  v_mfma_f32_32x32x16_bf16 a[112:127], a[156:159], v[108:111], a[112:127]
  buffer_load_dwordx4 v[204:207], v3, s[24:27], s49 offen offset:1024
  v_fma_mix_f32 v31, v119, v39, v47 op_sel:[1,0,0] op_sel_hi:[1,0,0]
  v_cvt_pk_bf16_f32 v116, v24, v25
  v_cvt_pk_bf16_f32 v117, v26, v27
  v_cvt_pk_bf16_f32 v118, v28, v29
  v_cvt_pk_bf16_f32 v119, v30, v31
  s_waitcnt lgkmcnt(6)
  v_mfma_f32_32x32x16_bf16 a[0:15], a[128:131], v[112:115], a[0:15]
  s_waitcnt vmcnt(24)
  s_barrier
  v_fma_mix_f32 v24, v120, v48, v56 op_sel:[0,0,0] op_sel_hi:[1,0,0]
  v_mfma_f32_32x32x16_bf16 a[64:79], a[128:131], v[116:119], a[64:79]
  ds_read_b128 v[32:35], v2 offset:512
  ds_read_b128 v[36:39], v2 offset:528
  s_add_u32 m0, s51, 147456
  s_add_u32 s50, s50, 131072
  v_fma_mix_f32 v25, v120, v49, v57 op_sel:[1,0,0] op_sel_hi:[1,0,0]
  v_fma_mix_f32 v26, v121, v50, v58 op_sel:[0,0,0] op_sel_hi:[1,0,0]
  v_fma_mix_f32 v27, v121, v51, v59 op_sel:[1,0,0] op_sel_hi:[1,0,0]
  s_waitcnt lgkmcnt(6)
  v_mfma_f32_32x32x16_bf16 a[16:31], a[132:135], v[112:115], a[16:31]
  ds_read_b128 v[40:43], v2 offset:2560
  ds_read_b128 v[44:47], v2 offset:2576
  buffer_load_dwordx4 v7, s[20:23], s50 offen lds
  buffer_load_dwordx4 v[208:211], v3, s[24:27], s48 offen offset:2048
  v_fma_mix_f32 v28, v122, v52, v60 op_sel:[0,0,0] op_sel_hi:[1,0,0]
  v_fma_mix_f32 v29, v122, v53, v61 op_sel:[1,0,0] op_sel_hi:[1,0,0]
  v_mfma_f32_32x32x16_bf16 a[80:95], a[132:135], v[116:119], a[80:95]
  ds_read_b64_tr_b16 a[144:145], v20 offset:28672
  ds_read_b64_tr_b16 a[146:147], v20 offset:29696
  buffer_load_dwordx4 v[212:215], v3, s[24:27], s49 offen offset:2048
  s_add_u32 m0, s51, 151552
  v_fma_mix_f32 v30, v123, v54, v62 op_sel:[0,0,0] op_sel_hi:[1,0,0]
  v_fma_mix_f32 v31, v123, v55, v63 op_sel:[1,0,0] op_sel_hi:[1,0,0]
  v_cvt_pk_bf16_f32 v120, v24, v25
  s_waitcnt lgkmcnt(8)
  v_mfma_f32_32x32x16_bf16 a[32:47], a[136:139], v[112:115], a[32:47]
  ds_read_b64_tr_b16 a[148:149], v21 offset:28672
  ds_read_b64_tr_b16 a[150:151], v21 offset:29696
  s_add_u32 s50, s50, 131072
  v_cvt_pk_bf16_f32 v121, v26, v27
  v_cvt_pk_bf16_f32 v122, v28, v29
  v_cvt_pk_bf16_f32 v123, v30, v31
  v_fma_mix_f32 v24, v124, v48, v56 op_sel:[0,0,0] op_sel_hi:[1,0,0]
  v_mfma_f32_32x32x16_bf16 a[96:111], a[136:139], v[116:119], a[96:111]
  ds_read_b64_tr_b16 a[152:153], v22 offset:28672
  ds_read_b64_tr_b16 a[154:155], v22 offset:29696
  buffer_load_dwordx4 v7, s[20:23], s50 offen lds
  buffer_load_dwordx4 v[216:219], v3, s[24:27], s48 offen offset:3072
  v_fma_mix_f32 v25, v124, v49, v57 op_sel:[1,0,0] op_sel_hi:[1,0,0]
  v_fma_mix_f32 v26, v125, v50, v58 op_sel:[0,0,0] op_sel_hi:[1,0,0]
  s_waitcnt lgkmcnt(10)
  v_mfma_f32_32x32x16_bf16 a[48:63], a[140:143], v[112:115], a[48:63]
  ds_read_b64_tr_b16 a[156:157], v23 offset:28672
  ds_read_b64_tr_b16 a[158:159], v23 offset:29696
  buffer_load_dwordx4 v[220:223], v3, s[24:27], s49 offen offset:3072
  s_add_u32 s48, s48, 4096
  v_fma_mix_f32 v27, v125, v51, v59 op_sel:[1,0,0] op_sel_hi:[1,0,0]
  v_fma_mix_f32 v28, v126, v52, v60 op_sel:[0,0,0] op_sel_hi:[1,0,0]
  v_fma_mix_f32 v29, v126, v53, v61 op_sel:[1,0,0] op_sel_hi:[1,0,0]
  v_mfma_f32_32x32x16_bf16 a[112:127], a[140:143], v[116:119], a[112:127]
  s_add_u32 s49, s49, 4096
  v_fma_mix_f32 v30, v127, v54, v62 op_sel:[0,0,0] op_sel_hi:[1,0,0]
  v_fma_mix_f32 v31, v127, v55, v63 op_sel:[1,0,0] op_sel_hi:[1,0,0]
  v_cvt_pk_bf16_f32 v124, v24, v25
  v_cvt_pk_bf16_f32 v125, v26, v27
  v_cvt_pk_bf16_f32 v126, v28, v29
  v_cvt_pk_bf16_f32 v127, v30, v31
  s_waitcnt lgkmcnt(6)
  v_mfma_f32_32x32x16_bf16 a[0:15], a[144:147], v[120:123], a[0:15]
  ds_read_b128 v[48:51], v2 offset:576
  ds_read_b128 v[52:55], v2 offset:592
  v_fma_mix_f32 v24, v128, v32, v40 op_sel:[0,0,0] op_sel_hi:[1,0,0]
  v_fma_mix_f32 v25, v128, v33, v41 op_sel:[1,0,0] op_sel_hi:[1,0,0]
  v_fma_mix_f32 v26, v129, v34, v42 op_sel:[0,0,0] op_sel_hi:[1,0,0]
  v_fma_mix_f32 v27, v129, v35, v43 op_sel:[1,0,0] op_sel_hi:[1,0,0]
  v_mfma_f32_32x32x16_bf16 a[64:79], a[144:147], v[124:127], a[64:79]
  ds_read_b128 v[56:59], v2 offset:2624
  ds_read_b128 v[60:63], v2 offset:2640
  s_add_u32 m0, s51, 155648
  s_add_u32 s50, s50, 131072
  v_fma_mix_f32 v28, v130, v36, v44 op_sel:[0,0,0] op_sel_hi:[1,0,0]
  v_fma_mix_f32 v29, v130, v37, v45 op_sel:[1,0,0] op_sel_hi:[1,0,0]
  s_waitcnt lgkmcnt(8)
  v_mfma_f32_32x32x16_bf16 a[16:31], a[148:151], v[120:123], a[16:31]
  ds_read_b64_tr_b16 a[128:129], v20 offset:49152
  ds_read_b64_tr_b16 a[130:131], v20 offset:50176
  buffer_load_dwordx4 v7, s[20:23], s50 offen lds
  v_fma_mix_f32 v30, v131, v38, v46 op_sel:[0,0,0] op_sel_hi:[1,0,0]
  v_fma_mix_f32 v31, v131, v39, v47 op_sel:[1,0,0] op_sel_hi:[1,0,0]
  v_mfma_f32_32x32x16_bf16 a[80:95], a[148:151], v[124:127], a[80:95]
  ds_read_b64_tr_b16 a[132:133], v21 offset:49152
  ds_read_b64_tr_b16 a[134:135], v21 offset:50176
  buffer_load_dwordx4 v[224:227], v3, s[24:27], s48 offen offset:0
  buffer_load_dwordx4 v[228:231], v3, s[24:27], s49 offen offset:0
  v_cvt_pk_bf16_f32 v128, v24, v25
  v_cvt_pk_bf16_f32 v129, v26, v27
  s_waitcnt lgkmcnt(10)
  v_mfma_f32_32x32x16_bf16 a[32:47], a[152:155], v[120:123], a[32:47]
  ds_read_b64_tr_b16 a[136:137], v22 offset:49152
  ds_read_b64_tr_b16 a[138:139], v22 offset:50176
  s_add_u32 m0, s51, 32768
  v_cvt_pk_bf16_f32 v130, v28, v29
  v_cvt_pk_bf16_f32 v131, v30, v31
  v_fma_mix_f32 v24, v132, v32, v40 op_sel:[0,0,0] op_sel_hi:[1,0,0]
  v_mfma_f32_32x32x16_bf16 a[96:111], a[152:155], v[124:127], a[96:111]
  ds_read_b64_tr_b16 a[140:141], v23 offset:49152
  ds_read_b64_tr_b16 a[142:143], v23 offset:50176
  s_add_u32 s50, s50, 131072
  buffer_load_dwordx4 v7, s[20:23], s50 offen lds
  v_fma_mix_f32 v25, v132, v33, v41 op_sel:[1,0,0] op_sel_hi:[1,0,0]
  v_fma_mix_f32 v26, v133, v34, v42 op_sel:[0,0,0] op_sel_hi:[1,0,0]
  s_waitcnt lgkmcnt(12)
  v_mfma_f32_32x32x16_bf16 a[48:63], a[156:159], v[120:123], a[48:63]
  buffer_load_dwordx4 v[232:235], v3, s[24:27], s48 offen offset:1024
  v_fma_mix_f32 v27, v133, v35, v43 op_sel:[1,0,0] op_sel_hi:[1,0,0]
  v_fma_mix_f32 v28, v134, v36, v44 op_sel:[0,0,0] op_sel_hi:[1,0,0]
  v_fma_mix_f32 v29, v134, v37, v45 op_sel:[1,0,0] op_sel_hi:[1,0,0]
  v_fma_mix_f32 v30, v135, v38, v46 op_sel:[0,0,0] op_sel_hi:[1,0,0]
  v_mfma_f32_32x32x16_bf16 a[112:127], a[156:159], v[124:127], a[112:127]
  buffer_load_dwordx4 v[236:239], v3, s[24:27], s49 offen offset:1024
  v_fma_mix_f32 v31, v135, v39, v47 op_sel:[1,0,0] op_sel_hi:[1,0,0]
  v_cvt_pk_bf16_f32 v132, v24, v25
  v_cvt_pk_bf16_f32 v133, v26, v27
  v_cvt_pk_bf16_f32 v134, v28, v29
  v_cvt_pk_bf16_f32 v135, v30, v31
  s_waitcnt lgkmcnt(6)
  v_mfma_f32_32x32x16_bf16 a[0:15], a[128:131], v[128:131], a[0:15]
  s_waitcnt vmcnt(30)
  s_barrier
  v_fma_mix_f32 v24, v136, v48, v56 op_sel:[0,0,0] op_sel_hi:[1,0,0]
  v_mfma_f32_32x32x16_bf16 a[64:79], a[128:131], v[132:135], a[64:79]
  ds_read_b128 v[32:35], v2 offset:640
  ds_read_b128 v[36:39], v2 offset:656
  s_add_u32 m0, s51, 36864
  s_add_u32 s50, s50, 131072
  v_fma_mix_f32 v25, v136, v49, v57 op_sel:[1,0,0] op_sel_hi:[1,0,0]
  v_fma_mix_f32 v26, v137, v50, v58 op_sel:[0,0,0] op_sel_hi:[1,0,0]
  v_fma_mix_f32 v27, v137, v51, v59 op_sel:[1,0,0] op_sel_hi:[1,0,0]
  s_waitcnt lgkmcnt(6)
  v_mfma_f32_32x32x16_bf16 a[16:31], a[132:135], v[128:131], a[16:31]
  ds_read_b128 v[40:43], v2 offset:2688
  ds_read_b128 v[44:47], v2 offset:2704
  buffer_load_dwordx4 v7, s[20:23], s50 offen lds
  buffer_load_dwordx4 v[240:243], v3, s[24:27], s48 offen offset:2048
  v_fma_mix_f32 v28, v138, v52, v60 op_sel:[0,0,0] op_sel_hi:[1,0,0]
  v_fma_mix_f32 v29, v138, v53, v61 op_sel:[1,0,0] op_sel_hi:[1,0,0]
  v_mfma_f32_32x32x16_bf16 a[80:95], a[132:135], v[132:135], a[80:95]
  ds_read_b64_tr_b16 a[144:145], v20 offset:53248
  ds_read_b64_tr_b16 a[146:147], v20 offset:54272
  buffer_load_dwordx4 v[244:247], v3, s[24:27], s49 offen offset:2048
  s_add_u32 m0, s51, 40960
  v_fma_mix_f32 v30, v139, v54, v62 op_sel:[0,0,0] op_sel_hi:[1,0,0]
  v_fma_mix_f32 v31, v139, v55, v63 op_sel:[1,0,0] op_sel_hi:[1,0,0]
  v_cvt_pk_bf16_f32 v136, v24, v25
  s_waitcnt lgkmcnt(8)
  v_mfma_f32_32x32x16_bf16 a[32:47], a[136:139], v[128:131], a[32:47]
  ds_read_b64_tr_b16 a[148:149], v21 offset:53248
  ds_read_b64_tr_b16 a[150:151], v21 offset:54272
  s_add_u32 s50, s50, 131072
  v_cvt_pk_bf16_f32 v137, v26, v27
  v_cvt_pk_bf16_f32 v138, v28, v29
  v_cvt_pk_bf16_f32 v139, v30, v31
  v_fma_mix_f32 v24, v140, v48, v56 op_sel:[0,0,0] op_sel_hi:[1,0,0]
  v_mfma_f32_32x32x16_bf16 a[96:111], a[136:139], v[132:135], a[96:111]
  ds_read_b64_tr_b16 a[152:153], v22 offset:53248
  ds_read_b64_tr_b16 a[154:155], v22 offset:54272
  buffer_load_dwordx4 v7, s[20:23], s50 offen lds
  buffer_load_dwordx4 v[248:251], v3, s[24:27], s48 offen offset:3072
  v_fma_mix_f32 v25, v140, v49, v57 op_sel:[1,0,0] op_sel_hi:[1,0,0]
  v_fma_mix_f32 v26, v141, v50, v58 op_sel:[0,0,0] op_sel_hi:[1,0,0]
  s_waitcnt lgkmcnt(10)
  v_mfma_f32_32x32x16_bf16 a[48:63], a[140:143], v[128:131], a[48:63]
  ds_read_b64_tr_b16 a[156:157], v23 offset:53248
  ds_read_b64_tr_b16 a[158:159], v23 offset:54272
  buffer_load_dwordx4 v[252:255], v3, s[24:27], s49 offen offset:3072
  s_add_u32 s48, s48, 4096
  v_fma_mix_f32 v27, v141, v51, v59 op_sel:[1,0,0] op_sel_hi:[1,0,0]
  v_fma_mix_f32 v28, v142, v52, v60 op_sel:[0,0,0] op_sel_hi:[1,0,0]
  v_fma_mix_f32 v29, v142, v53, v61 op_sel:[1,0,0] op_sel_hi:[1,0,0]
  v_mfma_f32_32x32x16_bf16 a[112:127], a[140:143], v[132:135], a[112:127]
  s_add_u32 s49, s49, 4096
  v_fma_mix_f32 v30, v143, v54, v62 op_sel:[0,0,0] op_sel_hi:[1,0,0]
  v_fma_mix_f32 v31, v143, v55, v63 op_sel:[1,0,0] op_sel_hi:[1,0,0]
  v_cvt_pk_bf16_f32 v140, v24, v25
  v_cvt_pk_bf16_f32 v141, v26, v27
  v_cvt_pk_bf16_f32 v142, v28, v29
  v_cvt_pk_bf16_f32 v143, v30, v31
  s_waitcnt lgkmcnt(6)
  v_mfma_f32_32x32x16_bf16 a[0:15], a[144:147], v[136:139], a[0:15]
  ds_read_b128 v[48:51], v2 offset:704
  ds_read_b128 v[52:55], v2 offset:720
  v_fma_mix_f32 v24, v144, v32, v40 op_sel:[0,0,0] op_sel_hi:[1,0,0]
  v_fma_mix_f32 v25, v144, v33, v41 op_sel:[1,0,0] op_sel_hi:[1,0,0]
  v_fma_mix_f32 v26, v145, v34, v42 op_sel:[0,0,0] op_sel_hi:[1,0,0]
  v_fma_mix_f32 v27, v145, v35, v43 op_sel:[1,0,0] op_sel_hi:[1,0,0]
  v_mfma_f32_32x32x16_bf16 a[64:79], a[144:147], v[140:143], a[64:79]
  ds_read_b128 v[56:59], v2 offset:2752
  ds_read_b128 v[60:63], v2 offset:2768
  s_add_u32 m0, s51, 45056
  s_add_u32 s50, s50, 131072
  v_fma_mix_f32 v28, v146, v36, v44 op_sel:[0,0,0] op_sel_hi:[1,0,0]
  v_fma_mix_f32 v29, v146, v37, v45 op_sel:[1,0,0] op_sel_hi:[1,0,0]
  s_waitcnt lgkmcnt(8)
  v_mfma_f32_32x32x16_bf16 a[16:31], a[148:151], v[136:139], a[16:31]
  ds_read_b64_tr_b16 a[128:129], v20 offset:57344
  ds_read_b64_tr_b16 a[130:131], v20 offset:58368
  buffer_load_dwordx4 v7, s[20:23], s50 offen lds
  v_fma_mix_f32 v30, v147, v38, v46 op_sel:[0,0,0] op_sel_hi:[1,0,0]
  v_fma_mix_f32 v31, v147, v39, v47 op_sel:[1,0,0] op_sel_hi:[1,0,0]
  v_mfma_f32_32x32x16_bf16 a[80:95], a[148:151], v[140:143], a[80:95]
  ds_read_b64_tr_b16 a[132:133], v21 offset:57344
  ds_read_b64_tr_b16 a[134:135], v21 offset:58368
  buffer_load_dwordx4 v[64:67], v3, s[24:27], s48 offen offset:0
  buffer_load_dwordx4 v[68:71], v3, s[24:27], s49 offen offset:0
  v_cvt_pk_bf16_f32 v144, v24, v25
  v_cvt_pk_bf16_f32 v145, v26, v27
  s_waitcnt lgkmcnt(10)
  v_mfma_f32_32x32x16_bf16 a[32:47], a[152:155], v[136:139], a[32:47]
  ds_read_b64_tr_b16 a[136:137], v22 offset:57344
  ds_read_b64_tr_b16 a[138:139], v22 offset:58368
  s_add_u32 m0, s51, 49152
  v_cvt_pk_bf16_f32 v146, v28, v29
  v_cvt_pk_bf16_f32 v147, v30, v31
  v_fma_mix_f32 v24, v148, v32, v40 op_sel:[0,0,0] op_sel_hi:[1,0,0]
  v_mfma_f32_32x32x16_bf16 a[96:111], a[152:155], v[140:143], a[96:111]
  ds_read_b64_tr_b16 a[140:141], v23 offset:57344
  ds_read_b64_tr_b16 a[142:143], v23 offset:58368
  s_add_u32 s50, s50, 131072
  buffer_load_dwordx4 v7, s[20:23], s50 offen lds
  v_fma_mix_f32 v25, v148, v33, v41 op_sel:[1,0,0] op_sel_hi:[1,0,0]
  v_fma_mix_f32 v26, v149, v34, v42 op_sel:[0,0,0] op_sel_hi:[1,0,0]
  s_waitcnt lgkmcnt(12)
  v_mfma_f32_32x32x16_bf16 a[48:63], a[156:159], v[136:139], a[48:63]
  buffer_load_dwordx4 v[72:75], v3, s[24:27], s48 offen offset:1024
  v_fma_mix_f32 v27, v149, v35, v43 op_sel:[1,0,0] op_sel_hi:[1,0,0]
  v_fma_mix_f32 v28, v150, v36, v44 op_sel:[0,0,0] op_sel_hi:[1,0,0]
  v_fma_mix_f32 v29, v150, v37, v45 op_sel:[1,0,0] op_sel_hi:[1,0,0]
  v_fma_mix_f32 v30, v151, v38, v46 op_sel:[0,0,0] op_sel_hi:[1,0,0]
  v_mfma_f32_32x32x16_bf16 a[112:127], a[156:159], v[140:143], a[112:127]
  buffer_load_dwordx4 v[76:79], v3, s[24:27], s49 offen offset:1024
  v_fma_mix_f32 v31, v151, v39, v47 op_sel:[1,0,0] op_sel_hi:[1,0,0]
  v_cvt_pk_bf16_f32 v148, v24, v25
  v_cvt_pk_bf16_f32 v149, v26, v27
  v_cvt_pk_bf16_f32 v150, v28, v29
  v_cvt_pk_bf16_f32 v151, v30, v31
  s_waitcnt lgkmcnt(6)
  v_mfma_f32_32x32x16_bf16 a[0:15], a[128:131], v[144:147], a[0:15]
  s_waitcnt vmcnt(36)
  s_barrier
  v_fma_mix_f32 v24, v152, v48, v56 op_sel:[0,0,0] op_sel_hi:[1,0,0]
  v_mfma_f32_32x32x16_bf16 a[64:79], a[128:131], v[148:151], a[64:79]
  ds_read_b128 v[32:35], v2 offset:768
  ds_read_b128 v[36:39], v2 offset:784
  buffer_load_dwordx4 v[80:83], v3, s[24:27], s48 offen offset:2048
  v_fma_mix_f32 v25, v152, v49, v57 op_sel:[1,0,0] op_sel_hi:[1,0,0]
  v_fma_mix_f32 v26, v153, v50, v58 op_sel:[0,0,0] op_sel_hi:[1,0,0]
  v_fma_mix_f32 v27, v153, v51, v59 op_sel:[1,0,0] op_sel_hi:[1,0,0]
  s_waitcnt lgkmcnt(6)
  v_mfma_f32_32x32x16_bf16 a[16:31], a[132:135], v[144:147], a[16:31]
  ds_read_b128 v[40:43], v2 offset:2816
  ds_read_b128 v[44:47], v2 offset:2832
  buffer_load_dwordx4 v[84:87], v3, s[24:27], s49 offen offset:2048
  v_fma_mix_f32 v28, v154, v52, v60 op_sel:[0,0,0] op_sel_hi:[1,0,0]
  v_fma_mix_f32 v29, v154, v53, v61 op_sel:[1,0,0] op_sel_hi:[1,0,0]
  v_fma_mix_f32 v30, v155, v54, v62 op_sel:[0,0,0] op_sel_hi:[1,0,0]
  v_mfma_f32_32x32x16_bf16 a[80:95], a[132:135], v[148:151], a[80:95]
  ds_read_b64_tr_b16 a[144:145], v20 offset:61440
  ds_read_b64_tr_b16 a[146:147], v20 offset:62464
  buffer_load_dwordx4 v[88:91], v3, s[24:27], s48 offen offset:3072
  v_fma_mix_f32 v31, v155, v55, v63 op_sel:[1,0,0] op_sel_hi:[1,0,0]
  v_cvt_pk_bf16_f32 v152, v24, v25
  v_cvt_pk_bf16_f32 v153, v26, v27
  s_waitcnt lgkmcnt(8)
  v_mfma_f32_32x32x16_bf16 a[32:47], a[136:139], v[144:147], a[32:47]
  ds_read_b64_tr_b16 a[148:149], v21 offset:61440
  ds_read_b64_tr_b16 a[150:151], v21 offset:62464
  buffer_load_dwordx4 v[92:95], v3, s[24:27], s49 offen offset:3072
  v_cvt_pk_bf16_f32 v154, v28, v29
  v_cvt_pk_bf16_f32 v155, v30, v31
  v_mfma_f32_32x32x16_bf16 a[96:111], a[136:139], v[148:151], a[96:111]
  ds_read_b64_tr_b16 a[152:153], v22 offset:61440
  ds_read_b64_tr_b16 a[154:155], v22 offset:62464
  s_add_u32 s48, s48, 4096
  v_fma_mix_f32 v24, v156, v48, v56 op_sel:[0,0,0] op_sel_hi:[1,0,0]
  v_fma_mix_f32 v25, v156, v49, v57 op_sel:[1,0,0] op_sel_hi:[1,0,0]
  v_fma_mix_f32 v26, v157, v50, v58 op_sel:[0,0,0] op_sel_hi:[1,0,0]
  s_waitcnt lgkmcnt(10)
  v_mfma_f32_32x32x16_bf16 a[48:63], a[140:143], v[144:147], a[48:63]
  ds_read_b64_tr_b16 a[156:157], v23 offset:61440
  ds_read_b64_tr_b16 a[158:159], v23 offset:62464
  s_add_u32 s49, s49, 4096
  v_fma_mix_f32 v27, v157, v51, v59 op_sel:[1,0,0] op_sel_hi:[1,0,0]
  v_fma_mix_f32 v28, v158, v52, v60 op_sel:[0,0,0] op_sel_hi:[1,0,0]
  v_fma_mix_f32 v29, v158, v53, v61 op_sel:[1,0,0] op_sel_hi:[1,0,0]
  v_mfma_f32_32x32x16_bf16 a[112:127], a[140:143], v[148:151], a[112:127]
  v_fma_mix_f32 v30, v159, v54, v62 op_sel:[0,0,0] op_sel_hi:[1,0,0]
  v_fma_mix_f32 v31, v159, v55, v63 op_sel:[1,0,0] op_sel_hi:[1,0,0]
  v_cvt_pk_bf16_f32 v156, v24, v25
  v_cvt_pk_bf16_f32 v157, v26, v27
  v_cvt_pk_bf16_f32 v158, v28, v29
  v_cvt_pk_bf16_f32 v159, v30, v31
  s_waitcnt lgkmcnt(6)
  v_mfma_f32_32x32x16_bf16 a[0:15], a[144:147], v[152:155], a[0:15]
  v_add_u32 v20, 0x8000, v16
  v_add_u32 v21, 0x8000, v17
  v_add_u32 v22, 0x8000, v18
  v_add_u32 v23, 0x8000, v19
  ds_read_b128 v[48:51], v2 offset:832
  ds_read_b128 v[52:55], v2 offset:848
  v_fma_mix_f32 v24, v160, v32, v40 op_sel:[0,0,0] op_sel_hi:[1,0,0]
  v_mfma_f32_32x32x16_bf16 a[64:79], a[144:147], v[156:159], a[64:79]
  ds_read_b128 v[56:59], v2 offset:2880
  ds_read_b128 v[60:63], v2 offset:2896
  buffer_load_dwordx4 v[96:99], v3, s[24:27], s48 offen offset:0
  v_fma_mix_f32 v25, v160, v33, v41 op_sel:[1,0,0] op_sel_hi:[1,0,0]
  v_fma_mix_f32 v26, v161, v34, v42 op_sel:[0,0,0] op_sel_hi:[1,0,0]
  s_waitcnt lgkmcnt(8)
  v_mfma_f32_32x32x16_bf16 a[16:31], a[148:151], v[152:155], a[16:31]
  ds_read_b64_tr_b16 a[128:129], v20 offset:0
  ds_read_b64_tr_b16 a[130:131], v20 offset:1024
  buffer_load_dwordx4 v[100:103], v3, s[24:27], s49 offen offset:0
  v_fma_mix_f32 v27, v161, v35, v43 op_sel:[1,0,0] op_sel_hi:[1,0,0]
  v_fma_mix_f32 v28, v162, v36, v44 op_sel:[0,0,0] op_sel_hi:[1,0,0]
  v_fma_mix_f32 v29, v162, v37, v45 op_sel:[1,0,0] op_sel_hi:[1,0,0]
  v_mfma_f32_32x32x16_bf16 a[80:95], a[148:151], v[156:159], a[80:95]
  ds_read_b64_tr_b16 a[132:133], v21 offset:0
  ds_read_b64_tr_b16 a[134:135], v21 offset:1024
  v_fma_mix_f32 v30, v163, v38, v46 op_sel:[0,0,0] op_sel_hi:[1,0,0]
  v_fma_mix_f32 v31, v163, v39, v47 op_sel:[1,0,0] op_sel_hi:[1,0,0]
  v_cvt_pk_bf16_f32 v160, v24, v25
  s_waitcnt lgkmcnt(10)
  v_mfma_f32_32x32x16_bf16 a[32:47], a[152:155], v[152:155], a[32:47]
  ds_read_b64_tr_b16 a[136:137], v22 offset:0
  ds_read_b64_tr_b16 a[138:139], v22 offset:1024
  buffer_load_dwordx4 v[104:107], v3, s[24:27], s48 offen offset:1024
  v_cvt_pk_bf16_f32 v161, v26, v27
  v_cvt_pk_bf16_f32 v162, v28, v29
  v_cvt_pk_bf16_f32 v163, v30, v31
  v_mfma_f32_32x32x16_bf16 a[96:111], a[152:155], v[156:159], a[96:111]
  ds_read_b64_tr_b16 a[140:141], v23 offset:0
  ds_read_b64_tr_b16 a[142:143], v23 offset:1024
  v_fma_mix_f32 v24, v164, v32, v40 op_sel:[0,0,0] op_sel_hi:[1,0,0]
  v_fma_mix_f32 v25, v164, v33, v41 op_sel:[1,0,0] op_sel_hi:[1,0,0]
  v_fma_mix_f32 v26, v165, v34, v42 op_sel:[0,0,0] op_sel_hi:[1,0,0]
  s_waitcnt lgkmcnt(12)
  v_mfma_f32_32x32x16_bf16 a[48:63], a[156:159], v[152:155], a[48:63]
  buffer_load_dwordx4 v[108:111], v3, s[24:27], s49 offen offset:1024
  v_fma_mix_f32 v27, v165, v35, v43 op_sel:[1,0,0] op_sel_hi:[1,0,0]
  v_fma_mix_f32 v28, v166, v36, v44 op_sel:[0,0,0] op_sel_hi:[1,0,0]
  v_fma_mix_f32 v29, v166, v37, v45 op_sel:[1,0,0] op_sel_hi:[1,0,0]
  v_fma_mix_f32 v30, v167, v38, v46 op_sel:[0,0,0] op_sel_hi:[1,0,0]
  v_mfma_f32_32x32x16_bf16 a[112:127], a[156:159], v[156:159], a[112:127]
  v_fma_mix_f32 v31, v167, v39, v47 op_sel:[1,0,0] op_sel_hi:[1,0,0]
  v_cvt_pk_bf16_f32 v164, v24, v25
  v_cvt_pk_bf16_f32 v165, v26, v27
  v_cvt_pk_bf16_f32 v166, v28, v29
  v_cvt_pk_bf16_f32 v167, v30, v31
  s_waitcnt lgkmcnt(6)
  v_mfma_f32_32x32x16_bf16 a[0:15], a[128:131], v[160:163], a[0:15]
  s_waitcnt vmcnt(38)
  s_barrier
  v_fma_mix_f32 v24, v168, v48, v56 op_sel:[0,0,0] op_sel_hi:[1,0,0]
  v_mfma_f32_32x32x16_bf16 a[64:79], a[128:131], v[164:167], a[64:79]
  ds_read_b128 v[32:35], v2 offset:896
  ds_read_b128 v[36:39], v2 offset:912
  buffer_load_dwordx4 v[112:115], v3, s[24:27], s48 offen offset:2048
  v_fma_mix_f32 v25, v168, v49, v57 op_sel:[1,0,0] op_sel_hi:[1,0,0]
  v_fma_mix_f32 v26, v169, v50, v58 op_sel:[0,0,0] op_sel_hi:[1,0,0]
  s_waitcnt lgkmcnt(6)
  v_mfma_f32_32x32x16_bf16 a[16:31], a[132:135], v[160:163], a[16:31]
  ds_read_b128 v[40:43], v2 offset:2944
  ds_read_b128 v[44:47], v2 offset:2960
  v_fma_mix_f32 v27, v169, v51, v59 op_sel:[1,0,0] op_sel_hi:[1,0,0]
  v_fma_mix_f32 v28, v170, v52, v60 op_sel:[0,0,0] op_sel_hi:[1,0,0]
  v_fma_mix_f32 v29, v170, v53, v61 op_sel:[1,0,0] op_sel_hi:[1,0,0]
  v_fma_mix_f32 v30, v171, v54, v62 op_sel:[0,0,0] op_sel_hi:[1,0,0]
  v_mfma_f32_32x32x16_bf16 a[80:95], a[132:135], v[164:167], a[80:95]
  ds_read_b64_tr_b16 a[144:145], v20 offset:4096
  ds_read_b64_tr_b16 a[146:147], v20 offset:5120
  v_fma_mix_f32 v31, v171, v55, v63 op_sel:[1,0,0] op_sel_hi:[1,0,0]
  v_cvt_pk_bf16_f32 v168, v24, v25
  v_cvt_pk_bf16_f32 v169, v26, v27
  s_waitcnt lgkmcnt(8)
  v_mfma_f32_32x32x16_bf16 a[32:47], a[136:139], v[160:163], a[32:47]
  ds_read_b64_tr_b16 a[148:149], v21 offset:4096
  ds_read_b64_tr_b16 a[150:151], v21 offset:5120
  buffer_load_dwordx4 v[116:119], v3, s[24:27], s49 offen offset:2048
  v_cvt_pk_bf16_f32 v170, v28, v29
  v_cvt_pk_bf16_f32 v171, v30, v31
  v_mfma_f32_32x32x16_bf16 a[96:111], a[136:139], v[164:167], a[96:111]
  ds_read_b64_tr_b16 a[152:153], v22 offset:4096
  ds_read_b64_tr_b16 a[154:155], v22 offset:5120
  v_fma_mix_f32 v24, v172, v48, v56 op_sel:[0,0,0] op_sel_hi:[1,0,0]
  v_fma_mix_f32 v25, v172, v49, v57 op_sel:[1,0,0] op_sel_hi:[1,0,0]
  v_fma_mix_f32 v26, v173, v50, v58 op_sel:[0,0,0] op_sel_hi:[1,0,0]
  v_fma_mix_f32 v27, v173, v51, v59 op_sel:[1,0,0] op_sel_hi:[1,0,0]
  s_waitcnt lgkmcnt(10)
  v_mfma_f32_32x32x16_bf16 a[48:63], a[140:143], v[160:163], a[48:63]
  ds_read_b64_tr_b16 a[156:157], v23 offset:4096
  ds_read_b64_tr_b16 a[158:159], v23 offset:5120
  v_fma_mix_f32 v28, v174, v52, v60 op_sel:[0,0,0] op_sel_hi:[1,0,0]
  v_fma_mix_f32 v29, v174, v53, v61 op_sel:[1,0,0] op_sel_hi:[1,0,0]
  v_fma_mix_f32 v30, v175, v54, v62 op_sel:[0,0,0] op_sel_hi:[1,0,0]
  v_mfma_f32_32x32x16_bf16 a[112:127], a[140:143], v[164:167], a[112:127]
  v_fma_mix_f32 v31, v175, v55, v63 op_sel:[1,0,0] op_sel_hi:[1,0,0]
  v_cvt_pk_bf16_f32 v172, v24, v25
  v_cvt_pk_bf16_f32 v173, v26, v27
  v_cvt_pk_bf16_f32 v174, v28, v29
  v_cvt_pk_bf16_f32 v175, v30, v31
  s_waitcnt lgkmcnt(6)
  v_mfma_f32_32x32x16_bf16 a[0:15], a[144:147], v[168:171], a[0:15]
  ds_read_b128 v[48:51], v2 offset:960
  ds_read_b128 v[52:55], v2 offset:976
  v_fma_mix_f32 v24, v176, v32, v40 op_sel:[0,0,0] op_sel_hi:[1,0,0]
  v_fma_mix_f32 v25, v176, v33, v41 op_sel:[1,0,0] op_sel_hi:[1,0,0]
  v_fma_mix_f32 v26, v177, v34, v42 op_sel:[0,0,0] op_sel_hi:[1,0,0]
  v_mfma_f32_32x32x16_bf16 a[64:79], a[144:147], v[172:175], a[64:79]
  ds_read_b128 v[56:59], v2 offset:3008
  ds_read_b128 v[60:63], v2 offset:3024
  buffer_load_dwordx4 v[120:123], v3, s[24:27], s48 offen offset:3072
  v_fma_mix_f32 v27, v177, v35, v43 op_sel:[1,0,0] op_sel_hi:[1,0,0]
  v_fma_mix_f32 v28, v178, v36, v44 op_sel:[0,0,0] op_sel_hi:[1,0,0]
  s_waitcnt lgkmcnt(8)
  v_mfma_f32_32x32x16_bf16 a[16:31], a[148:151], v[168:171], a[16:31]
  ds_read_b64_tr_b16 a[128:129], v20 offset:8192
  ds_read_b64_tr_b16 a[130:131], v20 offset:9216
  buffer_load_dwordx4 v[124:127], v3, s[24:27], s49 offen offset:3072
  v_fma_mix_f32 v29, v178, v37, v45 op_sel:[1,0,0] op_sel_hi:[1,0,0]
  v_fma_mix_f32 v30, v179, v38, v46 op_sel:[0,0,0] op_sel_hi:[1,0,0]
  v_fma_mix_f32 v31, v179, v39, v47 op_sel:[1,0,0] op_sel_hi:[1,0,0]
  v_mfma_f32_32x32x16_bf16 a[80:95], a[148:151], v[172:175], a[80:95]
  ds_read_b64_tr_b16 a[132:133], v21 offset:8192
  ds_read_b64_tr_b16 a[134:135], v21 offset:9216
  v_cvt_pk_bf16_f32 v176, v24, v25
  v_cvt_pk_bf16_f32 v177, v26, v27
  v_cvt_pk_bf16_f32 v178, v28, v29
  s_waitcnt lgkmcnt(10)
  v_mfma_f32_32x32x16_bf16 a[32:47], a[152:155], v[168:171], a[32:47]
  ds_read_b64_tr_b16 a[136:137], v22 offset:8192
  ds_read_b64_tr_b16 a[138:139], v22 offset:9216
  s_add_u32 s48, s48, 4096
  v_cvt_pk_bf16_f32 v179, v30, v31
  v_fma_mix_f32 v24, v180, v32, v40 op_sel:[0,0,0] op_sel_hi:[1,0,0]
  v_mfma_f32_32x32x16_bf16 a[96:111], a[152:155], v[172:175], a[96:111]
  ds_read_b64_tr_b16 a[140:141], v23 offset:8192
  ds_read_b64_tr_b16 a[142:143], v23 offset:9216
  v_fma_mix_f32 v25, v180, v33, v41 op_sel:[1,0,0] op_sel_hi:[1,0,0]
  v_fma_mix_f32 v26, v181, v34, v42 op_sel:[0,0,0] op_sel_hi:[1,0,0]
  v_fma_mix_f32 v27, v181, v35, v43 op_sel:[1,0,0] op_sel_hi:[1,0,0]
  s_waitcnt lgkmcnt(12)
  v_mfma_f32_32x32x16_bf16 a[48:63], a[156:159], v[168:171], a[48:63]
  s_add_u32 s49, s49, 4096
  v_fma_mix_f32 v28, v182, v36, v44 op_sel:[0,0,0] op_sel_hi:[1,0,0]
  v_fma_mix_f32 v29, v182, v37, v45 op_sel:[1,0,0] op_sel_hi:[1,0,0]
  v_fma_mix_f32 v30, v183, v38, v46 op_sel:[0,0,0] op_sel_hi:[1,0,0]
  v_fma_mix_f32 v31, v183, v39, v47 op_sel:[1,0,0] op_sel_hi:[1,0,0]
  v_mfma_f32_32x32x16_bf16 a[112:127], a[156:159], v[172:175], a[112:127]
  v_cvt_pk_bf16_f32 v180, v24, v25
  v_cvt_pk_bf16_f32 v181, v26, v27
  v_cvt_pk_bf16_f32 v182, v28, v29
  v_cvt_pk_bf16_f32 v183, v30, v31
  s_waitcnt lgkmcnt(6)
  v_mfma_f32_32x32x16_bf16 a[0:15], a[128:131], v[176:179], a[0:15]
  s_waitcnt vmcnt(36)
  s_barrier
  v_fma_mix_f32 v24, v184, v48, v56 op_sel:[0,0,0] op_sel_hi:[1,0,0]
  v_mfma_f32_32x32x16_bf16 a[64:79], a[128:131], v[180:183], a[64:79]
  ds_read_b128 v[32:35], v2 offset:1024
  ds_read_b128 v[36:39], v2 offset:1040
  s_add_u32 m0, s43, 0
  v_fma_mix_f32 v25, v184, v49, v57 op_sel:[1,0,0] op_sel_hi:[1,0,0]
  v_fma_mix_f32 v26, v185, v50, v58 op_sel:[0,0,0] op_sel_hi:[1,0,0]
  v_fma_mix_f32 v27, v185, v51, v59 op_sel:[1,0,0] op_sel_hi:[1,0,0]
  s_waitcnt lgkmcnt(6)
  v_mfma_f32_32x32x16_bf16 a[16:31], a[132:135], v[176:179], a[16:31]
  ds_read_b128 v[40:43], v2 offset:3072
  ds_read_b128 v[44:47], v2 offset:3088
  s_nop 0
  v_fma_mix_f32 v28, v186, v52, v60 op_sel:[0,0,0] op_sel_hi:[1,0,0]
  v_fma_mix_f32 v29, v186, v53, v61 op_sel:[1,0,0] op_sel_hi:[1,0,0]
  v_mfma_f32_32x32x16_bf16 a[80:95], a[132:135], v[180:183], a[80:95]
  ds_read_b64_tr_b16 a[144:145], v20 offset:12288
  ds_read_b64_tr_b16 a[146:147], v20 offset:13312
  buffer_load_dwordx4 v4, s[12:15], s52 offen lds
  v_fma_mix_f32 v30, v187, v54, v62 op_sel:[0,0,0] op_sel_hi:[1,0,0]
  v_fma_mix_f32 v31, v187, v55, v63 op_sel:[1,0,0] op_sel_hi:[1,0,0]
  v_cvt_pk_bf16_f32 v184, v24, v25
  s_waitcnt lgkmcnt(8)
  v_mfma_f32_32x32x16_bf16 a[32:47], a[136:139], v[176:179], a[32:47]
  ds_read_b64_tr_b16 a[148:149], v21 offset:12288
  ds_read_b64_tr_b16 a[150:151], v21 offset:13312
  v_cvt_pk_bf16_f32 v185, v26, v27
  v_cvt_pk_bf16_f32 v186, v28, v29
  v_cvt_pk_bf16_f32 v187, v30, v31
  v_fma_mix_f32 v24, v188, v48, v56 op_sel:[0,0,0] op_sel_hi:[1,0,0]
  v_mfma_f32_32x32x16_bf16 a[96:111], a[136:139], v[180:183], a[96:111]
  ds_read_b64_tr_b16 a[152:153], v22 offset:12288
  ds_read_b64_tr_b16 a[154:155], v22 offset:13312
  buffer_load_dwordx4 v5, s[12:15], s52 offen offset:1024 lds
  v_fma_mix_f32 v25, v188, v49, v57 op_sel:[1,0,0] op_sel_hi:[1,0,0]
  v_fma_mix_f32 v26, v189, v50, v58 op_sel:[0,0,0] op_sel_hi:[1,0,0]
  v_fma_mix_f32 v27, v189, v51, v59 op_sel:[1,0,0] op_sel_hi:[1,0,0]
  s_waitcnt lgkmcnt(10)
  v_mfma_f32_32x32x16_bf16 a[48:63], a[140:143], v[176:179], a[48:63]
  ds_read_b64_tr_b16 a[156:157], v23 offset:12288
  ds_read_b64_tr_b16 a[158:159], v23 offset:13312
  s_add_u32 s52, s52, 8192
  v_fma_mix_f32 v28, v190, v52, v60 op_sel:[0,0,0] op_sel_hi:[1,0,0]
  v_fma_mix_f32 v29, v190, v53, v61 op_sel:[1,0,0] op_sel_hi:[1,0,0]
  v_mfma_f32_32x32x16_bf16 a[112:127], a[140:143], v[180:183], a[112:127]
  v_fma_mix_f32 v30, v191, v54, v62 op_sel:[0,0,0] op_sel_hi:[1,0,0]
  v_fma_mix_f32 v31, v191, v55, v63 op_sel:[1,0,0] op_sel_hi:[1,0,0]
  v_cvt_pk_bf16_f32 v188, v24, v25
  v_cvt_pk_bf16_f32 v189, v26, v27
  v_cvt_pk_bf16_f32 v190, v28, v29
  v_cvt_pk_bf16_f32 v191, v30, v31
  s_waitcnt lgkmcnt(6)
  v_mfma_f32_32x32x16_bf16 a[0:15], a[144:147], v[184:187], a[0:15]
  ds_read_b128 v[48:51], v2 offset:1088
  ds_read_b128 v[52:55], v2 offset:1104
  v_fma_mix_f32 v24, v192, v32, v40 op_sel:[0,0,0] op_sel_hi:[1,0,0]
  v_fma_mix_f32 v25, v192, v33, v41 op_sel:[1,0,0] op_sel_hi:[1,0,0]
  v_fma_mix_f32 v26, v193, v34, v42 op_sel:[0,0,0] op_sel_hi:[1,0,0]
  v_mfma_f32_32x32x16_bf16 a[64:79], a[144:147], v[188:191], a[64:79]
  ds_read_b128 v[56:59], v2 offset:3136
  ds_read_b128 v[60:63], v2 offset:3152
  s_add_u32 m0, s43, 8192
  v_fma_mix_f32 v27, v193, v35, v43 op_sel:[1,0,0] op_sel_hi:[1,0,0]
  v_fma_mix_f32 v28, v194, v36, v44 op_sel:[0,0,0] op_sel_hi:[1,0,0]
  s_waitcnt lgkmcnt(8)
  v_mfma_f32_32x32x16_bf16 a[16:31], a[148:151], v[184:187], a[16:31]
  ds_read_b64_tr_b16 a[128:129], v20 offset:16384
  ds_read_b64_tr_b16 a[130:131], v20 offset:17408
  s_nop 0
  v_fma_mix_f32 v29, v194, v37, v45 op_sel:[1,0,0] op_sel_hi:[1,0,0]
  v_fma_mix_f32 v30, v195, v38, v46 op_sel:[0,0,0] op_sel_hi:[1,0,0]
  v_fma_mix_f32 v31, v195, v39, v47 op_sel:[1,0,0] op_sel_hi:[1,0,0]
  v_mfma_f32_32x32x16_bf16 a[80:95], a[148:151], v[188:191], a[80:95]
  ds_read_b64_tr_b16 a[132:133], v21 offset:16384
  ds_read_b64_tr_b16 a[134:135], v21 offset:17408
  buffer_load_dwordx4 v4, s[12:15], s52 offen lds
  v_cvt_pk_bf16_f32 v192, v24, v25
  v_cvt_pk_bf16_f32 v193, v26, v27
  s_waitcnt lgkmcnt(10)
  v_mfma_f32_32x32x16_bf16 a[32:47], a[152:155], v[184:187], a[32:47]
  ds_read_b64_tr_b16 a[136:137], v22 offset:16384
  ds_read_b64_tr_b16 a[138:139], v22 offset:17408
  v_cvt_pk_bf16_f32 v194, v28, v29
  v_cvt_pk_bf16_f32 v195, v30, v31
  v_fma_mix_f32 v24, v196, v32, v40 op_sel:[0,0,0] op_sel_hi:[1,0,0]
  v_mfma_f32_32x32x16_bf16 a[96:111], a[152:155], v[188:191], a[96:111]
  ds_read_b64_tr_b16 a[140:141], v23 offset:16384
  ds_read_b64_tr_b16 a[142:143], v23 offset:17408
  buffer_load_dwordx4 v5, s[12:15], s52 offen offset:1024 lds
  v_fma_mix_f32 v25, v196, v33, v41 op_sel:[1,0,0] op_sel_hi:[1,0,0]
  v_fma_mix_f32 v26, v197, v34, v42 op_sel:[0,0,0] op_sel_hi:[1,0,0]
  s_waitcnt lgkmcnt(12)
  v_mfma_f32_32x32x16_bf16 a[48:63], a[156:159], v[184:187], a[48:63]
  s_add_u32 s52, s52, 8192
  v_fma_mix_f32 v27, v197, v35, v43 op_sel:[1,0,0] op_sel_hi:[1,0,0]
  v_fma_mix_f32 v28, v198, v36, v44 op_sel:[0,0,0] op_sel_hi:[1,0,0]
  v_fma_mix_f32 v29, v198, v37, v45 op_sel:[1,0,0] op_sel_hi:[1,0,0]
  v_fma_mix_f32 v30, v199, v38, v46 op_sel:[0,0,0] op_sel_hi:[1,0,0]
  v_mfma_f32_32x32x16_bf16 a[112:127], a[156:159], v[188:191], a[112:127]
  v_fma_mix_f32 v31, v199, v39, v47 op_sel:[1,0,0] op_sel_hi:[1,0,0]
  v_cvt_pk_bf16_f32 v196, v24, v25
  v_cvt_pk_bf16_f32 v197, v26, v27
  v_cvt_pk_bf16_f32 v198, v28, v29
  v_cvt_pk_bf16_f32 v199, v30, v31
  s_waitcnt lgkmcnt(6)
  v_mfma_f32_32x32x16_bf16 a[0:15], a[128:131], v[192:195], a[0:15]
  s_waitcnt vmcnt(34)
  s_barrier
  v_fma_mix_f32 v24, v200, v48, v56 op_sel:[0,0,0] op_sel_hi:[1,0,0]
  v_mfma_f32_32x32x16_bf16 a[64:79], a[128:131], v[196:199], a[64:79]
  ds_read_b128 v[32:35], v2 offset:1152
  ds_read_b128 v[36:39], v2 offset:1168
  s_add_u32 m0, s43, 65536
  v_fma_mix_f32 v25, v200, v49, v57 op_sel:[1,0,0] op_sel_hi:[1,0,0]
  v_fma_mix_f32 v26, v201, v50, v58 op_sel:[0,0,0] op_sel_hi:[1,0,0]
  v_fma_mix_f32 v27, v201, v51, v59 op_sel:[1,0,0] op_sel_hi:[1,0,0]
  s_waitcnt lgkmcnt(6)
  v_mfma_f32_32x32x16_bf16 a[16:31], a[132:135], v[192:195], a[16:31]
  ds_read_b128 v[40:43], v2 offset:3200
  ds_read_b128 v[44:47], v2 offset:3216
  s_nop 0
  v_fma_mix_f32 v28, v202, v52, v60 op_sel:[0,0,0] op_sel_hi:[1,0,0]
  v_fma_mix_f32 v29, v202, v53, v61 op_sel:[1,0,0] op_sel_hi:[1,0,0]
  v_mfma_f32_32x32x16_bf16 a[80:95], a[132:135], v[196:199], a[80:95]
  ds_read_b64_tr_b16 a[144:145], v20 offset:20480
  ds_read_b64_tr_b16 a[146:147], v20 offset:21504
  buffer_load_dwordx4 v6, s[16:19], s53 offen lds
  v_fma_mix_f32 v30, v203, v54, v62 op_sel:[0,0,0] op_sel_hi:[1,0,0]
  v_fma_mix_f32 v31, v203, v55, v63 op_sel:[1,0,0] op_sel_hi:[1,0,0]
  v_cvt_pk_bf16_f32 v200, v24, v25
  s_waitcnt lgkmcnt(8)
  v_mfma_f32_32x32x16_bf16 a[32:47], a[136:139], v[192:195], a[32:47]
  ds_read_b64_tr_b16 a[148:149], v21 offset:20480
  ds_read_b64_tr_b16 a[150:151], v21 offset:21504
  v_cvt_pk_bf16_f32 v201, v26, v27
  v_cvt_pk_bf16_f32 v202, v28, v29
  v_cvt_pk_bf16_f32 v203, v30, v31
  v_fma_mix_f32 v24, v204, v48, v56 op_sel:[0,0,0] op_sel_hi:[1,0,0]
  v_mfma_f32_32x32x16_bf16 a[96:111], a[136:139], v[196:199], a[96:111]
  ds_read_b64_tr_b16 a[152:153], v22 offset:20480
  ds_read_b64_tr_b16 a[154:155], v22 offset:21504
  buffer_load_dwordx4 v6, s[16:19], s53 offen offset:1024 lds
  v_fma_mix_f32 v25, v204, v49, v57 op_sel:[1,0,0] op_sel_hi:[1,0,0]
  v_fma_mix_f32 v26, v205, v50, v58 op_sel:[0,0,0] op_sel_hi:[1,0,0]
  v_fma_mix_f32 v27, v205, v51, v59 op_sel:[1,0,0] op_sel_hi:[1,0,0]
  s_waitcnt lgkmcnt(10)
  v_mfma_f32_32x32x16_bf16 a[48:63], a[140:143], v[192:195], a[48:63]
  ds_read_b64_tr_b16 a[156:157], v23 offset:20480
  ds_read_b64_tr_b16 a[158:159], v23 offset:21504
  s_add_u32 s53, s53, 8192
  v_fma_mix_f32 v28, v206, v52, v60 op_sel:[0,0,0] op_sel_hi:[1,0,0]
  v_fma_mix_f32 v29, v206, v53, v61 op_sel:[1,0,0] op_sel_hi:[1,0,0]
  v_mfma_f32_32x32x16_bf16 a[112:127], a[140:143], v[196:199], a[112:127]
  v_fma_mix_f32 v30, v207, v54, v62 op_sel:[0,0,0] op_sel_hi:[1,0,0]
  v_fma_mix_f32 v31, v207, v55, v63 op_sel:[1,0,0] op_sel_hi:[1,0,0]
  v_cvt_pk_bf16_f32 v204, v24, v25
  v_cvt_pk_bf16_f32 v205, v26, v27
  v_cvt_pk_bf16_f32 v206, v28, v29
  v_cvt_pk_bf16_f32 v207, v30, v31
  s_waitcnt lgkmcnt(6)
  v_mfma_f32_32x32x16_bf16 a[0:15], a[144:147], v[200:203], a[0:15]
  ds_read_b128 v[48:51], v2 offset:1216
  ds_read_b128 v[52:55], v2 offset:1232
  v_fma_mix_f32 v24, v208, v32, v40 op_sel:[0,0,0] op_sel_hi:[1,0,0]
  v_fma_mix_f32 v25, v208, v33, v41 op_sel:[1,0,0] op_sel_hi:[1,0,0]
  v_fma_mix_f32 v26, v209, v34, v42 op_sel:[0,0,0] op_sel_hi:[1,0,0]
  v_mfma_f32_32x32x16_bf16 a[64:79], a[144:147], v[204:207], a[64:79]
  ds_read_b128 v[56:59], v2 offset:3264
  ds_read_b128 v[60:63], v2 offset:3280
  s_add_u32 m0, s43, 16384
  v_fma_mix_f32 v27, v209, v35, v43 op_sel:[1,0,0] op_sel_hi:[1,0,0]
  v_fma_mix_f32 v28, v210, v36, v44 op_sel:[0,0,0] op_sel_hi:[1,0,0]
  s_waitcnt lgkmcnt(8)
  v_mfma_f32_32x32x16_bf16 a[16:31], a[148:151], v[200:203], a[16:31]
  ds_read_b64_tr_b16 a[128:129], v20 offset:24576
  ds_read_b64_tr_b16 a[130:131], v20 offset:25600
  s_nop 0
  v_fma_mix_f32 v29, v210, v37, v45 op_sel:[1,0,0] op_sel_hi:[1,0,0]
  v_fma_mix_f32 v30, v211, v38, v46 op_sel:[0,0,0] op_sel_hi:[1,0,0]
  v_fma_mix_f32 v31, v211, v39, v47 op_sel:[1,0,0] op_sel_hi:[1,0,0]
  v_mfma_f32_32x32x16_bf16 a[80:95], a[148:151], v[204:207], a[80:95]
  ds_read_b64_tr_b16 a[132:133], v21 offset:24576
  ds_read_b64_tr_b16 a[134:135], v21 offset:25600
  buffer_load_dwordx4 v4, s[12:15], s52 offen lds
  v_cvt_pk_bf16_f32 v208, v24, v25
  v_cvt_pk_bf16_f32 v209, v26, v27
  s_waitcnt lgkmcnt(10)
  v_mfma_f32_32x32x16_bf16 a[32:47], a[152:155], v[200:203], a[32:47]
  ds_read_b64_tr_b16 a[136:137], v22 offset:24576
  ds_read_b64_tr_b16 a[138:139], v22 offset:25600
  v_cvt_pk_bf16_f32 v210, v28, v29
  v_cvt_pk_bf16_f32 v211, v30, v31
  v_fma_mix_f32 v24, v212, v32, v40 op_sel:[0,0,0] op_sel_hi:[1,0,0]
  v_mfma_f32_32x32x16_bf16 a[96:111], a[152:155], v[204:207], a[96:111]
  ds_read_b64_tr_b16 a[140:141], v23 offset:24576
  ds_read_b64_tr_b16 a[142:143], v23 offset:25600
  buffer_load_dwordx4 v5, s[12:15], s52 offen offset:1024 lds
  v_fma_mix_f32 v25, v212, v33, v41 op_sel:[1,0,0] op_sel_hi:[1,0,0]
  v_fma_mix_f32 v26, v213, v34, v42 op_sel:[0,0,0] op_sel_hi:[1,0,0]
  s_waitcnt lgkmcnt(12)
  v_mfma_f32_32x32x16_bf16 a[48:63], a[156:159], v[200:203], a[48:63]
  s_add_u32 s52, s52, 8192
  v_fma_mix_f32 v27, v213, v35, v43 op_sel:[1,0,0] op_sel_hi:[1,0,0]
  v_fma_mix_f32 v28, v214, v36, v44 op_sel:[0,0,0] op_sel_hi:[1,0,0]
  v_fma_mix_f32 v29, v214, v37, v45 op_sel:[1,0,0] op_sel_hi:[1,0,0]
  v_fma_mix_f32 v30, v215, v38, v46 op_sel:[0,0,0] op_sel_hi:[1,0,0]
  v_mfma_f32_32x32x16_bf16 a[112:127], a[156:159], v[204:207], a[112:127]
  v_fma_mix_f32 v31, v215, v39, v47 op_sel:[1,0,0] op_sel_hi:[1,0,0]
  v_cvt_pk_bf16_f32 v212, v24, v25
  v_cvt_pk_bf16_f32 v213, v26, v27
  v_cvt_pk_bf16_f32 v214, v28, v29
  v_cvt_pk_bf16_f32 v215, v30, v31
  s_waitcnt lgkmcnt(6)
  v_mfma_f32_32x32x16_bf16 a[0:15], a[128:131], v[208:211], a[0:15]
  s_waitcnt vmcnt(32)
  s_barrier
  v_fma_mix_f32 v24, v216, v48, v56 op_sel:[0,0,0] op_sel_hi:[1,0,0]
  v_mfma_f32_32x32x16_bf16 a[64:79], a[128:131], v[212:215], a[64:79]
  ds_read_b128 v[32:35], v2 offset:1280
  ds_read_b128 v[36:39], v2 offset:1296
  s_add_u32 m0, s43, 73728
  v_fma_mix_f32 v25, v216, v49, v57 op_sel:[1,0,0] op_sel_hi:[1,0,0]
  v_fma_mix_f32 v26, v217, v50, v58 op_sel:[0,0,0] op_sel_hi:[1,0,0]
  v_fma_mix_f32 v27, v217, v51, v59 op_sel:[1,0,0] op_sel_hi:[1,0,0]
  s_waitcnt lgkmcnt(6)
  v_mfma_f32_32x32x16_bf16 a[16:31], a[132:135], v[208:211], a[16:31]
  ds_read_b128 v[40:43], v2 offset:3328
  ds_read_b128 v[44:47], v2 offset:3344
  s_nop 0
  v_fma_mix_f32 v28, v218, v52, v60 op_sel:[0,0,0] op_sel_hi:[1,0,0]
  v_fma_mix_f32 v29, v218, v53, v61 op_sel:[1,0,0] op_sel_hi:[1,0,0]
  v_mfma_f32_32x32x16_bf16 a[80:95], a[132:135], v[212:215], a[80:95]
  ds_read_b64_tr_b16 a[144:145], v20 offset:28672
  ds_read_b64_tr_b16 a[146:147], v20 offset:29696
  buffer_load_dwordx4 v6, s[16:19], s53 offen lds
  v_fma_mix_f32 v30, v219, v54, v62 op_sel:[0,0,0] op_sel_hi:[1,0,0]
  v_fma_mix_f32 v31, v219, v55, v63 op_sel:[1,0,0] op_sel_hi:[1,0,0]
  v_cvt_pk_bf16_f32 v216, v24, v25
  s_waitcnt lgkmcnt(8)
  v_mfma_f32_32x32x16_bf16 a[32:47], a[136:139], v[208:211], a[32:47]
  ds_read_b64_tr_b16 a[148:149], v21 offset:28672
  ds_read_b64_tr_b16 a[150:151], v21 offset:29696
  v_cvt_pk_bf16_f32 v217, v26, v27
  v_cvt_pk_bf16_f32 v218, v28, v29
  v_cvt_pk_bf16_f32 v219, v30, v31
  v_fma_mix_f32 v24, v220, v48, v56 op_sel:[0,0,0] op_sel_hi:[1,0,0]
  v_mfma_f32_32x32x16_bf16 a[96:111], a[136:139], v[212:215], a[96:111]
  ds_read_b64_tr_b16 a[152:153], v22 offset:28672
  ds_read_b64_tr_b16 a[154:155], v22 offset:29696
  buffer_load_dwordx4 v6, s[16:19], s53 offen offset:1024 lds
  v_fma_mix_f32 v25, v220, v49, v57 op_sel:[1,0,0] op_sel_hi:[1,0,0]
  v_fma_mix_f32 v26, v221, v50, v58 op_sel:[0,0,0] op_sel_hi:[1,0,0]
  v_fma_mix_f32 v27, v221, v51, v59 op_sel:[1,0,0] op_sel_hi:[1,0,0]
  s_waitcnt lgkmcnt(10)
  v_mfma_f32_32x32x16_bf16 a[48:63], a[140:143], v[208:211], a[48:63]
  ds_read_b64_tr_b16 a[156:157], v23 offset:28672
  ds_read_b64_tr_b16 a[158:159], v23 offset:29696
  s_add_u32 s53, s53, 8192
  v_fma_mix_f32 v28, v222, v52, v60 op_sel:[0,0,0] op_sel_hi:[1,0,0]
  v_fma_mix_f32 v29, v222, v53, v61 op_sel:[1,0,0] op_sel_hi:[1,0,0]
  v_mfma_f32_32x32x16_bf16 a[112:127], a[140:143], v[212:215], a[112:127]
  v_fma_mix_f32 v30, v223, v54, v62 op_sel:[0,0,0] op_sel_hi:[1,0,0]
  v_fma_mix_f32 v31, v223, v55, v63 op_sel:[1,0,0] op_sel_hi:[1,0,0]
  v_cvt_pk_bf16_f32 v220, v24, v25
  v_cvt_pk_bf16_f32 v221, v26, v27
  v_cvt_pk_bf16_f32 v222, v28, v29
  v_cvt_pk_bf16_f32 v223, v30, v31
  s_waitcnt lgkmcnt(6)
  v_mfma_f32_32x32x16_bf16 a[0:15], a[144:147], v[216:219], a[0:15]
  ds_read_b128 v[48:51], v2 offset:1344
  ds_read_b128 v[52:55], v2 offset:1360
  v_fma_mix_f32 v24, v224, v32, v40 op_sel:[0,0,0] op_sel_hi:[1,0,0]
  v_fma_mix_f32 v25, v224, v33, v41 op_sel:[1,0,0] op_sel_hi:[1,0,0]
  v_fma_mix_f32 v26, v225, v34, v42 op_sel:[0,0,0] op_sel_hi:[1,0,0]
  v_mfma_f32_32x32x16_bf16 a[64:79], a[144:147], v[220:223], a[64:79]
  ds_read_b128 v[56:59], v2 offset:3392
  ds_read_b128 v[60:63], v2 offset:3408
  s_add_u32 m0, s43, 24576
  v_fma_mix_f32 v27, v225, v35, v43 op_sel:[1,0,0] op_sel_hi:[1,0,0]
  v_fma_mix_f32 v28, v226, v36, v44 op_sel:[0,0,0] op_sel_hi:[1,0,0]
  s_waitcnt lgkmcnt(8)
  v_mfma_f32_32x32x16_bf16 a[16:31], a[148:151], v[216:219], a[16:31]
  ds_read_b64_tr_b16 a[128:129], v20 offset:32768
  ds_read_b64_tr_b16 a[130:131], v20 offset:33792
  s_nop 0
  v_fma_mix_f32 v29, v226, v37, v45 op_sel:[1,0,0] op_sel_hi:[1,0,0]
  v_fma_mix_f32 v30, v227, v38, v46 op_sel:[0,0,0] op_sel_hi:[1,0,0]
  v_fma_mix_f32 v31, v227, v39, v47 op_sel:[1,0,0] op_sel_hi:[1,0,0]
  v_mfma_f32_32x32x16_bf16 a[80:95], a[148:151], v[220:223], a[80:95]
  ds_read_b64_tr_b16 a[132:133], v21 offset:32768
  ds_read_b64_tr_b16 a[134:135], v21 offset:33792
  buffer_load_dwordx4 v4, s[12:15], s52 offen lds
  v_cvt_pk_bf16_f32 v224, v24, v25
  v_cvt_pk_bf16_f32 v225, v26, v27
  s_waitcnt lgkmcnt(10)
  v_mfma_f32_32x32x16_bf16 a[32:47], a[152:155], v[216:219], a[32:47]
  ds_read_b64_tr_b16 a[136:137], v22 offset:32768
  ds_read_b64_tr_b16 a[138:139], v22 offset:33792
  v_cvt_pk_bf16_f32 v226, v28, v29
  v_cvt_pk_bf16_f32 v227, v30, v31
  v_fma_mix_f32 v24, v228, v32, v40 op_sel:[0,0,0] op_sel_hi:[1,0,0]
  v_mfma_f32_32x32x16_bf16 a[96:111], a[152:155], v[220:223], a[96:111]
  ds_read_b64_tr_b16 a[140:141], v23 offset:32768
  ds_read_b64_tr_b16 a[142:143], v23 offset:33792
  buffer_load_dwordx4 v5, s[12:15], s52 offen offset:1024 lds
  v_fma_mix_f32 v25, v228, v33, v41 op_sel:[1,0,0] op_sel_hi:[1,0,0]
  v_fma_mix_f32 v26, v229, v34, v42 op_sel:[0,0,0] op_sel_hi:[1,0,0]
  s_waitcnt lgkmcnt(12)
  v_mfma_f32_32x32x16_bf16 a[48:63], a[156:159], v[216:219], a[48:63]
  s_add_u32 s52, s52, 8192
  v_fma_mix_f32 v27, v229, v35, v43 op_sel:[1,0,0] op_sel_hi:[1,0,0]
  v_fma_mix_f32 v28, v230, v36, v44 op_sel:[0,0,0] op_sel_hi:[1,0,0]
  v_fma_mix_f32 v29, v230, v37, v45 op_sel:[1,0,0] op_sel_hi:[1,0,0]
  v_fma_mix_f32 v30, v231, v38, v46 op_sel:[0,0,0] op_sel_hi:[1,0,0]
  v_mfma_f32_32x32x16_bf16 a[112:127], a[156:159], v[220:223], a[112:127]
  v_fma_mix_f32 v31, v231, v39, v47 op_sel:[1,0,0] op_sel_hi:[1,0,0]
  v_cvt_pk_bf16_f32 v228, v24, v25
  v_cvt_pk_bf16_f32 v229, v26, v27
  v_cvt_pk_bf16_f32 v230, v28, v29
  v_cvt_pk_bf16_f32 v231, v30, v31
  s_waitcnt lgkmcnt(6)
  v_mfma_f32_32x32x16_bf16 a[0:15], a[128:131], v[224:227], a[0:15]
  s_waitcnt vmcnt(30)
  s_barrier
  v_fma_mix_f32 v24, v232, v48, v56 op_sel:[0,0,0] op_sel_hi:[1,0,0]
  v_mfma_f32_32x32x16_bf16 a[64:79], a[128:131], v[228:231], a[64:79]
  ds_read_b128 v[32:35], v2 offset:1408
  ds_read_b128 v[36:39], v2 offset:1424
  v_fma_mix_f32 v25, v232, v49, v57 op_sel:[1,0,0] op_sel_hi:[1,0,0]
  v_fma_mix_f32 v26, v233, v50, v58 op_sel:[0,0,0] op_sel_hi:[1,0,0]
  v_fma_mix_f32 v27, v233, v51, v59 op_sel:[1,0,0] op_sel_hi:[1,0,0]
  s_waitcnt lgkmcnt(6)
  v_mfma_f32_32x32x16_bf16 a[16:31], a[132:135], v[224:227], a[16:31]
  ds_read_b128 v[40:43], v2 offset:3456
  ds_read_b128 v[44:47], v2 offset:3472
  v_fma_mix_f32 v28, v234, v52, v60 op_sel:[0,0,0] op_sel_hi:[1,0,0]
  v_fma_mix_f32 v29, v234, v53, v61 op_sel:[1,0,0] op_sel_hi:[1,0,0]
  v_fma_mix_f32 v30, v235, v54, v62 op_sel:[0,0,0] op_sel_hi:[1,0,0]
  v_mfma_f32_32x32x16_bf16 a[80:95], a[132:135], v[228:231], a[80:95]
  ds_read_b64_tr_b16 a[144:145], v20 offset:36864
  ds_read_b64_tr_b16 a[146:147], v20 offset:37888
  v_fma_mix_f32 v31, v235, v55, v63 op_sel:[1,0,0] op_sel_hi:[1,0,0]
  v_cvt_pk_bf16_f32 v232, v24, v25
  v_cvt_pk_bf16_f32 v233, v26, v27
  s_waitcnt lgkmcnt(8)
  v_mfma_f32_32x32x16_bf16 a[32:47], a[136:139], v[224:227], a[32:47]
  ds_read_b64_tr_b16 a[148:149], v21 offset:36864
  ds_read_b64_tr_b16 a[150:151], v21 offset:37888
  v_cvt_pk_bf16_f32 v234, v28, v29
  v_cvt_pk_bf16_f32 v235, v30, v31
  v_fma_mix_f32 v24, v236, v48, v56 op_sel:[0,0,0] op_sel_hi:[1,0,0]
  v_mfma_f32_32x32x16_bf16 a[96:111], a[136:139], v[228:231], a[96:111]
  ds_read_b64_tr_b16 a[152:153], v22 offset:36864
  ds_read_b64_tr_b16 a[154:155], v22 offset:37888
  v_fma_mix_f32 v25, v236, v49, v57 op_sel:[1,0,0] op_sel_hi:[1,0,0]
  v_fma_mix_f32 v26, v237, v50, v58 op_sel:[0,0,0] op_sel_hi:[1,0,0]
  v_fma_mix_f32 v27, v237, v51, v59 op_sel:[1,0,0] op_sel_hi:[1,0,0]
  s_waitcnt lgkmcnt(10)
  v_mfma_f32_32x32x16_bf16 a[48:63], a[140:143], v[224:227], a[48:63]
  ds_read_b64_tr_b16 a[156:157], v23 offset:36864
  ds_read_b64_tr_b16 a[158:159], v23 offset:37888
  v_fma_mix_f32 v28, v238, v52, v60 op_sel:[0,0,0] op_sel_hi:[1,0,0]
  v_fma_mix_f32 v29, v238, v53, v61 op_sel:[1,0,0] op_sel_hi:[1,0,0]
  v_fma_mix_f32 v30, v239, v54, v62 op_sel:[0,0,0] op_sel_hi:[1,0,0]
  v_mfma_f32_32x32x16_bf16 a[112:127], a[140:143], v[228:231], a[112:127]
  v_fma_mix_f32 v31, v239, v55, v63 op_sel:[1,0,0] op_sel_hi:[1,0,0]
  v_cvt_pk_bf16_f32 v236, v24, v25
  v_cvt_pk_bf16_f32 v237, v26, v27
  v_cvt_pk_bf16_f32 v238, v28, v29
  v_cvt_pk_bf16_f32 v239, v30, v31
  s_waitcnt lgkmcnt(6)
  v_mfma_f32_32x32x16_bf16 a[0:15], a[144:147], v[232:235], a[0:15]
  ds_read_b128 v[48:51], v2 offset:1472
  ds_read_b128 v[52:55], v2 offset:1488
  v_fma_mix_f32 v24, v240, v32, v40 op_sel:[0,0,0] op_sel_hi:[1,0,0]
  v_fma_mix_f32 v25, v240, v33, v41 op_sel:[1,0,0] op_sel_hi:[1,0,0]
  v_fma_mix_f32 v26, v241, v34, v42 op_sel:[0,0,0] op_sel_hi:[1,0,0]
  v_mfma_f32_32x32x16_bf16 a[64:79], a[144:147], v[236:239], a[64:79]
  ds_read_b128 v[56:59], v2 offset:3520
  ds_read_b128 v[60:63], v2 offset:3536
  v_fma_mix_f32 v27, v241, v35, v43 op_sel:[1,0,0] op_sel_hi:[1,0,0]
  v_fma_mix_f32 v28, v242, v36, v44 op_sel:[0,0,0] op_sel_hi:[1,0,0]
  s_waitcnt lgkmcnt(8)
  v_mfma_f32_32x32x16_bf16 a[16:31], a[148:151], v[232:235], a[16:31]
  ds_read_b64_tr_b16 a[128:129], v20 offset:40960
  ds_read_b64_tr_b16 a[130:131], v20 offset:41984
  v_fma_mix_f32 v29, v242, v37, v45 op_sel:[1,0,0] op_sel_hi:[1,0,0]
  v_fma_mix_f32 v30, v243, v38, v46 op_sel:[0,0,0] op_sel_hi:[1,0,0]
  v_fma_mix_f32 v31, v243, v39, v47 op_sel:[1,0,0] op_sel_hi:[1,0,0]
  v_mfma_f32_32x32x16_bf16 a[80:95], a[148:151], v[236:239], a[80:95]
  ds_read_b64_tr_b16 a[132:133], v21 offset:40960
  ds_read_b64_tr_b16 a[134:135], v21 offset:41984
  v_cvt_pk_bf16_f32 v240, v24, v25
  v_cvt_pk_bf16_f32 v241, v26, v27
  v_cvt_pk_bf16_f32 v242, v28, v29
  s_waitcnt lgkmcnt(10)
  v_mfma_f32_32x32x16_bf16 a[32:47], a[152:155], v[232:235], a[32:47]
  ds_read_b64_tr_b16 a[136:137], v22 offset:40960
  ds_read_b64_tr_b16 a[138:139], v22 offset:41984
  v_cvt_pk_bf16_f32 v243, v30, v31
  v_fma_mix_f32 v24, v244, v32, v40 op_sel:[0,0,0] op_sel_hi:[1,0,0]
  v_mfma_f32_32x32x16_bf16 a[96:111], a[152:155], v[236:239], a[96:111]
  ds_read_b64_tr_b16 a[140:141], v23 offset:40960
  ds_read_b64_tr_b16 a[142:143], v23 offset:41984
  v_fma_mix_f32 v25, v244, v33, v41 op_sel:[1,0,0] op_sel_hi:[1,0,0]
  v_fma_mix_f32 v26, v245, v34, v42 op_sel:[0,0,0] op_sel_hi:[1,0,0]
  v_fma_mix_f32 v27, v245, v35, v43 op_sel:[1,0,0] op_sel_hi:[1,0,0]
  s_waitcnt lgkmcnt(12)
  v_mfma_f32_32x32x16_bf16 a[48:63], a[156:159], v[232:235], a[48:63]
  v_fma_mix_f32 v28, v246, v36, v44 op_sel:[0,0,0] op_sel_hi:[1,0,0]
  v_fma_mix_f32 v29, v246, v37, v45 op_sel:[1,0,0] op_sel_hi:[1,0,0]
  v_fma_mix_f32 v30, v247, v38, v46 op_sel:[0,0,0] op_sel_hi:[1,0,0]
  v_fma_mix_f32 v31, v247, v39, v47 op_sel:[1,0,0] op_sel_hi:[1,0,0]
  v_mfma_f32_32x32x16_bf16 a[112:127], a[156:159], v[236:239], a[112:127]
  v_cvt_pk_bf16_f32 v244, v24, v25
  v_cvt_pk_bf16_f32 v245, v26, v27
  v_cvt_pk_bf16_f32 v246, v28, v29
  v_cvt_pk_bf16_f32 v247, v30, v31
  s_waitcnt lgkmcnt(6)
  v_mfma_f32_32x32x16_bf16 a[0:15], a[128:131], v[240:243], a[0:15]
  s_waitcnt vmcnt(24)
  s_barrier
  v_fma_mix_f32 v24, v248, v48, v56 op_sel:[0,0,0] op_sel_hi:[1,0,0]
  v_mfma_f32_32x32x16_bf16 a[64:79], a[128:131], v[244:247], a[64:79]
  ds_read_b128 v[32:35], v2 offset:1536
  ds_read_b128 v[36:39], v2 offset:1552
  v_fma_mix_f32 v25, v248, v49, v57 op_sel:[1,0,0] op_sel_hi:[1,0,0]
  v_fma_mix_f32 v26, v249, v50, v58 op_sel:[0,0,0] op_sel_hi:[1,0,0]
  v_fma_mix_f32 v27, v249, v51, v59 op_sel:[1,0,0] op_sel_hi:[1,0,0]
  s_waitcnt lgkmcnt(6)
  v_mfma_f32_32x32x16_bf16 a[16:31], a[132:135], v[240:243], a[16:31]
  ds_read_b128 v[40:43], v2 offset:3584
  ds_read_b128 v[44:47], v2 offset:3600
  v_fma_mix_f32 v28, v250, v52, v60 op_sel:[0,0,0] op_sel_hi:[1,0,0]
  v_fma_mix_f32 v29, v250, v53, v61 op_sel:[1,0,0] op_sel_hi:[1,0,0]
  v_fma_mix_f32 v30, v251, v54, v62 op_sel:[0,0,0] op_sel_hi:[1,0,0]
  v_mfma_f32_32x32x16_bf16 a[80:95], a[132:135], v[244:247], a[80:95]
  ds_read_b64_tr_b16 a[144:145], v20 offset:45056
  ds_read_b64_tr_b16 a[146:147], v20 offset:46080
  v_fma_mix_f32 v31, v251, v55, v63 op_sel:[1,0,0] op_sel_hi:[1,0,0]
  v_cvt_pk_bf16_f32 v248, v24, v25
  v_cvt_pk_bf16_f32 v249, v26, v27
  s_waitcnt lgkmcnt(8)
  v_mfma_f32_32x32x16_bf16 a[32:47], a[136:139], v[240:243], a[32:47]
  ds_read_b64_tr_b16 a[148:149], v21 offset:45056
  ds_read_b64_tr_b16 a[150:151], v21 offset:46080
  v_cvt_pk_bf16_f32 v250, v28, v29
  v_cvt_pk_bf16_f32 v251, v30, v31
  v_fma_mix_f32 v24, v252, v48, v56 op_sel:[0,0,0] op_sel_hi:[1,0,0]
  v_mfma_f32_32x32x16_bf16 a[96:111], a[136:139], v[244:247], a[96:111]
  ds_read_b64_tr_b16 a[152:153], v22 offset:45056
  ds_read_b64_tr_b16 a[154:155], v22 offset:46080
  v_fma_mix_f32 v25, v252, v49, v57 op_sel:[1,0,0] op_sel_hi:[1,0,0]
  v_fma_mix_f32 v26, v253, v50, v58 op_sel:[0,0,0] op_sel_hi:[1,0,0]
  v_fma_mix_f32 v27, v253, v51, v59 op_sel:[1,0,0] op_sel_hi:[1,0,0]
  s_waitcnt lgkmcnt(10)
  v_mfma_f32_32x32x16_bf16 a[48:63], a[140:143], v[240:243], a[48:63]
  ds_read_b64_tr_b16 a[156:157], v23 offset:45056
  ds_read_b64_tr_b16 a[158:159], v23 offset:46080
  v_fma_mix_f32 v28, v254, v52, v60 op_sel:[0,0,0] op_sel_hi:[1,0,0]
  v_fma_mix_f32 v29, v254, v53, v61 op_sel:[1,0,0] op_sel_hi:[1,0,0]
  v_fma_mix_f32 v30, v255, v54, v62 op_sel:[0,0,0] op_sel_hi:[1,0,0]
  v_mfma_f32_32x32x16_bf16 a[112:127], a[140:143], v[244:247], a[112:127]
  v_fma_mix_f32 v31, v255, v55, v63 op_sel:[1,0,0] op_sel_hi:[1,0,0]
  v_cvt_pk_bf16_f32 v252, v24, v25
  v_cvt_pk_bf16_f32 v253, v26, v27
  v_cvt_pk_bf16_f32 v254, v28, v29
  v_cvt_pk_bf16_f32 v255, v30, v31
  s_waitcnt lgkmcnt(6)
  v_mfma_f32_32x32x16_bf16 a[0:15], a[144:147], v[248:251], a[0:15]
  ds_read_b128 v[48:51], v2 offset:1600
  ds_read_b128 v[52:55], v2 offset:1616
  v_fma_mix_f32 v24, v64, v32, v40 op_sel:[0,0,0] op_sel_hi:[1,0,0]
  v_fma_mix_f32 v25, v64, v33, v41 op_sel:[1,0,0] op_sel_hi:[1,0,0]
  v_fma_mix_f32 v26, v65, v34, v42 op_sel:[0,0,0] op_sel_hi:[1,0,0]
  v_mfma_f32_32x32x16_bf16 a[64:79], a[144:147], v[252:255], a[64:79]
  ds_read_b128 v[56:59], v2 offset:3648
  ds_read_b128 v[60:63], v2 offset:3664
  v_fma_mix_f32 v27, v65, v35, v43 op_sel:[1,0,0] op_sel_hi:[1,0,0]
  v_fma_mix_f32 v28, v66, v36, v44 op_sel:[0,0,0] op_sel_hi:[1,0,0]
  s_waitcnt lgkmcnt(8)
  v_mfma_f32_32x32x16_bf16 a[16:31], a[148:151], v[248:251], a[16:31]
  ds_read_b64_tr_b16 a[128:129], v20 offset:49152
  ds_read_b64_tr_b16 a[130:131], v20 offset:50176
  v_fma_mix_f32 v29, v66, v37, v45 op_sel:[1,0,0] op_sel_hi:[1,0,0]
  v_fma_mix_f32 v30, v67, v38, v46 op_sel:[0,0,0] op_sel_hi:[1,0,0]
  v_fma_mix_f32 v31, v67, v39, v47 op_sel:[1,0,0] op_sel_hi:[1,0,0]
  v_mfma_f32_32x32x16_bf16 a[80:95], a[148:151], v[252:255], a[80:95]
  ds_read_b64_tr_b16 a[132:133], v21 offset:49152
  ds_read_b64_tr_b16 a[134:135], v21 offset:50176
  v_cvt_pk_bf16_f32 v64, v24, v25
  v_cvt_pk_bf16_f32 v65, v26, v27
  v_cvt_pk_bf16_f32 v66, v28, v29
  s_waitcnt lgkmcnt(10)
  v_mfma_f32_32x32x16_bf16 a[32:47], a[152:155], v[248:251], a[32:47]
  ds_read_b64_tr_b16 a[136:137], v22 offset:49152
  ds_read_b64_tr_b16 a[138:139], v22 offset:50176
  v_cvt_pk_bf16_f32 v67, v30, v31
  v_fma_mix_f32 v24, v68, v32, v40 op_sel:[0,0,0] op_sel_hi:[1,0,0]
  v_mfma_f32_32x32x16_bf16 a[96:111], a[152:155], v[252:255], a[96:111]
  ds_read_b64_tr_b16 a[140:141], v23 offset:49152
  ds_read_b64_tr_b16 a[142:143], v23 offset:50176
  v_fma_mix_f32 v25, v68, v33, v41 op_sel:[1,0,0] op_sel_hi:[1,0,0]
  v_fma_mix_f32 v26, v69, v34, v42 op_sel:[0,0,0] op_sel_hi:[1,0,0]
  v_fma_mix_f32 v27, v69, v35, v43 op_sel:[1,0,0] op_sel_hi:[1,0,0]
  s_waitcnt lgkmcnt(12)
  v_mfma_f32_32x32x16_bf16 a[48:63], a[156:159], v[248:251], a[48:63]
  v_fma_mix_f32 v28, v70, v36, v44 op_sel:[0,0,0] op_sel_hi:[1,0,0]
  v_fma_mix_f32 v29, v70, v37, v45 op_sel:[1,0,0] op_sel_hi:[1,0,0]
  v_fma_mix_f32 v30, v71, v38, v46 op_sel:[0,0,0] op_sel_hi:[1,0,0]
  v_fma_mix_f32 v31, v71, v39, v47 op_sel:[1,0,0] op_sel_hi:[1,0,0]
  v_mfma_f32_32x32x16_bf16 a[112:127], a[156:159], v[252:255], a[112:127]
  v_cvt_pk_bf16_f32 v68, v24, v25
  v_cvt_pk_bf16_f32 v69, v26, v27
  v_cvt_pk_bf16_f32 v70, v28, v29
  v_cvt_pk_bf16_f32 v71, v30, v31
  s_waitcnt lgkmcnt(6)
  v_mfma_f32_32x32x16_bf16 a[0:15], a[128:131], v[64:67], a[0:15]
  s_waitcnt vmcnt(20)
  s_barrier
  v_fma_mix_f32 v24, v72, v48, v56 op_sel:[0,0,0] op_sel_hi:[1,0,0]
  v_mfma_f32_32x32x16_bf16 a[64:79], a[128:131], v[68:71], a[64:79]
  ds_read_b128 v[32:35], v2 offset:1664
  ds_read_b128 v[36:39], v2 offset:1680
  v_fma_mix_f32 v25, v72, v49, v57 op_sel:[1,0,0] op_sel_hi:[1,0,0]
  v_fma_mix_f32 v26, v73, v50, v58 op_sel:[0,0,0] op_sel_hi:[1,0,0]
  v_fma_mix_f32 v27, v73, v51, v59 op_sel:[1,0,0] op_sel_hi:[1,0,0]
  s_waitcnt lgkmcnt(6)
  v_mfma_f32_32x32x16_bf16 a[16:31], a[132:135], v[64:67], a[16:31]
  ds_read_b128 v[40:43], v2 offset:3712
  ds_read_b128 v[44:47], v2 offset:3728
  v_fma_mix_f32 v28, v74, v52, v60 op_sel:[0,0,0] op_sel_hi:[1,0,0]
  v_fma_mix_f32 v29, v74, v53, v61 op_sel:[1,0,0] op_sel_hi:[1,0,0]
  v_fma_mix_f32 v30, v75, v54, v62 op_sel:[0,0,0] op_sel_hi:[1,0,0]
  v_mfma_f32_32x32x16_bf16 a[80:95], a[132:135], v[68:71], a[80:95]
  ds_read_b64_tr_b16 a[144:145], v20 offset:53248
  ds_read_b64_tr_b16 a[146:147], v20 offset:54272
  v_fma_mix_f32 v31, v75, v55, v63 op_sel:[1,0,0] op_sel_hi:[1,0,0]
  v_cvt_pk_bf16_f32 v72, v24, v25
  v_cvt_pk_bf16_f32 v73, v26, v27
  s_waitcnt lgkmcnt(8)
  v_mfma_f32_32x32x16_bf16 a[32:47], a[136:139], v[64:67], a[32:47]
  ds_read_b64_tr_b16 a[148:149], v21 offset:53248
  ds_read_b64_tr_b16 a[150:151], v21 offset:54272
  v_cvt_pk_bf16_f32 v74, v28, v29
  v_cvt_pk_bf16_f32 v75, v30, v31
  v_fma_mix_f32 v24, v76, v48, v56 op_sel:[0,0,0] op_sel_hi:[1,0,0]
  v_mfma_f32_32x32x16_bf16 a[96:111], a[136:139], v[68:71], a[96:111]
  ds_read_b64_tr_b16 a[152:153], v22 offset:53248
  ds_read_b64_tr_b16 a[154:155], v22 offset:54272
  v_fma_mix_f32 v25, v76, v49, v57 op_sel:[1,0,0] op_sel_hi:[1,0,0]
  v_fma_mix_f32 v26, v77, v50, v58 op_sel:[0,0,0] op_sel_hi:[1,0,0]
  v_fma_mix_f32 v27, v77, v51, v59 op_sel:[1,0,0] op_sel_hi:[1,0,0]
  s_waitcnt lgkmcnt(10)
  v_mfma_f32_32x32x16_bf16 a[48:63], a[140:143], v[64:67], a[48:63]
  ds_read_b64_tr_b16 a[156:157], v23 offset:53248
  ds_read_b64_tr_b16 a[158:159], v23 offset:54272
  v_fma_mix_f32 v28, v78, v52, v60 op_sel:[0,0,0] op_sel_hi:[1,0,0]
  v_fma_mix_f32 v29, v78, v53, v61 op_sel:[1,0,0] op_sel_hi:[1,0,0]
  v_fma_mix_f32 v30, v79, v54, v62 op_sel:[0,0,0] op_sel_hi:[1,0,0]
  v_mfma_f32_32x32x16_bf16 a[112:127], a[140:143], v[68:71], a[112:127]
  v_fma_mix_f32 v31, v79, v55, v63 op_sel:[1,0,0] op_sel_hi:[1,0,0]
  v_cvt_pk_bf16_f32 v76, v24, v25
  v_cvt_pk_bf16_f32 v77, v26, v27
  v_cvt_pk_bf16_f32 v78, v28, v29
  v_cvt_pk_bf16_f32 v79, v30, v31
  s_waitcnt lgkmcnt(6)
  v_mfma_f32_32x32x16_bf16 a[0:15], a[144:147], v[72:75], a[0:15]
  ds_read_b128 v[48:51], v2 offset:1728
  ds_read_b128 v[52:55], v2 offset:1744
  v_fma_mix_f32 v24, v80, v32, v40 op_sel:[0,0,0] op_sel_hi:[1,0,0]
  v_fma_mix_f32 v25, v80, v33, v41 op_sel:[1,0,0] op_sel_hi:[1,0,0]
  v_fma_mix_f32 v26, v81, v34, v42 op_sel:[0,0,0] op_sel_hi:[1,0,0]
  v_mfma_f32_32x32x16_bf16 a[64:79], a[144:147], v[76:79], a[64:79]
  ds_read_b128 v[56:59], v2 offset:3776
  ds_read_b128 v[60:63], v2 offset:3792
  v_fma_mix_f32 v27, v81, v35, v43 op_sel:[1,0,0] op_sel_hi:[1,0,0]
  v_fma_mix_f32 v28, v82, v36, v44 op_sel:[0,0,0] op_sel_hi:[1,0,0]
  s_waitcnt lgkmcnt(8)
  v_mfma_f32_32x32x16_bf16 a[16:31], a[148:151], v[72:75], a[16:31]
  ds_read_b64_tr_b16 a[128:129], v20 offset:57344
  ds_read_b64_tr_b16 a[130:131], v20 offset:58368
  v_fma_mix_f32 v29, v82, v37, v45 op_sel:[1,0,0] op_sel_hi:[1,0,0]
  v_fma_mix_f32 v30, v83, v38, v46 op_sel:[0,0,0] op_sel_hi:[1,0,0]
  v_fma_mix_f32 v31, v83, v39, v47 op_sel:[1,0,0] op_sel_hi:[1,0,0]
  v_mfma_f32_32x32x16_bf16 a[80:95], a[148:151], v[76:79], a[80:95]
  ds_read_b64_tr_b16 a[132:133], v21 offset:57344
  ds_read_b64_tr_b16 a[134:135], v21 offset:58368
  v_cvt_pk_bf16_f32 v80, v24, v25
  v_cvt_pk_bf16_f32 v81, v26, v27
  v_cvt_pk_bf16_f32 v82, v28, v29
  s_waitcnt lgkmcnt(10)
  v_mfma_f32_32x32x16_bf16 a[32:47], a[152:155], v[72:75], a[32:47]
  ds_read_b64_tr_b16 a[136:137], v22 offset:57344
  ds_read_b64_tr_b16 a[138:139], v22 offset:58368
  v_cvt_pk_bf16_f32 v83, v30, v31
  v_fma_mix_f32 v24, v84, v32, v40 op_sel:[0,0,0] op_sel_hi:[1,0,0]
  v_mfma_f32_32x32x16_bf16 a[96:111], a[152:155], v[76:79], a[96:111]
  ds_read_b64_tr_b16 a[140:141], v23 offset:57344
  ds_read_b64_tr_b16 a[142:143], v23 offset:58368
  v_fma_mix_f32 v25, v84, v33, v41 op_sel:[1,0,0] op_sel_hi:[1,0,0]
  v_fma_mix_f32 v26, v85, v34, v42 op_sel:[0,0,0] op_sel_hi:[1,0,0]
  v_fma_mix_f32 v27, v85, v35, v43 op_sel:[1,0,0] op_sel_hi:[1,0,0]
  s_waitcnt lgkmcnt(12)
  v_mfma_f32_32x32x16_bf16 a[48:63], a[156:159], v[72:75], a[48:63]
  v_fma_mix_f32 v28, v86, v36, v44 op_sel:[0,0,0] op_sel_hi:[1,0,0]
  v_fma_mix_f32 v29, v86, v37, v45 op_sel:[1,0,0] op_sel_hi:[1,0,0]
  v_fma_mix_f32 v30, v87, v38, v46 op_sel:[0,0,0] op_sel_hi:[1,0,0]
  v_fma_mix_f32 v31, v87, v39, v47 op_sel:[1,0,0] op_sel_hi:[1,0,0]
  v_mfma_f32_32x32x16_bf16 a[112:127], a[156:159], v[76:79], a[112:127]
  v_cvt_pk_bf16_f32 v84, v24, v25
  v_cvt_pk_bf16_f32 v85, v26, v27
  v_cvt_pk_bf16_f32 v86, v28, v29
  v_cvt_pk_bf16_f32 v87, v30, v31
  s_waitcnt lgkmcnt(6)
  v_mfma_f32_32x32x16_bf16 a[0:15], a[128:131], v[80:83], a[0:15]
  s_waitcnt vmcnt(16)
  s_barrier
  v_add_u32 v20, 0xffff8000, v16
  v_add_u32 v21, 0xffff8000, v17
  v_add_u32 v22, 0xffff8000, v18
  v_add_u32 v23, 0xffff8000, v19
  v_fma_mix_f32 v24, v88, v48, v56 op_sel:[0,0,0] op_sel_hi:[1,0,0]
  v_mfma_f32_32x32x16_bf16 a[64:79], a[128:131], v[84:87], a[64:79]
  ds_read_b128 v[32:35], v2 offset:1792
  ds_read_b128 v[36:39], v2 offset:1808
  v_fma_mix_f32 v25, v88, v49, v57 op_sel:[1,0,0] op_sel_hi:[1,0,0]
  v_fma_mix_f32 v26, v89, v50, v58 op_sel:[0,0,0] op_sel_hi:[1,0,0]
  v_fma_mix_f32 v27, v89, v51, v59 op_sel:[1,0,0] op_sel_hi:[1,0,0]
  s_waitcnt lgkmcnt(6)
  v_mfma_f32_32x32x16_bf16 a[16:31], a[132:135], v[80:83], a[16:31]
  ds_read_b128 v[40:43], v2 offset:3840
  ds_read_b128 v[44:47], v2 offset:3856
  v_fma_mix_f32 v28, v90, v52, v60 op_sel:[0,0,0] op_sel_hi:[1,0,0]
  v_fma_mix_f32 v29, v90, v53, v61 op_sel:[1,0,0] op_sel_hi:[1,0,0]
  v_fma_mix_f32 v30, v91, v54, v62 op_sel:[0,0,0] op_sel_hi:[1,0,0]
  v_mfma_f32_32x32x16_bf16 a[80:95], a[132:135], v[84:87], a[80:95]
  ds_read_b64_tr_b16 a[144:145], v20 offset:0
  ds_read_b64_tr_b16 a[146:147], v20 offset:1024
  v_fma_mix_f32 v31, v91, v55, v63 op_sel:[1,0,0] op_sel_hi:[1,0,0]
  v_cvt_pk_bf16_f32 v88, v24, v25
  v_cvt_pk_bf16_f32 v89, v26, v27
  s_waitcnt lgkmcnt(8)
  v_mfma_f32_32x32x16_bf16 a[32:47], a[136:139], v[80:83], a[32:47]
  ds_read_b64_tr_b16 a[148:149], v21 offset:0
  ds_read_b64_tr_b16 a[150:151], v21 offset:1024
  v_cvt_pk_bf16_f32 v90, v28, v29
  v_cvt_pk_bf16_f32 v91, v30, v31
  v_fma_mix_f32 v24, v92, v48, v56 op_sel:[0,0,0] op_sel_hi:[1,0,0]
  v_mfma_f32_32x32x16_bf16 a[96:111], a[136:139], v[84:87], a[96:111]
  ds_read_b64_tr_b16 a[152:153], v22 offset:0
  ds_read_b64_tr_b16 a[154:155], v22 offset:1024
  v_fma_mix_f32 v25, v92, v49, v57 op_sel:[1,0,0] op_sel_hi:[1,0,0]
  v_fma_mix_f32 v26, v93, v50, v58 op_sel:[0,0,0] op_sel_hi:[1,0,0]
  v_fma_mix_f32 v27, v93, v51, v59 op_sel:[1,0,0] op_sel_hi:[1,0,0]
  s_waitcnt lgkmcnt(10)
  v_mfma_f32_32x32x16_bf16 a[48:63], a[140:143], v[80:83], a[48:63]
  ds_read_b64_tr_b16 a[156:157], v23 offset:0
  ds_read_b64_tr_b16 a[158:159], v23 offset:1024
  v_fma_mix_f32 v28, v94, v52, v60 op_sel:[0,0,0] op_sel_hi:[1,0,0]
  v_fma_mix_f32 v29, v94, v53, v61 op_sel:[1,0,0] op_sel_hi:[1,0,0]
  v_fma_mix_f32 v30, v95, v54, v62 op_sel:[0,0,0] op_sel_hi:[1,0,0]
  v_mfma_f32_32x32x16_bf16 a[112:127], a[140:143], v[84:87], a[112:127]
  v_fma_mix_f32 v31, v95, v55, v63 op_sel:[1,0,0] op_sel_hi:[1,0,0]
  v_cvt_pk_bf16_f32 v92, v24, v25
  v_cvt_pk_bf16_f32 v93, v26, v27
  v_cvt_pk_bf16_f32 v94, v28, v29
  v_cvt_pk_bf16_f32 v95, v30, v31
  s_waitcnt lgkmcnt(6)
  v_mfma_f32_32x32x16_bf16 a[0:15], a[144:147], v[88:91], a[0:15]
  ds_read_b128 v[48:51], v2 offset:1856
  ds_read_b128 v[52:55], v2 offset:1872
  v_fma_mix_f32 v24, v96, v32, v40 op_sel:[0,0,0] op_sel_hi:[1,0,0]
  v_fma_mix_f32 v25, v96, v33, v41 op_sel:[1,0,0] op_sel_hi:[1,0,0]
  v_fma_mix_f32 v26, v97, v34, v42 op_sel:[0,0,0] op_sel_hi:[1,0,0]
  v_mfma_f32_32x32x16_bf16 a[64:79], a[144:147], v[92:95], a[64:79]
  ds_read_b128 v[56:59], v2 offset:3904
  ds_read_b128 v[60:63], v2 offset:3920
  v_fma_mix_f32 v27, v97, v35, v43 op_sel:[1,0,0] op_sel_hi:[1,0,0]
  v_fma_mix_f32 v28, v98, v36, v44 op_sel:[0,0,0] op_sel_hi:[1,0,0]
  s_waitcnt lgkmcnt(8)
  v_mfma_f32_32x32x16_bf16 a[16:31], a[148:151], v[88:91], a[16:31]
  ds_read_b64_tr_b16 a[128:129], v20 offset:4096
  ds_read_b64_tr_b16 a[130:131], v20 offset:5120
  v_fma_mix_f32 v29, v98, v37, v45 op_sel:[1,0,0] op_sel_hi:[1,0,0]
  v_fma_mix_f32 v30, v99, v38, v46 op_sel:[0,0,0] op_sel_hi:[1,0,0]
  v_fma_mix_f32 v31, v99, v39, v47 op_sel:[1,0,0] op_sel_hi:[1,0,0]
  v_mfma_f32_32x32x16_bf16 a[80:95], a[148:151], v[92:95], a[80:95]
  ds_read_b64_tr_b16 a[132:133], v21 offset:4096
  ds_read_b64_tr_b16 a[134:135], v21 offset:5120
  v_cvt_pk_bf16_f32 v96, v24, v25
  v_cvt_pk_bf16_f32 v97, v26, v27
  v_cvt_pk_bf16_f32 v98, v28, v29
  s_waitcnt lgkmcnt(10)
  v_mfma_f32_32x32x16_bf16 a[32:47], a[152:155], v[88:91], a[32:47]
  ds_read_b64_tr_b16 a[136:137], v22 offset:4096
  ds_read_b64_tr_b16 a[138:139], v22 offset:5120
  v_cvt_pk_bf16_f32 v99, v30, v31
  v_fma_mix_f32 v24, v100, v32, v40 op_sel:[0,0,0] op_sel_hi:[1,0,0]
  v_mfma_f32_32x32x16_bf16 a[96:111], a[152:155], v[92:95], a[96:111]
  ds_read_b64_tr_b16 a[140:141], v23 offset:4096
  ds_read_b64_tr_b16 a[142:143], v23 offset:5120
  v_fma_mix_f32 v25, v100, v33, v41 op_sel:[1,0,0] op_sel_hi:[1,0,0]
  v_fma_mix_f32 v26, v101, v34, v42 op_sel:[0,0,0] op_sel_hi:[1,0,0]
  v_fma_mix_f32 v27, v101, v35, v43 op_sel:[1,0,0] op_sel_hi:[1,0,0]
  s_waitcnt lgkmcnt(12)
  v_mfma_f32_32x32x16_bf16 a[48:63], a[156:159], v[88:91], a[48:63]
  v_fma_mix_f32 v28, v102, v36, v44 op_sel:[0,0,0] op_sel_hi:[1,0,0]
  v_fma_mix_f32 v29, v102, v37, v45 op_sel:[1,0,0] op_sel_hi:[1,0,0]
  v_fma_mix_f32 v30, v103, v38, v46 op_sel:[0,0,0] op_sel_hi:[1,0,0]
  v_fma_mix_f32 v31, v103, v39, v47 op_sel:[1,0,0] op_sel_hi:[1,0,0]
  v_mfma_f32_32x32x16_bf16 a[112:127], a[156:159], v[92:95], a[112:127]
  v_cvt_pk_bf16_f32 v100, v24, v25
  v_cvt_pk_bf16_f32 v101, v26, v27
  v_cvt_pk_bf16_f32 v102, v28, v29
  v_cvt_pk_bf16_f32 v103, v30, v31
  s_waitcnt lgkmcnt(6)
  v_mfma_f32_32x32x16_bf16 a[0:15], a[128:131], v[96:99], a[0:15]
  s_waitcnt vmcnt(8)
  s_barrier
  v_fma_mix_f32 v24, v104, v48, v56 op_sel:[0,0,0] op_sel_hi:[1,0,0]
  v_mfma_f32_32x32x16_bf16 a[64:79], a[128:131], v[100:103], a[64:79]
  ds_read_b128 v[32:35], v2 offset:1920
  ds_read_b128 v[36:39], v2 offset:1936
  v_fma_mix_f32 v25, v104, v49, v57 op_sel:[1,0,0] op_sel_hi:[1,0,0]
  v_fma_mix_f32 v26, v105, v50, v58 op_sel:[0,0,0] op_sel_hi:[1,0,0]
  v_fma_mix_f32 v27, v105, v51, v59 op_sel:[1,0,0] op_sel_hi:[1,0,0]
  s_waitcnt lgkmcnt(6)
  v_mfma_f32_32x32x16_bf16 a[16:31], a[132:135], v[96:99], a[16:31]
  ds_read_b128 v[40:43], v2 offset:3968
  ds_read_b128 v[44:47], v2 offset:3984
  v_fma_mix_f32 v28, v106, v52, v60 op_sel:[0,0,0] op_sel_hi:[1,0,0]
  v_fma_mix_f32 v29, v106, v53, v61 op_sel:[1,0,0] op_sel_hi:[1,0,0]
  v_fma_mix_f32 v30, v107, v54, v62 op_sel:[0,0,0] op_sel_hi:[1,0,0]
  v_mfma_f32_32x32x16_bf16 a[80:95], a[132:135], v[100:103], a[80:95]
  ds_read_b64_tr_b16 a[144:145], v20 offset:8192
  ds_read_b64_tr_b16 a[146:147], v20 offset:9216
  v_fma_mix_f32 v31, v107, v55, v63 op_sel:[1,0,0] op_sel_hi:[1,0,0]
  v_cvt_pk_bf16_f32 v104, v24, v25
  v_cvt_pk_bf16_f32 v105, v26, v27
  s_waitcnt lgkmcnt(8)
  v_mfma_f32_32x32x16_bf16 a[32:47], a[136:139], v[96:99], a[32:47]
  ds_read_b64_tr_b16 a[148:149], v21 offset:8192
  ds_read_b64_tr_b16 a[150:151], v21 offset:9216
  v_cvt_pk_bf16_f32 v106, v28, v29
  v_cvt_pk_bf16_f32 v107, v30, v31
  v_fma_mix_f32 v24, v108, v48, v56 op_sel:[0,0,0] op_sel_hi:[1,0,0]
  v_mfma_f32_32x32x16_bf16 a[96:111], a[136:139], v[100:103], a[96:111]
  ds_read_b64_tr_b16 a[152:153], v22 offset:8192
  ds_read_b64_tr_b16 a[154:155], v22 offset:9216
  v_fma_mix_f32 v25, v108, v49, v57 op_sel:[1,0,0] op_sel_hi:[1,0,0]
  v_fma_mix_f32 v26, v109, v50, v58 op_sel:[0,0,0] op_sel_hi:[1,0,0]
  v_fma_mix_f32 v27, v109, v51, v59 op_sel:[1,0,0] op_sel_hi:[1,0,0]
  s_waitcnt lgkmcnt(10)
  v_mfma_f32_32x32x16_bf16 a[48:63], a[140:143], v[96:99], a[48:63]
  ds_read_b64_tr_b16 a[156:157], v23 offset:8192
  ds_read_b64_tr_b16 a[158:159], v23 offset:9216
  v_fma_mix_f32 v28, v110, v52, v60 op_sel:[0,0,0] op_sel_hi:[1,0,0]
  v_fma_mix_f32 v29, v110, v53, v61 op_sel:[1,0,0] op_sel_hi:[1,0,0]
  v_fma_mix_f32 v30, v111, v54, v62 op_sel:[0,0,0] op_sel_hi:[1,0,0]
  v_mfma_f32_32x32x16_bf16 a[112:127], a[140:143], v[100:103], a[112:127]
  v_fma_mix_f32 v31, v111, v55, v63 op_sel:[1,0,0] op_sel_hi:[1,0,0]
  v_cvt_pk_bf16_f32 v108, v24, v25
  v_cvt_pk_bf16_f32 v109, v26, v27
  v_cvt_pk_bf16_f32 v110, v28, v29
  v_cvt_pk_bf16_f32 v111, v30, v31
  s_waitcnt lgkmcnt(6)
  v_mfma_f32_32x32x16_bf16 a[0:15], a[144:147], v[104:107], a[0:15]
  ds_read_b128 v[48:51], v2 offset:1984
  ds_read_b128 v[52:55], v2 offset:2000
  v_fma_mix_f32 v24, v112, v32, v40 op_sel:[0,0,0] op_sel_hi:[1,0,0]
  v_fma_mix_f32 v25, v112, v33, v41 op_sel:[1,0,0] op_sel_hi:[1,0,0]
  v_fma_mix_f32 v26, v113, v34, v42 op_sel:[0,0,0] op_sel_hi:[1,0,0]
  v_mfma_f32_32x32x16_bf16 a[64:79], a[144:147], v[108:111], a[64:79]
  ds_read_b128 v[56:59], v2 offset:4032
  ds_read_b128 v[60:63], v2 offset:4048
  v_fma_mix_f32 v27, v113, v35, v43 op_sel:[1,0,0] op_sel_hi:[1,0,0]
  v_fma_mix_f32 v28, v114, v36, v44 op_sel:[0,0,0] op_sel_hi:[1,0,0]
  s_waitcnt lgkmcnt(8)
  v_mfma_f32_32x32x16_bf16 a[16:31], a[148:151], v[104:107], a[16:31]
  ds_read_b64_tr_b16 a[128:129], v20 offset:12288
  ds_read_b64_tr_b16 a[130:131], v20 offset:13312
  v_fma_mix_f32 v29, v114, v37, v45 op_sel:[1,0,0] op_sel_hi:[1,0,0]
  v_fma_mix_f32 v30, v115, v38, v46 op_sel:[0,0,0] op_sel_hi:[1,0,0]
  v_fma_mix_f32 v31, v115, v39, v47 op_sel:[1,0,0] op_sel_hi:[1,0,0]
  v_mfma_f32_32x32x16_bf16 a[80:95], a[148:151], v[108:111], a[80:95]
  ds_read_b64_tr_b16 a[132:133], v21 offset:12288
  ds_read_b64_tr_b16 a[134:135], v21 offset:13312
  v_cvt_pk_bf16_f32 v112, v24, v25
  v_cvt_pk_bf16_f32 v113, v26, v27
  v_cvt_pk_bf16_f32 v114, v28, v29
  s_waitcnt lgkmcnt(10)
  v_mfma_f32_32x32x16_bf16 a[32:47], a[152:155], v[104:107], a[32:47]
  ds_read_b64_tr_b16 a[136:137], v22 offset:12288
  ds_read_b64_tr_b16 a[138:139], v22 offset:13312
  v_cvt_pk_bf16_f32 v115, v30, v31
  v_fma_mix_f32 v24, v116, v32, v40 op_sel:[0,0,0] op_sel_hi:[1,0,0]
  v_mfma_f32_32x32x16_bf16 a[96:111], a[152:155], v[108:111], a[96:111]
  ds_read_b64_tr_b16 a[140:141], v23 offset:12288
  ds_read_b64_tr_b16 a[142:143], v23 offset:13312
  v_fma_mix_f32 v25, v116, v33, v41 op_sel:[1,0,0] op_sel_hi:[1,0,0]
  v_fma_mix_f32 v26, v117, v34, v42 op_sel:[0,0,0] op_sel_hi:[1,0,0]
  v_fma_mix_f32 v27, v117, v35, v43 op_sel:[1,0,0] op_sel_hi:[1,0,0]
  s_waitcnt lgkmcnt(12)
  v_mfma_f32_32x32x16_bf16 a[48:63], a[156:159], v[104:107], a[48:63]
  v_fma_mix_f32 v28, v118, v36, v44 op_sel:[0,0,0] op_sel_hi:[1,0,0]
  v_fma_mix_f32 v29, v118, v37, v45 op_sel:[1,0,0] op_sel_hi:[1,0,0]
  v_fma_mix_f32 v30, v119, v38, v46 op_sel:[0,0,0] op_sel_hi:[1,0,0]
  v_fma_mix_f32 v31, v119, v39, v47 op_sel:[1,0,0] op_sel_hi:[1,0,0]
  v_mfma_f32_32x32x16_bf16 a[112:127], a[156:159], v[108:111], a[112:127]
  v_cvt_pk_bf16_f32 v116, v24, v25
  v_cvt_pk_bf16_f32 v117, v26, v27
  v_cvt_pk_bf16_f32 v118, v28, v29
  v_cvt_pk_bf16_f32 v119, v30, v31
  s_waitcnt lgkmcnt(6)
  v_mfma_f32_32x32x16_bf16 a[0:15], a[128:131], v[112:115], a[0:15]
  v_fma_mix_f32 v24, v120, v48, v56 op_sel:[0,0,0] op_sel_hi:[1,0,0]
  v_mfma_f32_32x32x16_bf16 a[64:79], a[128:131], v[116:119], a[64:79]
  ds_read_b64_tr_b16 a[144:145], v20 offset:16384
  ds_read_b64_tr_b16 a[146:147], v20 offset:17408
  v_fma_mix_f32 v25, v120, v49, v57 op_sel:[1,0,0] op_sel_hi:[1,0,0]
  v_fma_mix_f32 v26, v121, v50, v58 op_sel:[0,0,0] op_sel_hi:[1,0,0]
  s_waitcnt lgkmcnt(6)
  v_mfma_f32_32x32x16_bf16 a[16:31], a[132:135], v[112:115], a[16:31]
  ds_read_b64_tr_b16 a[148:149], v21 offset:16384
  ds_read_b64_tr_b16 a[150:151], v21 offset:17408
  v_fma_mix_f32 v27, v121, v51, v59 op_sel:[1,0,0] op_sel_hi:[1,0,0]
  v_fma_mix_f32 v28, v122, v52, v60 op_sel:[0,0,0] op_sel_hi:[1,0,0]
  v_fma_mix_f32 v29, v122, v53, v61 op_sel:[1,0,0] op_sel_hi:[1,0,0]
  v_mfma_f32_32x32x16_bf16 a[80:95], a[132:135], v[116:119], a[80:95]
  ds_read_b64_tr_b16 a[152:153], v22 offset:16384
  ds_read_b64_tr_b16 a[154:155], v22 offset:17408
  v_fma_mix_f32 v30, v123, v54, v62 op_sel:[0,0,0] op_sel_hi:[1,0,0]
  v_fma_mix_f32 v31, v123, v55, v63 op_sel:[1,0,0] op_sel_hi:[1,0,0]
  v_cvt_pk_bf16_f32 v120, v24, v25
  s_waitcnt lgkmcnt(8)
  v_mfma_f32_32x32x16_bf16 a[32:47], a[136:139], v[112:115], a[32:47]
  ds_read_b64_tr_b16 a[156:157], v23 offset:16384
  ds_read_b64_tr_b16 a[158:159], v23 offset:17408
  v_cvt_pk_bf16_f32 v121, v26, v27
  v_cvt_pk_bf16_f32 v122, v28, v29
  v_cvt_pk_bf16_f32 v123, v30, v31
  v_mfma_f32_32x32x16_bf16 a[96:111], a[136:139], v[116:119], a[96:111]
  v_fma_mix_f32 v24, v124, v48, v56 op_sel:[0,0,0] op_sel_hi:[1,0,0]
  v_fma_mix_f32 v25, v124, v49, v57 op_sel:[1,0,0] op_sel_hi:[1,0,0]
  v_fma_mix_f32 v26, v125, v50, v58 op_sel:[0,0,0] op_sel_hi:[1,0,0]
  v_fma_mix_f32 v27, v125, v51, v59 op_sel:[1,0,0] op_sel_hi:[1,0,0]
  s_waitcnt lgkmcnt(8)
  v_mfma_f32_32x32x16_bf16 a[48:63], a[140:143], v[112:115], a[48:63]
  v_fma_mix_f32 v28, v126, v52, v60 op_sel:[0,0,0] op_sel_hi:[1,0,0]
  v_fma_mix_f32 v29, v126, v53, v61 op_sel:[1,0,0] op_sel_hi:[1,0,0]
  v_fma_mix_f32 v30, v127, v54, v62 op_sel:[0,0,0] op_sel_hi:[1,0,0]
  v_fma_mix_f32 v31, v127, v55, v63 op_sel:[1,0,0] op_sel_hi:[1,0,0]
  v_mfma_f32_32x32x16_bf16 a[112:127], a[140:143], v[116:119], a[112:127]
  v_cvt_pk_bf16_f32 v124, v24, v25
  v_cvt_pk_bf16_f32 v125, v26, v27
  v_cvt_pk_bf16_f32 v126, v28, v29
  v_cvt_pk_bf16_f32 v127, v30, v31
  s_waitcnt lgkmcnt(6)
  v_mfma_f32_32x32x16_bf16 a[0:15], a[144:147], v[120:123], a[0:15]
  s_waitcnt lgkmcnt(4)
  v_mfma_f32_32x32x16_bf16 a[16:31], a[148:151], v[120:123], a[16:31]
  s_waitcnt lgkmcnt(2)
  v_mfma_f32_32x32x16_bf16 a[32:47], a[152:155], v[120:123], a[32:47]
  s_waitcnt lgkmcnt(0)
  v_mfma_f32_32x32x16_bf16 a[48:63], a[156:159], v[120:123], a[48:63]
  v_mfma_f32_32x32x16_bf16 a[64:79], a[144:147], v[124:127], a[64:79]
  v_mfma_f32_32x32x16_bf16 a[80:95], a[148:151], v[124:127], a[80:95]
  v_mfma_f32_32x32x16_bf16 a[96:111], a[152:155], v[124:127], a[96:111]
  v_mfma_f32_32x32x16_bf16 a[112:127], a[156:159], v[124:127], a[112:127]
  ds_read_b128 a[128:131], v8 offset:0
  ds_read_b128 a[132:135], v9 offset:0
  ds_read_b128 a[136:139], v10 offset:0
  ds_read_b128 a[140:143], v11 offset:0
  ds_read_b128 a[144:147], v12 offset:0
  ds_read_b128 a[148:151], v13 offset:0
  ds_read_b128 a[152:155], v14 offset:0
  ds_read_b128 a[156:159], v15 offset:0
  v_accvgpr_read_b32 v32, a0
  v_accvgpr_read_b32 v33, a1
  v_accvgpr_read_b32 v34, a2
  v_accvgpr_read_b32 v35, a3
  v_accvgpr_read_b32 v36, a4
  v_accvgpr_read_b32 v37, a5
  v_accvgpr_read_b32 v38, a6
  v_accvgpr_read_b32 v39, a7
  v_cvt_pk_bf16_f32 v192, v32, v33
  v_cvt_pk_bf16_f32 v193, v34, v35
  v_cvt_pk_bf16_f32 v194, v36, v37
  v_cvt_pk_bf16_f32 v195, v38, v39
  v_accvgpr_read_b32 v40, a8
  v_accvgpr_read_b32 v41, a9
  v_accvgpr_read_b32 v42, a10
  v_accvgpr_read_b32 v43, a11
  v_accvgpr_read_b32 v44, a12
  v_accvgpr_read_b32 v45, a13
  v_accvgpr_read_b32 v46, a14
  v_accvgpr_read_b32 v47, a15
  v_cvt_pk_bf16_f32 v196, v40, v41
  v_cvt_pk_bf16_f32 v197, v42, v43
  v_cvt_pk_bf16_f32 v198, v44, v45
  v_cvt_pk_bf16_f32 v199, v46, v47
  v_accvgpr_read_b32 v32, a16
  v_accvgpr_read_b32 v33, a17
  v_accvgpr_read_b32 v34, a18
  v_accvgpr_read_b32 v35, a19
  v_accvgpr_read_b32 v36, a20
  v_accvgpr_read_b32 v37, a21
  v_accvgpr_read_b32 v38, a22
  v_accvgpr_read_b32 v39, a23
  v_cvt_pk_bf16_f32 v200, v32, v33
  v_cvt_pk_bf16_f32 v201, v34, v35
  v_cvt_pk_bf16_f32 v202, v36, v37
  v_cvt_pk_bf16_f32 v203, v38, v39
  v_accvgpr_read_b32 v40, a24
  v_accvgpr_read_b32 v41, a25
  v_accvgpr_read_b32 v42, a26
  v_accvgpr_read_b32 v43, a27
  v_accvgpr_read_b32 v44, a28
  v_accvgpr_read_b32 v45, a29
  v_accvgpr_read_b32 v46, a30
  v_accvgpr_read_b32 v47, a31
  v_cvt_pk_bf16_f32 v204, v40, v41
  v_cvt_pk_bf16_f32 v205, v42, v43
  v_cvt_pk_bf16_f32 v206, v44, v45
  v_cvt_pk_bf16_f32 v207, v46, v47
  v_accvgpr_read_b32 v32, a32
  v_accvgpr_read_b32 v33, a33
  v_accvgpr_read_b32 v34, a34
  v_accvgpr_read_b32 v35, a35
  v_accvgpr_read_b32 v36, a36
  v_accvgpr_read_b32 v37, a37
  v_accvgpr_read_b32 v38, a38
  v_accvgpr_read_b32 v39, a39
  v_cvt_pk_bf16_f32 v208, v32, v33
  v_cvt_pk_bf16_f32 v209, v34, v35
  v_cvt_pk_bf16_f32 v210, v36, v37
  v_cvt_pk_bf16_f32 v211, v38, v39
  v_accvgpr_read_b32 v40, a40
  v_accvgpr_read_b32 v41, a41
  v_accvgpr_read_b32 v42, a42
  v_accvgpr_read_b32 v43, a43
  v_accvgpr_read_b32 v44, a44
  v_accvgpr_read_b32 v45, a45
  v_accvgpr_read_b32 v46, a46
  v_accvgpr_read_b32 v47, a47
  v_cvt_pk_bf16_f32 v212, v40, v41
  v_cvt_pk_bf16_f32 v213, v42, v43
  v_cvt_pk_bf16_f32 v214, v44, v45
  v_cvt_pk_bf16_f32 v215, v46, v47
  v_accvgpr_read_b32 v32, a48
  v_accvgpr_read_b32 v33, a49
  v_accvgpr_read_b32 v34, a50
  v_accvgpr_read_b32 v35, a51
  v_accvgpr_read_b32 v36, a52
  v_accvgpr_read_b32 v37, a53
  v_accvgpr_read_b32 v38, a54
  v_accvgpr_read_b32 v39, a55
  v_cvt_pk_bf16_f32 v216, v32, v33
  v_cvt_pk_bf16_f32 v217, v34, v35
  v_cvt_pk_bf16_f32 v218, v36, v37
  v_cvt_pk_bf16_f32 v219, v38, v39
  v_accvgpr_read_b32 v40, a56
  v_accvgpr_read_b32 v41, a57
  v_accvgpr_read_b32 v42, a58
  v_accvgpr_read_b32 v43, a59
  v_accvgpr_read_b32 v44, a60
  v_accvgpr_read_b32 v45, a61
  v_accvgpr_read_b32 v46, a62
  v_accvgpr_read_b32 v47, a63
  v_cvt_pk_bf16_f32 v220, v40, v41
  v_cvt_pk_bf16_f32 v221, v42, v43
  v_cvt_pk_bf16_f32 v222, v44, v45
  v_cvt_pk_bf16_f32 v223, v46, v47
  s_waitcnt lgkmcnt(0)
  v_mfma_f32_32x32x16_bf16 v[64:79], a[128:131], v[192:195], 0
  v_accvgpr_read_b32 v32, a64
  v_accvgpr_read_b32 v33, a65
  v_accvgpr_read_b32 v34, a66
  v_accvgpr_read_b32 v35, a67
  v_accvgpr_read_b32 v36, a68
  v_accvgpr_read_b32 v37, a69
  v_accvgpr_read_b32 v38, a70
  v_accvgpr_read_b32 v39, a71
  v_cvt_pk_bf16_f32 v224, v32, v33
  v_cvt_pk_bf16_f32 v225, v34, v35
  v_cvt_pk_bf16_f32 v226, v36, v37
  v_cvt_pk_bf16_f32 v227, v38, v39
  v_mfma_f32_32x32x16_bf16 v[64:79], a[132:135], v[196:199], v[64:79]
  v_accvgpr_read_b32 v40, a72
  v_accvgpr_read_b32 v41, a73
  v_accvgpr_read_b32 v42, a74
  v_accvgpr_read_b32 v43, a75
  v_accvgpr_read_b32 v44, a76
  v_accvgpr_read_b32 v45, a77
  v_accvgpr_read_b32 v46, a78
  v_accvgpr_read_b32 v47, a79
  v_cvt_pk_bf16_f32 v228, v40, v41
  v_cvt_pk_bf16_f32 v229, v42, v43
  v_cvt_pk_bf16_f32 v230, v44, v45
  v_cvt_pk_bf16_f32 v231, v46, v47
  v_mfma_f32_32x32x16_bf16 v[64:79], a[136:139], v[200:203], v[64:79]
  v_accvgpr_read_b32 v32, a80
  v_accvgpr_read_b32 v33, a81
  v_accvgpr_read_b32 v34, a82
  v_accvgpr_read_b32 v35, a83
  v_accvgpr_read_b32 v36, a84
  v_accvgpr_read_b32 v37, a85
  v_accvgpr_read_b32 v38, a86
  v_accvgpr_read_b32 v39, a87
  v_cvt_pk_bf16_f32 v232, v32, v33
  v_cvt_pk_bf16_f32 v233, v34, v35
  v_cvt_pk_bf16_f32 v234, v36, v37
  v_cvt_pk_bf16_f32 v235, v38, v39
  v_mfma_f32_32x32x16_bf16 v[64:79], a[140:143], v[204:207], v[64:79]
  v_accvgpr_read_b32 v40, a88
  v_accvgpr_read_b32 v41, a89
  v_accvgpr_read_b32 v42, a90
  v_accvgpr_read_b32 v43, a91
  v_accvgpr_read_b32 v44, a92
  v_accvgpr_read_b32 v45, a93
  v_accvgpr_read_b32 v46, a94
  v_accvgpr_read_b32 v47, a95
  v_cvt_pk_bf16_f32 v236, v40, v41
  v_cvt_pk_bf16_f32 v237, v42, v43
  v_cvt_pk_bf16_f32 v238, v44, v45
  v_cvt_pk_bf16_f32 v239, v46, v47
  v_mfma_f32_32x32x16_bf16 v[64:79], a[144:147], v[208:211], v[64:79]
  v_accvgpr_read_b32 v32, a96
  v_accvgpr_read_b32 v33, a97
  v_accvgpr_read_b32 v34, a98
  v_accvgpr_read_b32 v35, a99
  v_accvgpr_read_b32 v36, a100
  v_accvgpr_read_b32 v37, a101
  v_accvgpr_read_b32 v38, a102
  v_accvgpr_read_b32 v39, a103
  v_cvt_pk_bf16_f32 v240, v32, v33
  v_cvt_pk_bf16_f32 v241, v34, v35
  v_cvt_pk_bf16_f32 v242, v36, v37
  v_cvt_pk_bf16_f32 v243, v38, v39
  v_mfma_f32_32x32x16_bf16 v[64:79], a[148:151], v[212:215], v[64:79]
  v_accvgpr_read_b32 v40, a104
  v_accvgpr_read_b32 v41, a105
  v_accvgpr_read_b32 v42, a106
  v_accvgpr_read_b32 v43, a107
  v_accvgpr_read_b32 v44, a108
  v_accvgpr_read_b32 v45, a109
  v_accvgpr_read_b32 v46, a110
  v_accvgpr_read_b32 v47, a111
  v_cvt_pk_bf16_f32 v244, v40, v41
  v_cvt_pk_bf16_f32 v245, v42, v43
  v_cvt_pk_bf16_f32 v246, v44, v45
  v_cvt_pk_bf16_f32 v247, v46, v47
  v_mfma_f32_32x32x16_bf16 v[64:79], a[152:155], v[216:219], v[64:79]
  v_accvgpr_read_b32 v32, a112
  v_accvgpr_read_b32 v33, a113
  v_accvgpr_read_b32 v34, a114
  v_accvgpr_read_b32 v35, a115
  v_accvgpr_read_b32 v36, a116
  v_accvgpr_read_b32 v37, a117
  v_accvgpr_read_b32 v38, a118
  v_accvgpr_read_b32 v39, a119
  v_cvt_pk_bf16_f32 v248, v32, v33
  v_cvt_pk_bf16_f32 v249, v34, v35
  v_cvt_pk_bf16_f32 v250, v36, v37
  v_cvt_pk_bf16_f32 v251, v38, v39
  v_mfma_f32_32x32x16_bf16 v[64:79], a[156:159], v[220:223], v[64:79]
  v_accvgpr_read_b32 v40, a120
  v_accvgpr_read_b32 v41, a121
  v_accvgpr_read_b32 v42, a122
  v_accvgpr_read_b32 v43, a123
  v_accvgpr_read_b32 v44, a124
  v_accvgpr_read_b32 v45, a125
  v_accvgpr_read_b32 v46, a126
  v_accvgpr_read_b32 v47, a127
  v_cvt_pk_bf16_f32 v252, v40, v41
  v_cvt_pk_bf16_f32 v253, v42, v43
  v_cvt_pk_bf16_f32 v254, v44, v45
  v_cvt_pk_bf16_f32 v255, v46, v47
  s_nop 0
  v_mfma_f32_32x32x16_bf16 v[80:95], a[128:131], v[224:227], 0
  s_nop 2
  v_mfma_f32_32x32x16_bf16 v[80:95], a[132:135], v[228:231], v[80:95]
  ds_read_b128 a[128:131], v8 offset:8192
  s_nop 2
  v_mfma_f32_32x32x16_bf16 v[80:95], a[136:139], v[232:235], v[80:95]
  ds_read_b128 a[132:135], v9 offset:8192
  s_nop 2
  v_mfma_f32_32x32x16_bf16 v[80:95], a[140:143], v[236:239], v[80:95]
  ds_read_b128 a[136:139], v10 offset:8192
  v_max3_f32 v26, v64, v65, v66
  v_max3_f32 v27, v67, v68, v69
  v_max3_f32 v26, v26, v70, v71
  v_max3_f32 v27, v27, v72, v73
  v_max3_f32 v26, v26, v74, v75
  v_max3_f32 v27, v27, v76, v77
  v_max3_f32 v26, v26, v78, v79
  v_max_f32 v26, v26, v27
  v_mov_b32 v27, v26
  v_mfma_f32_32x32x16_bf16 v[80:95], a[144:147], v[240:243], v[80:95]
  ds_read_b128 a[140:143], v11 offset:8192
  s_nop 1
  v_permlane32_swap_b32 v26, v27
  v_max_f32 v26, v26, v27
  v_sub_f32 v26, 0xc2cc0000, v26
  v_mov_b32 v160, v26
  v_mov_b32 v161, v26
  v_mov_b32 v162, v26
  v_mov_b32 v163, v26
  v_mov_b32 v164, v26
  v_mfma_f32_32x32x16_bf16 v[80:95], a[148:151], v[244:247], v[80:95]
  ds_read_b128 a[144:147], v12 offset:8192
  v_mov_b32 v165, v26
  v_mov_b32 v166, v26
  v_mov_b32 v167, v26
  v_mov_b32 v168, v26
  v_mov_b32 v169, v26
  v_mov_b32 v170, v26
  v_mov_b32 v171, v26
  v_mov_b32 v172, v26
  v_mov_b32 v173, v26
  v_mov_b32 v174, v26
  v_mfma_f32_32x32x16_bf16 v[80:95], a[152:155], v[248:251], v[80:95]
  ds_read_b128 a[148:151], v13 offset:8192
  v_mov_b32 v175, v26
  v_add_f32 v64, v64, v26
  v_add_f32 v65, v65, v26
  v_add_f32 v66, v66, v26
  v_add_f32 v67, v67, v26
  v_add_f32 v68, v68, v26
  v_add_f32 v69, v69, v26
  v_add_f32 v70, v70, v26
  v_add_f32 v71, v71, v26
  v_mfma_f32_32x32x16_bf16 v[80:95], a[156:159], v[252:255], v[80:95]
  ds_read_b128 a[152:155], v14 offset:8192
  v_add_f32 v72, v72, v26
  v_add_f32 v73, v73, v26
  v_add_f32 v74, v74, v26
  v_add_f32 v75, v75, v26
  v_add_f32 v76, v76, v26
  v_add_f32 v77, v77, v26
  v_add_f32 v78, v78, v26
  v_add_f32 v79, v79, v26
  v_mov_b32 v20, 0
  ds_read_b128 a[156:159], v15 offset:8192
  v_exp_f32 v32, v64
  v_exp_f32 v33, v65
  v_exp_f32 v34, v66
  v_add_f32 v22, v32, v33
  v_exp_f32 v35, v67
  v_cvt_pk_bf16_f32 v128, v32, v33
  v_exp_f32 v36, v68
  v_add_f32 v22, v22, v34
  v_exp_f32 v37, v69
  v_add_f32 v22, v22, v35
  v_cvt_pk_bf16_f32 v129, v34, v35
  v_exp_f32 v38, v70
  v_add_f32 v22, v22, v36
  v_exp_f32 v39, v71
  v_add_f32 v22, v22, v37
  v_cvt_pk_bf16_f32 v130, v36, v37
  v_exp_f32 v32, v72
  v_add_f32 v22, v22, v38
  v_exp_f32 v33, v73
  v_add_f32 v22, v22, v39
  v_cvt_pk_bf16_f32 v131, v38, v39
  v_exp_f32 v34, v74
  v_add_f32 v22, v22, v32
  v_exp_f32 v35, v75
  v_add_f32 v22, v22, v33
  v_cvt_pk_bf16_f32 v132, v32, v33
  v_exp_f32 v36, v76
  v_add_f32 v22, v22, v34
  v_exp_f32 v37, v77
  v_add_f32 v22, v22, v35
  v_cvt_pk_bf16_f32 v133, v34, v35
  v_exp_f32 v38, v78
  v_add_f32 v22, v22, v36
  v_exp_f32 v39, v79
  v_add_f32 v22, v22, v37
  v_cvt_pk_bf16_f32 v134, v36, v37
  v_add_f32 v22, v22, v38
  v_add_f32 v22, v22, v39
  v_cvt_pk_bf16_f32 v135, v38, v39
  v_max3_f32 v28, v80, v81, v82
  v_max3_f32 v29, v83, v84, v85
  v_max3_f32 v28, v28, v86, v87
  v_max3_f32 v29, v29, v88, v89
  v_max3_f32 v28, v28, v90, v91
  v_max3_f32 v29, v29, v92, v93
  v_max3_f32 v28, v28, v94, v95
  v_max_f32 v28, v28, v29
  v_mov_b32 v29, v28
  s_nop 1
  v_permlane32_swap_b32 v28, v29
  v_max_f32 v28, v28, v29
  v_sub_f32 v28, 0xc2cc0000, v28
  v_mov_b32 v176, v28
  v_mov_b32 v177, v28
  v_mov_b32 v178, v28
  v_mov_b32 v179, v28
  v_mov_b32 v180, v28
  v_mov_b32 v181, v28
  v_mov_b32 v182, v28
  v_mov_b32 v183, v28
  v_mov_b32 v184, v28
  v_mov_b32 v185, v28
  v_mov_b32 v186, v28
  v_mov_b32 v187, v28
  v_mov_b32 v188, v28
  v_mov_b32 v189, v28
  v_mov_b32 v190, v28
  v_mov_b32 v191, v28
  v_add_f32 v80, v80, v28
  v_add_f32 v81, v81, v28
  v_add_f32 v82, v82, v28
  v_add_f32 v83, v83, v28
  v_add_f32 v84, v84, v28
  v_add_f32 v85, v85, v28
  v_add_f32 v86, v86, v28
  v_add_f32 v87, v87, v28
  v_add_f32 v88, v88, v28
  v_add_f32 v89, v89, v28
  v_add_f32 v90, v90, v28
  v_add_f32 v91, v91, v28
  v_add_f32 v92, v92, v28
  v_add_f32 v93, v93, v28
  v_add_f32 v94, v94, v28
  v_add_f32 v95, v95, v28
  v_mov_b32 v21, 0
  s_waitcnt vmcnt(4) lgkmcnt(0)
  s_barrier
  s_add_u32 m0, s43, 81920
  s_nop 0
  buffer_load_dwordx4 v6, s[16:19], s53 offen lds
  buffer_load_dwordx4 v6, s[16:19], s53 offen offset:1024 lds
  s_add_u32 s53, s53, 8192
  s_add_u32 m0, s43, 32768
  s_nop 0
  buffer_load_dwordx4 v4, s[12:15], s52 offen lds
  buffer_load_dwordx4 v5, s[12:15], s52 offen offset:1024 lds
  s_add_u32 s52, s52, 8192
  s_add_u32 m0, s43, 90112
  s_nop 0
  buffer_load_dwordx4 v6, s[16:19], s53 offen lds
  buffer_load_dwordx4 v6, s[16:19], s53 offen offset:1024 lds
  s_add_u32 s53, s53, 8192
  s_add_u32 m0, s43, 40960
  s_nop 0
  buffer_load_dwordx4 v4, s[12:15], s52 offen lds
  buffer_load_dwordx4 v5, s[12:15], s52 offen offset:1024 lds
  s_add_u32 s52, s52, 8192
  v_mfma_f32_32x32x16_bf16 v[96:111], a[128:131], v[192:195], v[160:175]
  ds_read_b64_tr_b16 a[160:161], v16 offset:0
  ds_read_b64_tr_b16 a[162:163], v16 offset:1024
  v_exp_f32 v40, v80
  v_exp_f32 v41, v81
  v_mfma_f32_32x32x16_bf16 v[96:111], a[132:135], v[196:199], v[96:111]
  ds_read_b64_tr_b16 a[164:165], v17 offset:0
  ds_read_b64_tr_b16 a[166:167], v17 offset:1024
  v_exp_f32 v42, v82
  v_add_f32 v23, v40, v41
  v_mfma_f32_32x32x16_bf16 v[96:111], a[136:139], v[200:203], v[96:111]
  s_add_u32 m0, s43, 98304
  ds_read_b64_tr_b16 a[168:169], v18 offset:0
  v_exp_f32 v43, v83
  v_cvt_pk_bf16_f32 v136, v40, v41
  v_mfma_f32_32x32x16_bf16 v[96:111], a[140:143], v[204:207], v[96:111]
  ds_read_b64_tr_b16 a[170:171], v18 offset:1024
  buffer_load_dwordx4 v6, s[16:19], s53 offen lds
  v_exp_f32 v44, v84
  v_add_f32 v23, v23, v42
  v_mfma_f32_32x32x16_bf16 v[96:111], a[144:147], v[208:211], v[96:111]
  ds_read_b64_tr_b16 a[172:173], v19 offset:0
  v_exp_f32 v45, v85
  v_add_f32 v23, v23, v43
  v_cvt_pk_bf16_f32 v137, v42, v43
  v_mfma_f32_32x32x16_bf16 v[96:111], a[148:151], v[212:215], v[96:111]
  ds_read_b64_tr_b16 a[174:175], v19 offset:1024
  buffer_load_dwordx4 v6, s[16:19], s53 offen offset:1024 lds
  v_exp_f32 v46, v86
  v_add_f32 v23, v23, v44
  v_mfma_f32_32x32x16_bf16 v[96:111], a[152:155], v[216:219], v[96:111]
  ds_read_b64_tr_b16 a[176:177], v16 offset:4096
  s_add_u32 s53, s53, 8192
  v_exp_f32 v47, v87
  v_add_f32 v23, v23, v45
  v_cvt_pk_bf16_f32 v138, v44, v45
  v_mfma_f32_32x32x16_bf16 v[96:111], a[156:159], v[220:223], v[96:111]
  ds_read_b64_tr_b16 a[178:179], v16 offset:5120
  v_exp_f32 v40, v88
  v_add_f32 v23, v23, v46
  v_exp_f32 v41, v89
  v_mfma_f32_32x32x16_bf16 v[112:127], a[128:131], v[224:227], v[176:191]
  s_add_u32 m0, s43, 49152
  ds_read_b64_tr_b16 a[180:181], v17 offset:4096
  v_add_f32 v23, v23, v47
  v_cvt_pk_bf16_f32 v139, v46, v47
  v_mfma_f32_32x32x16_bf16 v[112:127], a[132:135], v[228:231], v[112:127]
  ds_read_b64_tr_b16 a[182:183], v17 offset:5120
  buffer_load_dwordx4 v4, s[12:15], s52 offen lds
  v_exp_f32 v42, v90
  v_add_f32 v23, v23, v40
  v_mfma_f32_32x32x16_bf16 v[112:127], a[136:139], v[232:235], v[112:127]
  ds_read_b64_tr_b16 a[184:185], v18 offset:4096
  v_exp_f32 v43, v91
  v_add_f32 v23, v23, v41
  v_cvt_pk_bf16_f32 v140, v40, v41
  v_mfma_f32_32x32x16_bf16 v[112:127], a[140:143], v[236:239], v[112:127]
  ds_read_b64_tr_b16 a[186:187], v18 offset:5120
  buffer_load_dwordx4 v5, s[12:15], s52 offen offset:1024 lds
  v_exp_f32 v44, v92
  v_add_f32 v23, v23, v42
  v_mfma_f32_32x32x16_bf16 v[112:127], a[144:147], v[240:243], v[112:127]
  ds_read_b64_tr_b16 a[188:189], v19 offset:4096
  s_add_u32 s52, s52, 8192
  v_exp_f32 v45, v93
  v_add_f32 v23, v23, v43
  v_cvt_pk_bf16_f32 v141, v42, v43
  v_mfma_f32_32x32x16_bf16 v[112:127], a[148:151], v[244:247], v[112:127]
  ds_read_b64_tr_b16 a[190:191], v19 offset:5120
  v_exp_f32 v46, v94
  v_add_f32 v23, v23, v44
  v_exp_f32 v47, v95
  v_mfma_f32_32x32x16_bf16 v[112:127], a[152:155], v[248:251], v[112:127]
  v_add_f32 v23, v23, v45
  v_cvt_pk_bf16_f32 v142, v44, v45
  v_add_f32 v23, v23, v46
  v_add_f32 v23, v23, v47
  v_cvt_pk_bf16_f32 v143, v46, v47
  v_mfma_f32_32x32x16_bf16 v[112:127], a[156:159], v[252:255], v[112:127]
  s_waitcnt lgkmcnt(0)
  v_mfma_f32_32x32x16_bf16 a[0:15], a[160:163], v[128:131], 0
  ds_read_b128 a[128:131], v8 offset:16384
  v_add_f32 v20, v20, v22
  v_add_f32 v21, v21, v23
  v_exp_f32 v32, v96
  v_mfma_f32_32x32x16_bf16 a[16:31], a[164:167], v[128:131], 0
  s_add_u32 m0, s43, 57344
  v_exp_f32 v33, v97
  v_exp_f32 v34, v98
  v_mfma_f32_32x32x16_bf16 a[32:47], a[168:171], v[128:131], 0
  buffer_load_dwordx4 v4, s[12:15], s52 offen lds
  v_add_f32 v22, v32, v33
  v_exp_f32 v35, v99
  v_cvt_pk_bf16_f32 v144, v32, v33
  v_mfma_f32_32x32x16_bf16 a[48:63], a[172:175], v[128:131], 0
  ds_read_b128 a[132:135], v9 offset:16384
  v_exp_f32 v36, v100
  v_add_f32 v22, v22, v34
  v_mfma_f32_32x32x16_bf16 a[0:15], a[176:179], v[132:135], a[0:15]
  buffer_load_dwordx4 v5, s[12:15], s52 offen offset:1024 lds
  v_exp_f32 v37, v101
  v_add_f32 v22, v22, v35
  v_cvt_pk_bf16_f32 v145, v34, v35
  v_mfma_f32_32x32x16_bf16 a[16:31], a[180:183], v[132:135], a[16:31]
  ds_read_b128 a[136:139], v10 offset:16384
  s_add_u32 s52, s52, 8192
  v_exp_f32 v38, v102
  v_add_f32 v22, v22, v36
  v_mfma_f32_32x32x16_bf16 a[32:47], a[184:187], v[132:135], a[32:47]
  s_add_u32 m0, s43, 106496
  ds_read_b128 a[140:143], v11 offset:16384
  v_exp_f32 v39, v103
  v_add_f32 v22, v22, v37
  v_cvt_pk_bf16_f32 v146, v36, v37
  v_mfma_f32_32x32x16_bf16 a[48:63], a[188:191], v[132:135], a[48:63]
  buffer_load_dwordx4 v6, s[16:19], s53 offen lds
  v_exp_f32 v32, v104
  v_add_f32 v22, v22, v38
  v_mfma_f32_32x32x16_bf16 a[64:79], a[160:163], v[136:139], 0
  ds_read_b128 a[144:147], v12 offset:16384
  v_exp_f32 v33, v105
  v_add_f32 v22, v22, v39
  v_cvt_pk_bf16_f32 v147, v38, v39
  v_mfma_f32_32x32x16_bf16 a[80:95], a[164:167], v[136:139], 0
  buffer_load_dwordx4 v6, s[16:19], s53 offen offset:1024 lds
  v_exp_f32 v34, v106
  v_add_f32 v22, v22, v32
  v_exp_f32 v35, v107
  v_mfma_f32_32x32x16_bf16 a[96:111], a[168:171], v[136:139], 0
  ds_read_b128 a[148:151], v13 offset:16384
  s_add_u32 s53, s53, 8192
  v_add_f32 v22, v22, v33
  v_cvt_pk_bf16_f32 v148, v32, v33
  v_mfma_f32_32x32x16_bf16 a[112:127], a[172:175], v[136:139], 0
  ds_read_b128 a[152:155], v14 offset:16384
  v_exp_f32 v36, v108
  v_add_f32 v22, v22, v34
  v_exp_f32 v37, v109
  v_mfma_f32_32x32x16_bf16 a[64:79], a[176:179], v[140:143], a[64:79]
  ds_read_b128 a[156:159], v15 offset:16384
  v_add_f32 v22, v22, v35
  v_cvt_pk_bf16_f32 v149, v34, v35
  v_exp_f32 v38, v110
  v_mfma_f32_32x32x16_bf16 a[80:95], a[180:183], v[140:143], a[80:95]
  v_add_f32 v22, v22, v36
  v_exp_f32 v39, v111
  v_add_f32 v22, v22, v37
  v_mfma_f32_32x32x16_bf16 a[96:111], a[184:187], v[140:143], a[96:111]
  s_waitcnt vmcnt(16) lgkmcnt(0)
  v_cvt_pk_bf16_f32 v150, v36, v37
  v_add_f32 v22, v22, v38
  v_add_f32 v22, v22, v39
  v_cvt_pk_bf16_f32 v151, v38, v39
  v_mfma_f32_32x32x16_bf16 a[112:127], a[188:191], v[140:143], a[112:127]
  s_barrier
  v_mfma_f32_32x32x16_bf16 v[64:79], a[128:131], v[192:195], v[160:175]
  ds_read_b64_tr_b16 a[160:161], v16 offset:8192
  ds_read_b64_tr_b16 a[162:163], v16 offset:9216
  v_exp_f32 v40, v112
  v_exp_f32 v41, v113
  v_mfma_f32_32x32x16_bf16 v[64:79], a[132:135], v[196:199], v[64:79]
  ds_read_b64_tr_b16 a[164:165], v17 offset:8192
  ds_read_b64_tr_b16 a[166:167], v17 offset:9216
  v_exp_f32 v42, v114
  v_add_f32 v23, v40, v41
  v_mfma_f32_32x32x16_bf16 v[64:79], a[136:139], v[200:203], v[64:79]
  s_add_u32 m0, s43, 114688
  ds_read_b64_tr_b16 a[168:169], v18 offset:8192
  v_exp_f32 v43, v115
  v_cvt_pk_bf16_f32 v152, v40, v41
  v_mfma_f32_32x32x16_bf16 v[64:79], a[140:143], v[204:207], v[64:79]
  ds_read_b64_tr_b16 a[170:171], v18 offset:9216
  buffer_load_dwordx4 v6, s[16:19], s53 offen lds
  v_exp_f32 v44, v116
  v_add_f32 v23, v23, v42
  v_mfma_f32_32x32x16_bf16 v[64:79], a[144:147], v[208:211], v[64:79]
  ds_read_b64_tr_b16 a[172:173], v19 offset:8192
  v_exp_f32 v45, v117
  v_add_f32 v23, v23, v43
  v_cvt_pk_bf16_f32 v153, v42, v43
  v_mfma_f32_32x32x16_bf16 v[64:79], a[148:151], v[212:215], v[64:79]
  ds_read_b64_tr_b16 a[174:175], v19 offset:9216
  buffer_load_dwordx4 v6, s[16:19], s53 offen offset:1024 lds
  v_exp_f32 v46, v118
  v_add_f32 v23, v23, v44
  v_mfma_f32_32x32x16_bf16 v[64:79], a[152:155], v[216:219], v[64:79]
  ds_read_b64_tr_b16 a[176:177], v16 offset:12288
  s_add_u32 s53, s53, 8192
  v_exp_f32 v47, v119
  v_add_f32 v23, v23, v45
  v_cvt_pk_bf16_f32 v154, v44, v45
  v_mfma_f32_32x32x16_bf16 v[64:79], a[156:159], v[220:223], v[64:79]
  ds_read_b64_tr_b16 a[178:179], v16 offset:13312
  v_exp_f32 v40, v120
  v_add_f32 v23, v23, v46
  v_exp_f32 v41, v121
  v_mfma_f32_32x32x16_bf16 v[80:95], a[128:131], v[224:227], v[176:191]
  s_add_u32 m0, s43, 0
  ds_read_b64_tr_b16 a[180:181], v17 offset:12288
  v_add_f32 v23, v23, v47
  v_cvt_pk_bf16_f32 v155, v46, v47
  v_mfma_f32_32x32x16_bf16 v[80:95], a[132:135], v[228:231], v[80:95]
  ds_read_b64_tr_b16 a[182:183], v17 offset:13312
  buffer_load_dwordx4 v4, s[12:15], s52 offen lds
  v_exp_f32 v42, v122
  v_add_f32 v23, v23, v40
  v_mfma_f32_32x32x16_bf16 v[80:95], a[136:139], v[232:235], v[80:95]
  ds_read_b64_tr_b16 a[184:185], v18 offset:12288
  v_exp_f32 v43, v123
  v_add_f32 v23, v23, v41
  v_cvt_pk_bf16_f32 v156, v40, v41
  v_mfma_f32_32x32x16_bf16 v[80:95], a[140:143], v[236:239], v[80:95]
  ds_read_b64_tr_b16 a[186:187], v18 offset:13312
  buffer_load_dwordx4 v5, s[12:15], s52 offen offset:1024 lds
  v_exp_f32 v44, v124
  v_add_f32 v23, v23, v42
  v_mfma_f32_32x32x16_bf16 v[80:95], a[144:147], v[240:243], v[80:95]
  ds_read_b64_tr_b16 a[188:189], v19 offset:12288
  s_add_u32 s52, s52, 8192
  v_exp_f32 v45, v125
  v_add_f32 v23, v23, v43
  v_cvt_pk_bf16_f32 v157, v42, v43
  v_mfma_f32_32x32x16_bf16 v[80:95], a[148:151], v[244:247], v[80:95]
  ds_read_b64_tr_b16 a[190:191], v19 offset:13312
  v_exp_f32 v46, v126
  v_add_f32 v23, v23, v44
  v_exp_f32 v47, v127
  v_mfma_f32_32x32x16_bf16 v[80:95], a[152:155], v[248:251], v[80:95]
  v_add_f32 v23, v23, v45
  v_cvt_pk_bf16_f32 v158, v44, v45
  v_add_f32 v23, v23, v46
  v_add_f32 v23, v23, v47
  v_cvt_pk_bf16_f32 v159, v46, v47
  v_mfma_f32_32x32x16_bf16 v[80:95], a[156:159], v[252:255], v[80:95]
  s_waitcnt lgkmcnt(0)
  v_max_f32 v26, v22, v23
  v_cmp_nge_f32 vcc, s54, v26
  s_cbranch_vccnz attn_kernel_slow4
attn_kernel_ret5:
  v_mfma_f32_32x32x16_bf16 a[0:15], a[160:163], v[144:147], a[0:15]
  ds_read_b128 a[128:131], v8 offset:24576
  v_add_f32 v20, v20, v22
  v_add_f32 v21, v21, v23
  s_mov_b32 s60, s4
  v_exp_f32 v32, v64
  v_exp_f32 v33, v65
  v_mfma_f32_32x32x16_bf16 a[16:31], a[164:167], v[144:147], a[16:31]
  s_add_u32 m0, s43, 8192
  s_and_b32 s61, s5, 0xffff
  v_exp_f32 v34, v66
  v_add_f32 v22, v32, v33
  s_mov_b32 s62, 4194304
  v_exp_f32 v35, v67
  v_mfma_f32_32x32x16_bf16 a[32:47], a[168:171], v[144:147], a[32:47]
  buffer_load_dwordx4 v4, s[12:15], s52 offen lds
  v_cvt_pk_bf16_f32 v128, v32, v33
  s_mov_b32 s63, 0x20000
  v_exp_f32 v36, v68
  v_add_f32 v22, v22, v34
  s_and_b32 s7, s7, 0xffff
  v_mfma_f32_32x32x16_bf16 a[48:63], a[172:175], v[144:147], a[48:63]
  ds_read_b128 a[132:135], v9 offset:24576
  v_exp_f32 v37, v69
  v_add_f32 v22, v22, v35
  s_mov_b32 s57, 1835008
  v_cvt_pk_bf16_f32 v129, v34, v35
  v_exp_f32 v38, v70
  v_mfma_f32_32x32x16_bf16 a[0:15], a[176:179], v[148:151], a[0:15]
  buffer_load_dwordx4 v5, s[12:15], s52 offen offset:1024 lds
  s_add_u32 s64, s10, 0x2400000
  s_addc_u32 s65, s11, 0
  v_add_f32 v22, v22, v36
  v_exp_f32 v39, v71
  s_and_b32 s65, s65, 0xffff
  v_add_f32 v22, v22, v37
  v_mfma_f32_32x32x16_bf16 a[16:31], a[180:183], v[148:151], a[16:31]
  ds_read_b128 a[136:139], v10 offset:24576
  s_add_u32 s52, s52, 8192
  v_cvt_pk_bf16_f32 v130, v36, v37
  s_mov_b32 s66, 0x5c0000
  v_exp_f32 v32, v72
  v_add_f32 v22, v22, v38
  v_mfma_f32_32x32x16_bf16 a[32:47], a[184:187], v[148:151], a[32:47]
  s_add_u32 m0, s43, 122880
  ds_read_b128 a[140:143], v11 offset:24576
  s_mov_b32 s67, 0x20000
  v_exp_f32 v33, v73
  v_add_f32 v22, v22, v39
  s_mov_b32 s68, s36
  v_mfma_f32_32x32x16_bf16 a[48:63], a[188:191], v[148:151], a[48:63]
  buffer_load_dwordx4 v6, s[16:19], s53 offen lds
  v_cvt_pk_bf16_f32 v131, v38, v39
  v_exp_f32 v34, v74
  s_and_b32 s69, s37, 0xffff
  v_add_f32 v22, v22, v32
  v_exp_f32 v35, v75
  v_mfma_f32_32x32x16_bf16 a[64:79], a[160:163], v[152:155], a[64:79]
  ds_read_b128 a[144:147], v12 offset:24576
  s_and_b32 s39, s39, 0xffff
  v_add_f32 v22, v22, v33
  v_cvt_pk_bf16_f32 v132, v32, v33
  s_mov_b32 s70, 1835008
  v_exp_f32 v36, v76
  v_mfma_f32_32x32x16_bf16 a[80:95], a[164:167], v[152:155], a[80:95]
  buffer_load_dwordx4 v6, s[16:19], s53 offen offset:1024 lds
  v_add_f32 v22, v22, v34
  s_mov_b32 s71, 0x20000
  v_exp_f32 v37, v77
  v_add_f32 v22, v22, v35
  s_mov_b32 s59, 1835008
  v_mfma_f32_32x32x16_bf16 a[96:111], a[168:171], v[152:155], a[96:111]
  ds_read_b128 a[148:151], v13 offset:24576
  s_add_u32 s53, s53, 8192
  v_cvt_pk_bf16_f32 v133, v34, v35
  v_exp_f32 v38, v78
  s_lshl_b32 s20, s2, 14
  v_add_f32 v22, v22, v36
  v_mfma_f32_32x32x16_bf16 a[112:127], a[172:175], v[152:155], a[112:127]
  ds_read_b128 a[152:155], v14 offset:24576
  v_exp_f32 v39, v79
  s_lshl_b32 s49, s40, 8
  v_add_f32 v22, v22, v37
  v_cvt_pk_bf16_f32 v134, v36, v37
  s_add_u32 s20, s20, s49
  v_add_f32 v22, v22, v38
  v_mfma_f32_32x32x16_bf16 a[64:79], a[176:179], v[156:159], a[64:79]
  ds_read_b128 a[156:159], v15 offset:24576
  v_add_f32 v22, v22, v39
  s_add_u32 s22, s20, 64
  v_cvt_pk_bf16_f32 v135, v38, v39
  s_add_u32 s24, s20, 128
  s_add_u32 s26, s20, 192
  s_mov_b32 s21, 0x7fff0000
  s_lshl_b32 s23, s40, 20
  v_mfma_f32_32x32x16_bf16 a[80:95], a[180:183], v[156:159], a[80:95]
  s_lshl_b32 s49, s2, 11
  s_add_u32 s23, s23, s49
  s_add_u32 s25, s23, 1024
  s_add_u32 s27, s23, 0x80000
  s_add_u32 s33, s27, 1024
  s_lshl_b32 s48, s2, 2
  s_add_u32 s48, s48, s40
  v_mfma_f32_32x32x16_bf16 a[96:111], a[184:187], v[156:159], a[96:111]
  s_waitcnt vmcnt(20) lgkmcnt(0)
  s_lshr_b32 s49, s48, 3
  s_and_b32 s50, s48, 7
  s_lshl_b32 s32, s49, 14
  s_lshl_b32 s55, s50, 7
  s_add_u32 s32, s32, s55
  s_add_u32 s34, s32, 64
  s_mov_b32 s8, 0x7fff0000
  v_mfma_f32_32x32x16_bf16 a[112:127], a[188:191], v[156:159], a[112:127]
  s_barrier
  v_mfma_f32_32x32x16_bf16 v[96:111], a[128:131], v[192:195], v[160:175]
  ds_read_b64_tr_b16 a[160:161], v16 offset:16384
  ds_read_b64_tr_b16 a[162:163], v16 offset:17408
  v_exp_f32 v40, v80
  v_exp_f32 v41, v81
  v_mfma_f32_32x32x16_bf16 v[96:111], a[132:135], v[196:199], v[96:111]
  ds_read_b64_tr_b16 a[164:165], v17 offset:16384
  ds_read_b64_tr_b16 a[166:167], v17 offset:17408
  v_exp_f32 v42, v82
  v_add_f32 v23, v40, v41
  v_mfma_f32_32x32x16_bf16 v[96:111], a[136:139], v[200:203], v[96:111]
  s_add_u32 m0, s43, 65536
  ds_read_b64_tr_b16 a[168:169], v18 offset:16384
  v_exp_f32 v43, v83
  v_cvt_pk_bf16_f32 v136, v40, v41
  v_mfma_f32_32x32x16_bf16 v[96:111], a[140:143], v[204:207], v[96:111]
  ds_read_b64_tr_b16 a[170:171], v18 offset:17408
  buffer_load_dwordx4 v6, s[16:19], s53 offen lds
  v_exp_f32 v44, v84
  v_add_f32 v23, v23, v42
  v_mfma_f32_32x32x16_bf16 v[96:111], a[144:147], v[208:211], v[96:111]
  ds_read_b64_tr_b16 a[172:173], v19 offset:16384
  v_exp_f32 v45, v85
  v_add_f32 v23, v23, v43
  v_cvt_pk_bf16_f32 v137, v42, v43
  v_mfma_f32_32x32x16_bf16 v[96:111], a[148:151], v[212:215], v[96:111]
  ds_read_b64_tr_b16 a[174:175], v19 offset:17408
  buffer_load_dwordx4 v6, s[16:19], s53 offen offset:1024 lds
  v_exp_f32 v46, v86
  v_add_f32 v23, v23, v44
  v_mfma_f32_32x32x16_bf16 v[96:111], a[152:155], v[216:219], v[96:111]
  ds_read_b64_tr_b16 a[176:177], v16 offset:20480
  s_add_u32 s53, s53, 8192
  v_exp_f32 v47, v87
  v_add_f32 v23, v23, v45
  v_cvt_pk_bf16_f32 v138, v44, v45
  v_mfma_f32_32x32x16_bf16 v[96:111], a[156:159], v[220:223], v[96:111]
  ds_read_b64_tr_b16 a[178:179], v16 offset:21504
  v_exp_f32 v40, v88
  v_add_f32 v23, v23, v46
  v_exp_f32 v41, v89
  v_mfma_f32_32x32x16_bf16 v[112:127], a[128:131], v[224:227], v[176:191]
  s_add_u32 m0, s43, 16384
  ds_read_b64_tr_b16 a[180:181], v17 offset:20480
  v_add_f32 v23, v23, v47
  v_cvt_pk_bf16_f32 v139, v46, v47
  v_mfma_f32_32x32x16_bf16 v[112:127], a[132:135], v[228:231], v[112:127]
  ds_read_b64_tr_b16 a[182:183], v17 offset:21504
  buffer_load_dwordx4 v4, s[12:15], s52 offen lds
  v_exp_f32 v42, v90
  v_add_f32 v23, v23, v40
  v_mfma_f32_32x32x16_bf16 v[112:127], a[136:139], v[232:235], v[112:127]
  ds_read_b64_tr_b16 a[184:185], v18 offset:20480
  v_exp_f32 v43, v91
  v_add_f32 v23, v23, v41
  v_cvt_pk_bf16_f32 v140, v40, v41
  v_mfma_f32_32x32x16_bf16 v[112:127], a[140:143], v[236:239], v[112:127]
  ds_read_b64_tr_b16 a[186:187], v18 offset:21504
  buffer_load_dwordx4 v5, s[12:15], s52 offen offset:1024 lds
  v_exp_f32 v44, v92
  v_add_f32 v23, v23, v42
  v_mfma_f32_32x32x16_bf16 v[112:127], a[144:147], v[240:243], v[112:127]
  ds_read_b64_tr_b16 a[188:189], v19 offset:20480
  s_add_u32 s52, s52, 8192
  v_exp_f32 v45, v93
  v_add_f32 v23, v23, v43
  v_cvt_pk_bf16_f32 v141, v42, v43
  v_mfma_f32_32x32x16_bf16 v[112:127], a[148:151], v[244:247], v[112:127]
  ds_read_b64_tr_b16 a[190:191], v19 offset:21504
  v_exp_f32 v46, v94
  v_add_f32 v23, v23, v44
  v_exp_f32 v47, v95
  v_mfma_f32_32x32x16_bf16 v[112:127], a[152:155], v[248:251], v[112:127]
  v_add_f32 v23, v23, v45
  v_cvt_pk_bf16_f32 v142, v44, v45
  v_add_f32 v23, v23, v46
  v_add_f32 v23, v23, v47
  v_cvt_pk_bf16_f32 v143, v46, v47
  v_mfma_f32_32x32x16_bf16 v[112:127], a[156:159], v[252:255], v[112:127]
  s_waitcnt lgkmcnt(0)
  v_max_f32 v26, v22, v23
  v_cmp_nge_f32 vcc, s54, v26
  s_cbranch_vccnz attn_kernel_slow6
attn_kernel_ret7:
  v_mfma_f32_32x32x16_bf16 a[0:15], a[160:163], v[128:131], a[0:15]
  ds_read_b128 a[128:131], v8 offset:32768
  v_add_f32 v20, v20, v22
  v_add_f32 v21, v21, v23
  s_mul_i32 s35, s50, 112
  v_exp_f32 v32, v96
  v_exp_f32 v33, v97
  v_mfma_f32_32x32x16_bf16 a[16:31], a[164:167], v[128:131], a[16:31]
  s_add_u32 m0, s43, 24576
  s_add_u32 s35, s35, s49
  v_exp_f32 v34, v98
  v_add_f32 v22, v32, v33
  s_lshl_b32 s35, s35, 11
  v_mfma_f32_32x32x16_bf16 a[32:47], a[168:171], v[128:131], a[32:47]
  buffer_load_dwordx4 v4, s[12:15], s52 offen lds
  v_exp_f32 v35, v99
  v_cvt_pk_bf16_f32 v144, v32, v33
  s_add_u32 s35, s35, 0x400000
  v_exp_f32 v36, v100
  v_add_f32 v22, v22, v34
  v_mfma_f32_32x32x16_bf16 a[48:63], a[172:175], v[128:131], a[48:63]
  ds_read_b128 a[132:135], v9 offset:32768
  s_cmp_lt_u32 s48, 896
  s_cselect_b32 s35, s35, 0x7fff0000
  v_exp_f32 v37, v101
  v_add_f32 v22, v22, v35
  s_add_u32 s9, s35, 1024
  v_cvt_pk_bf16_f32 v145, v34, v35
  v_mfma_f32_32x32x16_bf16 a[0:15], a[176:179], v[132:135], a[0:15]
  buffer_load_dwordx4 v5, s[12:15], s52 offen offset:1024 lds
  v_exp_f32 v38, v102
  s_mul_i32 s58, s48, 1792
  v_add_f32 v22, v22, v36
  v_exp_f32 v39, v103
  s_lshl_b32 s51, s40, 10
  v_mfma_f32_32x32x16_bf16 a[16:31], a[180:183], v[132:135], a[16:31]
  ds_read_b128 a[136:139], v10 offset:32768
  s_add_u32 s52, s52, 8192
  v_add_f32 v22, v22, v37
  v_cvt_pk_bf16_f32 v146, v36, v37
  s_add_u32 s51, s51, 131072
  v_exp_f32 v32, v104
  v_mfma_f32_32x32x16_bf16 a[32:47], a[184:187], v[132:135], a[32:47]
  s_add_u32 m0, s43, 73728
  ds_read_b128 a[140:143], v11 offset:32768
  v_add_f32 v22, v22, v38
  v_lshrrev_b32 v24, 2, v1
  v_exp_f32 v33, v105
  v_add_f32 v22, v22, v39
  v_mfma_f32_32x32x16_bf16 a[48:63], a[188:191], v[132:135], a[48:63]
  buffer_load_dwordx4 v6, s[16:19], s53 offen lds
  v_and_b32 v25, 3, v1
  v_cvt_pk_bf16_f32 v147, v38, v39
  v_exp_f32 v34, v106
  v_lshlrev_b32 v24, 10, v24
  v_add_f32 v22, v22, v32
  v_mfma_f32_32x32x16_bf16 a[64:79], a[160:163], v[136:139], a[64:79]
  ds_read_b128 a[144:147], v12 offset:32768
  v_exp_f32 v35, v107
  v_lshl_add_u32 v24, v25, 4, v24
  v_add_f32 v22, v22, v33
  v_cvt_pk_bf16_f32 v148, v32, v33
  v_bfe_u32 v30, v16, 8, 4
  v_exp_f32 v36, v108
  v_mfma_f32_32x32x16_bf16 a[80:95], a[164:167], v[136:139], a[80:95]
  buffer_load_dwordx4 v6, s[16:19], s53 offen offset:1024 lds
  v_add_f32 v22, v22, v34
  v_and_b32 v25, 63, v16
  v_exp_f32 v37, v109
  v_add_f32 v22, v22, v35
  v_lshl_add_u32 v25, v30, 6, v25
  v_mfma_f32_32x32x16_bf16 a[96:111], a[168:171], v[136:139], a[96:111]
  ds_read_b128 a[148:151], v13 offset:32768
  s_add_u32 s53, s53, 8192
  v_cvt_pk_bf16_f32 v149, v34, v35
  v_exp_f32 v38, v110
  v_add_u32 v25, s51, v25
  v_add_f32 v22, v22, v36
  v_mfma_f32_32x32x16_bf16 a[112:127], a[172:175], v[136:139], a[112:127]
  ds_read_b128 a[152:155], v14 offset:32768
  v_exp_f32 v39, v111
  v_lshlrev_b32 v0, 5, v1
  v_add_f32 v22, v22, v37
  v_cvt_pk_bf16_f32 v150, v36, v37
  s_lshr_b32 s55, s48, 5
  v_mfma_f32_32x32x16_bf16 a[64:79], a[176:179], v[140:143], a[64:79]
  ds_read_b128 a[156:159], v15 offset:32768
  v_add_f32 v22, v22, v38
  v_add_f32 v22, v22, v39
  s_and_b32 s49, s48, 3
  v_cvt_pk_bf16_f32 v151, v38, v39
  s_lshl_b32 s55, s55, 2
  s_add_u32 s55, s55, s49
  s_and_b32 s55, s55, 31
  v_mfma_f32_32x32x16_bf16 a[80:95], a[180:183], v[140:143], a[80:95]
  s_lshl_b32 s55, s55, 11
  s_lshr_b32 s45, s2, 5
  s_lshl_b32 s45, s45, 19
  s_mov_b32 s47, 0x7ff00000
  s_bfe_u32 s50, s2, 0x20003
  s_lshl_b32 s50, s50, 2
  s_add_u32 s50, s50, s40
  s_mul_i32 s50, s50, 0
  v_mfma_f32_32x32x16_bf16 a[96:111], a[184:187], v[140:143], a[96:111]
  s_waitcnt vmcnt(24) lgkmcnt(0)
  s_and_b32 s49, s2, 7
  s_lshl_b32 s49, s49, 16
  s_add_u32 s50, s50, s49
  v_lshlrev_b32 v30, 6, v1
  s_getpc_b64 s[4:5]
attn_kernel_pc3:
  s_add_u32 s4, s4, phase1-attn_kernel_pc3
  s_addc_u32 s5, s5, 0
  s_and_b32 s5, s5, 0xffff
  v_mfma_f32_32x32x16_bf16 a[112:127], a[188:191], v[140:143], a[112:127]
  s_barrier
  s_mov_b32 s56, 7
attn_kernel_loop8:
  v_mfma_f32_32x32x16_bf16 v[64:79], a[128:131], v[192:195], v[160:175]
  ds_read_b64_tr_b16 a[160:161], v16 offset:24576
  ds_read_b64_tr_b16 a[162:163], v16 offset:25600
  v_exp_f32 v40, v112
  v_mfma_f32_32x32x16_bf16 v[64:79], a[132:135], v[196:199], v[64:79]
  ds_read_b64_tr_b16 a[164:165], v17 offset:24576
  ds_read_b64_tr_b16 a[166:167], v17 offset:25600
  v_exp_f32 v41, v113
  v_exp_f32 v42, v114
  v_mfma_f32_32x32x16_bf16 v[64:79], a[136:139], v[200:203], v[64:79]
  ds_read_b64_tr_b16 a[168:169], v18 offset:24576
  v_add_f32 v23, v40, v41
  v_exp_f32 v43, v115
  v_cvt_pk_bf16_f32 v152, v40, v41
  v_mfma_f32_32x32x16_bf16 v[64:79], a[140:143], v[204:207], v[64:79]
  ds_read_b64_tr_b16 a[170:171], v18 offset:25600
  v_exp_f32 v44, v116
  v_add_f32 v23, v23, v42
  v_mfma_f32_32x32x16_bf16 v[64:79], a[144:147], v[208:211], v[64:79]
  ds_read_b64_tr_b16 a[172:173], v19 offset:24576
  v_exp_f32 v45, v117
  v_add_f32 v23, v23, v43
  v_cvt_pk_bf16_f32 v153, v42, v43
  v_mfma_f32_32x32x16_bf16 v[64:79], a[148:151], v[212:215], v[64:79]
  ds_read_b64_tr_b16 a[174:175], v19 offset:25600
  v_exp_f32 v46, v118
  v_add_f32 v23, v23, v44
  v_mfma_f32_32x32x16_bf16 v[64:79], a[152:155], v[216:219], v[64:79]
  ds_read_b64_tr_b16 a[176:177], v16 offset:28672
  v_exp_f32 v47, v119
  v_add_f32 v23, v23, v45
  v_cvt_pk_bf16_f32 v154, v44, v45
  v_mfma_f32_32x32x16_bf16 v[64:79], a[156:159], v[220:223], v[64:79]
  ds_read_b64_tr_b16 a[178:179], v16 offset:29696
  v_exp_f32 v40, v120
  v_add_f32 v23, v23, v46
  v_exp_f32 v41, v121
  v_mfma_f32_32x32x16_bf16 v[80:95], a[128:131], v[224:227], v[176:191]
  ds_read_b64_tr_b16 a[180:181], v17 offset:28672
  v_add_f32 v23, v23, v47
  v_cvt_pk_bf16_f32 v155, v46, v47
  v_mfma_f32_32x32x16_bf16 v[80:95], a[132:135], v[228:231], v[80:95]
  ds_read_b64_tr_b16 a[182:183], v17 offset:29696
  v_exp_f32 v42, v122
  v_add_f32 v23, v23, v40
  v_exp_f32 v43, v123
  v_mfma_f32_32x32x16_bf16 v[80:95], a[136:139], v[232:235], v[80:95]
  ds_read_b64_tr_b16 a[184:185], v18 offset:28672
  v_add_f32 v23, v23, v41
  v_cvt_pk_bf16_f32 v156, v40, v41
  v_exp_f32 v44, v124
  v_mfma_f32_32x32x16_bf16 v[80:95], a[140:143], v[236:239], v[80:95]
  ds_read_b64_tr_b16 a[186:187], v18 offset:29696
  v_add_f32 v23, v23, v42
  v_exp_f32 v45, v125
  v_mfma_f32_32x32x16_bf16 v[80:95], a[144:147], v[240:243], v[80:95]
  ds_read_b64_tr_b16 a[188:189], v19 offset:28672
  v_add_f32 v23, v23, v43
  v_cvt_pk_bf16_f32 v157, v42, v43
  v_exp_f32 v46, v126
  v_mfma_f32_32x32x16_bf16 v[80:95], a[148:151], v[244:247], v[80:95]
  ds_read_b64_tr_b16 a[190:191], v19 offset:29696
  v_add_f32 v23, v23, v44
  v_exp_f32 v47, v127
  v_add_f32 v23, v23, v45
  v_mfma_f32_32x32x16_bf16 v[80:95], a[152:155], v[248:251], v[80:95]
  v_cvt_pk_bf16_f32 v158, v44, v45
  v_add_f32 v23, v23, v46
  v_add_f32 v23, v23, v47
  v_cvt_pk_bf16_f32 v159, v46, v47
  v_mfma_f32_32x32x16_bf16 v[80:95], a[156:159], v[252:255], v[80:95]
  s_waitcnt lgkmcnt(0)
  v_max_f32 v26, v22, v23
  v_cmp_nge_f32 vcc, s54, v26
  s_cbranch_vccnz attn_kernel_slow9
attn_kernel_ret10:
  v_mfma_f32_32x32x16_bf16 a[0:15], a[160:163], v[144:147], a[0:15]
  ds_read_b128 a[128:131], v8 offset:40960
  v_add_f32 v20, v20, v22
  v_add_f32 v21, v21, v23
  v_exp_f32 v32, v64
  v_mfma_f32_32x32x16_bf16 a[16:31], a[164:167], v[144:147], a[16:31]
  s_add_u32 m0, s43, 32768
  ds_read_b64_tr_b16 a[192:193], v25 offset:0
  v_exp_f32 v33, v65
  v_exp_f32 v34, v66
  v_mfma_f32_32x32x16_bf16 a[32:47], a[168:171], v[144:147], a[32:47]
  buffer_load_dwordx4 v4, s[12:15], s52 offen lds
  v_add_f32 v22, v32, v33
  v_exp_f32 v35, v67
  v_mfma_f32_32x32x16_bf16 a[48:63], a[172:175], v[144:147], a[48:63]
  ds_read_b128 a[132:135], v9 offset:40960
  v_cvt_pk_bf16_f32 v128, v32, v33
  v_exp_f32 v36, v68
  v_add_f32 v22, v22, v34
  v_mfma_f32_32x32x16_bf16 a[0:15], a[176:179], v[148:151], a[0:15]
  buffer_load_dwordx4 v5, s[12:15], s52 offen offset:1024 lds
  ds_read_b64_tr_b16 a[194:195], v25 offset:256
  v_exp_f32 v37, v69
  v_add_f32 v22, v22, v35
  v_mfma_f32_32x32x16_bf16 a[16:31], a[180:183], v[148:151], a[16:31]
  ds_read_b128 a[136:139], v10 offset:40960
  s_add_u32 s52, s52, 8192
  v_cvt_pk_bf16_f32 v129, v34, v35
  v_exp_f32 v38, v70
  v_add_f32 v22, v22, v36
  v_mfma_f32_32x32x16_bf16 a[32:47], a[184:187], v[148:151], a[32:47]
  s_add_u32 m0, s43, 81920
  ds_read_b128 a[140:143], v11 offset:40960
  v_exp_f32 v39, v71
  v_add_f32 v22, v22, v37
  v_mfma_f32_32x32x16_bf16 a[48:63], a[188:191], v[148:151], a[48:63]
  buffer_load_dwordx4 v6, s[16:19], s53 offen lds
  v_cvt_pk_bf16_f32 v130, v36, v37
  v_exp_f32 v32, v72
  v_add_f32 v22, v22, v38
  v_mfma_f32_32x32x16_bf16 a[64:79], a[160:163], v[152:155], a[64:79]
  ds_read_b128 a[144:147], v12 offset:40960
  v_exp_f32 v33, v73
  v_add_f32 v22, v22, v39
  v_cvt_pk_bf16_f32 v131, v38, v39
  v_mfma_f32_32x32x16_bf16 a[80:95], a[164:167], v[152:155], a[80:95]
  buffer_load_dwordx4 v6, s[16:19], s53 offen offset:1024 lds
  v_exp_f32 v34, v74
  v_add_f32 v22, v22, v32
  v_mfma_f32_32x32x16_bf16 a[96:111], a[168:171], v[152:155], a[96:111]
  ds_read_b128 a[148:151], v13 offset:40960
  s_add_u32 s53, s53, 8192
  v_exp_f32 v35, v75
  v_add_f32 v22, v22, v33
  v_cvt_pk_bf16_f32 v132, v32, v33
  v_mfma_f32_32x32x16_bf16 a[112:127], a[172:175], v[152:155], a[112:127]
  ds_read_b128 a[152:155], v14 offset:40960
  v_exp_f32 v36, v76
  v_add_f32 v22, v22, v34
  v_exp_f32 v37, v77
  v_mfma_f32_32x32x16_bf16 a[64:79], a[176:179], v[156:159], a[64:79]
  ds_read_b128 a[156:159], v15 offset:40960
  v_add_f32 v22, v22, v35
  v_cvt_pk_bf16_f32 v133, v34, v35
  v_exp_f32 v38, v78
  v_mfma_f32_32x32x16_bf16 a[80:95], a[180:183], v[156:159], a[80:95]
  v_add_f32 v22, v22, v36
  v_exp_f32 v39, v79
  v_add_f32 v22, v22, v37
  v_mfma_f32_32x32x16_bf16 a[96:111], a[184:187], v[156:159], a[96:111]
  s_waitcnt vmcnt(24) lgkmcnt(0)
  v_cvt_pk_bf16_f32 v134, v36, v37
  v_add_f32 v22, v22, v38
  v_add_f32 v22, v22, v39
  v_cvt_pk_bf16_f32 v135, v38, v39
  v_mfma_f32_32x32x16_bf16 a[112:127], a[188:191], v[156:159], a[112:127]
  s_barrier
  v_mfma_f32_32x32x16_bf16 v[96:111], a[128:131], v[192:195], v[160:175]
  ds_read_b64_tr_b16 a[160:161], v16 offset:32768
  ds_read_b64_tr_b16 a[162:163], v16 offset:33792
  v_exp_f32 v40, v80
  v_exp_f32 v41, v81
  v_mfma_f32_32x32x16_bf16 v[96:111], a[132:135], v[196:199], v[96:111]
  ds_read_b64_tr_b16 a[164:165], v17 offset:32768
  ds_read_b64_tr_b16 a[166:167], v17 offset:33792
  v_exp_f32 v42, v82
  v_mfma_f32_32x32x16_bf16 v[96:111], a[136:139], v[200:203], v[96:111]
  ds_read_b64_tr_b16 a[168:169], v18 offset:32768
  v_add_f32 v23, v40, v41
  v_exp_f32 v43, v83
  v_cvt_pk_bf16_f32 v136, v40, v41
  v_mfma_f32_32x32x16_bf16 v[96:111], a[140:143], v[204:207], v[96:111]
  ds_read_b64_tr_b16 a[170:171], v18 offset:33792
  v_exp_f32 v44, v84
  v_add_f32 v23, v23, v42
  v_mfma_f32_32x32x16_bf16 v[96:111], a[144:147], v[208:211], v[96:111]
  ds_read_b64_tr_b16 a[172:173], v19 offset:32768
  v_exp_f32 v45, v85
  v_add_f32 v23, v23, v43
  v_cvt_pk_bf16_f32 v137, v42, v43
  v_mfma_f32_32x32x16_bf16 v[96:111], a[148:151], v[212:215], v[96:111]
  ds_read_b64_tr_b16 a[174:175], v19 offset:33792
  v_exp_f32 v46, v86
  v_add_f32 v23, v23, v44
  v_exp_f32 v47, v87
  v_mfma_f32_32x32x16_bf16 v[96:111], a[152:155], v[216:219], v[96:111]
  ds_read_b64_tr_b16 a[176:177], v16 offset:36864
  v_add_f32 v23, v23, v45
  v_cvt_pk_bf16_f32 v138, v44, v45
  v_mfma_f32_32x32x16_bf16 v[96:111], a[156:159], v[220:223], v[96:111]
  ds_read_b64_tr_b16 a[178:179], v16 offset:37888
  v_exp_f32 v40, v88
  v_add_f32 v23, v23, v46
  v_exp_f32 v41, v89
  v_mfma_f32_32x32x16_bf16 v[112:127], a[128:131], v[224:227], v[176:191]
  ds_read_b64_tr_b16 a[180:181], v17 offset:36864
  v_add_f32 v23, v23, v47
  v_cvt_pk_bf16_f32 v139, v46, v47
  v_exp_f32 v42, v90
  v_mfma_f32_32x32x16_bf16 v[112:127], a[132:135], v[228:231], v[112:127]
  ds_read_b64_tr_b16 a[182:183], v17 offset:37888
  v_add_f32 v23, v23, v40
  v_exp_f32 v43, v91
  v_mfma_f32_32x32x16_bf16 v[112:127], a[136:139], v[232:235], v[112:127]
  ds_read_b64_tr_b16 a[184:185], v18 offset:36864
  v_add_f32 v23, v23, v41
  v_cvt_pk_bf16_f32 v140, v40, v41
  v_exp_f32 v44, v92
  v_mfma_f32_32x32x16_bf16 v[112:127], a[140:143], v[236:239], v[112:127]
  ds_read_b64_tr_b16 a[186:187], v18 offset:37888
  v_add_f32 v23, v23, v42
  v_exp_f32 v45, v93
  v_add_f32 v23, v23, v43
  v_mfma_f32_32x32x16_bf16 v[112:127], a[144:147], v[240:243], v[112:127]
  ds_read_b64_tr_b16 a[188:189], v19 offset:36864
  v_cvt_pk_bf16_f32 v141, v42, v43
  v_exp_f32 v46, v94
  v_mfma_f32_32x32x16_bf16 v[112:127], a[148:151], v[244:247], v[112:127]
  ds_read_b64_tr_b16 a[190:191], v19 offset:37888
  v_add_f32 v23, v23, v44
  v_exp_f32 v47, v95
  v_add_f32 v23, v23, v45
  v_mfma_f32_32x32x16_bf16 v[112:127], a[152:155], v[248:251], v[112:127]
  buffer_store_dwordx4 a[192:195], v3, s[64:67], s21 offen sc0 sc1
  v_cvt_pk_bf16_f32 v142, v44, v45
  v_add_f32 v23, v23, v46
  v_add_f32 v23, v23, v47
  v_cvt_pk_bf16_f32 v143, v46, v47
  v_mfma_f32_32x32x16_bf16 v[112:127], a[156:159], v[252:255], v[112:127]
  s_waitcnt lgkmcnt(0)
  v_max_f32 v26, v22, v23
  v_cmp_nge_f32 vcc, s54, v26
  s_cbranch_vccnz attn_kernel_slow11
attn_kernel_ret12:
  v_mfma_f32_32x32x16_bf16 a[0:15], a[160:163], v[128:131], a[0:15]
  ds_read_b128 a[128:131], v8 offset:49152
  v_add_f32 v20, v20, v22
  v_add_f32 v21, v21, v23
  v_exp_f32 v32, v96
  v_mfma_f32_32x32x16_bf16 a[16:31], a[164:167], v[128:131], a[16:31]
  s_add_u32 m0, s43, 40960
  v_exp_f32 v33, v97
  v_exp_f32 v34, v98
  v_mfma_f32_32x32x16_bf16 a[32:47], a[168:171], v[128:131], a[32:47]
  buffer_load_dwordx4 v4, s[12:15], s52 offen lds
  v_add_f32 v22, v32, v33
  v_exp_f32 v35, v99
  v_cvt_pk_bf16_f32 v144, v32, v33
  v_mfma_f32_32x32x16_bf16 a[48:63], a[172:175], v[128:131], a[48:63]
  ds_read_b128 a[132:135], v9 offset:49152
  v_exp_f32 v36, v100
  v_add_f32 v22, v22, v34
  v_mfma_f32_32x32x16_bf16 a[0:15], a[176:179], v[132:135], a[0:15]
  buffer_load_dwordx4 v5, s[12:15], s52 offen offset:1024 lds
  v_exp_f32 v37, v101
  v_add_f32 v22, v22, v35
  v_cvt_pk_bf16_f32 v145, v34, v35
  v_mfma_f32_32x32x16_bf16 a[16:31], a[180:183], v[132:135], a[16:31]
  ds_read_b128 a[136:139], v10 offset:49152
  s_add_u32 s52, s52, 8192
  v_exp_f32 v38, v102
  v_add_f32 v22, v22, v36
  v_mfma_f32_32x32x16_bf16 a[32:47], a[184:187], v[132:135], a[32:47]
  s_add_u32 m0, s43, 90112
  ds_read_b128 a[140:143], v11 offset:49152
  v_exp_f32 v39, v103
  v_add_f32 v22, v22, v37
  v_cvt_pk_bf16_f32 v146, v36, v37
  v_mfma_f32_32x32x16_bf16 a[48:63], a[188:191], v[132:135], a[48:63]
  buffer_load_dwordx4 v6, s[16:19], s53 offen lds
  v_exp_f32 v32, v104
  v_add_f32 v22, v22, v38
  v_exp_f32 v33, v105
  v_mfma_f32_32x32x16_bf16 a[64:79], a[160:163], v[136:139], a[64:79]
  ds_read_b128 a[144:147], v12 offset:49152
  v_add_f32 v22, v22, v39
  v_cvt_pk_bf16_f32 v147, v38, v39
  v_exp_f32 v34, v106
  v_mfma_f32_32x32x16_bf16 a[80:95], a[164:167], v[136:139], a[80:95]
  buffer_load_dwordx4 v6, s[16:19], s53 offen offset:1024 lds
  v_add_f32 v22, v22, v32
  v_exp_f32 v35, v107
  v_mfma_f32_32x32x16_bf16 a[96:111], a[168:171], v[136:139], a[96:111]
  ds_read_b128 a[148:151], v13 offset:49152
  s_add_u32 s53, s53, 8192
  v_add_f32 v22, v22, v33
  v_cvt_pk_bf16_f32 v148, v32, v33
  v_exp_f32 v36, v108
  v_mfma_f32_32x32x16_bf16 a[112:127], a[172:175], v[136:139], a[112:127]
  ds_read_b128 a[152:155], v14 offset:49152
  v_add_f32 v22, v22, v34
  v_exp_f32 v37, v109
  v_mfma_f32_32x32x16_bf16 a[64:79], a[176:179], v[140:143], a[64:79]
  ds_read_b128 a[156:159], v15 offset:49152
  v_add_f32 v22, v22, v35
  v_cvt_pk_bf16_f32 v149, v34, v35
  v_exp_f32 v38, v110
  v_mfma_f32_32x32x16_bf16 a[80:95], a[180:183], v[140:143], a[80:95]
  buffer_load_dword a255, v0, s[68:71], s58 offen
  v_add_f32 v22, v22, v36
  v_exp_f32 v39, v111
  v_add_f32 v22, v22, v37
  v_mfma_f32_32x32x16_bf16 a[96:111], a[184:187], v[140:143], a[96:111]
  s_waitcnt vmcnt(24) lgkmcnt(0)
  v_cvt_pk_bf16_f32 v150, v36, v37
  v_add_f32 v22, v22, v38
  v_add_f32 v22, v22, v39
  v_cvt_pk_bf16_f32 v151, v38, v39
  v_mfma_f32_32x32x16_bf16 a[112:127], a[188:191], v[140:143], a[112:127]
  s_barrier
  v_mfma_f32_32x32x16_bf16 v[64:79], a[128:131], v[192:195], v[160:175]
  ds_read_b64_tr_b16 a[160:161], v16 offset:40960
  ds_read_b64_tr_b16 a[162:163], v16 offset:41984
  v_exp_f32 v40, v112
  v_exp_f32 v41, v113
  v_mfma_f32_32x32x16_bf16 v[64:79], a[132:135], v[196:199], v[64:79]
  ds_read_b64_tr_b16 a[164:165], v17 offset:40960
  ds_read_b64_tr_b16 a[166:167], v17 offset:41984
  v_exp_f32 v42, v114
  v_mfma_f32_32x32x16_bf16 v[64:79], a[136:139], v[200:203], v[64:79]
  ds_read_b64_tr_b16 a[168:169], v18 offset:40960
  v_add_f32 v23, v40, v41
  v_exp_f32 v43, v115
  v_cvt_pk_bf16_f32 v152, v40, v41
  v_mfma_f32_32x32x16_bf16 v[64:79], a[140:143], v[204:207], v[64:79]
  ds_read_b64_tr_b16 a[170:171], v18 offset:41984
  v_exp_f32 v44, v116
  v_add_f32 v23, v23, v42
  v_mfma_f32_32x32x16_bf16 v[64:79], a[144:147], v[208:211], v[64:79]
  ds_read_b64_tr_b16 a[172:173], v19 offset:40960
  v_exp_f32 v45, v117
  v_add_f32 v23, v23, v43
  v_cvt_pk_bf16_f32 v153, v42, v43
  v_mfma_f32_32x32x16_bf16 v[64:79], a[148:151], v[212:215], v[64:79]
  ds_read_b64_tr_b16 a[174:175], v19 offset:41984
  v_exp_f32 v46, v118
  v_add_f32 v23, v23, v44
  v_exp_f32 v47, v119
  v_mfma_f32_32x32x16_bf16 v[64:79], a[152:155], v[216:219], v[64:79]
  ds_read_b64_tr_b16 a[176:177], v16 offset:45056
  v_add_f32 v23, v23, v45
  v_cvt_pk_bf16_f32 v154, v44, v45
  v_exp_f32 v40, v120
  v_mfma_f32_32x32x16_bf16 v[64:79], a[156:159], v[220:223], v[64:79]
  ds_read_b64_tr_b16 a[178:179], v16 offset:46080
  v_add_f32 v23, v23, v46
  v_exp_f32 v41, v121
  v_mfma_f32_32x32x16_bf16 v[80:95], a[128:131], v[224:227], v[176:191]
  ds_read_b64_tr_b16 a[180:181], v17 offset:45056
  v_add_f32 v23, v23, v47
  v_cvt_pk_bf16_f32 v155, v46, v47
  v_exp_f32 v42, v122
  v_mfma_f32_32x32x16_bf16 v[80:95], a[132:135], v[228:231], v[80:95]
  ds_read_b64_tr_b16 a[182:183], v17 offset:46080
  v_add_f32 v23, v23, v40
  v_exp_f32 v43, v123
  v_add_f32 v23, v23, v41
  v_mfma_f32_32x32x16_bf16 v[80:95], a[136:139], v[232:235], v[80:95]
  ds_read_b64_tr_b16 a[184:185], v18 offset:45056
  v_cvt_pk_bf16_f32 v156, v40, v41
  v_exp_f32 v44, v124
  v_mfma_f32_32x32x16_bf16 v[80:95], a[140:143], v[236:239], v[80:95]
  ds_read_b64_tr_b16 a[186:187], v18 offset:46080
  v_add_f32 v23, v23, v42
  v_exp_f32 v45, v125
  v_add_f32 v23, v23, v43
  v_mfma_f32_32x32x16_bf16 v[80:95], a[144:147], v[240:243], v[80:95]
  ds_read_b64_tr_b16 a[188:189], v19 offset:45056
  v_cvt_pk_bf16_f32 v157, v42, v43
  v_exp_f32 v46, v126
  v_add_f32 v23, v23, v44
  v_mfma_f32_32x32x16_bf16 v[80:95], a[148:151], v[244:247], v[80:95]
  s_mov_b32 m0, s51
  ds_read_b64_tr_b16 a[190:191], v19 offset:46080
  v_exp_f32 v47, v127
  v_add_f32 v23, v23, v45
  v_mfma_f32_32x32x16_bf16 v[80:95], a[152:155], v[248:251], v[80:95]
  buffer_load_dwordx4 v24, s[60:63], s20 offen lds
  v_cvt_pk_bf16_f32 v158, v44, v45
  v_add_f32 v23, v23, v46
  v_add_f32 v23, v23, v47
  v_cvt_pk_bf16_f32 v159, v46, v47
  v_mfma_f32_32x32x16_bf16 v[80:95], a[156:159], v[252:255], v[80:95]
  s_waitcnt lgkmcnt(0)
  v_max_f32 v26, v22, v23
  v_cmp_nge_f32 vcc, s54, v26
  s_cbranch_vccnz attn_kernel_slow13
attn_kernel_ret14:
  v_mfma_f32_32x32x16_bf16 a[0:15], a[160:163], v[144:147], a[0:15]
  ds_read_b128 a[128:131], v8 offset:57344
  v_add_f32 v20, v20, v22
  v_add_f32 v21, v21, v23
  v_exp_f32 v32, v64
  v_mfma_f32_32x32x16_bf16 a[16:31], a[164:167], v[144:147], a[16:31]
  s_add_u32 m0, s43, 49152
  v_exp_f32 v33, v65
  v_exp_f32 v34, v66
  v_mfma_f32_32x32x16_bf16 a[32:47], a[168:171], v[144:147], a[32:47]
  buffer_load_dwordx4 v4, s[12:15], s52 offen lds
  v_add_f32 v22, v32, v33
  v_exp_f32 v35, v67
  v_cvt_pk_bf16_f32 v128, v32, v33
  v_mfma_f32_32x32x16_bf16 a[48:63], a[172:175], v[144:147], a[48:63]
  ds_read_b128 a[132:135], v9 offset:57344
  v_exp_f32 v36, v68
  v_add_f32 v22, v22, v34
  v_exp_f32 v37, v69
  v_mfma_f32_32x32x16_bf16 a[0:15], a[176:179], v[148:151], a[0:15]
  buffer_load_dwordx4 v5, s[12:15], s52 offen offset:1024 lds
  v_add_f32 v22, v22, v35
  v_cvt_pk_bf16_f32 v129, v34, v35
  v_exp_f32 v38, v70
  v_mfma_f32_32x32x16_bf16 a[16:31], a[180:183], v[148:151], a[16:31]
  ds_read_b128 a[136:139], v10 offset:57344
  s_add_u32 s52, s52, 8192
  v_add_f32 v22, v22, v36
  v_exp_f32 v39, v71
  v_mfma_f32_32x32x16_bf16 a[32:47], a[184:187], v[148:151], a[32:47]
  s_add_u32 m0, s43, 98304
  ds_read_b128 a[140:143], v11 offset:57344
  v_add_f32 v22, v22, v37
  v_cvt_pk_bf16_f32 v130, v36, v37
  v_mfma_f32_32x32x16_bf16 a[48:63], a[188:191], v[148:151], a[48:63]
  buffer_load_dwordx4 v6, s[16:19], s53 offen lds
  v_exp_f32 v32, v72
  v_add_f32 v22, v22, v38
  v_exp_f32 v33, v73
  v_mfma_f32_32x32x16_bf16 a[64:79], a[160:163], v[152:155], a[64:79]
  ds_read_b128 a[144:147], v12 offset:57344
  v_add_f32 v22, v22, v39
  v_cvt_pk_bf16_f32 v131, v38, v39
  v_exp_f32 v34, v74
  v_mfma_f32_32x32x16_bf16 a[80:95], a[164:167], v[152:155], a[80:95]
  buffer_load_dwordx4 v6, s[16:19], s53 offen offset:1024 lds
  v_add_f32 v22, v22, v32
  v_exp_f32 v35, v75
  v_add_f32 v22, v22, v33
  v_mfma_f32_32x32x16_bf16 a[96:111], a[168:171], v[152:155], a[96:111]
  ds_read_b128 a[148:151], v13 offset:57344
  s_add_u32 s53, s53, 8192
  v_cvt_pk_bf16_f32 v132, v32, v33
  v_exp_f32 v36, v76
  v_mfma_f32_32x32x16_bf16 a[112:127], a[172:175], v[152:155], a[112:127]
  ds_read_b128 a[152:155], v14 offset:57344
  v_add_f32 v22, v22, v34
  v_exp_f32 v37, v77
  v_add_f32 v22, v22, v35
  v_mfma_f32_32x32x16_bf16 a[64:79], a[176:179], v[156:159], a[64:79]
  ds_read_b128 a[156:159], v15 offset:57344
  v_cvt_pk_bf16_f32 v133, v34, v35
  v_exp_f32 v38, v78
  v_add_f32 v22, v22, v36
  v_mfma_f32_32x32x16_bf16 a[80:95], a[180:183], v[156:159], a[80:95]
  s_mov_b64 s[68:69], s[38:39]
  s_mov_b32 s70, s59
  v_exp_f32 v39, v79
  v_add_f32 v22, v22, v37
  v_mfma_f32_32x32x16_bf16 a[96:111], a[184:187], v[156:159], a[96:111]
  s_waitcnt vmcnt(24) lgkmcnt(0)
  v_cvt_pk_bf16_f32 v134, v36, v37
  v_add_f32 v22, v22, v38
  v_add_f32 v22, v22, v39
  v_cvt_pk_bf16_f32 v135, v38, v39
  v_mfma_f32_32x32x16_bf16 a[112:127], a[188:191], v[156:159], a[112:127]
  s_barrier
  v_mfma_f32_32x32x16_bf16 v[96:111], a[128:131], v[192:195], v[160:175]
  ds_read_b64_tr_b16 a[160:161], v16 offset:49152
  ds_read_b64_tr_b16 a[162:163], v16 offset:50176
  v_exp_f32 v40, v80
  v_exp_f32 v41, v81
  v_mfma_f32_32x32x16_bf16 v[96:111], a[132:135], v[196:199], v[96:111]
  ds_read_b64_tr_b16 a[164:165], v17 offset:49152
  ds_read_b64_tr_b16 a[166:167], v17 offset:50176
  v_exp_f32 v42, v82
  v_mfma_f32_32x32x16_bf16 v[96:111], a[136:139], v[200:203], v[96:111]
  ds_read_b64_tr_b16 a[168:169], v18 offset:49152
  v_add_f32 v23, v40, v41
  v_exp_f32 v43, v83
  v_cvt_pk_bf16_f32 v136, v40, v41
  v_mfma_f32_32x32x16_bf16 v[96:111], a[140:143], v[204:207], v[96:111]
  ds_read_b64_tr_b16 a[170:171], v18 offset:50176
  v_exp_f32 v44, v84
  v_add_f32 v23, v23, v42
  v_mfma_f32_32x32x16_bf16 v[96:111], a[144:147], v[208:211], v[96:111]
  ds_read_b64_tr_b16 a[172:173], v19 offset:49152
  v_exp_f32 v45, v85
  v_add_f32 v23, v23, v43
  v_cvt_pk_bf16_f32 v137, v42, v43
  v_mfma_f32_32x32x16_bf16 v[96:111], a[148:151], v[212:215], v[96:111]
  ds_read_b64_tr_b16 a[174:175], v19 offset:50176
  v_exp_f32 v46, v86
  v_add_f32 v23, v23, v44
  v_exp_f32 v47, v87
  v_mfma_f32_32x32x16_bf16 v[96:111], a[152:155], v[216:219], v[96:111]
  ds_read_b64_tr_b16 a[176:177], v16 offset:53248
  v_add_f32 v23, v23, v45
  v_cvt_pk_bf16_f32 v138, v44, v45
  v_exp_f32 v40, v88
  v_mfma_f32_32x32x16_bf16 v[96:111], a[156:159], v[220:223], v[96:111]
  ds_read_b64_tr_b16 a[178:179], v16 offset:54272
  v_add_f32 v23, v23, v46
  v_exp_f32 v41, v89
  v_mfma_f32_32x32x16_bf16 v[112:127], a[128:131], v[224:227], v[176:191]
  ds_read_b64_tr_b16 a[180:181], v17 offset:53248
  v_add_f32 v23, v23, v47
  v_cvt_pk_bf16_f32 v139, v46, v47
  v_exp_f32 v42, v90
  v_mfma_f32_32x32x16_bf16 v[112:127], a[132:135], v[228:231], v[112:127]
  ds_read_b64_tr_b16 a[182:183], v17 offset:54272
  v_add_f32 v23, v23, v40
  v_exp_f32 v43, v91
  v_add_f32 v23, v23, v41
  v_mfma_f32_32x32x16_bf16 v[112:127], a[136:139], v[232:235], v[112:127]
  ds_read_b64_tr_b16 a[184:185], v18 offset:53248
  v_cvt_pk_bf16_f32 v140, v40, v41
  v_exp_f32 v44, v92
  v_add_f32 v23, v23, v42
  v_mfma_f32_32x32x16_bf16 v[112:127], a[140:143], v[236:239], v[112:127]
  ds_read_b64_tr_b16 a[186:187], v18 offset:54272
  v_exp_f32 v45, v93
  v_add_f32 v23, v23, v43
  v_cvt_pk_bf16_f32 v141, v42, v43
  v_mfma_f32_32x32x16_bf16 v[112:127], a[144:147], v[240:243], v[112:127]
  ds_read_b64_tr_b16 a[188:189], v19 offset:53248
  v_exp_f32 v46, v94
  v_add_f32 v23, v23, v44
  v_mfma_f32_32x32x16_bf16 v[112:127], a[148:151], v[244:247], v[112:127]
  ds_read_b64_tr_b16 a[190:191], v19 offset:54272
  v_exp_f32 v47, v95
  v_add_f32 v23, v23, v45
  v_cvt_pk_bf16_f32 v142, v44, v45
  v_add_f32 v23, v23, v46
  v_mfma_f32_32x32x16_bf16 v[112:127], a[152:155], v[248:251], v[112:127]
  s_mov_b64 s[20:21], s[22:23]
  s_mov_b64 s[22:23], s[24:25]
  s_mov_b64 s[24:25], s[26:27]
  v_add_f32 v23, v23, v47
  v_cvt_pk_bf16_f32 v143, v46, v47
  v_mfma_f32_32x32x16_bf16 v[112:127], a[156:159], v[252:255], v[112:127]
  s_waitcnt lgkmcnt(0)
  v_max_f32 v26, v22, v23
  v_cmp_nge_f32 vcc, s54, v26
  s_cbranch_vccnz attn_kernel_slow15
attn_kernel_ret16:
  v_mfma_f32_32x32x16_bf16 a[0:15], a[160:163], v[128:131], a[0:15]
  ds_read_b128 a[128:131], v8 offset:0
  v_add_f32 v20, v20, v22
  v_add_f32 v21, v21, v23
  v_exp_f32 v32, v96
  v_mfma_f32_32x32x16_bf16 a[16:31], a[164:167], v[128:131], a[16:31]
  s_add_u32 m0, s43, 57344
  v_exp_f32 v33, v97
  v_exp_f32 v34, v98
  v_mfma_f32_32x32x16_bf16 a[32:47], a[168:171], v[128:131], a[32:47]
  buffer_load_dwordx4 v4, s[12:15], s52 offen lds
  v_add_f32 v22, v32, v33
  v_exp_f32 v35, v99
  v_cvt_pk_bf16_f32 v144, v32, v33
  v_mfma_f32_32x32x16_bf16 a[48:63], a[172:175], v[128:131], a[48:63]
  ds_read_b128 a[132:135], v9 offset:0
  v_exp_f32 v36, v100
  v_add_f32 v22, v22, v34
  v_exp_f32 v37, v101
  v_mfma_f32_32x32x16_bf16 a[0:15], a[176:179], v[132:135], a[0:15]
  buffer_load_dwordx4 v5, s[12:15], s52 offen offset:1024 lds
  v_add_f32 v22, v22, v35
  v_cvt_pk_bf16_f32 v145, v34, v35
  v_exp_f32 v38, v102
  v_mfma_f32_32x32x16_bf16 a[16:31], a[180:183], v[132:135], a[16:31]
  ds_read_b128 a[136:139], v10 offset:0
  s_add_u32 s52, s52, 8192
  v_add_f32 v22, v22, v36
  v_exp_f32 v39, v103
  v_mfma_f32_32x32x16_bf16 a[32:47], a[184:187], v[132:135], a[32:47]
  s_add_u32 m0, s43, 106496
  ds_read_b128 a[140:143], v11 offset:0
  v_add_f32 v22, v22, v37
  v_cvt_pk_bf16_f32 v146, v36, v37
  v_mfma_f32_32x32x16_bf16 a[48:63], a[188:191], v[132:135], a[48:63]
  buffer_load_dwordx4 v6, s[16:19], s53 offen lds
  v_exp_f32 v32, v104
  v_add_f32 v22, v22, v38
  v_exp_f32 v33, v105
  v_mfma_f32_32x32x16_bf16 a[64:79], a[160:163], v[136:139], a[64:79]
  ds_read_b128 a[144:147], v12 offset:0
  v_add_f32 v22, v22, v39
  v_cvt_pk_bf16_f32 v147, v38, v39
  v_exp_f32 v34, v106
  v_mfma_f32_32x32x16_bf16 a[80:95], a[164:167], v[136:139], a[80:95]
  buffer_load_dwordx4 v6, s[16:19], s53 offen offset:1024 lds
  v_add_f32 v22, v22, v32
  v_exp_f32 v35, v107
  v_add_f32 v22, v22, v33
  v_mfma_f32_32x32x16_bf16 a[96:111], a[168:171], v[136:139], a[96:111]
  ds_read_b128 a[148:151], v13 offset:0
  s_add_u32 s53, s53, 8192
  v_cvt_pk_bf16_f32 v148, v32, v33
  v_exp_f32 v36, v108
  v_mfma_f32_32x32x16_bf16 a[112:127], a[172:175], v[136:139], a[112:127]
  ds_read_b128 a[152:155], v14 offset:0
  v_add_f32 v22, v22, v34
  v_exp_f32 v37, v109
  v_add_f32 v22, v22, v35
  v_mfma_f32_32x32x16_bf16 a[64:79], a[176:179], v[140:143], a[64:79]
  ds_read_b128 a[156:159], v15 offset:0
  v_cvt_pk_bf16_f32 v149, v34, v35
  v_exp_f32 v38, v110
  v_add_f32 v22, v22, v36
  v_mfma_f32_32x32x16_bf16 a[80:95], a[180:183], v[140:143], a[80:95]
  s_mov_b64 s[26:27], s[32:33]
  s_mov_b64 s[32:33], s[34:35]
  v_exp_f32 v39, v111
  v_add_f32 v22, v22, v37
  v_mfma_f32_32x32x16_bf16 a[96:111], a[184:187], v[140:143], a[96:111]
  s_waitcnt vmcnt(24) lgkmcnt(0)
  v_cvt_pk_bf16_f32 v150, v36, v37
  v_add_f32 v22, v22, v38
  v_add_f32 v22, v22, v39
  v_cvt_pk_bf16_f32 v151, v38, v39
  v_mfma_f32_32x32x16_bf16 a[112:127], a[188:191], v[140:143], a[112:127]
  s_barrier
  v_mfma_f32_32x32x16_bf16 v[64:79], a[128:131], v[192:195], v[160:175]
  ds_read_b64_tr_b16 a[160:161], v16 offset:57344
  ds_read_b64_tr_b16 a[162:163], v16 offset:58368
  v_exp_f32 v40, v112
  v_exp_f32 v41, v113
  v_mfma_f32_32x32x16_bf16 v[64:79], a[132:135], v[196:199], v[64:79]
  ds_read_b64_tr_b16 a[164:165], v17 offset:57344
  ds_read_b64_tr_b16 a[166:167], v17 offset:58368
  v_exp_f32 v42, v114
  v_mfma_f32_32x32x16_bf16 v[64:79], a[136:139], v[200:203], v[64:79]
  ds_read_b64_tr_b16 a[168:169], v18 offset:57344
  v_add_f32 v23, v40, v41
  v_exp_f32 v43, v115
  v_cvt_pk_bf16_f32 v152, v40, v41
  v_mfma_f32_32x32x16_bf16 v[64:79], a[140:143], v[204:207], v[64:79]
  ds_read_b64_tr_b16 a[170:171], v18 offset:58368
  v_exp_f32 v44, v116
  v_add_f32 v23, v23, v42
  v_mfma_f32_32x32x16_bf16 v[64:79], a[144:147], v[208:211], v[64:79]
  ds_read_b64_tr_b16 a[172:173], v19 offset:57344
  v_exp_f32 v45, v117
  v_add_f32 v23, v23, v43
  v_cvt_pk_bf16_f32 v153, v42, v43
  v_mfma_f32_32x32x16_bf16 v[64:79], a[148:151], v[212:215], v[64:79]
  ds_read_b64_tr_b16 a[174:175], v19 offset:58368
  v_exp_f32 v46, v118
  v_add_f32 v23, v23, v44
  v_exp_f32 v47, v119
  v_mfma_f32_32x32x16_bf16 v[64:79], a[152:155], v[216:219], v[64:79]
  ds_read_b64_tr_b16 a[176:177], v16 offset:61440
  v_add_f32 v23, v23, v45
  v_cvt_pk_bf16_f32 v154, v44, v45
  v_exp_f32 v40, v120
  v_mfma_f32_32x32x16_bf16 v[64:79], a[156:159], v[220:223], v[64:79]
  ds_read_b64_tr_b16 a[178:179], v16 offset:62464
  v_add_f32 v23, v23, v46
  v_exp_f32 v41, v121
  v_mfma_f32_32x32x16_bf16 v[80:95], a[128:131], v[224:227], v[176:191]
  ds_read_b64_tr_b16 a[180:181], v17 offset:61440
  v_add_f32 v23, v23, v47
  v_cvt_pk_bf16_f32 v155, v46, v47
  v_exp_f32 v42, v122
  v_mfma_f32_32x32x16_bf16 v[80:95], a[132:135], v[228:231], v[80:95]
  ds_read_b64_tr_b16 a[182:183], v17 offset:62464
  v_add_f32 v23, v23, v40
  v_exp_f32 v43, v123
  v_add_f32 v23, v23, v41
  v_mfma_f32_32x32x16_bf16 v[80:95], a[136:139], v[232:235], v[80:95]
  ds_read_b64_tr_b16 a[184:185], v18 offset:61440
  v_cvt_pk_bf16_f32 v156, v40, v41
  v_exp_f32 v44, v124
  v_mfma_f32_32x32x16_bf16 v[80:95], a[140:143], v[236:239], v[80:95]
  ds_read_b64_tr_b16 a[186:187], v18 offset:62464
  v_add_f32 v23, v23, v42
  v_exp_f32 v45, v125
  v_add_f32 v23, v23, v43
  v_mfma_f32_32x32x16_bf16 v[80:95], a[144:147], v[240:243], v[80:95]
  ds_read_b64_tr_b16 a[188:189], v19 offset:61440
  v_cvt_pk_bf16_f32 v157, v42, v43
  v_exp_f32 v46, v126
  v_add_f32 v23, v23, v44
  v_mfma_f32_32x32x16_bf16 v[80:95], a[148:151], v[244:247], v[80:95]
  ds_read_b64_tr_b16 a[190:191], v19 offset:62464
  v_exp_f32 v47, v127
  v_add_f32 v23, v23, v45
  v_cvt_pk_bf16_f32 v158, v44, v45
  v_mfma_f32_32x32x16_bf16 v[80:95], a[152:155], v[248:251], v[80:95]
  s_mov_b64 s[34:35], s[8:9]
  s_mov_b32 s59, 0
  v_add_f32 v23, v23, v46
  v_add_f32 v23, v23, v47
  v_cvt_pk_bf16_f32 v159, v46, v47
  v_mfma_f32_32x32x16_bf16 v[80:95], a[156:159], v[252:255], v[80:95]
  s_waitcnt lgkmcnt(0)
  v_max_f32 v26, v22, v23
  v_cmp_nge_f32 vcc, s54, v26
  s_cbranch_vccnz attn_kernel_slow17
attn_kernel_ret18:
  v_mfma_f32_32x32x16_bf16 a[0:15], a[160:163], v[144:147], a[0:15]
  ds_read_b128 a[128:131], v8 offset:8192
  v_add_f32 v20, v20, v22
  v_add_f32 v21, v21, v23
  v_exp_f32 v32, v64
  v_mfma_f32_32x32x16_bf16 a[16:31], a[164:167], v[144:147], a[16:31]
  s_add_u32 m0, s43, 0
  v_exp_f32 v33, v65
  v_exp_f32 v34, v66
  v_mfma_f32_32x32x16_bf16 a[32:47], a[168:171], v[144:147], a[32:47]
  buffer_load_dwordx4 v4, s[12:15], s52 offen lds
  v_add_f32 v22, v32, v33
  v_exp_f32 v35, v67
  v_cvt_pk_bf16_f32 v128, v32, v33
  v_mfma_f32_32x32x16_bf16 a[48:63], a[172:175], v[144:147], a[48:63]
  ds_read_b128 a[132:135], v9 offset:8192
  v_exp_f32 v36, v68
  v_add_f32 v22, v22, v34
  v_exp_f32 v37, v69
  v_mfma_f32_32x32x16_bf16 a[0:15], a[176:179], v[148:151], a[0:15]
  buffer_load_dwordx4 v5, s[12:15], s52 offen offset:1024 lds
  v_add_f32 v22, v22, v35
  v_cvt_pk_bf16_f32 v129, v34, v35
  v_exp_f32 v38, v70
  v_mfma_f32_32x32x16_bf16 a[16:31], a[180:183], v[148:151], a[16:31]
  ds_read_b128 a[136:139], v10 offset:8192
  s_add_u32 s52, s52, 8192
  v_add_f32 v22, v22, v36
  v_exp_f32 v39, v71
  v_mfma_f32_32x32x16_bf16 a[32:47], a[184:187], v[148:151], a[32:47]
  s_add_u32 m0, s43, 114688
  ds_read_b128 a[140:143], v11 offset:8192
  v_add_f32 v22, v22, v37
  v_cvt_pk_bf16_f32 v130, v36, v37
  v_mfma_f32_32x32x16_bf16 a[48:63], a[188:191], v[148:151], a[48:63]
  buffer_load_dwordx4 v6, s[16:19], s53 offen lds
  v_exp_f32 v32, v72
  v_add_f32 v22, v22, v38
  v_exp_f32 v33, v73
  v_mfma_f32_32x32x16_bf16 a[64:79], a[160:163], v[152:155], a[64:79]
  ds_read_b128 a[144:147], v12 offset:8192
  v_add_f32 v22, v22, v39
  v_cvt_pk_bf16_f32 v131, v38, v39
  v_exp_f32 v34, v74
  v_mfma_f32_32x32x16_bf16 a[80:95], a[164:167], v[152:155], a[80:95]
  buffer_load_dwordx4 v6, s[16:19], s53 offen offset:1024 lds
  v_add_f32 v22, v22, v32
  v_exp_f32 v35, v75
  v_add_f32 v22, v22, v33
  v_mfma_f32_32x32x16_bf16 a[96:111], a[168:171], v[152:155], a[96:111]
  ds_read_b128 a[148:151], v13 offset:8192
  s_add_u32 s53, s53, 8192
  v_cvt_pk_bf16_f32 v132, v32, v33
  v_exp_f32 v36, v76
  v_mfma_f32_32x32x16_bf16 a[112:127], a[172:175], v[152:155], a[112:127]
  ds_read_b128 a[152:155], v14 offset:8192
  v_add_f32 v22, v22, v34
  v_exp_f32 v37, v77
  v_add_f32 v22, v22, v35
  v_mfma_f32_32x32x16_bf16 a[64:79], a[176:179], v[156:159], a[64:79]
  ds_read_b128 a[156:159], v15 offset:8192
  v_cvt_pk_bf16_f32 v133, v34, v35
  v_exp_f32 v38, v78
  v_add_f32 v22, v22, v36
  v_mfma_f32_32x32x16_bf16 a[80:95], a[180:183], v[156:159], a[80:95]
  s_cmp_eq_u32 s56, 4
  s_cselect_b64 s[60:61], s[6:7], s[60:61]
  v_exp_f32 v39, v79
  v_add_f32 v22, v22, v37
  v_mfma_f32_32x32x16_bf16 a[96:111], a[184:187], v[156:159], a[96:111]
  s_waitcnt vmcnt(24) lgkmcnt(0)
  v_cvt_pk_bf16_f32 v134, v36, v37
  v_add_f32 v22, v22, v38
  v_add_f32 v22, v22, v39
  v_cvt_pk_bf16_f32 v135, v38, v39
  v_mfma_f32_32x32x16_bf16 a[112:127], a[188:191], v[156:159], a[112:127]
  s_barrier
  v_mfma_f32_32x32x16_bf16 v[96:111], a[128:131], v[192:195], v[160:175]
  ds_read_b64_tr_b16 a[160:161], v16 offset:0
  ds_read_b64_tr_b16 a[162:163], v16 offset:1024
  v_exp_f32 v40, v80
  v_exp_f32 v41, v81
  v_mfma_f32_32x32x16_bf16 v[96:111], a[132:135], v[196:199], v[96:111]
  ds_read_b64_tr_b16 a[164:165], v17 offset:0
  ds_read_b64_tr_b16 a[166:167], v17 offset:1024
  v_exp_f32 v42, v82
  v_mfma_f32_32x32x16_bf16 v[96:111], a[136:139], v[200:203], v[96:111]
  ds_read_b64_tr_b16 a[168:169], v18 offset:0
  v_add_f32 v23, v40, v41
  v_exp_f32 v43, v83
  v_cvt_pk_bf16_f32 v136, v40, v41
  v_mfma_f32_32x32x16_bf16 v[96:111], a[140:143], v[204:207], v[96:111]
  ds_read_b64_tr_b16 a[170:171], v18 offset:1024
  v_exp_f32 v44, v84
  v_add_f32 v23, v23, v42
  v_mfma_f32_32x32x16_bf16 v[96:111], a[144:147], v[208:211], v[96:111]
  ds_read_b64_tr_b16 a[172:173], v19 offset:0
  v_exp_f32 v45, v85
  v_add_f32 v23, v23, v43
  v_cvt_pk_bf16_f32 v137, v42, v43
  v_mfma_f32_32x32x16_bf16 v[96:111], a[148:151], v[212:215], v[96:111]
  ds_read_b64_tr_b16 a[174:175], v19 offset:1024
  v_exp_f32 v46, v86
  v_add_f32 v23, v23, v44
  v_exp_f32 v47, v87
  v_mfma_f32_32x32x16_bf16 v[96:111], a[152:155], v[216:219], v[96:111]
  ds_read_b64_tr_b16 a[176:177], v16 offset:4096
  v_add_f32 v23, v23, v45
  v_cvt_pk_bf16_f32 v138, v44, v45
  v_exp_f32 v40, v88
  v_mfma_f32_32x32x16_bf16 v[96:111], a[156:159], v[220:223], v[96:111]
  ds_read_b64_tr_b16 a[178:179], v16 offset:5120
  v_add_f32 v23, v23, v46
  v_exp_f32 v41, v89
  v_mfma_f32_32x32x16_bf16 v[112:127], a[128:131], v[224:227], v[176:191]
  ds_read_b64_tr_b16 a[180:181], v17 offset:4096
  v_add_f32 v23, v23, v47
  v_cvt_pk_bf16_f32 v139, v46, v47
  v_exp_f32 v42, v90
  v_mfma_f32_32x32x16_bf16 v[112:127], a[132:135], v[228:231], v[112:127]
  ds_read_b64_tr_b16 a[182:183], v17 offset:5120
  v_add_f32 v23, v23, v40
  v_exp_f32 v43, v91
  v_add_f32 v23, v23, v41
  v_mfma_f32_32x32x16_bf16 v[112:127], a[136:139], v[232:235], v[112:127]
  ds_read_b64_tr_b16 a[184:185], v18 offset:4096
  v_cvt_pk_bf16_f32 v140, v40, v41
  v_exp_f32 v44, v92
  v_mfma_f32_32x32x16_bf16 v[112:127], a[140:143], v[236:239], v[112:127]
  ds_read_b64_tr_b16 a[186:187], v18 offset:5120
  v_add_f32 v23, v23, v42
  v_exp_f32 v45, v93
  v_add_f32 v23, v23, v43
  v_mfma_f32_32x32x16_bf16 v[112:127], a[144:147], v[240:243], v[112:127]
  ds_read_b64_tr_b16 a[188:189], v19 offset:4096
  v_cvt_pk_bf16_f32 v141, v42, v43
  v_exp_f32 v46, v94
  v_add_f32 v23, v23, v44
  v_mfma_f32_32x32x16_bf16 v[112:127], a[148:151], v[244:247], v[112:127]
  ds_read_b64_tr_b16 a[190:191], v19 offset:5120
  v_exp_f32 v47, v95
  v_add_f32 v23, v23, v45
  v_cvt_pk_bf16_f32 v142, v44, v45
  v_mfma_f32_32x32x16_bf16 v[112:127], a[152:155], v[248:251], v[112:127]
  s_cmp_eq_u32 s56, 4
  s_cselect_b32 s62, s57, s62
  v_add_f32 v23, v23, v46
  v_add_f32 v23, v23, v47
  v_cvt_pk_bf16_f32 v143, v46, v47
  v_mfma_f32_32x32x16_bf16 v[112:127], a[156:159], v[252:255], v[112:127]
  s_waitcnt lgkmcnt(0)
  v_max_f32 v26, v22, v23
  v_cmp_nge_f32 vcc, s54, v26
  s_cbranch_vccnz attn_kernel_slow19
attn_kernel_ret20:
  v_mfma_f32_32x32x16_bf16 a[0:15], a[160:163], v[128:131], a[0:15]
  ds_read_b128 a[128:131], v8 offset:16384
  v_add_f32 v20, v20, v22
  v_add_f32 v21, v21, v23
  v_exp_f32 v32, v96
  v_mfma_f32_32x32x16_bf16 a[16:31], a[164:167], v[128:131], a[16:31]
  s_add_u32 m0, s43, 8192
  v_exp_f32 v33, v97
  v_exp_f32 v34, v98
  v_mfma_f32_32x32x16_bf16 a[32:47], a[168:171], v[128:131], a[32:47]
  buffer_load_dwordx4 v4, s[12:15], s52 offen lds
  v_add_f32 v22, v32, v33
  v_exp_f32 v35, v99
  v_cvt_pk_bf16_f32 v144, v32, v33
  v_mfma_f32_32x32x16_bf16 a[48:63], a[172:175], v[128:131], a[48:63]
  ds_read_b128 a[132:135], v9 offset:16384
  v_exp_f32 v36, v100
  v_add_f32 v22, v22, v34
  v_mfma_f32_32x32x16_bf16 a[0:15], a[176:179], v[132:135], a[0:15]
  buffer_load_dwordx4 v5, s[12:15], s52 offen offset:1024 lds
  v_exp_f32 v37, v101
  v_add_f32 v22, v22, v35
  v_cvt_pk_bf16_f32 v145, v34, v35
  v_mfma_f32_32x32x16_bf16 a[16:31], a[180:183], v[132:135], a[16:31]
  ds_read_b128 a[136:139], v10 offset:16384
  s_add_u32 s52, s52, 8192
  v_exp_f32 v38, v102
  v_add_f32 v22, v22, v36
  v_mfma_f32_32x32x16_bf16 a[32:47], a[184:187], v[132:135], a[32:47]
  s_add_u32 m0, s43, 122880
  ds_read_b128 a[140:143], v11 offset:16384
  v_exp_f32 v39, v103
  v_add_f32 v22, v22, v37
  v_cvt_pk_bf16_f32 v146, v36, v37
  v_mfma_f32_32x32x16_bf16 a[48:63], a[188:191], v[132:135], a[48:63]
  buffer_load_dwordx4 v6, s[16:19], s53 offen lds
  v_exp_f32 v32, v104
  v_add_f32 v22, v22, v38
  v_mfma_f32_32x32x16_bf16 a[64:79], a[160:163], v[136:139], a[64:79]
  ds_read_b128 a[144:147], v12 offset:16384
  v_exp_f32 v33, v105
  v_add_f32 v22, v22, v39
  v_cvt_pk_bf16_f32 v147, v38, v39
  v_mfma_f32_32x32x16_bf16 a[80:95], a[164:167], v[136:139], a[80:95]
  buffer_load_dwordx4 v6, s[16:19], s53 offen offset:1024 lds
  v_exp_f32 v34, v106
  v_add_f32 v22, v22, v32
  v_exp_f32 v35, v107
  v_mfma_f32_32x32x16_bf16 a[96:111], a[168:171], v[136:139], a[96:111]
  ds_read_b128 a[148:151], v13 offset:16384
  s_add_u32 s53, s53, 8192
  v_add_f32 v22, v22, v33
  v_cvt_pk_bf16_f32 v148, v32, v33
  v_mfma_f32_32x32x16_bf16 a[112:127], a[172:175], v[136:139], a[112:127]
  ds_read_b128 a[152:155], v14 offset:16384
  v_exp_f32 v36, v108
  v_add_f32 v22, v22, v34
  v_exp_f32 v37, v109
  v_mfma_f32_32x32x16_bf16 a[64:79], a[176:179], v[140:143], a[64:79]
  ds_read_b128 a[156:159], v15 offset:16384
  v_add_f32 v22, v22, v35
  v_cvt_pk_bf16_f32 v149, v34, v35
  v_exp_f32 v38, v110
  v_mfma_f32_32x32x16_bf16 a[80:95], a[180:183], v[140:143], a[80:95]
  v_add_f32 v22, v22, v36
  v_exp_f32 v39, v111
  v_add_f32 v22, v22, v37
  v_mfma_f32_32x32x16_bf16 a[96:111], a[184:187], v[140:143], a[96:111]
  s_waitcnt vmcnt(24) lgkmcnt(0)
  v_cvt_pk_bf16_f32 v150, v36, v37
  v_add_f32 v22, v22, v38
  v_add_f32 v22, v22, v39
  v_cvt_pk_bf16_f32 v151, v38, v39
  v_mfma_f32_32x32x16_bf16 a[112:127], a[188:191], v[140:143], a[112:127]
  s_barrier
  v_mfma_f32_32x32x16_bf16 v[64:79], a[128:131], v[192:195], v[160:175]
  ds_read_b64_tr_b16 a[160:161], v16 offset:8192
  ds_read_b64_tr_b16 a[162:163], v16 offset:9216
  v_exp_f32 v40, v112
  v_exp_f32 v41, v113
  v_mfma_f32_32x32x16_bf16 v[64:79], a[132:135], v[196:199], v[64:79]
  ds_read_b64_tr_b16 a[164:165], v17 offset:8192
  ds_read_b64_tr_b16 a[166:167], v17 offset:9216
  v_exp_f32 v42, v114
  v_mfma_f32_32x32x16_bf16 v[64:79], a[136:139], v[200:203], v[64:79]
  ds_read_b64_tr_b16 a[168:169], v18 offset:8192
  v_add_f32 v23, v40, v41
  v_exp_f32 v43, v115
  v_cvt_pk_bf16_f32 v152, v40, v41
  v_mfma_f32_32x32x16_bf16 v[64:79], a[140:143], v[204:207], v[64:79]
  ds_read_b64_tr_b16 a[170:171], v18 offset:9216
  v_exp_f32 v44, v116
  v_add_f32 v23, v23, v42
  v_mfma_f32_32x32x16_bf16 v[64:79], a[144:147], v[208:211], v[64:79]
  ds_read_b64_tr_b16 a[172:173], v19 offset:8192
  v_exp_f32 v45, v117
  v_add_f32 v23, v23, v43
  v_cvt_pk_bf16_f32 v153, v42, v43
  v_mfma_f32_32x32x16_bf16 v[64:79], a[148:151], v[212:215], v[64:79]
  ds_read_b64_tr_b16 a[174:175], v19 offset:9216
  v_exp_f32 v46, v118
  v_add_f32 v23, v23, v44
  v_exp_f32 v47, v119
  v_mfma_f32_32x32x16_bf16 v[64:79], a[152:155], v[216:219], v[64:79]
  ds_read_b64_tr_b16 a[176:177], v16 offset:12288
  v_add_f32 v23, v23, v45
  v_cvt_pk_bf16_f32 v154, v44, v45
  v_exp_f32 v40, v120
  v_mfma_f32_32x32x16_bf16 v[64:79], a[156:159], v[220:223], v[64:79]
  ds_read_b64_tr_b16 a[178:179], v16 offset:13312
  v_add_f32 v23, v23, v46
  v_exp_f32 v41, v121
  v_mfma_f32_32x32x16_bf16 v[80:95], a[128:131], v[224:227], v[176:191]
  ds_read_b64_tr_b16 a[180:181], v17 offset:12288
  v_add_f32 v23, v23, v47
  v_cvt_pk_bf16_f32 v155, v46, v47
  v_exp_f32 v42, v122
  v_mfma_f32_32x32x16_bf16 v[80:95], a[132:135], v[228:231], v[80:95]
  ds_read_b64_tr_b16 a[182:183], v17 offset:13312
  v_add_f32 v23, v23, v40
  v_exp_f32 v43, v123
  v_add_f32 v23, v23, v41
  v_mfma_f32_32x32x16_bf16 v[80:95], a[136:139], v[232:235], v[80:95]
  ds_read_b64_tr_b16 a[184:185], v18 offset:12288
  v_cvt_pk_bf16_f32 v156, v40, v41
  v_exp_f32 v44, v124
  v_mfma_f32_32x32x16_bf16 v[80:95], a[140:143], v[236:239], v[80:95]
  ds_read_b64_tr_b16 a[186:187], v18 offset:13312
  v_add_f32 v23, v23, v42
  v_exp_f32 v45, v125
  v_add_f32 v23, v23, v43
  v_mfma_f32_32x32x16_bf16 v[80:95], a[144:147], v[240:243], v[80:95]
  ds_read_b64_tr_b16 a[188:189], v19 offset:12288
  v_cvt_pk_bf16_f32 v157, v42, v43
  v_exp_f32 v46, v126
  v_add_f32 v23, v23, v44
  v_mfma_f32_32x32x16_bf16 v[80:95], a[148:151], v[244:247], v[80:95]
  ds_read_b64_tr_b16 a[190:191], v19 offset:13312
  v_exp_f32 v47, v127
  v_add_f32 v23, v23, v45
  v_cvt_pk_bf16_f32 v158, v44, v45
  v_mfma_f32_32x32x16_bf16 v[80:95], a[152:155], v[248:251], v[80:95]
  s_cmp_eq_u32 s56, 3
  s_cselect_b64 s[68:69], s[4:5], s[68:69]
  v_add_f32 v23, v23, v46
  v_add_f32 v23, v23, v47
  v_cvt_pk_bf16_f32 v159, v46, v47
  v_mfma_f32_32x32x16_bf16 v[80:95], a[156:159], v[252:255], v[80:95]
  s_waitcnt lgkmcnt(0)
  v_max_f32 v26, v22, v23
  v_cmp_nge_f32 vcc, s54, v26
  s_cbranch_vccnz attn_kernel_slow21
attn_kernel_ret22:
  v_mfma_f32_32x32x16_bf16 a[0:15], a[160:163], v[144:147], a[0:15]
  ds_read_b128 a[128:131], v8 offset:24576
  v_add_f32 v20, v20, v22
  v_add_f32 v21, v21, v23
  v_exp_f32 v32, v64
  v_mfma_f32_32x32x16_bf16 a[16:31], a[164:167], v[144:147], a[16:31]
  s_add_u32 m0, s43, 16384
  v_exp_f32 v33, v65
  v_exp_f32 v34, v66
  v_mfma_f32_32x32x16_bf16 a[32:47], a[168:171], v[144:147], a[32:47]
  buffer_load_dwordx4 v4, s[12:15], s52 offen lds
  v_add_f32 v22, v32, v33
  v_exp_f32 v35, v67
  v_cvt_pk_bf16_f32 v128, v32, v33
  v_mfma_f32_32x32x16_bf16 a[48:63], a[172:175], v[144:147], a[48:63]
  ds_read_b128 a[132:135], v9 offset:24576
  v_exp_f32 v36, v68
  v_add_f32 v22, v22, v34
  v_exp_f32 v37, v69
  v_mfma_f32_32x32x16_bf16 a[0:15], a[176:179], v[148:151], a[0:15]
  buffer_load_dwordx4 v5, s[12:15], s52 offen offset:1024 lds
  v_add_f32 v22, v22, v35
  v_cvt_pk_bf16_f32 v129, v34, v35
  v_exp_f32 v38, v70
  v_mfma_f32_32x32x16_bf16 a[16:31], a[180:183], v[148:151], a[16:31]
  ds_read_b128 a[136:139], v10 offset:24576
  s_add_u32 s52, s52, 8192
  v_add_f32 v22, v22, v36
  v_exp_f32 v39, v71
  v_mfma_f32_32x32x16_bf16 a[32:47], a[184:187], v[148:151], a[32:47]
  s_add_u32 m0, s43, 65536
  ds_read_b128 a[140:143], v11 offset:24576
  v_add_f32 v22, v22, v37
  v_cvt_pk_bf16_f32 v130, v36, v37
  v_mfma_f32_32x32x16_bf16 a[48:63], a[188:191], v[148:151], a[48:63]
  buffer_load_dwordx4 v6, s[16:19], s53 offen lds
  v_exp_f32 v32, v72
  v_add_f32 v22, v22, v38
  v_exp_f32 v33, v73
  v_mfma_f32_32x32x16_bf16 a[64:79], a[160:163], v[152:155], a[64:79]
  ds_read_b128 a[144:147], v12 offset:24576
  v_add_f32 v22, v22, v39
  v_cvt_pk_bf16_f32 v131, v38, v39
  v_exp_f32 v34, v74
  v_mfma_f32_32x32x16_bf16 a[80:95], a[164:167], v[152:155], a[80:95]
  buffer_load_dwordx4 v6, s[16:19], s53 offen offset:1024 lds
  v_add_f32 v22, v22, v32
  v_exp_f32 v35, v75
  v_add_f32 v22, v22, v33
  v_mfma_f32_32x32x16_bf16 a[96:111], a[168:171], v[152:155], a[96:111]
  ds_read_b128 a[148:151], v13 offset:24576
  s_add_u32 s53, s53, 8192
  v_cvt_pk_bf16_f32 v132, v32, v33
  v_exp_f32 v36, v76
  v_mfma_f32_32x32x16_bf16 a[112:127], a[172:175], v[152:155], a[112:127]
  ds_read_b128 a[152:155], v14 offset:24576
  v_add_f32 v22, v22, v34
  v_exp_f32 v37, v77
  v_add_f32 v22, v22, v35
  v_mfma_f32_32x32x16_bf16 a[64:79], a[176:179], v[156:159], a[64:79]
  ds_read_b128 a[156:159], v15 offset:24576
  v_cvt_pk_bf16_f32 v133, v34, v35
  v_exp_f32 v38, v78
  v_add_f32 v22, v22, v36
  v_mfma_f32_32x32x16_bf16 a[80:95], a[180:183], v[156:159], a[80:95]
  s_cmp_eq_u32 s56, 3
  s_cselect_b32 s70, mega_end-phase1, s70
  v_exp_f32 v39, v79
  v_add_f32 v22, v22, v37
  v_mfma_f32_32x32x16_bf16 a[96:111], a[184:187], v[156:159], a[96:111]
  s_waitcnt vmcnt(24) lgkmcnt(0)
  v_cvt_pk_bf16_f32 v134, v36, v37
  v_add_f32 v22, v22, v38
  v_add_f32 v22, v22, v39
  v_cvt_pk_bf16_f32 v135, v38, v39
  v_mfma_f32_32x32x16_bf16 a[112:127], a[188:191], v[156:159], a[112:127]
  s_barrier
  v_mfma_f32_32x32x16_bf16 v[96:111], a[128:131], v[192:195], v[160:175]
  ds_read_b64_tr_b16 a[160:161], v16 offset:16384
  ds_read_b64_tr_b16 a[162:163], v16 offset:17408
  v_exp_f32 v40, v80
  v_exp_f32 v41, v81
  v_mfma_f32_32x32x16_bf16 v[96:111], a[132:135], v[196:199], v[96:111]
  ds_read_b64_tr_b16 a[164:165], v17 offset:16384
  ds_read_b64_tr_b16 a[166:167], v17 offset:17408
  v_exp_f32 v42, v82
  v_mfma_f32_32x32x16_bf16 v[96:111], a[136:139], v[200:203], v[96:111]
  ds_read_b64_tr_b16 a[168:169], v18 offset:16384
  v_add_f32 v23, v40, v41
  v_exp_f32 v43, v83
  v_cvt_pk_bf16_f32 v136, v40, v41
  v_mfma_f32_32x32x16_bf16 v[96:111], a[140:143], v[204:207], v[96:111]
  ds_read_b64_tr_b16 a[170:171], v18 offset:17408
  v_exp_f32 v44, v84
  v_add_f32 v23, v23, v42
  v_mfma_f32_32x32x16_bf16 v[96:111], a[144:147], v[208:211], v[96:111]
  ds_read_b64_tr_b16 a[172:173], v19 offset:16384
  v_exp_f32 v45, v85
  v_add_f32 v23, v23, v43
  v_cvt_pk_bf16_f32 v137, v42, v43
  v_mfma_f32_32x32x16_bf16 v[96:111], a[148:151], v[212:215], v[96:111]
  ds_read_b64_tr_b16 a[174:175], v19 offset:17408
  v_exp_f32 v46, v86
  v_add_f32 v23, v23, v44
  v_exp_f32 v47, v87
  v_mfma_f32_32x32x16_bf16 v[96:111], a[152:155], v[216:219], v[96:111]
  ds_read_b64_tr_b16 a[176:177], v16 offset:20480
  v_add_f32 v23, v23, v45
  v_cvt_pk_bf16_f32 v138, v44, v45
  v_exp_f32 v40, v88
  v_mfma_f32_32x32x16_bf16 v[96:111], a[156:159], v[220:223], v[96:111]
  ds_read_b64_tr_b16 a[178:179], v16 offset:21504
  v_add_f32 v23, v23, v46
  v_exp_f32 v41, v89
  v_mfma_f32_32x32x16_bf16 v[112:127], a[128:131], v[224:227], v[176:191]
  ds_read_b64_tr_b16 a[180:181], v17 offset:20480
  v_add_f32 v23, v23, v47
  v_cvt_pk_bf16_f32 v139, v46, v47
  v_exp_f32 v42, v90
  v_mfma_f32_32x32x16_bf16 v[112:127], a[132:135], v[228:231], v[112:127]
  ds_read_b64_tr_b16 a[182:183], v17 offset:21504
  v_add_f32 v23, v23, v40
  v_exp_f32 v43, v91
  v_add_f32 v23, v23, v41
  v_mfma_f32_32x32x16_bf16 v[112:127], a[136:139], v[232:235], v[112:127]
  ds_read_b64_tr_b16 a[184:185], v18 offset:20480
  v_cvt_pk_bf16_f32 v140, v40, v41
  v_exp_f32 v44, v92
  v_mfma_f32_32x32x16_bf16 v[112:127], a[140:143], v[236:239], v[112:127]
  ds_read_b64_tr_b16 a[186:187], v18 offset:21504
  v_add_f32 v23, v23, v42
  v_exp_f32 v45, v93
  v_add_f32 v23, v23, v43
  v_mfma_f32_32x32x16_bf16 v[112:127], a[144:147], v[240:243], v[112:127]
  ds_read_b64_tr_b16 a[188:189], v19 offset:20480
  v_cvt_pk_bf16_f32 v141, v42, v43
  v_exp_f32 v46, v94
  v_add_f32 v23, v23, v44
  v_mfma_f32_32x32x16_bf16 v[112:127], a[148:151], v[244:247], v[112:127]
  ds_read_b64_tr_b16 a[190:191], v19 offset:21504
  v_exp_f32 v47, v95
  v_add_f32 v23, v23, v45
  v_cvt_pk_bf16_f32 v142, v44, v45
  v_mfma_f32_32x32x16_bf16 v[112:127], a[152:155], v[248:251], v[112:127]
  s_cmp_eq_u32 s56, 3
  s_cselect_b32 s58, s55, s58
  v_add_f32 v23, v23, v46
  v_add_f32 v23, v23, v47
  v_cvt_pk_bf16_f32 v143, v46, v47
  v_mfma_f32_32x32x16_bf16 v[112:127], a[156:159], v[252:255], v[112:127]
  s_waitcnt lgkmcnt(0)
  v_max_f32 v26, v22, v23
  v_cmp_nge_f32 vcc, s54, v26
  s_cbranch_vccnz attn_kernel_slow23
attn_kernel_ret24:
  v_mfma_f32_32x32x16_bf16 a[0:15], a[160:163], v[128:131], a[0:15]
  ds_read_b128 a[128:131], v8 offset:32768
  v_add_f32 v20, v20, v22
  v_add_f32 v21, v21, v23
  v_exp_f32 v32, v96
  v_mfma_f32_32x32x16_bf16 a[16:31], a[164:167], v[128:131], a[16:31]
  s_add_u32 m0, s43, 24576
  v_exp_f32 v33, v97
  v_exp_f32 v34, v98
  v_mfma_f32_32x32x16_bf16 a[32:47], a[168:171], v[128:131], a[32:47]
  buffer_load_dwordx4 v4, s[12:15], s52 offen lds
  v_add_f32 v22, v32, v33
  v_exp_f32 v35, v99
  v_cvt_pk_bf16_f32 v144, v32, v33
  v_mfma_f32_32x32x16_bf16 a[48:63], a[172:175], v[128:131], a[48:63]
  ds_read_b128 a[132:135], v9 offset:32768
  v_exp_f32 v36, v100
  v_add_f32 v22, v22, v34
  v_exp_f32 v37, v101
  v_mfma_f32_32x32x16_bf16 a[0:15], a[176:179], v[132:135], a[0:15]
  buffer_load_dwordx4 v5, s[12:15], s52 offen offset:1024 lds
  v_add_f32 v22, v22, v35
  v_cvt_pk_bf16_f32 v145, v34, v35
  v_exp_f32 v38, v102
  v_mfma_f32_32x32x16_bf16 a[16:31], a[180:183], v[132:135], a[16:31]
  ds_read_b128 a[136:139], v10 offset:32768
  s_add_u32 s52, s52, 8192
  v_add_f32 v22, v22, v36
  v_exp_f32 v39, v103
  v_mfma_f32_32x32x16_bf16 a[32:47], a[184:187], v[132:135], a[32:47]
  s_add_u32 m0, s43, 73728
  ds_read_b128 a[140:143], v11 offset:32768
  v_add_f32 v22, v22, v37
  v_cvt_pk_bf16_f32 v146, v36, v37
  v_mfma_f32_32x32x16_bf16 a[48:63], a[188:191], v[132:135], a[48:63]
  buffer_load_dwordx4 v6, s[16:19], s53 offen lds
  v_exp_f32 v32, v104
  v_add_f32 v22, v22, v38
  v_exp_f32 v33, v105
  v_mfma_f32_32x32x16_bf16 a[64:79], a[160:163], v[136:139], a[64:79]
  ds_read_b128 a[144:147], v12 offset:32768
  v_add_f32 v22, v22, v39
  v_cvt_pk_bf16_f32 v147, v38, v39
  v_exp_f32 v34, v106
  v_mfma_f32_32x32x16_bf16 a[80:95], a[164:167], v[136:139], a[80:95]
  buffer_load_dwordx4 v6, s[16:19], s53 offen offset:1024 lds
  v_add_f32 v22, v22, v32
  v_exp_f32 v35, v107
  v_add_f32 v22, v22, v33
  v_mfma_f32_32x32x16_bf16 a[96:111], a[168:171], v[136:139], a[96:111]
  ds_read_b128 a[148:151], v13 offset:32768
  s_add_u32 s53, s53, 8192
  v_cvt_pk_bf16_f32 v148, v32, v33
  v_exp_f32 v36, v108
  v_mfma_f32_32x32x16_bf16 a[112:127], a[172:175], v[136:139], a[112:127]
  ds_read_b128 a[152:155], v14 offset:32768
  v_add_f32 v22, v22, v34
  v_exp_f32 v37, v109
  v_add_f32 v22, v22, v35
  v_mfma_f32_32x32x16_bf16 a[64:79], a[176:179], v[140:143], a[64:79]
  ds_read_b128 a[156:159], v15 offset:32768
  v_cvt_pk_bf16_f32 v149, v34, v35
  v_exp_f32 v38, v110
  v_add_f32 v22, v22, v36
  v_mfma_f32_32x32x16_bf16 a[80:95], a[180:183], v[140:143], a[80:95]
  s_sub_u32 s56, s56, 1
  s_cmp_lg_u32 s56, 0
  v_exp_f32 v39, v111
  v_add_f32 v22, v22, v37
  v_mfma_f32_32x32x16_bf16 a[96:111], a[184:187], v[140:143], a[96:111]
  s_waitcnt vmcnt(24) lgkmcnt(0)
  v_cvt_pk_bf16_f32 v150, v36, v37
  v_add_f32 v22, v22, v38
  v_add_f32 v22, v22, v39
  v_cvt_pk_bf16_f32 v151, v38, v39
  v_mfma_f32_32x32x16_bf16 a[112:127], a[188:191], v[140:143], a[112:127]
  s_barrier
  s_cbranch_scc1 attn_kernel_loop8
  s_lshl_b32 s48, s46, 18
  s_lshl_b32 s49, s41, 13
  s_add_u32 s48, s48, s49
  s_add_u32 s49, s48, 0x40000
  v_add_u32 v31, 4096, v3
  v_mfma_f32_32x32x16_bf16 v[64:79], a[128:131], v[192:195], v[160:175]
  ds_read_b64_tr_b16 a[160:161], v16 offset:24576
  ds_read_b64_tr_b16 a[162:163], v16 offset:25600
  ds_read_b64_tr_b16 a[164:165], v17 offset:24576
  v_exp_f32 v40, v112
  v_mfma_f32_32x32x16_bf16 v[64:79], a[132:135], v[196:199], v[64:79]
  ds_read_b64_tr_b16 a[166:167], v17 offset:25600
  ds_read_b64_tr_b16 a[168:169], v18 offset:24576
  ds_read_b64_tr_b16 a[170:171], v18 offset:25600
  v_exp_f32 v41, v113
  v_mfma_f32_32x32x16_bf16 v[64:79], a[136:139], v[200:203], v[64:79]
  ds_read_b64_tr_b16 a[172:173], v19 offset:24576
  ds_read_b64_tr_b16 a[174:175], v19 offset:25600
  v_exp_f32 v42, v114
  v_add_f32 v23, v40, v41
  v_mfma_f32_32x32x16_bf16 v[64:79], a[140:143], v[204:207], v[64:79]
  ds_read_b64_tr_b16 a[176:177], v16 offset:28672
  ds_read_b64_tr_b16 a[178:179], v16 offset:29696
  ds_read_b64_tr_b16 a[180:181], v17 offset:28672
  v_exp_f32 v43, v115
  v_cvt_pk_bf16_f32 v152, v40, v41
  v_mfma_f32_32x32x16_bf16 v[64:79], a[144:147], v[208:211], v[64:79]
  ds_read_b64_tr_b16 a[182:183], v17 offset:29696
  ds_read_b64_tr_b16 a[184:185], v18 offset:28672
  ds_read_b64_tr_b16 a[186:187], v18 offset:29696
  v_exp_f32 v44, v116
  v_add_f32 v23, v23, v42
  v_mfma_f32_32x32x16_bf16 v[64:79], a[148:151], v[212:215], v[64:79]
  ds_read_b64_tr_b16 a[188:189], v19 offset:28672
  ds_read_b64_tr_b16 a[190:191], v19 offset:29696
  v_exp_f32 v45, v117
  v_add_f32 v23, v23, v43
  v_cvt_pk_bf16_f32 v153, v42, v43
  v_mfma_f32_32x32x16_bf16 v[64:79], a[152:155], v[216:219], v[64:79]
  v_exp_f32 v46, v118
  v_add_f32 v23, v23, v44
  v_exp_f32 v47, v119
  v_add_f32 v23, v23, v45
  v_mfma_f32_32x32x16_bf16 v[64:79], a[156:159], v[220:223], v[64:79]
  v_cmp_nge_f32 vcc, s54, v22
  s_cbranch_vccnz attn_kernel_slow25
attn_kernel_ret26:
  v_add_f32 v20, v20, v22
  s_waitcnt lgkmcnt(14)
  v_mfma_f32_32x32x16_bf16 a[0:15], a[160:163], v[144:147], a[0:15]
  ds_read_b128 a[128:131], v8 offset:40960
  ds_read_b128 a[132:135], v9 offset:40960
  v_cvt_pk_bf16_f32 v154, v44, v45
  v_exp_f32 v40, v120
  v_add_f32 v23, v23, v46
  s_waitcnt lgkmcnt(14)
  v_mfma_f32_32x32x16_bf16 a[16:31], a[164:167], v[144:147], a[16:31]
  ds_read_b128 a[136:139], v10 offset:40960
  v_exp_f32 v41, v121
  v_add_f32 v23, v23, v47
  v_cvt_pk_bf16_f32 v155, v46, v47
  s_waitcnt lgkmcnt(13)
  v_mfma_f32_32x32x16_bf16 a[32:47], a[168:171], v[144:147], a[32:47]
  ds_read_b128 a[140:143], v11 offset:40960
  v_exp_f32 v42, v122
  v_add_f32 v23, v23, v40
  v_exp_f32 v43, v123
  s_waitcnt lgkmcnt(12)
  v_mfma_f32_32x32x16_bf16 a[48:63], a[172:175], v[144:147], a[48:63]
  ds_read_b128 a[144:147], v12 offset:40960
  v_exp_f32 v32, v64
  v_exp_f32 v33, v65
  v_add_f32 v23, v23, v41
  s_waitcnt lgkmcnt(11)
  v_mfma_f32_32x32x16_bf16 a[0:15], a[176:179], v[148:151], a[0:15]
  s_waitcnt vmcnt(8)
  s_barrier
  ds_read_b128 a[148:151], v13 offset:40960
  v_exp_f32 v34, v66
  v_add_f32 v22, v32, v33
  v_exp_f32 v35, v67
  s_waitcnt lgkmcnt(10)
  v_mfma_f32_32x32x16_bf16 a[16:31], a[180:183], v[148:151], a[16:31]
  ds_read_b128 a[152:155], v14 offset:40960
  v_cvt_pk_bf16_f32 v128, v32, v33
  v_exp_f32 v36, v68
  v_add_f32 v22, v22, v34
  v_cvt_pk_bf16_f32 v156, v40, v41
  s_waitcnt lgkmcnt(9)
  v_mfma_f32_32x32x16_bf16 a[32:47], a[184:187], v[148:151], a[32:47]
  ds_read_b64_tr_b16 a[192:193], v16 offset:32768
  ds_read_b64_tr_b16 a[194:195], v16 offset:33792
  ds_read_b128 a[156:159], v15 offset:40960
  v_exp_f32 v37, v69
  v_add_f32 v22, v22, v35
  v_cvt_pk_bf16_f32 v129, v34, v35
  s_waitcnt lgkmcnt(10)
  v_mfma_f32_32x32x16_bf16 a[48:63], a[188:191], v[148:151], a[48:63]
  s_cmp_lg_u32 s40, 0
  s_cbranch_scc1 attn_kernel_noflag1
  s_lshl_b32 s80, s2, 2
  v_mov_b32 v24, 1
  v_mov_b32 v25, 0
  s_mov_b64 exec, 1
  buffer_store_dword v24, v25, s[76:79], s80 offen sc0 sc1
  s_mov_b64 exec, -1
attn_kernel_noflag1:
  ds_read_b64_tr_b16 a[196:197], v17 offset:32768
  ds_read_b64_tr_b16 a[198:199], v17 offset:33792
  v_exp_f32 v38, v70
  v_add_f32 v22, v22, v36
  v_exp_f32 v39, v71
  s_waitcnt lgkmcnt(11)
  v_mfma_f32_32x32x16_bf16 v[96:111], a[128:131], v[192:195], v[160:175]
  ds_read_b64_tr_b16 a[200:201], v18 offset:32768
  ds_read_b64_tr_b16 a[202:203], v18 offset:33792
  ds_read_b64_tr_b16 a[160:161], v16 offset:40960
  v_add_f32 v22, v22, v37
  v_cvt_pk_bf16_f32 v130, v36, v37
  v_exp_f32 v32, v72
  v_add_f32 v22, v22, v38
  s_waitcnt lgkmcnt(13)
  v_mfma_f32_32x32x16_bf16 v[96:111], a[132:135], v[196:199], v[96:111]
  ds_read_b64_tr_b16 a[204:205], v19 offset:32768
  ds_read_b64_tr_b16 a[206:207], v19 offset:33792
  ds_read_b64_tr_b16 a[162:163], v16 offset:41984
  v_exp_f32 v33, v73
  v_add_f32 v22, v22, v39
  v_cvt_pk_bf16_f32 v131, v38, v39
  s_waitcnt lgkmcnt(15)
  v_mfma_f32_32x32x16_bf16 v[96:111], a[136:139], v[200:203], v[96:111]
  ds_read_b64_tr_b16 a[208:209], v16 offset:36864
  ds_read_b64_tr_b16 a[210:211], v16 offset:37888
  ds_read_b64_tr_b16 a[164:165], v17 offset:40960
  v_exp_f32 v34, v74
  v_add_f32 v22, v22, v32
  v_exp_f32 v35, v75
  s_waitcnt lgkmcnt(15)
  v_mfma_f32_32x32x16_bf16 v[96:111], a[140:143], v[204:207], v[96:111]
  ds_read_b64_tr_b16 a[212:213], v17 offset:36864
  ds_read_b64_tr_b16 a[214:215], v17 offset:37888
  v_add_f32 v22, v22, v33
  v_cvt_pk_bf16_f32 v132, v32, v33
  v_exp_f32 v36, v76
  v_add_f32 v22, v22, v34
  v_mfma_f32_32x32x16_bf16 v[96:111], a[144:147], v[208:211], v[96:111]
  ds_read_b64_tr_b16 a[216:217], v18 offset:36864
  ds_read_b64_tr_b16 a[218:219], v18 offset:37888
  ds_read_b64_tr_b16 a[166:167], v17 offset:41984
  v_exp_f32 v37, v77
  v_add_f32 v22, v22, v35
  v_cvt_pk_bf16_f32 v133, v34, v35
  v_mfma_f32_32x32x16_bf16 v[96:111], a[148:151], v[212:215], v[96:111]
  ds_read_b64_tr_b16 a[220:221], v19 offset:36864
  ds_read_b64_tr_b16 a[222:223], v19 offset:37888
  ds_read_b64_tr_b16 a[168:169], v18 offset:40960
  v_exp_f32 v38, v78
  v_add_f32 v22, v22, v36
  v_exp_f32 v39, v79
  s_waitcnt lgkmcnt(15)
  v_mfma_f32_32x32x16_bf16 v[96:111], a[152:155], v[216:219], v[96:111]
  ds_read_b64_tr_b16 a[170:171], v18 offset:41984
  v_add_f32 v22, v22, v37
  v_cvt_pk_bf16_f32 v134, v36, v37
  v_add_f32 v22, v22, v38
  v_add_f32 v22, v22, v39
  v_cvt_pk_bf16_f32 v135, v38, v39
  v_mfma_f32_32x32x16_bf16 v[96:111], a[156:159], v[220:223], v[96:111]
  v_cmp_nge_f32 vcc, s54, v22
  s_cbranch_vccnz attn_kernel_slow27
attn_kernel_ret28:
  v_add_f32 v20, v20, v22
  v_mfma_f32_32x32x16_bf16 a[0:15], a[192:195], v[128:131], a[0:15]
  ds_read_b64_tr_b16 a[172:173], v19 offset:40960
  ds_read_b128 a[128:131], v8 offset:49152
  ds_read_b128 a[132:135], v9 offset:49152
  v_exp_f32 v44, v124
  v_add_f32 v23, v23, v42
  v_mfma_f32_32x32x16_bf16 a[16:31], a[196:199], v[128:131], a[16:31]
  ds_read_b64_tr_b16 a[174:175], v19 offset:41984
  ds_read_b128 a[136:139], v10 offset:49152
  v_exp_f32 v45, v125
  v_add_f32 v23, v23, v43
  v_cvt_pk_bf16_f32 v157, v42, v43
  v_mfma_f32_32x32x16_bf16 a[32:47], a[200:203], v[128:131], a[32:47]
  ds_read_b128 a[140:143], v11 offset:49152
  v_exp_f32 v46, v126
  v_add_f32 v23, v23, v44
  v_exp_f32 v47, v127
  s_waitcnt lgkmcnt(15)
  v_mfma_f32_32x32x16_bf16 a[48:63], a[204:207], v[128:131], a[48:63]
  ds_read_b64_tr_b16 a[176:177], v16 offset:45056
  ds_read_b128 a[144:147], v12 offset:49152
  v_exp_f32 v32, v96
  v_exp_f32 v33, v97
  v_mfma_f32_32x32x16_bf16 a[0:15], a[208:211], v[132:135], a[0:15]
  ds_read_b64_tr_b16 a[178:179], v16 offset:46080
  ds_read_b128 a[148:151], v13 offset:49152
  v_exp_f32 v34, v98
  v_add_f32 v22, v32, v33
  v_exp_f32 v35, v99
  s_waitcnt lgkmcnt(15)
  v_mfma_f32_32x32x16_bf16 a[16:31], a[212:215], v[132:135], a[16:31]
  ds_read_b64_tr_b16 a[180:181], v17 offset:45056
  ds_read_b128 a[152:155], v14 offset:49152
  v_cvt_pk_bf16_f32 v144, v32, v33
  v_exp_f32 v36, v100
  v_add_f32 v22, v22, v34
  v_mfma_f32_32x32x16_bf16 a[32:47], a[216:219], v[132:135], a[32:47]
  ds_read_b128 a[156:159], v15 offset:49152
  v_exp_f32 v37, v101
  v_add_f32 v22, v22, v35
  v_cvt_pk_bf16_f32 v145, v34, v35
  v_add_f32 v23, v23, v45
  s_waitcnt lgkmcnt(15)
  v_mfma_f32_32x32x16_bf16 a[48:63], a[220:223], v[132:135], a[48:63]
  ds_read_b64_tr_b16 a[182:183], v17 offset:46080
  v_exp_f32 v38, v102
  v_add_f32 v22, v22, v36
  v_exp_f32 v39, v103
  s_waitcnt lgkmcnt(12)
  v_mfma_f32_32x32x16_bf16 v[64:79], a[128:131], v[192:195], v[160:175]
  ds_read_b64_tr_b16 a[184:185], v18 offset:45056
  ds_read_b64_tr_b16 a[192:193], v16 offset:49152
  v_add_f32 v22, v22, v37
  v_cvt_pk_bf16_f32 v146, v36, v37
  v_exp_f32 v32, v104
  v_add_f32 v22, v22, v38
  s_waitcnt lgkmcnt(13)
  v_mfma_f32_32x32x16_bf16 v[64:79], a[132:135], v[196:199], v[64:79]
  ds_read_b64_tr_b16 a[186:187], v18 offset:46080
  ds_read_b64_tr_b16 a[194:195], v16 offset:50176
  v_exp_f32 v33, v105
  v_add_f32 v22, v22, v39
  v_cvt_pk_bf16_f32 v147, v38, v39
  s_waitcnt lgkmcnt(13)
  v_mfma_f32_32x32x16_bf16 v[64:79], a[136:139], v[200:203], v[64:79]
  ds_read_b64_tr_b16 a[196:197], v17 offset:49152
  v_exp_f32 v34, v106
  v_add_f32 v22, v22, v32
  v_exp_f32 v35, v107
  s_waitcnt lgkmcnt(13)
  v_mfma_f32_32x32x16_bf16 v[64:79], a[140:143], v[204:207], v[64:79]
  ds_read_b64_tr_b16 a[188:189], v19 offset:45056
  v_add_f32 v22, v22, v33
  v_cvt_pk_bf16_f32 v148, v32, v33
  v_exp_f32 v36, v108
  v_add_f32 v22, v22, v34
  s_waitcnt lgkmcnt(12)
  v_mfma_f32_32x32x16_bf16 v[64:79], a[144:147], v[208:211], v[64:79]
  ds_read_b64_tr_b16 a[190:191], v19 offset:46080
  ds_read_b64_tr_b16 a[198:199], v17 offset:50176
  v_exp_f32 v37, v109
  v_add_f32 v22, v22, v35
  v_cvt_pk_bf16_f32 v149, v34, v35
  s_waitcnt lgkmcnt(12)
  v_mfma_f32_32x32x16_bf16 v[64:79], a[148:151], v[212:215], v[64:79]
  ds_read_b64_tr_b16 a[200:201], v18 offset:49152
  v_exp_f32 v38, v110
  v_add_f32 v22, v22, v36
  v_exp_f32 v39, v111
  s_waitcnt lgkmcnt(11)
  v_mfma_f32_32x32x16_bf16 v[64:79], a[152:155], v[216:219], v[64:79]
  ds_read_b64_tr_b16 a[202:203], v18 offset:50176
  v_add_f32 v22, v22, v37
  v_cvt_pk_bf16_f32 v150, v36, v37
  v_add_f32 v22, v22, v38
  v_add_f32 v22, v22, v39
  v_cvt_pk_bf16_f32 v151, v38, v39
  s_waitcnt lgkmcnt(11)
  v_mfma_f32_32x32x16_bf16 v[64:79], a[156:159], v[220:223], v[64:79]
  v_cmp_nge_f32 vcc, s54, v22
  s_cbranch_vccnz attn_kernel_slow29
attn_kernel_ret30:
  v_add_f32 v20, v20, v22
  v_mfma_f32_32x32x16_bf16 a[0:15], a[160:163], v[144:147], a[0:15]
  ds_read_b64_tr_b16 a[204:205], v19 offset:49152
  ds_read_b128 a[128:131], v8 offset:57344
  ds_read_b128 a[132:135], v9 offset:57344
  v_cvt_pk_bf16_f32 v158, v44, v45
  v_add_f32 v23, v23, v46
  v_add_f32 v23, v23, v47
  v_mfma_f32_32x32x16_bf16 a[16:31], a[164:167], v[144:147], a[16:31]
  ds_read_b64_tr_b16 a[206:207], v19 offset:50176
  ds_read_b128 a[136:139], v10 offset:57344
  v_cvt_pk_bf16_f32 v159, v46, v47
  v_mfma_f32_32x32x16_bf16 a[32:47], a[168:171], v[144:147], a[32:47]
  ds_read_b128 a[140:143], v11 offset:57344
  v_mfma_f32_32x32x16_bf16 a[48:63], a[172:175], v[144:147], a[48:63]
  ds_read_b64_tr_b16 a[208:209], v16 offset:53248
  ds_read_b128 a[144:147], v12 offset:57344
  v_exp_f32 v32, v64
  v_exp_f32 v33, v65
  v_mfma_f32_32x32x16_bf16 a[0:15], a[176:179], v[148:151], a[0:15]
  ds_read_b64_tr_b16 a[210:211], v16 offset:54272
  ds_read_b128 a[148:151], v13 offset:57344
  v_exp_f32 v34, v66
  v_add_f32 v22, v32, v33
  v_exp_f32 v35, v67
  s_waitcnt lgkmcnt(15)
  v_mfma_f32_32x32x16_bf16 a[16:31], a[180:183], v[148:151], a[16:31]
  ds_read_b64_tr_b16 a[212:213], v17 offset:53248
  ds_read_b128 a[152:155], v14 offset:57344
  v_cvt_pk_bf16_f32 v128, v32, v33
  v_exp_f32 v36, v68
  v_add_f32 v22, v22, v34
  v_mfma_f32_32x32x16_bf16 a[32:47], a[184:187], v[148:151], a[32:47]
  ds_read_b128 a[156:159], v15 offset:57344
  v_exp_f32 v37, v69
  v_add_f32 v22, v22, v35
  v_cvt_pk_bf16_f32 v129, v34, v35
  s_waitcnt lgkmcnt(15)
  v_mfma_f32_32x32x16_bf16 a[48:63], a[188:191], v[148:151], a[48:63]
  ds_read_b64_tr_b16 a[214:215], v17 offset:54272
  v_exp_f32 v38, v70
  v_add_f32 v22, v22, v36
  v_exp_f32 v39, v71
  s_waitcnt lgkmcnt(12)
  v_mfma_f32_32x32x16_bf16 v[96:111], a[128:131], v[192:195], v[160:175]
  ds_read_b64_tr_b16 a[216:217], v18 offset:53248
  ds_read_b64_tr_b16 a[160:161], v16 offset:24576
  v_add_f32 v22, v22, v37
  v_cvt_pk_bf16_f32 v130, v36, v37
  v_exp_f32 v32, v72
  v_add_f32 v22, v22, v38
  s_waitcnt lgkmcnt(13)
  v_mfma_f32_32x32x16_bf16 v[96:111], a[132:135], v[196:199], v[96:111]
  ds_read_b64_tr_b16 a[218:219], v18 offset:54272
  ds_read_b64_tr_b16 a[162:163], v16 offset:25600
  v_exp_f32 v33, v73
  v_add_f32 v22, v22, v39
  v_cvt_pk_bf16_f32 v131, v38, v39
  s_waitcnt lgkmcnt(13)
  v_mfma_f32_32x32x16_bf16 v[96:111], a[136:139], v[200:203], v[96:111]
  ds_read_b64_tr_b16 a[164:165], v17 offset:24576
  v_exp_f32 v34, v74
  v_add_f32 v22, v22, v32
  v_exp_f32 v35, v75
  s_waitcnt lgkmcnt(13)
  v_mfma_f32_32x32x16_bf16 v[96:111], a[140:143], v[204:207], v[96:111]
  ds_read_b64_tr_b16 a[220:221], v19 offset:53248
  v_add_f32 v22, v22, v33
  v_cvt_pk_bf16_f32 v132, v32, v33
  v_exp_f32 v36, v76
  v_add_f32 v22, v22, v34
  s_waitcnt lgkmcnt(12)
  v_mfma_f32_32x32x16_bf16 v[96:111], a[144:147], v[208:211], v[96:111]
  ds_read_b64_tr_b16 a[222:223], v19 offset:54272
  ds_read_b64_tr_b16 a[166:167], v17 offset:25600
  v_exp_f32 v37, v77
  v_add_f32 v22, v22, v35
  v_cvt_pk_bf16_f32 v133, v34, v35
  s_waitcnt lgkmcnt(12)
  v_mfma_f32_32x32x16_bf16 v[96:111], a[148:151], v[212:215], v[96:111]
  ds_read_b64_tr_b16 a[168:169], v18 offset:24576
  v_exp_f32 v38, v78
  v_add_f32 v22, v22, v36
  v_exp_f32 v39, v79
  s_waitcnt lgkmcnt(11)
  v_mfma_f32_32x32x16_bf16 v[96:111], a[152:155], v[216:219], v[96:111]
  ds_read_b64_tr_b16 a[170:171], v18 offset:25600
  v_add_f32 v22, v22, v37
  v_cvt_pk_bf16_f32 v134, v36, v37
  v_add_f32 v22, v22, v38
  v_add_f32 v22, v22, v39
  v_cvt_pk_bf16_f32 v135, v38, v39
  s_waitcnt lgkmcnt(11)
  v_mfma_f32_32x32x16_bf16 v[96:111], a[156:159], v[220:223], v[96:111]
  v_cmp_nge_f32 vcc, s54, v22
  s_cbranch_vccnz attn_kernel_slow31
attn_kernel_ret32:
  v_add_f32 v20, v20, v22
  v_mfma_f32_32x32x16_bf16 a[0:15], a[192:195], v[128:131], a[0:15]
  ds_read_b64_tr_b16 a[172:173], v19 offset:24576
  ds_read_b128 a[128:131], v8 offset:32768
  ds_read_b128 a[132:135], v9 offset:32768
  v_mfma_f32_32x32x16_bf16 a[16:31], a[196:199], v[128:131], a[16:31]
  ds_read_b64_tr_b16 a[174:175], v19 offset:25600
  ds_read_b128 a[136:139], v10 offset:32768
  v_mfma_f32_32x32x16_bf16 a[32:47], a[200:203], v[128:131], a[32:47]
  ds_read_b128 a[140:143], v11 offset:32768
  v_mfma_f32_32x32x16_bf16 a[48:63], a[204:207], v[128:131], a[48:63]
  ds_read_b64_tr_b16 a[176:177], v16 offset:28672
  ds_read_b128 a[144:147], v12 offset:32768
  v_exp_f32 v32, v96
  v_exp_f32 v33, v97
  v_mfma_f32_32x32x16_bf16 a[0:15], a[208:211], v[132:135], a[0:15]
  ds_read_b64_tr_b16 a[178:179], v16 offset:29696
  ds_read_b128 a[148:151], v13 offset:32768
  v_exp_f32 v34, v98
  v_add_f32 v22, v32, v33
  s_waitcnt lgkmcnt(15)
  v_mfma_f32_32x32x16_bf16 a[16:31], a[212:215], v[132:135], a[16:31]
  ds_read_b64_tr_b16 a[180:181], v17 offset:28672
  ds_read_b128 a[152:155], v14 offset:32768
  v_exp_f32 v35, v99
  v_cvt_pk_bf16_f32 v144, v32, v33
  v_mfma_f32_32x32x16_bf16 a[32:47], a[216:219], v[132:135], a[32:47]
  ds_read_b128 a[156:159], v15 offset:32768
  v_exp_f32 v36, v100
  v_add_f32 v22, v22, v34
  v_exp_f32 v37, v101
  s_waitcnt lgkmcnt(15)
  v_mfma_f32_32x32x16_bf16 a[48:63], a[220:223], v[132:135], a[48:63]
  ds_read_b64_tr_b16 a[182:183], v17 offset:29696
  v_add_f32 v22, v22, v35
  v_cvt_pk_bf16_f32 v145, v34, v35
  v_exp_f32 v38, v102
  v_add_f32 v22, v22, v36
  s_waitcnt lgkmcnt(12)
  v_mfma_f32_32x32x16_bf16 v[80:95], a[128:131], v[224:227], v[176:191]
  ds_read_b64_tr_b16 a[184:185], v18 offset:28672
  ds_read_b64_tr_b16 a[192:193], v16 offset:57344
  ds_read_b64_tr_b16 a[194:195], v16 offset:58368
  v_exp_f32 v39, v103
  v_add_f32 v22, v22, v37
  s_waitcnt lgkmcnt(14)
  v_mfma_f32_32x32x16_bf16 v[80:95], a[132:135], v[228:231], v[80:95]
  ds_read_b64_tr_b16 a[186:187], v18 offset:29696
  ds_read_b64_tr_b16 a[196:197], v17 offset:57344
  v_cvt_pk_bf16_f32 v146, v36, v37
  v_exp_f32 v32, v104
  v_add_f32 v22, v22, v38
  s_waitcnt lgkmcnt(14)
  v_mfma_f32_32x32x16_bf16 v[80:95], a[136:139], v[232:235], v[80:95]
  ds_read_b64_tr_b16 a[198:199], v17 offset:58368
  v_exp_f32 v33, v105
  v_add_f32 v22, v22, v39
  v_cvt_pk_bf16_f32 v147, v38, v39
  s_waitcnt lgkmcnt(14)
  v_mfma_f32_32x32x16_bf16 v[80:95], a[140:143], v[236:239], v[80:95]
  ds_read_b64_tr_b16 a[188:189], v19 offset:28672
  ds_read_b64_tr_b16 a[200:201], v18 offset:57344
  v_exp_f32 v34, v106
  v_add_f32 v22, v22, v32
  s_waitcnt lgkmcnt(14)
  v_mfma_f32_32x32x16_bf16 v[80:95], a[144:147], v[240:243], v[80:95]
  ds_read_b64_tr_b16 a[190:191], v19 offset:29696
  ds_read_b64_tr_b16 a[202:203], v18 offset:58368
  v_exp_f32 v35, v107
  v_add_f32 v22, v22, v33
  v_cvt_pk_bf16_f32 v148, v32, v33
  s_waitcnt lgkmcnt(14)
  v_mfma_f32_32x32x16_bf16 v[80:95], a[148:151], v[244:247], v[80:95]
  ds_read_b64_tr_b16 a[204:205], v19 offset:57344
  v_exp_f32 v36, v108
  v_add_f32 v22, v22, v34
  v_exp_f32 v37, v109
  s_waitcnt lgkmcnt(13)
  v_mfma_f32_32x32x16_bf16 v[80:95], a[152:155], v[248:251], v[80:95]
  ds_read_b64_tr_b16 a[206:207], v19 offset:58368
  v_add_f32 v22, v22, v35
  v_cvt_pk_bf16_f32 v149, v34, v35
  v_exp_f32 v38, v110
  v_add_f32 v22, v22, v36
  s_waitcnt lgkmcnt(13)
  v_mfma_f32_32x32x16_bf16 v[80:95], a[156:159], v[252:255], v[80:95]
  ds_read_b64_tr_b16 a[208:209], v16 offset:61440
  ds_read_b64_tr_b16 a[210:211], v16 offset:62464
  v_cmp_nge_f32 vcc, s54, v23
  s_cbranch_vccnz attn_kernel_slow33
attn_kernel_ret34:
  v_add_f32 v21, v21, v23
  v_mfma_f32_32x32x16_bf16 a[64:79], a[160:163], v[152:155], a[64:79]
  ds_read_b64_tr_b16 a[212:213], v17 offset:61440
  ds_read_b128 a[128:131], v8 offset:40960
  v_exp_f32 v39, v111
  v_add_f32 v22, v22, v37
  v_cvt_pk_bf16_f32 v150, v36, v37
  v_mfma_f32_32x32x16_bf16 a[80:95], a[164:167], v[152:155], a[80:95]
  ds_read_b64_tr_b16 a[214:215], v17 offset:62464
  ds_read_b128 a[132:135], v9 offset:40960
  v_add_f32 v22, v22, v38
  v_add_f32 v22, v22, v39
  v_cvt_pk_bf16_f32 v151, v38, v39
  v_mfma_f32_32x32x16_bf16 a[96:111], a[168:171], v[152:155], a[96:111]
  ds_read_b64_tr_b16 a[216:217], v18 offset:61440
  v_mfma_f32_32x32x16_bf16 a[112:127], a[172:175], v[152:155], a[112:127]
  ds_read_b64_tr_b16 a[218:219], v18 offset:62464
  ds_read_b128 a[136:139], v10 offset:40960
  v_exp_f32 v40, v80
  v_exp_f32 v41, v81
  v_mfma_f32_32x32x16_bf16 a[64:79], a[176:179], v[156:159], a[64:79]
  ds_read_b64_tr_b16 a[220:221], v19 offset:61440
  v_exp_f32 v42, v82
  v_add_f32 v23, v40, v41
  v_exp_f32 v43, v83
  s_waitcnt lgkmcnt(15)
  v_mfma_f32_32x32x16_bf16 a[80:95], a[180:183], v[156:159], a[80:95]
  ds_read_b64_tr_b16 a[222:223], v19 offset:62464
  ds_read_b128 a[140:143], v11 offset:40960
  v_cvt_pk_bf16_f32 v136, v40, v41
  v_exp_f32 v44, v84
  v_add_f32 v23, v23, v42
  v_mfma_f32_32x32x16_bf16 a[96:111], a[184:187], v[156:159], a[96:111]
  v_exp_f32 v45, v85
  v_add_f32 v23, v23, v43
  v_cvt_pk_bf16_f32 v137, v42, v43
  v_exp_f32 v46, v86
  s_waitcnt lgkmcnt(15)
  v_mfma_f32_32x32x16_bf16 a[112:127], a[188:191], v[156:159], a[112:127]
  ds_read_b128 a[144:147], v12 offset:40960
  v_cmp_nge_f32 vcc, s54, v22
  s_cbranch_vccnz attn_kernel_slow35
attn_kernel_ret36:
  v_add_f32 v20, v20, v22
  v_mfma_f32_32x32x16_bf16 a[0:15], a[192:195], v[144:147], a[0:15]
  ds_read_b64_tr_b16 a[160:161], v16 offset:32768
  ds_read_b64_tr_b16 a[162:163], v16 offset:33792
  v_add_f32 v23, v23, v44
  v_exp_f32 v47, v87
  v_add_f32 v23, v23, v45
  v_mfma_f32_32x32x16_bf16 a[16:31], a[196:199], v[144:147], a[16:31]
  ds_read_b64_tr_b16 a[164:165], v17 offset:32768
  ds_read_b128 a[148:151], v13 offset:40960
  v_cvt_pk_bf16_f32 v138, v44, v45
  v_exp_f32 v40, v88
  v_add_f32 v23, v23, v46
  s_waitcnt lgkmcnt(15)
  v_mfma_f32_32x32x16_bf16 a[32:47], a[200:203], v[144:147], a[32:47]
  ds_read_b64_tr_b16 a[166:167], v17 offset:33792
  v_exp_f32 v41, v89
  v_add_f32 v23, v23, v47
  v_cvt_pk_bf16_f32 v139, v46, v47
  v_mfma_f32_32x32x16_bf16 a[48:63], a[204:207], v[144:147], a[48:63]
  ds_read_b64_tr_b16 a[168:169], v18 offset:32768
  ds_read_b128 a[152:155], v14 offset:40960
  v_exp_f32 v42, v90
  v_add_f32 v23, v23, v40
  v_mfma_f32_32x32x16_bf16 a[0:15], a[208:211], v[148:151], a[0:15]
  ds_read_b64_tr_b16 a[170:171], v18 offset:33792
  v_exp_f32 v43, v91
  v_add_f32 v23, v23, v41
  v_cvt_pk_bf16_f32 v140, v40, v41
  s_waitcnt lgkmcnt(15)
  v_mfma_f32_32x32x16_bf16 a[16:31], a[212:215], v[148:151], a[16:31]
  ds_read_b64_tr_b16 a[172:173], v19 offset:32768
  ds_read_b128 a[156:159], v15 offset:40960
  v_exp_f32 v44, v92
  v_add_f32 v23, v23, v42
  s_waitcnt lgkmcnt(15)
  v_mfma_f32_32x32x16_bf16 a[32:47], a[216:219], v[148:151], a[32:47]
  ds_read_b64_tr_b16 a[174:175], v19 offset:33792
  v_exp_f32 v45, v93
  v_add_f32 v23, v23, v43
  v_cvt_pk_bf16_f32 v141, v42, v43
  s_waitcnt lgkmcnt(13)
  v_mfma_f32_32x32x16_bf16 a[48:63], a[220:223], v[148:151], a[48:63]
  ds_read_b64_tr_b16 a[176:177], v16 offset:36864
  ds_read_b64_tr_b16 a[178:179], v16 offset:37888
  v_exp_f32 v46, v94
  v_add_f32 v23, v23, v44
  v_mfma_f32_32x32x16_bf16 v[112:127], a[128:131], v[224:227], v[176:191]
  ds_read_b64_tr_b16 a[180:181], v17 offset:36864
  ds_read_b64_tr_b16 a[192:193], v16 offset:40960
  v_exp_f32 v47, v95
  v_add_f32 v23, v23, v45
  v_cvt_pk_bf16_f32 v142, v44, v45
  v_mfma_f32_32x32x16_bf16 v[112:127], a[132:135], v[228:231], v[112:127]
  ds_read_b64_tr_b16 a[182:183], v17 offset:37888
  ds_read_b64_tr_b16 a[194:195], v16 offset:41984
  v_add_f32 v23, v23, v46
  v_add_f32 v23, v23, v47
  v_cvt_pk_bf16_f32 v143, v46, v47
  v_mfma_f32_32x32x16_bf16 v[112:127], a[136:139], v[232:235], v[112:127]
  ds_read_b64_tr_b16 a[184:185], v18 offset:36864
  ds_read_b64_tr_b16 a[196:197], v17 offset:40960
  v_mov_b32 v28, v20
  s_nop 1
  v_permlane32_swap_b32 v20, v28
  v_add_f32 v28, v28, v20
  s_waitcnt lgkmcnt(15)
  v_mfma_f32_32x32x16_bf16 v[112:127], a[140:143], v[236:239], v[112:127]
  ds_read_b64_tr_b16 a[186:187], v18 offset:37888
  v_rcp_f32 v20, v28
  v_accvgpr_read_b32 v192, a0
  v_accvgpr_read_b32 v193, a1
  v_accvgpr_read_b32 v194, a2
  v_mfma_f32_32x32x16_bf16 v[112:127], a[144:147], v[240:243], v[112:127]
  ds_read_b64_tr_b16 a[188:189], v19 offset:36864
  ds_read_b64_tr_b16 a[198:199], v17 offset:41984
  v_accvgpr_read_b32 v195, a3
  v_accvgpr_read_b32 v196, a4
  v_accvgpr_read_b32 v197, a5
  v_accvgpr_read_b32 v198, a6
  v_mfma_f32_32x32x16_bf16 v[112:127], a[148:151], v[244:247], v[112:127]
  ds_read_b64_tr_b16 a[190:191], v19 offset:37888
  ds_read_b64_tr_b16 a[200:201], v18 offset:40960
  v_accvgpr_read_b32 v199, a7
  v_mul_f32 v192, v192, v20
  v_mul_f32 v193, v193, v20
  v_mul_f32 v194, v194, v20
  s_waitcnt lgkmcnt(15)
  v_mfma_f32_32x32x16_bf16 v[112:127], a[152:155], v[248:251], v[112:127]
  ds_read_b64_tr_b16 a[202:203], v18 offset:41984
  v_mul_f32 v195, v195, v20
  v_mul_f32 v196, v196, v20
  v_mul_f32 v197, v197, v20
  v_mul_f32 v198, v198, v20
  v_mul_f32 v199, v199, v20
  s_waitcnt lgkmcnt(15)
  v_mfma_f32_32x32x16_bf16 v[112:127], a[156:159], v[252:255], v[112:127]
  v_cmp_nge_f32 vcc, s54, v23
  s_cbranch_vccnz attn_kernel_slow37
attn_kernel_ret38:
  v_add_f32 v21, v21, v23
  v_mfma_f32_32x32x16_bf16 a[64:79], a[160:163], v[136:139], a[64:79]
  ds_read_b64_tr_b16 a[204:205], v19 offset:40960
  ds_read_b128 a[128:131], v8 offset:49152
  ds_read_b128 a[132:135], v9 offset:49152
  v_cvt_pk_bf16_f32 v200, v192, v193
  v_cvt_pk_bf16_f32 v201, v194, v195
  v_cvt_pk_bf16_f32 v202, v196, v197
  v_mfma_f32_32x32x16_bf16 a[80:95], a[164:167], v[136:139], a[80:95]
  ds_read_b64_tr_b16 a[206:207], v19 offset:41984
  ds_read_b128 a[136:139], v10 offset:49152
  v_cvt_pk_bf16_f32 v203, v198, v199
  v_accvgpr_read_b32 v208, a8
  v_accvgpr_read_b32 v209, a9
  v_mfma_f32_32x32x16_bf16 a[96:111], a[168:171], v[136:139], a[96:111]
  ds_read_b128 a[140:143], v11 offset:49152
  buffer_store_dwordx4 v[200:203], v3, s[28:31], s48 offen offset:0 sc0 sc1
  v_accvgpr_read_b32 v210, a10
  v_accvgpr_read_b32 v211, a11
  v_accvgpr_read_b32 v212, a12
  v_accvgpr_read_b32 v213, a13
  v_accvgpr_read_b32 v214, a14
  s_waitcnt lgkmcnt(15)
  v_mfma_f32_32x32x16_bf16 a[112:127], a[172:175], v[136:139], a[112:127]
  ds_read_b64_tr_b16 a[208:209], v16 offset:45056
  ds_read_b128 a[144:147], v12 offset:49152
  v_accvgpr_read_b32 v215, a15
  v_mul_f32 v208, v208, v20
  v_mul_f32 v209, v209, v20
  v_mul_f32 v210, v210, v20
  v_exp_f32 v40, v112
  v_exp_f32 v41, v113
  v_mfma_f32_32x32x16_bf16 a[64:79], a[176:179], v[140:143], a[64:79]
  ds_read_b64_tr_b16 a[210:211], v16 offset:46080
  ds_read_b128 a[148:151], v13 offset:49152
  v_mul_f32 v211, v211, v20
  v_mul_f32 v212, v212, v20
  v_mul_f32 v213, v213, v20
  v_mul_f32 v214, v214, v20
  v_exp_f32 v42, v114
  v_add_f32 v23, v40, v41
  v_exp_f32 v43, v115
  v_mfma_f32_32x32x16_bf16 a[80:95], a[180:183], v[140:143], a[80:95]
  ds_read_b64_tr_b16 a[212:213], v17 offset:45056
  ds_read_b128 a[152:155], v14 offset:49152
  v_mul_f32 v215, v215, v20
  v_cvt_pk_bf16_f32 v216, v208, v209
  v_cvt_pk_bf16_f32 v217, v210, v211
  v_cvt_pk_bf16_f32 v218, v212, v213
  v_cvt_pk_bf16_f32 v152, v40, v41
  v_exp_f32 v44, v116
  v_add_f32 v23, v23, v42
  s_waitcnt lgkmcnt(15)
  v_mfma_f32_32x32x16_bf16 a[96:111], a[184:187], v[140:143], a[96:111]
  ds_read_b128 a[156:159], v15 offset:49152
  v_cvt_pk_bf16_f32 v219, v214, v215
  v_exp_f32 v45, v117
  v_add_f32 v23, v23, v43
  v_cvt_pk_bf16_f32 v153, v42, v43
  v_accvgpr_read_b32 v192, a16
  v_accvgpr_read_b32 v193, a17
  s_waitcnt lgkmcnt(15)
  v_mfma_f32_32x32x16_bf16 a[112:127], a[188:191], v[140:143], a[112:127]
  ds_read_b64_tr_b16 a[214:215], v17 offset:46080
  buffer_store_dwordx4 v[216:219], v3, s[28:31], s48 offen offset:1024 sc0 sc1
  v_exp_f32 v46, v118
  v_add_f32 v23, v23, v44
  v_exp_f32 v47, v119
  v_accvgpr_read_b32 v194, a18
  v_accvgpr_read_b32 v195, a19
  s_waitcnt lgkmcnt(12)
  v_mfma_f32_32x32x16_bf16 v[80:95], a[128:131], v[224:227], v[176:191]
  ds_read_b64_tr_b16 a[216:217], v18 offset:45056
  ds_read_b64_tr_b16 a[160:161], v16 offset:49152
  v_add_f32 v23, v23, v45
  v_cvt_pk_bf16_f32 v154, v44, v45
  v_exp_f32 v40, v120
  v_add_f32 v23, v23, v46
  v_accvgpr_read_b32 v196, a20
  v_accvgpr_read_b32 v197, a21
  s_waitcnt lgkmcnt(13)
  v_mfma_f32_32x32x16_bf16 v[80:95], a[132:135], v[228:231], v[80:95]
  ds_read_b64_tr_b16 a[218:219], v18 offset:46080
  ds_read_b64_tr_b16 a[162:163], v16 offset:50176
  v_exp_f32 v41, v121
  v_add_f32 v23, v23, v47
  v_cvt_pk_bf16_f32 v155, v46, v47
  v_accvgpr_read_b32 v198, a22
  v_accvgpr_read_b32 v199, a23
  s_waitcnt lgkmcnt(13)
  v_mfma_f32_32x32x16_bf16 v[80:95], a[136:139], v[232:235], v[80:95]
  ds_read_b64_tr_b16 a[164:165], v17 offset:49152
  v_exp_f32 v42, v122
  v_add_f32 v23, v23, v40
  v_exp_f32 v43, v123
  v_mul_f32 v192, v192, v20
  v_mul_f32 v193, v193, v20
  s_waitcnt lgkmcnt(13)
  v_mfma_f32_32x32x16_bf16 v[80:95], a[140:143], v[236:239], v[80:95]
  ds_read_b64_tr_b16 a[220:221], v19 offset:45056
  v_add_f32 v23, v23, v41
  v_cvt_pk_bf16_f32 v156, v40, v41
  v_exp_f32 v44, v124
  v_add_f32 v23, v23, v42
  v_mul_f32 v194, v194, v20
  v_mul_f32 v195, v195, v20
  s_waitcnt lgkmcnt(12)
  v_mfma_f32_32x32x16_bf16 v[80:95], a[144:147], v[240:243], v[80:95]
  ds_read_b64_tr_b16 a[222:223], v19 offset:46080
  ds_read_b64_tr_b16 a[166:167], v17 offset:50176
  v_exp_f32 v45, v125
  v_add_f32 v23, v23, v43
  v_cvt_pk_bf16_f32 v157, v42, v43
  v_mul_f32 v196, v196, v20
  v_mul_f32 v197, v197, v20
  s_waitcnt lgkmcnt(12)
  v_mfma_f32_32x32x16_bf16 v[80:95], a[148:151], v[244:247], v[80:95]
  ds_read_b64_tr_b16 a[168:169], v18 offset:49152
  v_exp_f32 v46, v126
  v_add_f32 v23, v23, v44
  v_exp_f32 v47, v127
  v_mul_f32 v198, v198, v20
  v_mul_f32 v199, v199, v20
  s_waitcnt lgkmcnt(11)
  v_mfma_f32_32x32x16_bf16 v[80:95], a[152:155], v[248:251], v[80:95]
  ds_read_b64_tr_b16 a[170:171], v18 offset:50176
  v_add_f32 v23, v23, v45
  v_cvt_pk_bf16_f32 v158, v44, v45
  v_add_f32 v23, v23, v46
  v_add_f32 v23, v23, v47
  v_cvt_pk_bf16_f32 v159, v46, v47
  s_waitcnt lgkmcnt(11)
  v_mfma_f32_32x32x16_bf16 v[80:95], a[156:159], v[252:255], v[80:95]
  v_cmp_nge_f32 vcc, s54, v23
  s_cbranch_vccnz attn_kernel_slow39
attn_kernel_ret40:
  v_add_f32 v21, v21, v23
  v_mfma_f32_32x32x16_bf16 a[64:79], a[192:195], v[152:155], a[64:79]
  ds_read_b64_tr_b16 a[172:173], v19 offset:49152
  ds_read_b128 a[128:131], v8 offset:57344
  ds_read_b128 a[132:135], v9 offset:57344
  v_cvt_pk_bf16_f32 v204, v192, v193
  v_cvt_pk_bf16_f32 v205, v194, v195
  v_cvt_pk_bf16_f32 v206, v196, v197
  v_mfma_f32_32x32x16_bf16 a[80:95], a[196:199], v[152:155], a[80:95]
  ds_read_b64_tr_b16 a[174:175], v19 offset:50176
  ds_read_b128 a[136:139], v10 offset:57344
  v_cvt_pk_bf16_f32 v207, v198, v199
  v_accvgpr_read_b32 v208, a24
  v_accvgpr_read_b32 v209, a25
  v_mfma_f32_32x32x16_bf16 a[96:111], a[200:203], v[152:155], a[96:111]
  ds_read_b128 a[140:143], v11 offset:57344
  buffer_store_dwordx4 v[204:207], v3, s[28:31], s48 offen offset:2048 sc0 sc1
  v_accvgpr_read_b32 v210, a26
  v_accvgpr_read_b32 v211, a27
  v_accvgpr_read_b32 v212, a28
  v_accvgpr_read_b32 v213, a29
  v_accvgpr_read_b32 v214, a30
  v_mfma_f32_32x32x16_bf16 a[112:127], a[204:207], v[152:155], a[112:127]
  ds_read_b64_tr_b16 a[176:177], v16 offset:53248
  ds_read_b128 a[144:147], v12 offset:57344
  v_accvgpr_read_b32 v215, a31
  v_mul_f32 v208, v208, v20
  v_mul_f32 v209, v209, v20
  v_mul_f32 v210, v210, v20
  v_exp_f32 v40, v80
  v_exp_f32 v41, v81
  v_mfma_f32_32x32x16_bf16 a[64:79], a[208:211], v[156:159], a[64:79]
  ds_read_b64_tr_b16 a[178:179], v16 offset:54272
  ds_read_b128 a[148:151], v13 offset:57344
  v_mul_f32 v211, v211, v20
  v_mul_f32 v212, v212, v20
  v_mul_f32 v213, v213, v20
  v_mul_f32 v214, v214, v20
  v_exp_f32 v42, v82
  v_add_f32 v23, v40, v41
  v_exp_f32 v43, v83
  s_waitcnt lgkmcnt(15)
  v_mfma_f32_32x32x16_bf16 a[80:95], a[212:215], v[156:159], a[80:95]
  ds_read_b64_tr_b16 a[180:181], v17 offset:53248
  ds_read_b128 a[152:155], v14 offset:57344
  v_mul_f32 v215, v215, v20
  v_cvt_pk_bf16_f32 v220, v208, v209
  v_cvt_pk_bf16_f32 v221, v210, v211
  v_cvt_pk_bf16_f32 v222, v212, v213
  v_cvt_pk_bf16_f32 v136, v40, v41
  v_exp_f32 v44, v84
  v_add_f32 v23, v23, v42
  v_mfma_f32_32x32x16_bf16 a[96:111], a[216:219], v[156:159], a[96:111]
  ds_read_b128 a[156:159], v15 offset:57344
  v_cvt_pk_bf16_f32 v223, v214, v215
  v_accvgpr_read_b32 v192, a32
  v_accvgpr_read_b32 v193, a33
  v_accvgpr_read_b32 v194, a34
  v_exp_f32 v45, v85
  v_add_f32 v23, v23, v43
  v_cvt_pk_bf16_f32 v137, v42, v43
  s_waitcnt lgkmcnt(15)
  v_mfma_f32_32x32x16_bf16 a[112:127], a[220:223], v[156:159], a[112:127]
  ds_read_b64_tr_b16 a[182:183], v17 offset:54272
  buffer_store_dwordx4 v[220:223], v3, s[28:31], s48 offen offset:3072 sc0 sc1
  v_accvgpr_read_b32 v195, a35
  v_accvgpr_read_b32 v196, a36
  v_accvgpr_read_b32 v197, a37
  v_accvgpr_read_b32 v198, a38
  v_accvgpr_read_b32 v199, a39
  v_exp_f32 v46, v86
  v_add_f32 v23, v23, v44
  v_exp_f32 v47, v87
  s_waitcnt lgkmcnt(12)
  v_mfma_f32_32x32x16_bf16 v[112:127], a[128:131], v[224:227], v[176:191]
  ds_read_b64_tr_b16 a[184:185], v18 offset:53248
  ds_read_b64_tr_b16 a[192:193], v16 offset:57344
  ds_read_b64_tr_b16 a[194:195], v16 offset:58368
  v_mul_f32 v192, v192, v20
  v_mul_f32 v193, v193, v20
  v_mul_f32 v194, v194, v20
  v_add_f32 v23, v23, v45
  v_cvt_pk_bf16_f32 v138, v44, v45
  v_exp_f32 v40, v88
  v_add_f32 v23, v23, v46
  s_waitcnt lgkmcnt(14)
  v_mfma_f32_32x32x16_bf16 v[112:127], a[132:135], v[228:231], v[112:127]
  ds_read_b64_tr_b16 a[186:187], v18 offset:54272
  ds_read_b64_tr_b16 a[196:197], v17 offset:57344
  v_mul_f32 v195, v195, v20
  v_mul_f32 v196, v196, v20
  v_mul_f32 v197, v197, v20
  v_mul_f32 v198, v198, v20
  v_exp_f32 v41, v89
  v_add_f32 v23, v23, v47
  v_cvt_pk_bf16_f32 v139, v46, v47
  s_waitcnt lgkmcnt(14)
  v_mfma_f32_32x32x16_bf16 v[112:127], a[136:139], v[232:235], v[112:127]
  ds_read_b64_tr_b16 a[198:199], v17 offset:58368
  v_mul_f32 v199, v199, v20
  v_cvt_pk_bf16_f32 v200, v192, v193
  v_cvt_pk_bf16_f32 v201, v194, v195
  v_cvt_pk_bf16_f32 v202, v196, v197
  v_cvt_pk_bf16_f32 v203, v198, v199
  v_exp_f32 v42, v90
  v_add_f32 v23, v23, v40
  v_exp_f32 v43, v91
  s_waitcnt lgkmcnt(14)
  v_mfma_f32_32x32x16_bf16 v[112:127], a[140:143], v[236:239], v[112:127]
  ds_read_b64_tr_b16 a[188:189], v19 offset:53248
  ds_read_b64_tr_b16 a[200:201], v18 offset:57344
  v_add_f32 v23, v23, v41
  v_cvt_pk_bf16_f32 v140, v40, v41
  v_exp_f32 v44, v92
  v_add_f32 v23, v23, v42
  v_accvgpr_read_b32 v208, a40
  v_accvgpr_read_b32 v209, a41
  v_accvgpr_read_b32 v210, a42
  s_waitcnt lgkmcnt(14)
  v_mfma_f32_32x32x16_bf16 v[112:127], a[144:147], v[240:243], v[112:127]
  ds_read_b64_tr_b16 a[190:191], v19 offset:54272
  ds_read_b64_tr_b16 a[202:203], v18 offset:58368
  buffer_store_dwordx4 v[200:203], v31, s[28:31], s48 offen offset:0 sc0 sc1
  v_exp_f32 v45, v93
  v_add_f32 v23, v23, v43
  v_cvt_pk_bf16_f32 v141, v42, v43
  v_accvgpr_read_b32 v211, a43
  v_accvgpr_read_b32 v212, a44
  v_accvgpr_read_b32 v213, a45
  s_waitcnt lgkmcnt(14)
  v_mfma_f32_32x32x16_bf16 v[112:127], a[148:151], v[244:247], v[112:127]
  ds_read_b64_tr_b16 a[204:205], v19 offset:57344
  v_exp_f32 v46, v94
  v_add_f32 v23, v23, v44
  v_exp_f32 v47, v95
  s_waitcnt lgkmcnt(13)
  v_mfma_f32_32x32x16_bf16 v[112:127], a[152:155], v[248:251], v[112:127]
  ds_read_b64_tr_b16 a[206:207], v19 offset:58368
  v_add_f32 v23, v23, v45
  v_cvt_pk_bf16_f32 v142, v44, v45
  v_add_f32 v23, v23, v46
  v_add_f32 v23, v23, v47
  v_cvt_pk_bf16_f32 v143, v46, v47
  s_waitcnt lgkmcnt(13)
  v_mfma_f32_32x32x16_bf16 v[112:127], a[156:159], v[252:255], v[112:127]
  ds_read_b64_tr_b16 a[208:209], v16 offset:61440
  ds_read_b64_tr_b16 a[210:211], v16 offset:62464
  v_cmp_nge_f32 vcc, s54, v23
  s_cbranch_vccnz attn_kernel_slow41
attn_kernel_ret42:
  v_add_f32 v21, v21, v23
  v_mfma_f32_32x32x16_bf16 a[64:79], a[160:163], v[136:139], a[64:79]
  ds_read_b64_tr_b16 a[212:213], v17 offset:61440
  v_accvgpr_read_b32 v214, a46
  v_accvgpr_read_b32 v215, a47
  v_mul_f32 v208, v208, v20
  v_mul_f32 v209, v209, v20
  v_mul_f32 v210, v210, v20
  v_mfma_f32_32x32x16_bf16 a[80:95], a[164:167], v[136:139], a[80:95]
  ds_read_b64_tr_b16 a[214:215], v17 offset:62464
  v_mul_f32 v211, v211, v20
  v_mul_f32 v212, v212, v20
  v_mul_f32 v213, v213, v20
  v_mul_f32 v214, v214, v20
  v_mul_f32 v215, v215, v20
  v_mfma_f32_32x32x16_bf16 a[96:111], a[168:171], v[136:139], a[96:111]
  ds_read_b64_tr_b16 a[216:217], v18 offset:61440
  v_cvt_pk_bf16_f32 v216, v208, v209
  v_cvt_pk_bf16_f32 v217, v210, v211
  v_cvt_pk_bf16_f32 v218, v212, v213
  v_cvt_pk_bf16_f32 v219, v214, v215
  v_mfma_f32_32x32x16_bf16 a[112:127], a[172:175], v[136:139], a[112:127]
  ds_read_b64_tr_b16 a[218:219], v18 offset:62464
  buffer_store_dwordx4 v[216:219], v31, s[28:31], s48 offen offset:1024 sc0 sc1
  v_exp_f32 v40, v112
  v_exp_f32 v41, v113
  v_exp_f32 v42, v114
  v_add_f32 v23, v40, v41
  v_exp_f32 v43, v115
  v_cvt_pk_bf16_f32 v152, v40, v41
  v_exp_f32 v44, v116
  v_add_f32 v23, v23, v42
  v_accvgpr_read_b32 v192, a48
  v_accvgpr_read_b32 v193, a49
  v_accvgpr_read_b32 v194, a50
  v_accvgpr_read_b32 v195, a51
  v_mfma_f32_32x32x16_bf16 a[64:79], a[176:179], v[140:143], a[64:79]
  ds_read_b64_tr_b16 a[220:221], v19 offset:61440
  v_exp_f32 v45, v117
  v_add_f32 v23, v23, v43
  v_cvt_pk_bf16_f32 v153, v42, v43
  v_exp_f32 v46, v118
  v_add_f32 v23, v23, v44
  v_exp_f32 v47, v119
  v_add_f32 v23, v23, v45
  v_cvt_pk_bf16_f32 v154, v44, v45
  v_exp_f32 v40, v120
  v_add_f32 v23, v23, v46
  v_accvgpr_read_b32 v196, a52
  v_accvgpr_read_b32 v197, a53
  v_accvgpr_read_b32 v198, a54
  s_waitcnt lgkmcnt(15)
  v_mfma_f32_32x32x16_bf16 a[80:95], a[180:183], v[140:143], a[80:95]
  ds_read_b64_tr_b16 a[222:223], v19 offset:62464
  v_exp_f32 v41, v121
  v_add_f32 v23, v23, v47
  v_cvt_pk_bf16_f32 v155, v46, v47
  v_exp_f32 v42, v122
  v_add_f32 v23, v23, v40
  v_exp_f32 v43, v123
  v_add_f32 v23, v23, v41
  v_cvt_pk_bf16_f32 v156, v40, v41
  v_exp_f32 v44, v124
  v_add_f32 v23, v23, v42
  v_accvgpr_read_b32 v199, a55
  v_mul_f32 v192, v192, v20
  v_mul_f32 v193, v193, v20
  v_mul_f32 v194, v194, v20
  v_mfma_f32_32x32x16_bf16 a[96:111], a[184:187], v[140:143], a[96:111]
  v_exp_f32 v45, v125
  v_add_f32 v23, v23, v43
  v_cvt_pk_bf16_f32 v157, v42, v43
  v_exp_f32 v46, v126
  v_add_f32 v23, v23, v44
  v_exp_f32 v47, v127
  v_add_f32 v23, v23, v45
  v_cvt_pk_bf16_f32 v158, v44, v45
  v_add_f32 v23, v23, v46
  v_add_f32 v23, v23, v47
  v_cvt_pk_bf16_f32 v159, v46, v47
  s_waitcnt lgkmcnt(11)
  v_mfma_f32_32x32x16_bf16 a[112:127], a[188:191], v[140:143], a[112:127]
  v_cmp_nge_f32 vcc, s54, v23
  s_cbranch_vccnz attn_kernel_slow43
attn_kernel_ret44:
  v_add_f32 v21, v21, v23
  v_mfma_f32_32x32x16_bf16 a[64:79], a[192:195], v[152:155], a[64:79]
  v_mul_f32 v195, v195, v20
  v_mul_f32 v196, v196, v20
  v_mul_f32 v197, v197, v20
  v_mul_f32 v198, v198, v20
  v_mul_f32 v199, v199, v20
  v_cvt_pk_bf16_f32 v204, v192, v193
  v_mfma_f32_32x32x16_bf16 a[80:95], a[196:199], v[152:155], a[80:95]
  v_cvt_pk_bf16_f32 v205, v194, v195
  v_cvt_pk_bf16_f32 v206, v196, v197
  v_cvt_pk_bf16_f32 v207, v198, v199
  v_accvgpr_read_b32 v208, a56
  v_accvgpr_read_b32 v209, a57
  s_waitcnt lgkmcnt(10)
  v_mfma_f32_32x32x16_bf16 a[96:111], a[200:203], v[152:155], a[96:111]
  buffer_store_dwordx4 v[204:207], v31, s[28:31], s48 offen offset:2048 sc0 sc1
  v_accvgpr_read_b32 v210, a58
  v_accvgpr_read_b32 v211, a59
  v_accvgpr_read_b32 v212, a60
  v_accvgpr_read_b32 v213, a61
  v_accvgpr_read_b32 v214, a62
  v_accvgpr_read_b32 v215, a63
  s_waitcnt lgkmcnt(8)
  v_mfma_f32_32x32x16_bf16 a[112:127], a[204:207], v[152:155], a[112:127]
  v_mul_f32 v208, v208, v20
  v_mul_f32 v209, v209, v20
  v_mul_f32 v210, v210, v20
  v_mul_f32 v211, v211, v20
  v_mul_f32 v212, v212, v20
  v_mul_f32 v213, v213, v20
  s_waitcnt lgkmcnt(6)
  v_mfma_f32_32x32x16_bf16 a[64:79], a[208:211], v[156:159], a[64:79]
  v_mul_f32 v214, v214, v20
  v_mul_f32 v215, v215, v20
  v_cvt_pk_bf16_f32 v220, v208, v209
  v_cvt_pk_bf16_f32 v221, v210, v211
  v_cvt_pk_bf16_f32 v222, v212, v213
  v_cvt_pk_bf16_f32 v223, v214, v215
  s_waitcnt lgkmcnt(4)
  v_mfma_f32_32x32x16_bf16 a[80:95], a[212:215], v[156:159], a[80:95]
  s_waitcnt lgkmcnt(2)
  v_mfma_f32_32x32x16_bf16 a[96:111], a[216:219], v[156:159], a[96:111]
  buffer_store_dwordx4 v[220:223], v31, s[28:31], s48 offen offset:3072 sc0 sc1
  s_waitcnt lgkmcnt(0)
  v_mfma_f32_32x32x16_bf16 a[112:127], a[220:223], v[156:159], a[112:127]
  v_mov_b32 v28, v21
  s_nop 1
  v_permlane32_swap_b32 v21, v28
  v_add_f32 v28, v28, v21
  v_rcp_f32 v21, v28
  v_accvgpr_read_b32 v64, a64
  v_accvgpr_read_b32 v65, a65
  v_accvgpr_read_b32 v66, a66
  v_accvgpr_read_b32 v67, a67
  v_accvgpr_read_b32 v68, a68
  v_accvgpr_read_b32 v69, a69
  v_accvgpr_read_b32 v70, a70
  v_accvgpr_read_b32 v71, a71
  v_mul_f32 v64, v64, v21
  v_mul_f32 v65, v65, v21
  v_mul_f32 v66, v66, v21
  v_mul_f32 v67, v67, v21
  v_mul_f32 v68, v68, v21
  v_mul_f32 v69, v69, v21
  v_mul_f32 v70, v70, v21
  v_mul_f32 v71, v71, v21
  v_cvt_pk_bf16_f32 v72, v64, v65
  v_cvt_pk_bf16_f32 v73, v66, v67
  v_cvt_pk_bf16_f32 v74, v68, v69
  v_cvt_pk_bf16_f32 v75, v70, v71
  buffer_store_dwordx4 v[72:75], v3, s[28:31], s49 offen offset:0 sc0 sc1
  v_accvgpr_read_b32 v80, a72
  v_accvgpr_read_b32 v81, a73
  v_accvgpr_read_b32 v82, a74
  v_accvgpr_read_b32 v83, a75
  v_accvgpr_read_b32 v84, a76
  v_accvgpr_read_b32 v85, a77
  v_accvgpr_read_b32 v86, a78
  v_accvgpr_read_b32 v87, a79
  v_mul_f32 v80, v80, v21
  v_mul_f32 v81, v81, v21
  v_mul_f32 v82, v82, v21
  v_mul_f32 v83, v83, v21
  v_mul_f32 v84, v84, v21
  v_mul_f32 v85, v85, v21
  v_mul_f32 v86, v86, v21
  v_mul_f32 v87, v87, v21
  v_cvt_pk_bf16_f32 v88, v80, v81
  v_cvt_pk_bf16_f32 v89, v82, v83
  v_cvt_pk_bf16_f32 v90, v84, v85
  v_cvt_pk_bf16_f32 v91, v86, v87
  buffer_store_dwordx4 v[88:91], v3, s[28:31], s49 offen offset:1024 sc0 sc1
  v_accvgpr_read_b32 v64, a80
  v_accvgpr_read_b32 v65, a81
  v_accvgpr_read_b32 v66, a82
  v_accvgpr_read_b32 v67, a83
  v_accvgpr_read_b32 v68, a84
  v_accvgpr_read_b32 v69, a85
  v_accvgpr_read_b32 v70, a86
  v_accvgpr_read_b32 v71, a87
  v_mul_f32 v64, v64, v21
  v_mul_f32 v65, v65, v21
  v_mul_f32 v66, v66, v21
  v_mul_f32 v67, v67, v21
  v_mul_f32 v68, v68, v21
  v_mul_f32 v69, v69, v21
  v_mul_f32 v70, v70, v21
  v_mul_f32 v71, v71, v21
  v_cvt_pk_bf16_f32 v76, v64, v65
  v_cvt_pk_bf16_f32 v77, v66, v67
  v_cvt_pk_bf16_f32 v78, v68, v69
  v_cvt_pk_bf16_f32 v79, v70, v71
  buffer_store_dwordx4 v[76:79], v3, s[28:31], s49 offen offset:2048 sc0 sc1
  v_accvgpr_read_b32 v80, a88
  v_accvgpr_read_b32 v81, a89
  v_accvgpr_read_b32 v82, a90
  v_accvgpr_read_b32 v83, a91
  v_accvgpr_read_b32 v84, a92
  v_accvgpr_read_b32 v85, a93
  v_accvgpr_read_b32 v86, a94
  v_accvgpr_read_b32 v87, a95
  v_mul_f32 v80, v80, v21
  v_mul_f32 v81, v81, v21
  v_mul_f32 v82, v82, v21
  v_mul_f32 v83, v83, v21
  v_mul_f32 v84, v84, v21
  v_mul_f32 v85, v85, v21
  v_mul_f32 v86, v86, v21
  v_mul_f32 v87, v87, v21
  v_cvt_pk_bf16_f32 v92, v80, v81
  v_cvt_pk_bf16_f32 v93, v82, v83
  v_cvt_pk_bf16_f32 v94, v84, v85
  v_cvt_pk_bf16_f32 v95, v86, v87
  buffer_store_dwordx4 v[92:95], v3, s[28:31], s49 offen offset:3072 sc0 sc1
  v_accvgpr_read_b32 v64, a96
  v_accvgpr_read_b32 v65, a97
  v_accvgpr_read_b32 v66, a98
  v_accvgpr_read_b32 v67, a99
  v_accvgpr_read_b32 v68, a100
  v_accvgpr_read_b32 v69, a101
  v_accvgpr_read_b32 v70, a102
  v_accvgpr_read_b32 v71, a103
  v_mul_f32 v64, v64, v21
  v_mul_f32 v65, v65, v21
  v_mul_f32 v66, v66, v21
  v_mul_f32 v67, v67, v21
  v_mul_f32 v68, v68, v21
  v_mul_f32 v69, v69, v21
  v_mul_f32 v70, v70, v21
  v_mul_f32 v71, v71, v21
  v_cvt_pk_bf16_f32 v72, v64, v65
  v_cvt_pk_bf16_f32 v73, v66, v67
  v_cvt_pk_bf16_f32 v74, v68, v69
  v_cvt_pk_bf16_f32 v75, v70, v71
  buffer_store_dwordx4 v[72:75], v31, s[28:31], s49 offen offset:0 sc0 sc1
  v_accvgpr_read_b32 v80, a104
  v_accvgpr_read_b32 v81, a105
  v_accvgpr_read_b32 v82, a106
  v_accvgpr_read_b32 v83, a107
  v_accvgpr_read_b32 v84, a108
  v_accvgpr_read_b32 v85, a109
  v_accvgpr_read_b32 v86, a110
  v_accvgpr_read_b32 v87, a111
  v_mul_f32 v80, v80, v21
  v_mul_f32 v81, v81, v21
  v_mul_f32 v82, v82, v21
  v_mul_f32 v83, v83, v21
  v_mul_f32 v84, v84, v21
  v_mul_f32 v85, v85, v21
  v_mul_f32 v86, v86, v21
  v_mul_f32 v87, v87, v21
  v_cvt_pk_bf16_f32 v88, v80, v81
  v_cvt_pk_bf16_f32 v89, v82, v83
  v_cvt_pk_bf16_f32 v90, v84, v85
  v_cvt_pk_bf16_f32 v91, v86, v87
  buffer_store_dwordx4 v[88:91], v31, s[28:31], s49 offen offset:1024 sc0 sc1
  v_accvgpr_read_b32 v64, a112
  v_accvgpr_read_b32 v65, a113
  v_accvgpr_read_b32 v66, a114
  v_accvgpr_read_b32 v67, a115
  v_accvgpr_read_b32 v68, a116
  v_accvgpr_read_b32 v69, a117
  v_accvgpr_read_b32 v70, a118
  v_accvgpr_read_b32 v71, a119
  v_mul_f32 v64, v64, v21
  v_mul_f32 v65, v65, v21
  v_mul_f32 v66, v66, v21
  v_mul_f32 v67, v67, v21
  v_mul_f32 v68, v68, v21
  v_mul_f32 v69, v69, v21
  v_mul_f32 v70, v70, v21
  v_mul_f32 v71, v71, v21
  v_cvt_pk_bf16_f32 v76, v64, v65
  v_cvt_pk_bf16_f32 v77, v66, v67
  v_cvt_pk_bf16_f32 v78, v68, v69
  v_cvt_pk_bf16_f32 v79, v70, v71
  buffer_store_dwordx4 v[76:79], v31, s[28:31], s49 offen offset:2048 sc0 sc1
  v_accvgpr_read_b32 v80, a120
  v_accvgpr_read_b32 v81, a121
  v_accvgpr_read_b32 v82, a122
  v_accvgpr_read_b32 v83, a123
  v_accvgpr_read_b32 v84, a124
  v_accvgpr_read_b32 v85, a125
  v_accvgpr_read_b32 v86, a126
  v_accvgpr_read_b32 v87, a127
  v_mul_f32 v80, v80, v21
  v_mul_f32 v81, v81, v21
  v_mul_f32 v82, v82, v21
  v_mul_f32 v83, v83, v21
  v_mul_f32 v84, v84, v21
  v_mul_f32 v85, v85, v21
  v_mul_f32 v86, v86, v21
  v_mul_f32 v87, v87, v21
  v_cvt_pk_bf16_f32 v92, v80, v81
  v_cvt_pk_bf16_f32 v93, v82, v83
  v_cvt_pk_bf16_f32 v94, v84, v85
  v_cvt_pk_bf16_f32 v95, v86, v87
  buffer_store_dwordx4 v[92:95], v31, s[28:31], s49 offen offset:3072 sc0 sc1
  s_mov_b64 exec, -1
  s_waitcnt vmcnt(0) lgkmcnt(0)
  s_barrier
  s_cmp_lg_u32 s40, 0
  s_cbranch_scc1 attn_kernel_noflag2
  s_lshl_b32 s80, s42, 7
  s_lshl_b32 s81, s41, 2
  s_add_u32 s80, s80, s81
  s_add_u32 s80, s80, 2048
  v_mov_b32 v252, 1
  v_mov_b32 v253, 0
  s_mov_b64 exec, 1
  buffer_store_dword v252, v253, s[76:79], s80 offen sc0 sc1
  s_mov_b64 exec, -1
attn_kernel_noflag2:
phase1:
  v_mbcnt_lo_u32_b32 v0, -1, 0
  v_mbcnt_hi_u32_b32 v0, -1, v0
  s_lshl_b32 s80, s40, 6
  v_add_u32 v0, s80, v0
  s_load_dwordx2 s[8:9], s[0:1], 104
  s_load_dwordx2 s[10:11], s[0:1], 0
  s_load_dwordx4 s[4:7], s[0:1], 48
  v_and_b32 v1, 63, v0
  v_lshrrev_b32 v2, 6, v0
  v_lshlrev_b32 v3, 4, v1
  v_readfirstlane_b32 s40, v2
  s_and_b32 s41, s2, 7
  s_lshl_b32 s41, s41, 2
  s_bfe_u32 s42, s2, 0x20003
  s_add_u32 s41, s41, s42
  s_lshr_b32 s42, s2, 5
  s_and_b32 s50, s40, 1
  s_lshr_b32 s51, s40, 1
  s_lshl_b32 s52, s41, 1
  s_add_u32 s52, s52, s51
  s_mul_i32 s45, s52, 262144
  s_xor_b32 s46, s52, 1
  s_mul_i32 s46, s46, 262144
  s_mul_i32 s47, s42, 524288
  s_lshl_b32 s43, s50, 10
  v_add_u32 v4, s43, v3
  v_xor_b32 v5, 1024, v4
  s_and_b32 s59, s2, 7
  s_mul_i32 s59, s59, 32
  s_add_u32 s59, s59, s40
  s_waitcnt lgkmcnt(0)
  s_add_u32 s12, s8, 0x2400000
  s_addc_u32 s13, s9, 0
  s_and_b32 s13, s13, 0xffff
  s_mov_b32 s14, 0x400000
  s_mov_b32 s15, 0x20000
  s_add_u32 s20, s8, 0x1000000
  s_addc_u32 s21, s9, 0
  s_and_b32 s21, s21, 0xffff
  s_mov_b32 s22, 0x1000000
  s_mov_b32 s23, 0x20000
  s_cmp_lg_u32 s40, 0
  s_cbranch_scc1 attn_kernel_nopoll3
  s_mov_b32 s80, 0x40000
  s_movk_i32 s75, 0
attn_kernel_poll4:
  buffer_load_dwordx4 v[248:251], v3, s[76:79], s75 offen sc0 sc1
  s_waitcnt vmcnt(0)
  v_min_u32 v248, v248, v249
  v_min3_u32 v248, v248, v250, v251
  v_cmp_eq_u32 vcc, 0, v248
  s_cbranch_vccz attn_kernel_nopoll3
  s_sub_u32 s80, s80, 1
  s_cbranch_scc1 attn_kernel_nopoll3
  s_sleep 4
  s_branch attn_kernel_poll4
attn_kernel_nopoll3:
  s_barrier
  s_add_u32 s24, s8, 0x20000
  s_addc_u32 s25, s9, 0
  s_and_b32 s25, s25, 0xffff
  s_mov_b32 s26, 0x3000
  s_mov_b32 s27, 0x20000
  s_and_b32 s64, s2, 7
  s_lshl_b32 s64, s64, 5
  s_lshr_b32 s65, s2, 3
  s_add_u32 s64, s64, s65
  s_lshr_b32 s65, s64, 3
  s_and_b32 s66, s64, 7
  s_lshl_b32 s71, s66, 2
  s_add_u32 s71, s71, s40
  s_mov_b32 s32, s4
  s_and_b32 s33, s5, 0xffff
  s_mov_b32 s34, 0x1c0000
  s_mov_b32 s35, 0x20000
  s_mov_b32 s36, s6
  s_and_b32 s37, s7, 0xffff
  s_mov_b32 s38, 0x1c0000
  s_mov_b32 s39, 0x20000
  v_lshrrev_b32 v6, 3, v1
  s_movk_i32 s67, 3584
  v_mul_lo_u32 v6, v6, s67
  v_and_b32 v7, 7, v1
  v_lshl_add_u32 v6, v7, 4, v6
  s_mul_i32 s67, s71, 57344
  s_lshl_b32 s68, s65, 7
  s_add_u32 s67, s67, s68
  s_cmp_lt_u32 s64, 224
  s_cselect_b32 s67, s67, 0x7ff00000
  s_add_u32 s68, s67, 28672
  s_mul_i32 s69, s40, 5120
  s_add_u32 s69, s69, 49152
  s_add_u32 m0, s69, 0
  s_nop 0
  buffer_load_dwordx4 v6, s[32:35], s67 offen lds
  s_add_u32 m0, s69, 1024
  s_nop 0
  buffer_load_dwordx4 v6, s[32:35], s68 offen lds
  s_add_u32 m0, s69, 2048
  s_nop 0
  buffer_load_dwordx4 v6, s[36:39], s67 offen lds
  s_add_u32 m0, s69, 3072
  s_nop 0
  buffer_load_dwordx4 v6, s[36:39], s68 offen lds
  s_lshl_b32 s67, s71, 6
  s_add_u32 s67, s67, 6144
  v_lshrrev_b32 v15, 5, v1
  v_lshlrev_b32 v15, 5, v15
  v_bfe_u32 v12, v1, 4, 1
  buffer_load_dwordx4 v[56:59], v15, s[24:27], s67 offen offset:0 sc0 sc1
  buffer_load_dwordx4 v[32:35], v15, s[24:27], s67 offen offset:2048 sc0 sc1
  buffer_load_dwordx4 v[60:63], v15, s[24:27], s67 offen offset:16 sc0 sc1
  buffer_load_dwordx4 v[36:39], v15, s[24:27], s67 offen offset:2064 sc0 sc1
  s_mov_b32 s72, s59
  s_lshl_b32 s60, s59, 10
  s_add_u32 s61, s60, s45
  s_add_u32 s62, s60, s46
  s_lshl_b32 s60, s59, 11
  s_add_u32 s63, s60, s47
  buffer_load_dwordx4 a[0:3], v4, s[12:15], s63 offen sc0 sc1
  s_add_u32 s59, s59, 4
  s_sub_u32 s60, s59, 256
  s_cselect_b32 s59, s59, s60
  buffer_load_dwordx4 a[4:7], v5, s[12:15], s63 offen sc0 sc1
  s_lshl_b32 s60, s59, 10
  s_add_u32 s61, s60, s45
  s_add_u32 s62, s60, s46
  s_lshl_b32 s60, s59, 11
  s_add_u32 s63, s60, s47
  buffer_load_dwordx4 a[16:19], v4, s[12:15], s63 offen sc0 sc1
  s_add_u32 s59, s59, 4
  s_sub_u32 s60, s59, 256
  s_cselect_b32 s59, s59, s60
  buffer_load_dwordx4 a[20:23], v5, s[12:15], s63 offen sc0 sc1
  s_add_u32 s28, s8, 0x300000
  s_addc_u32 s29, s9, 0
  s_and_b32 s29, s29, 0xffff
  s_mov_b32 s30, 0x200000
  s_mov_b32 s31, 0x20000
  v_lshrrev_b32 v15, 5, v1
  v_lshlrev_b32 v15, 5, v15
  s_lshl_b32 s53, s42, 8
  s_lshl_b32 s54, s50, 7
  s_add_u32 s53, s53, s54
  s_add_u32 s53, s53, 4096
  v_and_b32 v40, 31, v1
  v_lshlrev_b32 v40, 10, v40
  v_lshrrev_b32 v41, 5, v1
  v_lshl_add_u32 v40, v41, 4, v40
  s_lshl_b32 s55, s52, 15
  s_lshl_b32 s56, s42, 7
  s_add_u32 s55, s55, s56
  s_lshl_b32 s56, s50, 6
  s_add_u32 s55, s55, s56
  s_lshl_b32 s56, s52, 15
  s_lshl_b32 s57, s42, 12
  s_add_u32 s56, s56, s57
  s_lshl_b32 s57, s50, 11
  s_add_u32 s56, s56, s57
  s_xor_b32 s58, s40, 1
  s_mul_i32 s58, s58, 12288
  v_add_u32 v9, s58, v3
  s_xor_b32 s58, s40, 2
  s_mul_i32 s58, s58, 12288
  v_add_u32 v10, s58, v3
  s_xor_b32 s58, s40, 3
  s_mul_i32 s58, s58, 12288
  v_add_u32 v11, s58, v3
  s_mul_i32 s58, s40, 12288
  v_add_u32 v8, s58, v3
  s_add_u32 s32, s8, 0x2000000
  s_addc_u32 s33, s9, 0
  s_and_b32 s33, s33, 0xffff
  s_mov_b32 s34, 0x380000
  s_mov_b32 s35, 0x20000
  s_add_u32 s36, s8, 0xc0000
  s_addc_u32 s37, s9, 0
  s_and_b32 s37, s37, 0xffff
  s_mov_b32 s38, 0x38000
  s_mov_b32 s39, 0x20000
  v_bfe_u32 v44, v1, 2, 2
  v_and_b32 v45, 3, v1
  v_lshrrev_b32 v46, 1, v45
  v_and_b32 v45, 1, v45
  v_lshl_or_b32 v45, v45, 1, v46
  v_lshl_add_u32 v46, v41, 3, v44
  v_lshlrev_b32 v6, 7, v46
  v_lshl_add_u32 v6, v12, 11, v6
  v_lshl_add_u32 v6, v45, 3, v6
  v_add_u32 v6, s69, v6
  v_mov_b32 v13, 0xbfb8aa3b
  v_mov_b32 v14, 0xbf317218
  v_cmp_eq_u32 vcc, 0, v12
  s_nop 1
  v_cndmask_b32 v13, v14, v13, vcc
  s_lshl_b32 s67, s65, 17
  s_lshl_b32 s68, s71, 10
  s_add_u32 s67, s67, s68
  s_lshl_b32 s68, s65, 2
  s_add_u32 s68, s68, s40
  s_lshl_b32 s68, s68, 11
  s_lshl_b32 s70, s66, 8
  s_add_u32 s68, s68, s70
  v_lshlrev_b32 v14, 2, v1
  v_lshlrev_b32 v7, 2, v1
  v_add_u32 v7, s69, v7
  s_lshl_b32 s60, s59, 10
  s_add_u32 s61, s60, s45
  s_add_u32 s62, s60, s46
  s_lshl_b32 s60, s59, 11
  s_add_u32 s63, s60, s47
  buffer_load_dwordx4 a[32:35], v4, s[12:15], s63 offen sc0 sc1
  s_add_u32 s59, s59, 4
  s_sub_u32 s60, s59, 256
  s_cselect_b32 s59, s59, s60
  buffer_load_dwordx4 a[36:39], v5, s[12:15], s63 offen sc0 sc1
  s_lshl_b32 s60, s59, 10
  s_add_u32 s61, s60, s45
  s_add_u32 s62, s60, s46
  s_lshl_b32 s60, s59, 11
  s_add_u32 s63, s60, s47
  buffer_load_dwordx4 a[48:51], v4, s[12:15], s63 offen sc0 sc1
  s_add_u32 s59, s59, 4
  s_sub_u32 s60, s59, 256
  s_cselect_b32 s59, s59, s60
  buffer_load_dwordx4 a[52:55], v5, s[12:15], s63 offen sc0 sc1
  s_lshl_b32 s60, s59, 10
  s_add_u32 s61, s60, s45
  s_add_u32 s62, s60, s46
  s_lshl_b32 s60, s59, 11
  s_add_u32 s63, s60, s47
  buffer_load_dwordx4 a[64:67], v4, s[12:15], s63 offen sc0 sc1
  s_add_u32 s59, s59, 4
  s_sub_u32 s60, s59, 256
  s_cselect_b32 s59, s59, s60
  buffer_load_dwordx4 a[68:71], v5, s[12:15], s63 offen sc0 sc1
  s_lshl_b32 s60, s59, 10
  s_add_u32 s61, s60, s45
  s_add_u32 s62, s60, s46
  s_lshl_b32 s60, s59, 11
  s_add_u32 s63, s60, s47
  buffer_load_dwordx4 a[80:83], v4, s[12:15], s63 offen sc0 sc1
  s_add_u32 s59, s59, 4
  s_sub_u32 s60, s59, 256
  s_cselect_b32 s59, s59, s60
  buffer_load_dwordx4 a[84:87], v5, s[12:15], s63 offen sc0 sc1
  s_lshl_b32 s60, s59, 10
  s_add_u32 s61, s60, s45
  s_add_u32 s62, s60, s46
  s_lshl_b32 s60, s59, 11
  s_add_u32 s63, s60, s47
  buffer_load_dwordx4 a[96:99], v4, s[12:15], s63 offen sc0 sc1
  s_add_u32 s59, s59, 4
  s_sub_u32 s60, s59, 256
  s_cselect_b32 s59, s59, s60
  buffer_load_dwordx4 a[100:103], v5, s[12:15], s63 offen sc0 sc1
  s_lshl_b32 s60, s59, 10
  s_add_u32 s61, s60, s45
  s_add_u32 s62, s60, s46
  s_lshl_b32 s60, s59, 11
  s_add_u32 s63, s60, s47
  buffer_load_dwordx4 a[112:115], v4, s[12:15], s63 offen sc0 sc1
  s_add_u32 s59, s59, 4
  s_sub_u32 s60, s59, 256
  s_cselect_b32 s59, s59, s60
  buffer_load_dwordx4 a[116:119], v5, s[12:15], s63 offen sc0 sc1
  s_mov_b32 s59, s72
  s_cmp_lg_u32 s40, 0
  s_cbranch_scc1 attn_kernel_nopoll5
  s_mov_b32 s80, 0x40000
  s_lshr_b32 s81, s41, 2
  s_lshl_b32 s81, s81, 7
  s_add_u32 s81, s81, 2048
  v_and_b32 v253, 31, v1
  v_lshlrev_b32 v253, 2, v253
attn_kernel_poll6:
  buffer_load_dword v252, v253, s[76:79], s81 offen sc0 sc1
  s_waitcnt vmcnt(0)
  v_cmp_eq_u32 vcc, 0, v252
  s_cbranch_vccz attn_kernel_nopoll5
  s_sub_u32 s80, s80, 1
  s_cbranch_scc1 attn_kernel_nopoll5
  s_sleep 1
  s_branch attn_kernel_poll6
attn_kernel_nopoll5:
  s_barrier
  s_lshl_b32 s60, s59, 10
  s_add_u32 s61, s60, s45
  s_add_u32 s62, s60, s46
  s_lshl_b32 s60, s59, 11
  s_add_u32 s63, s60, s47
  buffer_load_dwordx4 a[8:11], v3, s[20:23], s61 offen sc0 sc1
  s_add_u32 s59, s59, 4
  s_sub_u32 s60, s59, 256
  s_cselect_b32 s59, s59, s60
  buffer_load_dwordx4 a[12:15], v3, s[20:23], s62 offen sc0 sc1
  s_lshl_b32 s60, s59, 10
  s_add_u32 s61, s60, s45
  s_add_u32 s62, s60, s46
  s_lshl_b32 s60, s59, 11
  s_add_u32 s63, s60, s47
  buffer_load_dwordx4 a[24:27], v3, s[20:23], s61 offen sc0 sc1
  s_add_u32 s59, s59, 4
  s_sub_u32 s60, s59, 256
  s_cselect_b32 s59, s59, s60
  buffer_load_dwordx4 a[28:31], v3, s[20:23], s62 offen sc0 sc1
  s_lshl_b32 s60, s59, 10
  s_add_u32 s61, s60, s45
  s_add_u32 s62, s60, s46
  s_lshl_b32 s60, s59, 11
  s_add_u32 s63, s60, s47
  buffer_load_dwordx4 a[40:43], v3, s[20:23], s61 offen sc0 sc1
  s_add_u32 s59, s59, 4
  s_sub_u32 s60, s59, 256
  s_cselect_b32 s59, s59, s60
  buffer_load_dwordx4 a[44:47], v3, s[20:23], s62 offen sc0 sc1
  s_lshl_b32 s60, s59, 10
  s_add_u32 s61, s60, s45
  s_add_u32 s62, s60, s46
  s_lshl_b32 s60, s59, 11
  s_add_u32 s63, s60, s47
  buffer_load_dwordx4 a[56:59], v3, s[20:23], s61 offen sc0 sc1
  s_add_u32 s59, s59, 4
  s_sub_u32 s60, s59, 256
  s_cselect_b32 s59, s59, s60
  buffer_load_dwordx4 a[60:63], v3, s[20:23], s62 offen sc0 sc1
  s_lshl_b32 s60, s59, 10
  s_add_u32 s61, s60, s45
  s_add_u32 s62, s60, s46
  s_lshl_b32 s60, s59, 11
  s_add_u32 s63, s60, s47
  buffer_load_dwordx4 a[72:75], v3, s[20:23], s61 offen sc0 sc1
  s_add_u32 s59, s59, 4
  s_sub_u32 s60, s59, 256
  s_cselect_b32 s59, s59, s60
  buffer_load_dwordx4 a[76:79], v3, s[20:23], s62 offen sc0 sc1
  s_lshl_b32 s60, s59, 10
  s_add_u32 s61, s60, s45
  s_add_u32 s62, s60, s46
  s_lshl_b32 s60, s59, 11
  s_add_u32 s63, s60, s47
  buffer_load_dwordx4 a[88:91], v3, s[20:23], s61 offen sc0 sc1
  s_add_u32 s59, s59, 4
  s_sub_u32 s60, s59, 256
  s_cselect_b32 s59, s59, s60
  buffer_load_dwordx4 a[92:95], v3, s[20:23], s62 offen sc0 sc1
  s_lshl_b32 s60, s59, 10
  s_add_u32 s61, s60, s45
  s_add_u32 s62, s60, s46
  s_lshl_b32 s60, s59, 11
  s_add_u32 s63, s60, s47
  buffer_load_dwordx4 a[104:107], v3, s[20:23], s61 offen sc0 sc1
  s_add_u32 s59, s59, 4
  s_sub_u32 s60, s59, 256
  s_cselect_b32 s59, s59, s60
  buffer_load_dwordx4 a[108:111], v3, s[20:23], s62 offen sc0 sc1
  s_lshl_b32 s60, s59, 10
  s_add_u32 s61, s60, s45
  s_add_u32 s62, s60, s46
  s_lshl_b32 s60, s59, 11
  s_add_u32 s63, s60, s47
  buffer_load_dwordx4 a[120:123], v3, s[20:23], s61 offen sc0 sc1
  s_add_u32 s59, s59, 4
  s_sub_u32 s60, s59, 256
  s_cselect_b32 s59, s59, s60
  buffer_load_dwordx4 a[124:127], v3, s[20:23], s62 offen sc0 sc1
  s_waitcnt vmcnt(15)
  v_mfma_f32_32x32x16_bf16 v[64:79], a[0:3], a[8:11], 0
  v_mfma_f32_32x32x16_bf16 v[80:95], a[4:7], a[8:11], 0
  s_waitcnt vmcnt(14)
  v_mfma_f32_32x32x16_bf16 v[112:127], a[4:7], a[12:15], 0
  v_mfma_f32_32x32x16_bf16 v[96:111], a[0:3], a[12:15], 0
  s_lshl_b32 s60, s59, 10
  s_add_u32 s61, s60, s45
  s_add_u32 s62, s60, s46
  s_lshl_b32 s60, s59, 11
  s_add_u32 s63, s60, s47
  buffer_load_dwordx4 a[8:11], v3, s[20:23], s61 offen sc0 sc1
  buffer_load_dwordx4 a[0:3], v4, s[12:15], s63 offen sc0 sc1
  s_add_u32 s59, s59, 4
  s_sub_u32 s60, s59, 256
  s_cselect_b32 s59, s59, s60
  buffer_load_dwordx4 a[4:7], v5, s[12:15], s63 offen sc0 sc1
  buffer_load_dwordx4 a[12:15], v3, s[20:23], s62 offen sc0 sc1
  s_waitcnt vmcnt(40)
  ds_read_b64_tr_b16 v[16:17], v6 offset:0
  ds_read_b64_tr_b16 v[18:19], v6 offset:512
  ds_read_b64_tr_b16 v[20:21], v6 offset:32
  ds_read_b64_tr_b16 v[22:23], v6 offset:544
  ds_read_b64_tr_b16 v[24:25], v6 offset:64
  ds_read_b64_tr_b16 v[26:27], v6 offset:576
  ds_read_b64_tr_b16 v[28:29], v6 offset:96
  ds_read_b64_tr_b16 v[30:31], v6 offset:608
  s_waitcnt vmcnt(17)
  v_mfma_f32_32x32x16_bf16 v[64:79], a[16:19], a[24:27], v[64:79]
  v_mfma_f32_32x32x16_bf16 v[80:95], a[20:23], a[24:27], v[80:95]
  s_waitcnt vmcnt(16)
  v_mfma_f32_32x32x16_bf16 v[112:127], a[20:23], a[28:31], v[112:127]
  v_mfma_f32_32x32x16_bf16 v[96:111], a[16:19], a[28:31], v[96:111]
  s_lshl_b32 s60, s59, 10
  s_add_u32 s61, s60, s45
  s_add_u32 s62, s60, s46
  s_lshl_b32 s60, s59, 11
  s_add_u32 s63, s60, s47
  buffer_load_dwordx4 a[24:27], v3, s[20:23], s61 offen sc0 sc1
  buffer_load_dwordx4 a[16:19], v4, s[12:15], s63 offen sc0 sc1
  s_add_u32 s59, s59, 4
  s_sub_u32 s60, s59, 256
  s_cselect_b32 s59, s59, s60
  buffer_load_dwordx4 a[20:23], v5, s[12:15], s63 offen sc0 sc1
  buffer_load_dwordx4 a[28:31], v3, s[20:23], s62 offen sc0 sc1
  v_add_f32 v32, 1.0, v32
  v_add_f32 v33, 1.0, v33
  v_add_f32 v34, 1.0, v34
  v_add_f32 v35, 1.0, v35
  v_add_f32 v36, 1.0, v36
  v_add_f32 v37, 1.0, v37
  v_add_f32 v38, 1.0, v38
  v_add_f32 v39, 1.0, v39
  v_cvt_pk_bf16_f32 v44, v32, v33
  v_cvt_pk_bf16_f32 v45, v34, v35
  v_cvt_pk_bf16_f32 v46, v36, v37
  v_cvt_pk_bf16_f32 v47, v38, v39
  s_waitcnt vmcnt(19)
  v_mfma_f32_32x32x16_bf16 v[64:79], a[32:35], a[40:43], v[64:79]
  v_mfma_f32_32x32x16_bf16 v[80:95], a[36:39], a[40:43], v[80:95]
  s_waitcnt vmcnt(18)
  v_mfma_f32_32x32x16_bf16 v[112:127], a[36:39], a[44:47], v[112:127]
  v_mfma_f32_32x32x16_bf16 v[96:111], a[32:35], a[44:47], v[96:111]
  s_lshl_b32 s60, s59, 10
  s_add_u32 s61, s60, s45
  s_add_u32 s62, s60, s46
  s_lshl_b32 s60, s59, 11
  s_add_u32 s63, s60, s47
  buffer_load_dwordx4 a[40:43], v3, s[20:23], s61 offen sc0 sc1
  buffer_load_dwordx4 a[32:35], v4, s[12:15], s63 offen sc0 sc1
  s_add_u32 s59, s59, 4
  s_sub_u32 s60, s59, 256
  s_cselect_b32 s59, s59, s60
  buffer_load_dwordx4 a[36:39], v5, s[12:15], s63 offen sc0 sc1
  buffer_load_dwordx4 a[44:47], v3, s[20:23], s62 offen sc0 sc1
  v_lshlrev_b32 v32, 16, v44
  v_and_b32 v33, 0xffff0000, v44
  v_lshlrev_b32 v34, 16, v45
  v_and_b32 v35, 0xffff0000, v45
  v_lshlrev_b32 v36, 16, v46
  v_and_b32 v37, 0xffff0000, v46
  v_lshlrev_b32 v38, 16, v47
  v_and_b32 v39, 0xffff0000, v47
  v_mul_f32 v32, v32, v13
  v_mul_f32 v56, v56, v13
  v_mul_f32 v33, v33, v13
  v_mul_f32 v57, v57, v13
  s_waitcnt vmcnt(21)
  v_mfma_f32_32x32x16_bf16 v[64:79], a[48:51], a[56:59], v[64:79]
  v_mfma_f32_32x32x16_bf16 v[80:95], a[52:55], a[56:59], v[80:95]
  s_waitcnt vmcnt(20)
  v_mfma_f32_32x32x16_bf16 v[112:127], a[52:55], a[60:63], v[112:127]
  v_mfma_f32_32x32x16_bf16 v[96:111], a[48:51], a[60:63], v[96:111]
  s_lshl_b32 s60, s59, 10
  s_add_u32 s61, s60, s45
  s_add_u32 s62, s60, s46
  s_lshl_b32 s60, s59, 11
  s_add_u32 s63, s60, s47
  buffer_load_dwordx4 a[56:59], v3, s[20:23], s61 offen sc0 sc1
  buffer_load_dwordx4 a[48:51], v4, s[12:15], s63 offen sc0 sc1
  s_add_u32 s59, s59, 4
  s_sub_u32 s60, s59, 256
  s_cselect_b32 s59, s59, s60
  buffer_load_dwordx4 a[52:55], v5, s[12:15], s63 offen sc0 sc1
  buffer_load_dwordx4 a[60:63], v3, s[20:23], s62 offen sc0 sc1
  v_mul_f32 v34, v34, v13
  v_mul_f32 v58, v58, v13
  v_mul_f32 v35, v35, v13
  v_mul_f32 v59, v59, v13
  v_mul_f32 v36, v36, v13
  v_mul_f32 v60, v60, v13
  v_mul_f32 v37, v37, v13
  v_mul_f32 v61, v61, v13
  v_mul_f32 v38, v38, v13
  v_mul_f32 v62, v62, v13
  v_mul_f32 v39, v39, v13
  v_mul_f32 v63, v63, v13
  s_waitcnt vmcnt(23)
  v_mfma_f32_32x32x16_bf16 v[64:79], a[64:67], a[72:75], v[64:79]
  v_mfma_f32_32x32x16_bf16 v[80:95], a[68:71], a[72:75], v[80:95]
  s_waitcnt vmcnt(22)
  v_mfma_f32_32x32x16_bf16 v[112:127], a[68:71], a[76:79], v[112:127]
  v_mfma_f32_32x32x16_bf16 v[96:111], a[64:67], a[76:79], v[96:111]
  s_lshl_b32 s60, s59, 10
  s_add_u32 s61, s60, s45
  s_add_u32 s62, s60, s46
  s_lshl_b32 s60, s59, 11
  s_add_u32 s63, s60, s47
  buffer_load_dwordx4 a[72:75], v3, s[20:23], s61 offen sc0 sc1
  buffer_load_dwordx4 a[64:67], v4, s[12:15], s63 offen sc0 sc1
  s_add_u32 s59, s59, 4
  s_sub_u32 s60, s59, 256
  s_cselect_b32 s59, s59, s60
  buffer_load_dwordx4 a[68:71], v5, s[12:15], s63 offen sc0 sc1
  buffer_load_dwordx4 a[76:79], v3, s[20:23], s62 offen sc0 sc1
  s_waitcnt lgkmcnt(7)
  v_lshlrev_b32 v48, 16, v16
  v_and_b32 v49, 0xffff0000, v16
  v_lshlrev_b32 v50, 16, v17
  v_and_b32 v51, 0xffff0000, v17
  s_waitcnt lgkmcnt(6)
  v_lshlrev_b32 v52, 16, v18
  v_and_b32 v53, 0xffff0000, v18
  v_lshlrev_b32 v54, 16, v19
  v_and_b32 v55, 0xffff0000, v19
  v_mul_f32 v43, v48, v56
  v_fmac_f32 v43, v49, v57
  v_fmac_f32 v43, v50, v58
  v_fmac_f32 v43, v51, v59
  s_waitcnt vmcnt(25)
  v_mfma_f32_32x32x16_bf16 v[64:79], a[80:83], a[88:91], v[64:79]
  v_mfma_f32_32x32x16_bf16 v[80:95], a[84:87], a[88:91], v[80:95]
  s_waitcnt vmcnt(24)
  v_mfma_f32_32x32x16_bf16 v[112:127], a[84:87], a[92:95], v[112:127]
  v_mfma_f32_32x32x16_bf16 v[96:111], a[80:83], a[92:95], v[96:111]
  s_lshl_b32 s60, s59, 10
  s_add_u32 s61, s60, s45
  s_add_u32 s62, s60, s46
  s_lshl_b32 s60, s59, 11
  s_add_u32 s63, s60, s47
  buffer_load_dwordx4 a[88:91], v3, s[20:23], s61 offen sc0 sc1
  buffer_load_dwordx4 a[80:83], v4, s[12:15], s63 offen sc0 sc1
  s_add_u32 s59, s59, 4
  s_sub_u32 s60, s59, 256
  s_cselect_b32 s59, s59, s60
  buffer_load_dwordx4 a[84:87], v5, s[12:15], s63 offen sc0 sc1
  buffer_load_dwordx4 a[92:95], v3, s[20:23], s62 offen sc0 sc1
  v_fmac_f32 v43, v52, v60
  v_fmac_f32 v43, v53, v61
  v_fmac_f32 v43, v54, v62
  v_fmac_f32 v43, v55, v63
  v_mul_f32 v48, v48, v32
  v_mul_f32 v49, v49, v33
  v_mul_f32 v50, v50, v34
  v_mul_f32 v51, v51, v35
  v_mul_f32 v52, v52, v36
  v_mul_f32 v53, v53, v37
  v_mul_f32 v54, v54, v38
  v_mul_f32 v55, v55, v39
  s_waitcnt vmcnt(27)
  v_mfma_f32_32x32x16_bf16 v[64:79], a[96:99], a[104:107], v[64:79]
  v_mfma_f32_32x32x16_bf16 v[80:95], a[100:103], a[104:107], v[80:95]
  s_waitcnt vmcnt(26)
  v_mfma_f32_32x32x16_bf16 v[112:127], a[100:103], a[108:111], v[112:127]
  v_mfma_f32_32x32x16_bf16 v[96:111], a[96:99], a[108:111], v[96:111]
  s_lshl_b32 s60, s59, 10
  s_add_u32 s61, s60, s45
  s_add_u32 s62, s60, s46
  s_lshl_b32 s60, s59, 11
  s_add_u32 s63, s60, s47
  buffer_load_dwordx4 a[104:107], v3, s[20:23], s61 offen sc0 sc1
  buffer_load_dwordx4 a[96:99], v4, s[12:15], s63 offen sc0 sc1
  s_add_u32 s59, s59, 4
  s_sub_u32 s60, s59, 256
  s_cselect_b32 s59, s59, s60
  buffer_load_dwordx4 a[100:103], v5, s[12:15], s63 offen sc0 sc1
  buffer_load_dwordx4 a[108:111], v3, s[20:23], s62 offen sc0 sc1
  v_cvt_pk_bf16_f32 v16, v48, v49
  v_cvt_pk_bf16_f32 v17, v50, v51
  v_cvt_pk_bf16_f32 v18, v52, v53
  v_cvt_pk_bf16_f32 v19, v54, v55
  s_add_u32 s70, s67, 0
  buffer_store_dwordx4 v[16:19], v3, s[32:35], s70 offen sc0 sc1
  v_lshlrev_b32 v48, 16, v16
  v_and_b32 v49, 0xffff0000, v16
  v_lshlrev_b32 v50, 16, v17
  v_and_b32 v51, 0xffff0000, v17
  v_lshlrev_b32 v52, 16, v18
  v_and_b32 v53, 0xffff0000, v18
  v_lshlrev_b32 v54, 16, v19
  s_waitcnt vmcnt(30)
  v_mfma_f32_32x32x16_bf16 v[64:79], a[112:115], a[120:123], v[64:79]
  v_mfma_f32_32x32x16_bf16 v[80:95], a[116:119], a[120:123], v[80:95]
  s_waitcnt vmcnt(29)
  v_mfma_f32_32x32x16_bf16 v[112:127], a[116:119], a[124:127], v[112:127]
  v_mfma_f32_32x32x16_bf16 v[96:111], a[112:115], a[124:127], v[96:111]
  s_lshl_b32 s60, s59, 10
  s_add_u32 s61, s60, s45
  s_add_u32 s62, s60, s46
  s_lshl_b32 s60, s59, 11
  s_add_u32 s63, s60, s47
  buffer_load_dwordx4 a[120:123], v3, s[20:23], s61 offen sc0 sc1
  buffer_load_dwordx4 a[112:115], v4, s[12:15], s63 offen sc0 sc1
  s_add_u32 s59, s59, 4
  s_sub_u32 s60, s59, 256
  s_cselect_b32 s59, s59, s60
  buffer_load_dwordx4 a[116:119], v5, s[12:15], s63 offen sc0 sc1
  buffer_load_dwordx4 a[124:127], v3, s[20:23], s62 offen sc0 sc1
  v_and_b32 v55, 0xffff0000, v19
  v_add_f32 v42, v48, v49
  v_add_f32 v42, v42, v50
  v_add_f32 v42, v42, v51
  v_add_f32 v42, v42, v52
  v_add_f32 v42, v42, v53
  v_add_f32 v42, v42, v54
  v_add_f32 v42, v42, v55
  s_nop 1
  v_permlane32_swap_b32 v42, v43
  v_add_f32 v42, v42, v43
  ds_write_b32 v7, v42 offset:4096
  s_waitcnt lgkmcnt(6)
  v_lshlrev_b32 v48, 16, v20
  v_and_b32 v49, 0xffff0000, v20
  v_lshlrev_b32 v50, 16, v21
  s_waitcnt vmcnt(31)
  v_mfma_f32_32x32x16_bf16 v[64:79], a[0:3], a[8:11], v[64:79]
  s_waitcnt vmcnt(30)
  v_mfma_f32_32x32x16_bf16 v[80:95], a[4:7], a[8:11], v[80:95]
  s_waitcnt vmcnt(29)
  v_mfma_f32_32x32x16_bf16 v[112:127], a[4:7], a[12:15], v[112:127]
  v_mfma_f32_32x32x16_bf16 v[96:111], a[0:3], a[12:15], v[96:111]
  s_lshl_b32 s60, s59, 10
  s_add_u32 s61, s60, s45
  s_add_u32 s62, s60, s46
  s_lshl_b32 s60, s59, 11
  s_add_u32 s63, s60, s47
  buffer_load_dwordx4 a[8:11], v3, s[20:23], s61 offen sc0 sc1
  buffer_load_dwordx4 a[0:3], v4, s[12:15], s63 offen sc0 sc1
  s_add_u32 s59, s59, 4
  s_sub_u32 s60, s59, 256
  s_cselect_b32 s59, s59, s60
  buffer_load_dwordx4 a[4:7], v5, s[12:15], s63 offen sc0 sc1
  buffer_load_dwordx4 a[12:15], v3, s[20:23], s62 offen sc0 sc1
  v_and_b32 v51, 0xffff0000, v21
  s_waitcnt lgkmcnt(5)
  v_lshlrev_b32 v52, 16, v22
  v_and_b32 v53, 0xffff0000, v22
  v_lshlrev_b32 v54, 16, v23
  v_and_b32 v55, 0xffff0000, v23
  v_mul_f32 v43, v48, v56
  v_fmac_f32 v43, v49, v57
  v_fmac_f32 v43, v50, v58
  v_fmac_f32 v43, v51, v59
  v_fmac_f32 v43, v52, v60
  v_fmac_f32 v43, v53, v61
  v_fmac_f32 v43, v54, v62
  s_waitcnt vmcnt(31)
  v_mfma_f32_32x32x16_bf16 v[64:79], a[16:19], a[24:27], v[64:79]
  s_waitcnt vmcnt(30)
  v_mfma_f32_32x32x16_bf16 v[80:95], a[20:23], a[24:27], v[80:95]
  s_waitcnt vmcnt(29)
  v_mfma_f32_32x32x16_bf16 v[112:127], a[20:23], a[28:31], v[112:127]
  v_mfma_f32_32x32x16_bf16 v[96:111], a[16:19], a[28:31], v[96:111]
  s_lshl_b32 s60, s59, 10
  s_add_u32 s61, s60, s45
  s_add_u32 s62, s60, s46
  s_lshl_b32 s60, s59, 11
  s_add_u32 s63, s60, s47
  buffer_load_dwordx4 a[24:27], v3, s[20:23], s61 offen sc0 sc1
  buffer_load_dwordx4 a[16:19], v4, s[12:15], s63 offen sc0 sc1
  s_add_u32 s59, s59, 4
  s_sub_u32 s60, s59, 256
  s_cselect_b32 s59, s59, s60
  buffer_load_dwordx4 a[20:23], v5, s[12:15], s63 offen sc0 sc1
  buffer_load_dwordx4 a[28:31], v3, s[20:23], s62 offen sc0 sc1
  v_fmac_f32 v43, v55, v63
  v_mul_f32 v48, v48, v32
  v_mul_f32 v49, v49, v33
  v_mul_f32 v50, v50, v34
  v_mul_f32 v51, v51, v35
  v_mul_f32 v52, v52, v36
  v_mul_f32 v53, v53, v37
  v_mul_f32 v54, v54, v38
  v_mul_f32 v55, v55, v39
  v_cvt_pk_bf16_f32 v20, v48, v49
  v_cvt_pk_bf16_f32 v21, v50, v51
  v_cvt_pk_bf16_f32 v22, v52, v53
  s_waitcnt vmcnt(31)
  v_mfma_f32_32x32x16_bf16 v[64:79], a[32:35], a[40:43], v[64:79]
  s_waitcnt vmcnt(30)
  v_mfma_f32_32x32x16_bf16 v[80:95], a[36:39], a[40:43], v[80:95]
  s_waitcnt vmcnt(29)
  v_mfma_f32_32x32x16_bf16 v[112:127], a[36:39], a[44:47], v[112:127]
  v_mfma_f32_32x32x16_bf16 v[96:111], a[32:35], a[44:47], v[96:111]
  s_lshl_b32 s60, s59, 10
  s_add_u32 s61, s60, s45
  s_add_u32 s62, s60, s46
  s_lshl_b32 s60, s59, 11
  s_add_u32 s63, s60, s47
  buffer_load_dwordx4 a[40:43], v3, s[20:23], s61 offen sc0 sc1
  buffer_load_dwordx4 a[32:35], v4, s[12:15], s63 offen sc0 sc1
  s_add_u32 s59, s59, 4
  s_sub_u32 s60, s59, 256
  s_cselect_b32 s59, s59, s60
  buffer_load_dwordx4 a[36:39], v5, s[12:15], s63 offen sc0 sc1
  buffer_load_dwordx4 a[44:47], v3, s[20:23], s62 offen sc0 sc1
  v_cvt_pk_bf16_f32 v23, v54, v55
  s_add_u32 s70, s67, 32768
  buffer_store_dwordx4 v[20:23], v3, s[32:35], s70 offen sc0 sc1
  v_lshlrev_b32 v48, 16, v20
  v_and_b32 v49, 0xffff0000, v20
  v_lshlrev_b32 v50, 16, v21
  v_and_b32 v51, 0xffff0000, v21
  v_lshlrev_b32 v52, 16, v22
  v_and_b32 v53, 0xffff0000, v22
  v_lshlrev_b32 v54, 16, v23
  v_and_b32 v55, 0xffff0000, v23
  v_add_f32 v42, v48, v49
  v_add_f32 v42, v42, v50
  s_waitcnt vmcnt(32)
  v_mfma_f32_32x32x16_bf16 v[64:79], a[48:51], a[56:59], v[64:79]
  s_waitcnt vmcnt(31)
  v_mfma_f32_32x32x16_bf16 v[80:95], a[52:55], a[56:59], v[80:95]
  s_waitcnt vmcnt(30)
  v_mfma_f32_32x32x16_bf16 v[112:127], a[52:55], a[60:63], v[112:127]
  v_mfma_f32_32x32x16_bf16 v[96:111], a[48:51], a[60:63], v[96:111]
  s_lshl_b32 s60, s59, 10
  s_add_u32 s61, s60, s45
  s_add_u32 s62, s60, s46
  s_lshl_b32 s60, s59, 11
  s_add_u32 s63, s60, s47
  buffer_load_dwordx4 a[56:59], v3, s[20:23], s61 offen sc0 sc1
  buffer_load_dwordx4 a[48:51], v4, s[12:15], s63 offen sc0 sc1
  s_add_u32 s59, s59, 4
  s_sub_u32 s60, s59, 256
  s_cselect_b32 s59, s59, s60
  buffer_load_dwordx4 a[52:55], v5, s[12:15], s63 offen sc0 sc1
  buffer_load_dwordx4 a[60:63], v3, s[20:23], s62 offen sc0 sc1
  v_add_f32 v42, v42, v51
  v_add_f32 v42, v42, v52
  v_add_f32 v42, v42, v53
  v_add_f32 v42, v42, v54
  v_add_f32 v42, v42, v55
  s_nop 1
  v_permlane32_swap_b32 v42, v43
  v_add_f32 v42, v42, v43
  ds_write_b32 v7, v42 offset:4352
  s_waitcnt lgkmcnt(5)
  v_lshlrev_b32 v48, 16, v24
  v_and_b32 v49, 0xffff0000, v24
  v_lshlrev_b32 v50, 16, v25
  v_and_b32 v51, 0xffff0000, v25
  s_waitcnt lgkmcnt(4)
  v_lshlrev_b32 v52, 16, v26
  v_and_b32 v53, 0xffff0000, v26
  s_waitcnt vmcnt(32)
  v_mfma_f32_32x32x16_bf16 v[64:79], a[64:67], a[72:75], v[64:79]
  s_waitcnt vmcnt(31)
  v_mfma_f32_32x32x16_bf16 v[80:95], a[68:71], a[72:75], v[80:95]
  s_waitcnt vmcnt(30)
  v_mfma_f32_32x32x16_bf16 v[112:127], a[68:71], a[76:79], v[112:127]
  v_mfma_f32_32x32x16_bf16 v[96:111], a[64:67], a[76:79], v[96:111]
  s_lshl_b32 s60, s59, 10
  s_add_u32 s61, s60, s45
  s_add_u32 s62, s60, s46
  s_lshl_b32 s60, s59, 11
  s_add_u32 s63, s60, s47
  buffer_load_dwordx4 a[72:75], v3, s[20:23], s61 offen sc0 sc1
  buffer_load_dwordx4 a[64:67], v4, s[12:15], s63 offen sc0 sc1
  s_add_u32 s59, s59, 4
  s_sub_u32 s60, s59, 256
  s_cselect_b32 s59, s59, s60
  buffer_load_dwordx4 a[68:71], v5, s[12:15], s63 offen sc0 sc1
  buffer_load_dwordx4 a[76:79], v3, s[20:23], s62 offen sc0 sc1
  v_lshlrev_b32 v54, 16, v27
  v_and_b32 v55, 0xffff0000, v27
  v_mul_f32 v43, v48, v56
  v_fmac_f32 v43, v49, v57
  v_fmac_f32 v43, v50, v58
  v_fmac_f32 v43, v51, v59
  v_fmac_f32 v43, v52, v60
  v_fmac_f32 v43, v53, v61
  v_fmac_f32 v43, v54, v62
  v_fmac_f32 v43, v55, v63
  v_mul_f32 v48, v48, v32
  v_mul_f32 v49, v49, v33
  s_waitcnt vmcnt(32)
  v_mfma_f32_32x32x16_bf16 v[64:79], a[80:83], a[88:91], v[64:79]
  s_waitcnt vmcnt(31)
  v_mfma_f32_32x32x16_bf16 v[80:95], a[84:87], a[88:91], v[80:95]
  s_waitcnt vmcnt(30)
  v_mfma_f32_32x32x16_bf16 v[112:127], a[84:87], a[92:95], v[112:127]
  v_mfma_f32_32x32x16_bf16 v[96:111], a[80:83], a[92:95], v[96:111]
  s_lshl_b32 s60, s59, 10
  s_add_u32 s61, s60, s45
  s_add_u32 s62, s60, s46
  s_lshl_b32 s60, s59, 11
  s_add_u32 s63, s60, s47
  buffer_load_dwordx4 a[88:91], v3, s[20:23], s61 offen sc0 sc1
  buffer_load_dwordx4 a[80:83], v4, s[12:15], s63 offen sc0 sc1
  s_add_u32 s59, s59, 4
  s_sub_u32 s60, s59, 256
  s_cselect_b32 s59, s59, s60
  buffer_load_dwordx4 a[84:87], v5, s[12:15], s63 offen sc0 sc1
  buffer_load_dwordx4 a[92:95], v3, s[20:23], s62 offen sc0 sc1
  v_mul_f32 v50, v50, v34
  v_mul_f32 v51, v51, v35
  v_mul_f32 v52, v52, v36
  v_mul_f32 v53, v53, v37
  v_mul_f32 v54, v54, v38
  v_mul_f32 v55, v55, v39
  v_cvt_pk_bf16_f32 v24, v48, v49
  v_cvt_pk_bf16_f32 v25, v50, v51
  v_cvt_pk_bf16_f32 v26, v52, v53
  v_cvt_pk_bf16_f32 v27, v54, v55
  s_add_u32 s70, s67, 65536
  buffer_store_dwordx4 v[24:27], v3, s[32:35], s70 offen sc0 sc1
  v_lshlrev_b32 v48, 16, v24
  s_waitcnt vmcnt(33)
  v_mfma_f32_32x32x16_bf16 v[64:79], a[96:99], a[104:107], v[64:79]
  s_waitcnt vmcnt(32)
  v_mfma_f32_32x32x16_bf16 v[80:95], a[100:103], a[104:107], v[80:95]
  s_waitcnt vmcnt(31)
  v_mfma_f32_32x32x16_bf16 v[112:127], a[100:103], a[108:111], v[112:127]
  v_mfma_f32_32x32x16_bf16 v[96:111], a[96:99], a[108:111], v[96:111]
  s_lshl_b32 s60, s59, 10
  s_add_u32 s61, s60, s45
  s_add_u32 s62, s60, s46
  s_lshl_b32 s60, s59, 11
  s_add_u32 s63, s60, s47
  buffer_load_dwordx4 a[104:107], v3, s[20:23], s61 offen sc0 sc1
  buffer_load_dwordx4 a[96:99], v4, s[12:15], s63 offen sc0 sc1
  s_add_u32 s59, s59, 4
  s_sub_u32 s60, s59, 256
  s_cselect_b32 s59, s59, s60
  buffer_load_dwordx4 a[100:103], v5, s[12:15], s63 offen sc0 sc1
  buffer_load_dwordx4 a[108:111], v3, s[20:23], s62 offen sc0 sc1
  v_and_b32 v49, 0xffff0000, v24
  v_lshlrev_b32 v50, 16, v25
  v_and_b32 v51, 0xffff0000, v25
  v_lshlrev_b32 v52, 16, v26
  v_and_b32 v53, 0xffff0000, v26
  v_lshlrev_b32 v54, 16, v27
  v_and_b32 v55, 0xffff0000, v27
  v_add_f32 v42, v48, v49
  v_add_f32 v42, v42, v50
  v_add_f32 v42, v42, v51
  v_add_f32 v42, v42, v52
  v_add_f32 v42, v42, v53
  s_waitcnt vmcnt(32)
  v_mfma_f32_32x32x16_bf16 v[64:79], a[112:115], a[120:123], v[64:79]
  s_waitcnt vmcnt(31)
  v_mfma_f32_32x32x16_bf16 v[80:95], a[116:119], a[120:123], v[80:95]
  s_waitcnt vmcnt(30)
  v_mfma_f32_32x32x16_bf16 v[112:127], a[116:119], a[124:127], v[112:127]
  v_mfma_f32_32x32x16_bf16 v[96:111], a[112:115], a[124:127], v[96:111]
  s_lshl_b32 s60, s59, 10
  s_add_u32 s61, s60, s45
  s_add_u32 s62, s60, s46
  s_lshl_b32 s60, s59, 11
  s_add_u32 s63, s60, s47
  buffer_load_dwordx4 a[120:123], v3, s[20:23], s61 offen sc0 sc1
  buffer_load_dwordx4 a[112:115], v4, s[12:15], s63 offen sc0 sc1
  s_add_u32 s59, s59, 4
  s_sub_u32 s60, s59, 256
  s_cselect_b32 s59, s59, s60
  buffer_load_dwordx4 a[116:119], v5, s[12:15], s63 offen sc0 sc1
  buffer_load_dwordx4 a[124:127], v3, s[20:23], s62 offen sc0 sc1
  v_add_f32 v42, v42, v54
  v_add_f32 v42, v42, v55
  s_nop 1
  v_permlane32_swap_b32 v42, v43
  v_add_f32 v42, v42, v43
  ds_write_b32 v7, v42 offset:4608
  s_waitcnt lgkmcnt(4)
  v_lshlrev_b32 v48, 16, v28
  v_and_b32 v49, 0xffff0000, v28
  v_lshlrev_b32 v50, 16, v29
  v_and_b32 v51, 0xffff0000, v29
  s_waitcnt lgkmcnt(3)
  v_lshlrev_b32 v52, 16, v30
  v_and_b32 v53, 0xffff0000, v30
  v_lshlrev_b32 v54, 16, v31
  v_and_b32 v55, 0xffff0000, v31
  v_mul_f32 v43, v48, v56
  s_waitcnt vmcnt(32)
  v_mfma_f32_32x32x16_bf16 v[64:79], a[0:3], a[8:11], v[64:79]
  s_waitcnt vmcnt(31)
  v_mfma_f32_32x32x16_bf16 v[80:95], a[4:7], a[8:11], v[80:95]
  s_waitcnt vmcnt(30)
  v_mfma_f32_32x32x16_bf16 v[112:127], a[4:7], a[12:15], v[112:127]
  v_mfma_f32_32x32x16_bf16 v[96:111], a[0:3], a[12:15], v[96:111]
  s_lshl_b32 s60, s59, 10
  s_add_u32 s61, s60, s45
  s_add_u32 s62, s60, s46
  s_lshl_b32 s60, s59, 11
  s_add_u32 s63, s60, s47
  buffer_load_dwordx4 a[8:11], v3, s[20:23], s61 offen sc0 sc1
  buffer_load_dwordx4 a[0:3], v4, s[12:15], s63 offen sc0 sc1
  s_add_u32 s59, s59, 4
  s_sub_u32 s60, s59, 256
  s_cselect_b32 s59, s59, s60
  buffer_load_dwordx4 a[4:7], v5, s[12:15], s63 offen sc0 sc1
  buffer_load_dwordx4 a[12:15], v3, s[20:23], s62 offen sc0 sc1
  v_fmac_f32 v43, v49, v57
  v_fmac_f32 v43, v50, v58
  v_fmac_f32 v43, v51, v59
  v_fmac_f32 v43, v52, v60
  v_fmac_f32 v43, v53, v61
  v_fmac_f32 v43, v54, v62
  v_fmac_f32 v43, v55, v63
  v_mul_f32 v48, v48, v32
  v_mul_f32 v49, v49, v33
  v_mul_f32 v50, v50, v34
  v_mul_f32 v51, v51, v35
  v_mul_f32 v52, v52, v36
  s_waitcnt vmcnt(32)
  v_mfma_f32_32x32x16_bf16 v[64:79], a[16:19], a[24:27], v[64:79]
  s_waitcnt vmcnt(31)
  v_mfma_f32_32x32x16_bf16 v[80:95], a[20:23], a[24:27], v[80:95]
  s_waitcnt vmcnt(30)
  v_mfma_f32_32x32x16_bf16 v[112:127], a[20:23], a[28:31], v[112:127]
  v_mfma_f32_32x32x16_bf16 v[96:111], a[16:19], a[28:31], v[96:111]
  s_lshl_b32 s60, s59, 10
  s_add_u32 s61, s60, s45
  s_add_u32 s62, s60, s46
  s_lshl_b32 s60, s59, 11
  s_add_u32 s63, s60, s47
  buffer_load_dwordx4 a[24:27], v3, s[20:23], s61 offen sc0 sc1
  buffer_load_dwordx4 a[16:19], v4, s[12:15], s63 offen sc0 sc1
  s_add_u32 s59, s59, 4
  s_sub_u32 s60, s59, 256
  s_cselect_b32 s59, s59, s60
  buffer_load_dwordx4 a[20:23], v5, s[12:15], s63 offen sc0 sc1
  buffer_load_dwordx4 a[28:31], v3, s[20:23], s62 offen sc0 sc1
  v_mul_f32 v53, v53, v37
  v_mul_f32 v54, v54, v38
  v_mul_f32 v55, v55, v39
  v_cvt_pk_bf16_f32 v28, v48, v49
  v_cvt_pk_bf16_f32 v29, v50, v51
  v_cvt_pk_bf16_f32 v30, v52, v53
  v_cvt_pk_bf16_f32 v31, v54, v55
  s_add_u32 s70, s67, 98304
  buffer_store_dwordx4 v[28:31], v3, s[32:35], s70 offen sc0 sc1
  v_lshlrev_b32 v48, 16, v28
  v_and_b32 v49, 0xffff0000, v28
  v_lshlrev_b32 v50, 16, v29
  v_and_b32 v51, 0xffff0000, v29
  s_waitcnt vmcnt(33)
  v_mfma_f32_32x32x16_bf16 v[64:79], a[32:35], a[40:43], v[64:79]
  s_waitcnt vmcnt(32)
  v_mfma_f32_32x32x16_bf16 v[80:95], a[36:39], a[40:43], v[80:95]
  s_waitcnt vmcnt(31)
  v_mfma_f32_32x32x16_bf16 v[112:127], a[36:39], a[44:47], v[112:127]
  v_mfma_f32_32x32x16_bf16 v[96:111], a[32:35], a[44:47], v[96:111]
  s_lshl_b32 s60, s59, 10
  s_add_u32 s61, s60, s45
  s_add_u32 s62, s60, s46
  s_lshl_b32 s60, s59, 11
  s_add_u32 s63, s60, s47
  buffer_load_dwordx4 a[40:43], v3, s[20:23], s61 offen sc0 sc1
  buffer_load_dwordx4 a[32:35], v4, s[12:15], s63 offen sc0 sc1
  s_add_u32 s59, s59, 4
  s_sub_u32 s60, s59, 256
  s_cselect_b32 s59, s59, s60
  buffer_load_dwordx4 a[36:39], v5, s[12:15], s63 offen sc0 sc1
  buffer_load_dwordx4 a[44:47], v3, s[20:23], s62 offen sc0 sc1
  v_lshlrev_b32 v52, 16, v30
  v_and_b32 v53, 0xffff0000, v30
  v_lshlrev_b32 v54, 16, v31
  v_and_b32 v55, 0xffff0000, v31
  v_add_f32 v42, v48, v49
  v_add_f32 v42, v42, v50
  v_add_f32 v42, v42, v51
  v_add_f32 v42, v42, v52
  v_add_f32 v42, v42, v53
  v_add_f32 v42, v42, v54
  v_add_f32 v42, v42, v55
  s_nop 1
  v_permlane32_swap_b32 v42, v43
  v_add_f32 v42, v42, v43
  ds_write_b32 v7, v42 offset:4864
  s_waitcnt vmcnt(32)
  v_mfma_f32_32x32x16_bf16 v[64:79], a[48:51], a[56:59], v[64:79]
  s_waitcnt vmcnt(31)
  v_mfma_f32_32x32x16_bf16 v[80:95], a[52:55], a[56:59], v[80:95]
  s_waitcnt vmcnt(30)
  v_mfma_f32_32x32x16_bf16 v[112:127], a[52:55], a[60:63], v[112:127]
  v_mfma_f32_32x32x16_bf16 v[96:111], a[48:51], a[60:63], v[96:111]
  s_lshl_b32 s60, s59, 10
  s_add_u32 s61, s60, s45
  s_add_u32 s62, s60, s46
  s_lshl_b32 s60, s59, 11
  s_add_u32 s63, s60, s47
  buffer_load_dwordx4 a[56:59], v3, s[20:23], s61 offen sc0 sc1
  buffer_load_dwordx4 a[48:51], v4, s[12:15], s63 offen sc0 sc1
  s_add_u32 s59, s59, 4
  s_sub_u32 s60, s59, 256
  s_cselect_b32 s59, s59, s60
  buffer_load_dwordx4 a[52:55], v5, s[12:15], s63 offen sc0 sc1
  buffer_load_dwordx4 a[60:63], v3, s[20:23], s62 offen sc0 sc1
  s_waitcnt vmcnt(32)
  v_mfma_f32_32x32x16_bf16 v[64:79], a[64:67], a[72:75], v[64:79]
  s_waitcnt vmcnt(31)
  v_mfma_f32_32x32x16_bf16 v[80:95], a[68:71], a[72:75], v[80:95]
  s_waitcnt vmcnt(30)
  v_mfma_f32_32x32x16_bf16 v[112:127], a[68:71], a[76:79], v[112:127]
  v_mfma_f32_32x32x16_bf16 v[96:111], a[64:67], a[76:79], v[96:111]
  s_lshl_b32 s60, s59, 10
  s_add_u32 s61, s60, s45
  s_add_u32 s62, s60, s46
  s_lshl_b32 s60, s59, 11
  s_add_u32 s63, s60, s47
  buffer_load_dwordx4 a[72:75], v3, s[20:23], s61 offen sc0 sc1
  buffer_load_dwordx4 a[64:67], v4, s[12:15], s63 offen sc0 sc1
  s_add_u32 s59, s59, 4
  s_sub_u32 s60, s59, 256
  s_cselect_b32 s59, s59, s60
  buffer_load_dwordx4 a[68:71], v5, s[12:15], s63 offen sc0 sc1
  buffer_load_dwordx4 a[76:79], v3, s[20:23], s62 offen sc0 sc1
  s_waitcnt vmcnt(32)
  v_mfma_f32_32x32x16_bf16 v[64:79], a[80:83], a[88:91], v[64:79]
  s_waitcnt vmcnt(31)
  v_mfma_f32_32x32x16_bf16 v[80:95], a[84:87], a[88:91], v[80:95]
  s_waitcnt vmcnt(30)
  v_mfma_f32_32x32x16_bf16 v[112:127], a[84:87], a[92:95], v[112:127]
  v_mfma_f32_32x32x16_bf16 v[96:111], a[80:83], a[92:95], v[96:111]
  s_lshl_b32 s60, s59, 10
  s_add_u32 s61, s60, s45
  s_add_u32 s62, s60, s46
  s_lshl_b32 s60, s59, 11
  s_add_u32 s63, s60, s47
  buffer_load_dwordx4 a[88:91], v3, s[20:23], s61 offen sc0 sc1
  buffer_load_dwordx4 a[80:83], v4, s[12:15], s63 offen sc0 sc1
  s_add_u32 s59, s59, 4
  s_sub_u32 s60, s59, 256
  s_cselect_b32 s59, s59, s60
  buffer_load_dwordx4 a[84:87], v5, s[12:15], s63 offen sc0 sc1
  buffer_load_dwordx4 a[92:95], v3, s[20:23], s62 offen sc0 sc1
  s_waitcnt vmcnt(31)
  v_mfma_f32_32x32x16_bf16 v[64:79], a[96:99], a[104:107], v[64:79]
  s_waitcnt vmcnt(30)
  v_mfma_f32_32x32x16_bf16 v[80:95], a[100:103], a[104:107], v[80:95]
  s_waitcnt vmcnt(29)
  v_mfma_f32_32x32x16_bf16 v[112:127], a[100:103], a[108:111], v[112:127]
  v_mfma_f32_32x32x16_bf16 v[96:111], a[96:99], a[108:111], v[96:111]
  s_lshl_b32 s60, s59, 10
  s_add_u32 s61, s60, s45
  s_add_u32 s62, s60, s46
  s_lshl_b32 s60, s59, 11
  s_add_u32 s63, s60, s47
  buffer_load_dwordx4 a[104:107], v3, s[20:23], s61 offen sc0 sc1
  buffer_load_dwordx4 a[96:99], v4, s[12:15], s63 offen sc0 sc1
  s_add_u32 s59, s59, 4
  s_sub_u32 s60, s59, 256
  s_cselect_b32 s59, s59, s60
  buffer_load_dwordx4 a[100:103], v5, s[12:15], s63 offen sc0 sc1
  buffer_load_dwordx4 a[108:111], v3, s[20:23], s62 offen sc0 sc1
  s_waitcnt vmcnt(31)
  v_mfma_f32_32x32x16_bf16 v[64:79], a[112:115], a[120:123], v[64:79]
  s_waitcnt vmcnt(30)
  v_mfma_f32_32x32x16_bf16 v[80:95], a[116:119], a[120:123], v[80:95]
  s_waitcnt vmcnt(29)
  v_mfma_f32_32x32x16_bf16 v[112:127], a[116:119], a[124:127], v[112:127]
  v_mfma_f32_32x32x16_bf16 v[96:111], a[112:115], a[124:127], v[96:111]
  s_lshl_b32 s60, s59, 10
  s_add_u32 s61, s60, s45
  s_add_u32 s62, s60, s46
  s_lshl_b32 s60, s59, 11
  s_add_u32 s63, s60, s47
  buffer_load_dwordx4 a[120:123], v3, s[20:23], s61 offen sc0 sc1
  buffer_load_dwordx4 a[112:115], v4, s[12:15], s63 offen sc0 sc1
  s_add_u32 s59, s59, 4
  s_sub_u32 s60, s59, 256
  s_cselect_b32 s59, s59, s60
  buffer_load_dwordx4 a[116:119], v5, s[12:15], s63 offen sc0 sc1
  buffer_load_dwordx4 a[124:127], v3, s[20:23], s62 offen sc0 sc1
  s_waitcnt vmcnt(31)
  v_mfma_f32_32x32x16_bf16 v[64:79], a[0:3], a[8:11], v[64:79]
  s_waitcnt vmcnt(30)
  v_mfma_f32_32x32x16_bf16 v[80:95], a[4:7], a[8:11], v[80:95]
  s_waitcnt vmcnt(29)
  v_mfma_f32_32x32x16_bf16 v[112:127], a[4:7], a[12:15], v[112:127]
  v_mfma_f32_32x32x16_bf16 v[96:111], a[0:3], a[12:15], v[96:111]
  s_lshl_b32 s60, s59, 10
  s_add_u32 s61, s60, s45
  s_add_u32 s62, s60, s46
  s_lshl_b32 s60, s59, 11
  s_add_u32 s63, s60, s47
  buffer_load_dwordx4 a[8:11], v3, s[20:23], s61 offen sc0 sc1
  buffer_load_dwordx4 a[0:3], v4, s[12:15], s63 offen sc0 sc1
  s_add_u32 s59, s59, 4
  s_sub_u32 s60, s59, 256
  s_cselect_b32 s59, s59, s60
  buffer_load_dwordx4 a[4:7], v5, s[12:15], s63 offen sc0 sc1
  buffer_load_dwordx4 a[12:15], v3, s[20:23], s62 offen sc0 sc1
  s_waitcnt vmcnt(31)
  v_mfma_f32_32x32x16_bf16 v[64:79], a[16:19], a[24:27], v[64:79]
  s_waitcnt vmcnt(30)
  v_mfma_f32_32x32x16_bf16 v[80:95], a[20:23], a[24:27], v[80:95]
  s_waitcnt vmcnt(29)
  v_mfma_f32_32x32x16_bf16 v[112:127], a[20:23], a[28:31], v[112:127]
  v_mfma_f32_32x32x16_bf16 v[96:111], a[16:19], a[28:31], v[96:111]
  s_lshl_b32 s60, s59, 10
  s_add_u32 s61, s60, s45
  s_add_u32 s62, s60, s46
  s_lshl_b32 s60, s59, 11
  s_add_u32 s63, s60, s47
  buffer_load_dwordx4 a[24:27], v3, s[20:23], s61 offen sc0 sc1
  buffer_load_dwordx4 a[16:19], v4, s[12:15], s63 offen sc0 sc1
  s_add_u32 s59, s59, 4
  s_sub_u32 s60, s59, 256
  s_cselect_b32 s59, s59, s60
  buffer_load_dwordx4 a[20:23], v5, s[12:15], s63 offen sc0 sc1
  buffer_load_dwordx4 a[28:31], v3, s[20:23], s62 offen sc0 sc1
  s_waitcnt vmcnt(30)
  v_mfma_f32_32x32x16_bf16 v[64:79], a[32:35], a[40:43], v[64:79]
  s_waitcnt vmcnt(29)
  v_mfma_f32_32x32x16_bf16 v[80:95], a[36:39], a[40:43], v[80:95]
  s_waitcnt vmcnt(28)
  v_mfma_f32_32x32x16_bf16 v[112:127], a[36:39], a[44:47], v[112:127]
  v_mfma_f32_32x32x16_bf16 v[96:111], a[32:35], a[44:47], v[96:111]
  s_lshl_b32 s60, s59, 10
  s_add_u32 s61, s60, s45
  s_add_u32 s62, s60, s46
  s_lshl_b32 s60, s59, 11
  s_add_u32 s63, s60, s47
  buffer_load_dwordx4 a[40:43], v3, s[20:23], s61 offen sc0 sc1
  buffer_load_dwordx4 a[32:35], v4, s[12:15], s63 offen sc0 sc1
  s_add_u32 s59, s59, 4
  s_sub_u32 s60, s59, 256
  s_cselect_b32 s59, s59, s60
  buffer_load_dwordx4 a[36:39], v5, s[12:15], s63 offen sc0 sc1
  buffer_load_dwordx4 a[44:47], v3, s[20:23], s62 offen sc0 sc1
  s_waitcnt vmcnt(30)
  v_mfma_f32_32x32x16_bf16 v[64:79], a[48:51], a[56:59], v[64:79]
  s_waitcnt vmcnt(29)
  v_mfma_f32_32x32x16_bf16 v[80:95], a[52:55], a[56:59], v[80:95]
  s_waitcnt vmcnt(28)
  v_mfma_f32_32x32x16_bf16 v[112:127], a[52:55], a[60:63], v[112:127]
  v_mfma_f32_32x32x16_bf16 v[96:111], a[48:51], a[60:63], v[96:111]
  s_lshl_b32 s60, s59, 10
  s_add_u32 s61, s60, s45
  s_add_u32 s62, s60, s46
  s_lshl_b32 s60, s59, 11
  s_add_u32 s63, s60, s47
  buffer_load_dwordx4 a[56:59], v3, s[20:23], s61 offen sc0 sc1
  buffer_load_dwordx4 a[48:51], v4, s[12:15], s63 offen sc0 sc1
  s_add_u32 s59, s59, 4
  s_sub_u32 s60, s59, 256
  s_cselect_b32 s59, s59, s60
  buffer_load_dwordx4 a[52:55], v5, s[12:15], s63 offen sc0 sc1
  buffer_load_dwordx4 a[60:63], v3, s[20:23], s62 offen sc0 sc1
  s_waitcnt vmcnt(30)
  v_mfma_f32_32x32x16_bf16 v[64:79], a[64:67], a[72:75], v[64:79]
  s_waitcnt vmcnt(29)
  v_mfma_f32_32x32x16_bf16 v[80:95], a[68:71], a[72:75], v[80:95]
  s_waitcnt vmcnt(28)
  v_mfma_f32_32x32x16_bf16 v[112:127], a[68:71], a[76:79], v[112:127]
  v_mfma_f32_32x32x16_bf16 v[96:111], a[64:67], a[76:79], v[96:111]
  s_lshl_b32 s60, s59, 10
  s_add_u32 s61, s60, s45
  s_add_u32 s62, s60, s46
  s_lshl_b32 s60, s59, 11
  s_add_u32 s63, s60, s47
  buffer_load_dwordx4 a[72:75], v3, s[20:23], s61 offen sc0 sc1
  buffer_load_dwordx4 a[64:67], v4, s[12:15], s63 offen sc0 sc1
  s_add_u32 s59, s59, 4
  s_sub_u32 s60, s59, 256
  s_cselect_b32 s59, s59, s60
  buffer_load_dwordx4 a[68:71], v5, s[12:15], s63 offen sc0 sc1
  buffer_load_dwordx4 a[76:79], v3, s[20:23], s62 offen sc0 sc1
  s_waitcnt vmcnt(30)
  v_mfma_f32_32x32x16_bf16 v[64:79], a[80:83], a[88:91], v[64:79]
  s_waitcnt vmcnt(29)
  v_mfma_f32_32x32x16_bf16 v[80:95], a[84:87], a[88:91], v[80:95]
  s_waitcnt vmcnt(28)
  v_mfma_f32_32x32x16_bf16 v[112:127], a[84:87], a[92:95], v[112:127]
  v_mfma_f32_32x32x16_bf16 v[96:111], a[80:83], a[92:95], v[96:111]
  s_lshl_b32 s60, s59, 10
  s_add_u32 s61, s60, s45
  s_add_u32 s62, s60, s46
  s_lshl_b32 s60, s59, 11
  s_add_u32 s63, s60, s47
  buffer_load_dwordx4 a[88:91], v3, s[20:23], s61 offen sc0 sc1
  buffer_load_dwordx4 a[80:83], v4, s[12:15], s63 offen sc0 sc1
  s_add_u32 s59, s59, 4
  s_sub_u32 s60, s59, 256
  s_cselect_b32 s59, s59, s60
  buffer_load_dwordx4 a[84:87], v5, s[12:15], s63 offen sc0 sc1
  buffer_load_dwordx4 a[92:95], v3, s[20:23], s62 offen sc0 sc1
  s_waitcnt vmcnt(30)
  v_mfma_f32_32x32x16_bf16 v[64:79], a[96:99], a[104:107], v[64:79]
  s_waitcnt vmcnt(29)
  v_mfma_f32_32x32x16_bf16 v[80:95], a[100:103], a[104:107], v[80:95]
  s_waitcnt vmcnt(28)
  v_mfma_f32_32x32x16_bf16 v[112:127], a[100:103], a[108:111], v[112:127]
  v_mfma_f32_32x32x16_bf16 v[96:111], a[96:99], a[108:111], v[96:111]
  s_lshl_b32 s60, s59, 10
  s_add_u32 s61, s60, s45
  s_add_u32 s62, s60, s46
  s_lshl_b32 s60, s59, 11
  s_add_u32 s63, s60, s47
  buffer_load_dwordx4 a[104:107], v3, s[20:23], s61 offen sc0 sc1
  buffer_load_dwordx4 a[96:99], v4, s[12:15], s63 offen sc0 sc1
  s_add_u32 s59, s59, 4
  s_sub_u32 s60, s59, 256
  s_cselect_b32 s59, s59, s60
  buffer_load_dwordx4 a[100:103], v5, s[12:15], s63 offen sc0 sc1
  buffer_load_dwordx4 a[108:111], v3, s[20:23], s62 offen sc0 sc1
  s_waitcnt vmcnt(30)
  v_mfma_f32_32x32x16_bf16 v[64:79], a[112:115], a[120:123], v[64:79]
  s_waitcnt vmcnt(29)
  v_mfma_f32_32x32x16_bf16 v[80:95], a[116:119], a[120:123], v[80:95]
  s_waitcnt vmcnt(28)
  v_mfma_f32_32x32x16_bf16 v[112:127], a[116:119], a[124:127], v[112:127]
  v_mfma_f32_32x32x16_bf16 v[96:111], a[112:115], a[124:127], v[96:111]
  s_lshl_b32 s60, s59, 10
  s_add_u32 s61, s60, s45
  s_add_u32 s62, s60, s46
  s_lshl_b32 s60, s59, 11
  s_add_u32 s63, s60, s47
  buffer_load_dwordx4 a[120:123], v3, s[20:23], s61 offen sc0 sc1
  buffer_load_dwordx4 a[112:115], v4, s[12:15], s63 offen sc0 sc1
  s_add_u32 s59, s59, 4
  s_sub_u32 s60, s59, 256
  s_cselect_b32 s59, s59, s60
  buffer_load_dwordx4 a[116:119], v5, s[12:15], s63 offen sc0 sc1
  buffer_load_dwordx4 a[124:127], v3, s[20:23], s62 offen sc0 sc1
  s_waitcnt vmcnt(30)
  v_mfma_f32_32x32x16_bf16 v[64:79], a[0:3], a[8:11], v[64:79]
  s_waitcnt vmcnt(29)
  v_mfma_f32_32x32x16_bf16 v[80:95], a[4:7], a[8:11], v[80:95]
  s_waitcnt vmcnt(28)
  v_mfma_f32_32x32x16_bf16 v[112:127], a[4:7], a[12:15], v[112:127]
  v_mfma_f32_32x32x16_bf16 v[96:111], a[0:3], a[12:15], v[96:111]
  s_lshl_b32 s60, s59, 10
  s_add_u32 s61, s60, s45
  s_add_u32 s62, s60, s46
  s_lshl_b32 s60, s59, 11
  s_add_u32 s63, s60, s47
  buffer_load_dwordx4 a[8:11], v3, s[20:23], s61 offen sc0 sc1
  buffer_load_dwordx4 a[0:3], v4, s[12:15], s63 offen sc0 sc1
  s_add_u32 s59, s59, 4
  s_sub_u32 s60, s59, 256
  s_cselect_b32 s59, s59, s60
  buffer_load_dwordx4 a[4:7], v5, s[12:15], s63 offen sc0 sc1
  buffer_load_dwordx4 a[12:15], v3, s[20:23], s62 offen sc0 sc1
  s_waitcnt vmcnt(30)
  v_mfma_f32_32x32x16_bf16 v[64:79], a[16:19], a[24:27], v[64:79]
  s_waitcnt vmcnt(29)
  v_mfma_f32_32x32x16_bf16 v[80:95], a[20:23], a[24:27], v[80:95]
  s_waitcnt vmcnt(28)
  v_mfma_f32_32x32x16_bf16 v[112:127], a[20:23], a[28:31], v[112:127]
  v_mfma_f32_32x32x16_bf16 v[96:111], a[16:19], a[28:31], v[96:111]
  s_lshl_b32 s60, s59, 10
  s_add_u32 s61, s60, s45
  s_add_u32 s62, s60, s46
  s_lshl_b32 s60, s59, 11
  s_add_u32 s63, s60, s47
  buffer_load_dwordx4 a[24:27], v3, s[20:23], s61 offen sc0 sc1
  buffer_load_dwordx4 a[16:19], v4, s[12:15], s63 offen sc0 sc1
  s_add_u32 s59, s59, 4
  s_sub_u32 s60, s59, 256
  s_cselect_b32 s59, s59, s60
  buffer_load_dwordx4 a[20:23], v5, s[12:15], s63 offen sc0 sc1
  buffer_load_dwordx4 a[28:31], v3, s[20:23], s62 offen sc0 sc1
  s_waitcnt vmcnt(30)
  v_mfma_f32_32x32x16_bf16 v[64:79], a[32:35], a[40:43], v[64:79]
  s_waitcnt vmcnt(29)
  v_mfma_f32_32x32x16_bf16 v[80:95], a[36:39], a[40:43], v[80:95]
  s_waitcnt vmcnt(28)
  v_mfma_f32_32x32x16_bf16 v[112:127], a[36:39], a[44:47], v[112:127]
  v_mfma_f32_32x32x16_bf16 v[96:111], a[32:35], a[44:47], v[96:111]
  s_lshl_b32 s60, s59, 10
  s_add_u32 s61, s60, s45
  s_add_u32 s62, s60, s46
  s_lshl_b32 s60, s59, 11
  s_add_u32 s63, s60, s47
  buffer_load_dwordx4 a[40:43], v3, s[20:23], s61 offen sc0 sc1
  buffer_load_dwordx4 a[32:35], v4, s[12:15], s63 offen sc0 sc1
  s_add_u32 s59, s59, 4
  s_sub_u32 s60, s59, 256
  s_cselect_b32 s59, s59, s60
  buffer_load_dwordx4 a[36:39], v5, s[12:15], s63 offen sc0 sc1
  buffer_load_dwordx4 a[44:47], v3, s[20:23], s62 offen sc0 sc1
  s_waitcnt vmcnt(30)
  v_mfma_f32_32x32x16_bf16 v[64:79], a[48:51], a[56:59], v[64:79]
  s_waitcnt vmcnt(29)
  v_mfma_f32_32x32x16_bf16 v[80:95], a[52:55], a[56:59], v[80:95]
  s_waitcnt vmcnt(28)
  v_mfma_f32_32x32x16_bf16 v[112:127], a[52:55], a[60:63], v[112:127]
  v_mfma_f32_32x32x16_bf16 v[96:111], a[48:51], a[60:63], v[96:111]
  s_lshl_b32 s60, s59, 10
  s_add_u32 s61, s60, s45
  s_add_u32 s62, s60, s46
  s_lshl_b32 s60, s59, 11
  s_add_u32 s63, s60, s47
  buffer_load_dwordx4 a[56:59], v3, s[20:23], s61 offen sc0 sc1
  buffer_load_dwordx4 a[48:51], v4, s[12:15], s63 offen sc0 sc1
  s_add_u32 s59, s59, 4
  s_sub_u32 s60, s59, 256
  s_cselect_b32 s59, s59, s60
  buffer_load_dwordx4 a[52:55], v5, s[12:15], s63 offen sc0 sc1
  buffer_load_dwordx4 a[60:63], v3, s[20:23], s62 offen sc0 sc1
  s_waitcnt vmcnt(30)
  v_mfma_f32_32x32x16_bf16 v[64:79], a[64:67], a[72:75], v[64:79]
  s_waitcnt vmcnt(29)
  v_mfma_f32_32x32x16_bf16 v[80:95], a[68:71], a[72:75], v[80:95]
  s_waitcnt vmcnt(28)
  v_mfma_f32_32x32x16_bf16 v[112:127], a[68:71], a[76:79], v[112:127]
  v_mfma_f32_32x32x16_bf16 v[96:111], a[64:67], a[76:79], v[96:111]
  s_lshl_b32 s60, s59, 10
  s_add_u32 s61, s60, s45
  s_add_u32 s62, s60, s46
  s_lshl_b32 s60, s59, 11
  s_add_u32 s63, s60, s47
  buffer_load_dwordx4 a[72:75], v3, s[20:23], s61 offen sc0 sc1
  buffer_load_dwordx4 a[64:67], v4, s[12:15], s63 offen sc0 sc1
  s_add_u32 s59, s59, 4
  s_sub_u32 s60, s59, 256
  s_cselect_b32 s59, s59, s60
  buffer_load_dwordx4 a[68:71], v5, s[12:15], s63 offen sc0 sc1
  buffer_load_dwordx4 a[76:79], v3, s[20:23], s62 offen sc0 sc1
  s_lshl_b32 s70, s40, 8
  s_add_u32 s70, s70, 53248
  v_lshlrev_b32 v7, 2, v1
  v_add_u32 v7, s70, v7
  s_waitcnt lgkmcnt(0)
  s_barrier
  ds_read_b32 v60, v7 offset:0
  ds_read_b32 v61, v7 offset:5120
  ds_read_b32 v62, v7 offset:10240
  ds_read_b32 v63, v7 offset:15360
  s_waitcnt vmcnt(30)
  v_mfma_f32_32x32x16_bf16 v[64:79], a[80:83], a[88:91], v[64:79]
  s_waitcnt vmcnt(29)
  v_mfma_f32_32x32x16_bf16 v[80:95], a[84:87], a[88:91], v[80:95]
  s_waitcnt vmcnt(28)
  v_mfma_f32_32x32x16_bf16 v[112:127], a[84:87], a[92:95], v[112:127]
  v_mfma_f32_32x32x16_bf16 v[96:111], a[80:83], a[92:95], v[96:111]
  s_lshl_b32 s60, s59, 10
  s_add_u32 s61, s60, s45
  s_add_u32 s62, s60, s46
  s_lshl_b32 s60, s59, 11
  s_add_u32 s63, s60, s47
  buffer_load_dwordx4 a[88:91], v3, s[20:23], s61 offen sc0 sc1
  buffer_load_dwordx4 a[80:83], v4, s[12:15], s63 offen sc0 sc1
  s_add_u32 s59, s59, 4
  s_sub_u32 s60, s59, 256
  s_cselect_b32 s59, s59, s60
  buffer_load_dwordx4 a[84:87], v5, s[12:15], s63 offen sc0 sc1
  buffer_load_dwordx4 a[92:95], v3, s[20:23], s62 offen sc0 sc1
  s_waitcnt lgkmcnt(2)
  v_add_f32 v60, v60, v61
  s_waitcnt lgkmcnt(0)
  v_add_f32 v62, v62, v63
  v_add_f32 v60, v60, v62
  buffer_store_dword v60, v14, s[36:39], s68 offen sc0 sc1
  s_waitcnt vmcnt(31)
  v_mfma_f32_32x32x16_bf16 v[64:79], a[96:99], a[104:107], v[64:79]
  s_waitcnt vmcnt(30)
  v_mfma_f32_32x32x16_bf16 v[80:95], a[100:103], a[104:107], v[80:95]
  s_waitcnt vmcnt(29)
  v_mfma_f32_32x32x16_bf16 v[112:127], a[100:103], a[108:111], v[112:127]
  v_mfma_f32_32x32x16_bf16 v[96:111], a[96:99], a[108:111], v[96:111]
  s_lshl_b32 s60, s59, 10
  s_add_u32 s61, s60, s45
  s_add_u32 s62, s60, s46
  s_lshl_b32 s60, s59, 11
  s_add_u32 s63, s60, s47
  buffer_load_dwordx4 a[104:107], v3, s[20:23], s61 offen sc0 sc1
  buffer_load_dwordx4 a[96:99], v4, s[12:15], s63 offen sc0 sc1
  s_add_u32 s59, s59, 4
  s_sub_u32 s60, s59, 256
  s_cselect_b32 s59, s59, s60
  buffer_load_dwordx4 a[100:103], v5, s[12:15], s63 offen sc0 sc1
  buffer_load_dwordx4 a[108:111], v3, s[20:23], s62 offen sc0 sc1
  s_waitcnt vmcnt(31)
  v_mfma_f32_32x32x16_bf16 v[64:79], a[112:115], a[120:123], v[64:79]
  s_waitcnt vmcnt(30)
  v_mfma_f32_32x32x16_bf16 v[80:95], a[116:119], a[120:123], v[80:95]
  s_waitcnt vmcnt(29)
  v_mfma_f32_32x32x16_bf16 v[112:127], a[116:119], a[124:127], v[112:127]
  v_mfma_f32_32x32x16_bf16 v[96:111], a[112:115], a[124:127], v[96:111]
  s_lshl_b32 s60, s59, 10
  s_add_u32 s61, s60, s45
  s_add_u32 s62, s60, s46
  s_lshl_b32 s60, s59, 11
  s_add_u32 s63, s60, s47
  buffer_load_dwordx4 a[120:123], v3, s[20:23], s61 offen sc0 sc1
  buffer_load_dwordx4 a[112:115], v4, s[12:15], s63 offen sc0 sc1
  s_add_u32 s59, s59, 4
  s_sub_u32 s60, s59, 256
  s_cselect_b32 s59, s59, s60
  buffer_load_dwordx4 a[116:119], v5, s[12:15], s63 offen sc0 sc1
  buffer_load_dwordx4 a[124:127], v3, s[20:23], s62 offen sc0 sc1
  s_waitcnt vmcnt(31)
  v_mfma_f32_32x32x16_bf16 v[64:79], a[0:3], a[8:11], v[64:79]
  s_waitcnt vmcnt(30)
  v_mfma_f32_32x32x16_bf16 v[80:95], a[4:7], a[8:11], v[80:95]
  s_waitcnt vmcnt(29)
  v_mfma_f32_32x32x16_bf16 v[112:127], a[4:7], a[12:15], v[112:127]
  v_mfma_f32_32x32x16_bf16 v[96:111], a[0:3], a[12:15], v[96:111]
  s_lshl_b32 s60, s59, 10
  s_add_u32 s61, s60, s45
  s_add_u32 s62, s60, s46
  s_lshl_b32 s60, s59, 11
  s_add_u32 s63, s60, s47
  buffer_load_dwordx4 a[8:11], v3, s[20:23], s61 offen sc0 sc1
  buffer_load_dwordx4 a[0:3], v4, s[12:15], s63 offen sc0 sc1
  s_add_u32 s59, s59, 4
  s_sub_u32 s60, s59, 256
  s_cselect_b32 s59, s59, s60
  buffer_load_dwordx4 a[4:7], v5, s[12:15], s63 offen sc0 sc1
  buffer_load_dwordx4 a[12:15], v3, s[20:23], s62 offen sc0 sc1
  s_waitcnt vmcnt(31)
  v_mfma_f32_32x32x16_bf16 v[64:79], a[16:19], a[24:27], v[64:79]
  s_waitcnt vmcnt(30)
  v_mfma_f32_32x32x16_bf16 v[80:95], a[20:23], a[24:27], v[80:95]
  s_waitcnt vmcnt(29)
  v_mfma_f32_32x32x16_bf16 v[112:127], a[20:23], a[28:31], v[112:127]
  v_mfma_f32_32x32x16_bf16 v[96:111], a[16:19], a[28:31], v[96:111]
  s_lshl_b32 s60, s59, 10
  s_add_u32 s61, s60, s45
  s_add_u32 s62, s60, s46
  s_lshl_b32 s60, s59, 11
  s_add_u32 s63, s60, s47
  buffer_load_dwordx4 a[24:27], v3, s[20:23], s61 offen sc0 sc1
  buffer_load_dwordx4 a[16:19], v4, s[12:15], s63 offen sc0 sc1
  s_add_u32 s59, s59, 4
  s_sub_u32 s60, s59, 256
  s_cselect_b32 s59, s59, s60
  buffer_load_dwordx4 a[20:23], v5, s[12:15], s63 offen sc0 sc1
  buffer_load_dwordx4 a[28:31], v3, s[20:23], s62 offen sc0 sc1
  s_waitcnt vmcnt(31)
  v_mfma_f32_32x32x16_bf16 v[64:79], a[32:35], a[40:43], v[64:79]
  s_waitcnt vmcnt(30)
  v_mfma_f32_32x32x16_bf16 v[80:95], a[36:39], a[40:43], v[80:95]
  s_waitcnt vmcnt(29)
  v_mfma_f32_32x32x16_bf16 v[112:127], a[36:39], a[44:47], v[112:127]
  v_mfma_f32_32x32x16_bf16 v[96:111], a[32:35], a[44:47], v[96:111]
  s_lshl_b32 s60, s59, 10
  s_add_u32 s61, s60, s45
  s_add_u32 s62, s60, s46
  s_lshl_b32 s60, s59, 11
  s_add_u32 s63, s60, s47
  buffer_load_dwordx4 a[40:43], v3, s[20:23], s61 offen sc0 sc1
  buffer_load_dwordx4 a[32:35], v4, s[12:15], s63 offen sc0 sc1
  s_add_u32 s59, s59, 4
  s_sub_u32 s60, s59, 256
  s_cselect_b32 s59, s59, s60
  buffer_load_dwordx4 a[36:39], v5, s[12:15], s63 offen sc0 sc1
  buffer_load_dwordx4 a[44:47], v3, s[20:23], s62 offen sc0 sc1
  s_waitcnt vmcnt(31)
  v_mfma_f32_32x32x16_bf16 v[64:79], a[48:51], a[56:59], v[64:79]
  s_waitcnt vmcnt(30)
  v_mfma_f32_32x32x16_bf16 v[80:95], a[52:55], a[56:59], v[80:95]
  s_waitcnt vmcnt(29)
  v_mfma_f32_32x32x16_bf16 v[112:127], a[52:55], a[60:63], v[112:127]
  v_mfma_f32_32x32x16_bf16 v[96:111], a[48:51], a[60:63], v[96:111]
  s_lshl_b32 s60, s59, 10
  s_add_u32 s61, s60, s45
  s_add_u32 s62, s60, s46
  s_lshl_b32 s60, s59, 11
  s_add_u32 s63, s60, s47
  buffer_load_dwordx4 a[56:59], v3, s[20:23], s61 offen sc0 sc1
  buffer_load_dwordx4 a[48:51], v4, s[12:15], s63 offen sc0 sc1
  s_add_u32 s59, s59, 4
  s_sub_u32 s60, s59, 256
  s_cselect_b32 s59, s59, s60
  buffer_load_dwordx4 a[52:55], v5, s[12:15], s63 offen sc0 sc1
  buffer_load_dwordx4 a[60:63], v3, s[20:23], s62 offen sc0 sc1
  s_waitcnt vmcnt(31)
  v_mfma_f32_32x32x16_bf16 v[64:79], a[64:67], a[72:75], v[64:79]
  s_waitcnt vmcnt(30)
  v_mfma_f32_32x32x16_bf16 v[80:95], a[68:71], a[72:75], v[80:95]
  s_waitcnt vmcnt(29)
  v_mfma_f32_32x32x16_bf16 v[112:127], a[68:71], a[76:79], v[112:127]
  v_mfma_f32_32x32x16_bf16 v[96:111], a[64:67], a[76:79], v[96:111]
  s_lshl_b32 s60, s59, 10
  s_add_u32 s61, s60, s45
  s_add_u32 s62, s60, s46
  s_lshl_b32 s60, s59, 11
  s_add_u32 s63, s60, s47
  buffer_load_dwordx4 a[72:75], v3, s[20:23], s61 offen sc0 sc1
  buffer_load_dwordx4 a[64:67], v4, s[12:15], s63 offen sc0 sc1
  s_add_u32 s59, s59, 4
  s_sub_u32 s60, s59, 256
  s_cselect_b32 s59, s59, s60
  buffer_load_dwordx4 a[68:71], v5, s[12:15], s63 offen sc0 sc1
  buffer_load_dwordx4 a[76:79], v3, s[20:23], s62 offen sc0 sc1
  s_waitcnt vmcnt(31)
  v_mfma_f32_32x32x16_bf16 v[64:79], a[80:83], a[88:91], v[64:79]
  s_waitcnt vmcnt(30)
  v_mfma_f32_32x32x16_bf16 v[80:95], a[84:87], a[88:91], v[80:95]
  s_waitcnt vmcnt(29)
  v_mfma_f32_32x32x16_bf16 v[112:127], a[84:87], a[92:95], v[112:127]
  v_mfma_f32_32x32x16_bf16 v[96:111], a[80:83], a[92:95], v[96:111]
  s_lshl_b32 s60, s59, 10
  s_add_u32 s61, s60, s45
  s_add_u32 s62, s60, s46
  s_lshl_b32 s60, s59, 11
  s_add_u32 s63, s60, s47
  buffer_load_dwordx4 a[88:91], v3, s[20:23], s61 offen sc0 sc1
  buffer_load_dwordx4 a[80:83], v4, s[12:15], s63 offen sc0 sc1
  s_add_u32 s59, s59, 4
  s_sub_u32 s60, s59, 256
  s_cselect_b32 s59, s59, s60
  buffer_load_dwordx4 a[84:87], v5, s[12:15], s63 offen sc0 sc1
  buffer_load_dwordx4 a[92:95], v3, s[20:23], s62 offen sc0 sc1
  s_waitcnt vmcnt(30)
  v_mfma_f32_32x32x16_bf16 v[64:79], a[96:99], a[104:107], v[64:79]
  s_waitcnt vmcnt(29)
  v_mfma_f32_32x32x16_bf16 v[80:95], a[100:103], a[104:107], v[80:95]
  s_waitcnt vmcnt(28)
  v_mfma_f32_32x32x16_bf16 v[112:127], a[100:103], a[108:111], v[112:127]
  v_mfma_f32_32x32x16_bf16 v[96:111], a[96:99], a[108:111], v[96:111]
  s_lshl_b32 s60, s59, 10
  s_add_u32 s61, s60, s45
  s_add_u32 s62, s60, s46
  s_lshl_b32 s60, s59, 11
  s_add_u32 s63, s60, s47
  buffer_load_dwordx4 a[104:107], v3, s[20:23], s61 offen sc0 sc1
  buffer_load_dwordx4 a[96:99], v4, s[12:15], s63 offen sc0 sc1
  s_add_u32 s59, s59, 4
  s_sub_u32 s60, s59, 256
  s_cselect_b32 s59, s59, s60
  buffer_load_dwordx4 a[100:103], v5, s[12:15], s63 offen sc0 sc1
  buffer_load_dwordx4 a[108:111], v3, s[20:23], s62 offen sc0 sc1
  s_waitcnt vmcnt(30)
  v_mfma_f32_32x32x16_bf16 v[64:79], a[112:115], a[120:123], v[64:79]
  s_waitcnt vmcnt(29)
  v_mfma_f32_32x32x16_bf16 v[80:95], a[116:119], a[120:123], v[80:95]
  s_waitcnt vmcnt(28)
  v_mfma_f32_32x32x16_bf16 v[112:127], a[116:119], a[124:127], v[112:127]
  v_mfma_f32_32x32x16_bf16 v[96:111], a[112:115], a[124:127], v[96:111]
  s_lshl_b32 s60, s59, 10
  s_add_u32 s61, s60, s45
  s_add_u32 s62, s60, s46
  s_lshl_b32 s60, s59, 11
  s_add_u32 s63, s60, s47
  buffer_load_dwordx4 a[120:123], v3, s[20:23], s61 offen sc0 sc1
  buffer_load_dwordx4 a[112:115], v4, s[12:15], s63 offen sc0 sc1
  s_add_u32 s59, s59, 4
  s_sub_u32 s60, s59, 256
  s_cselect_b32 s59, s59, s60
  buffer_load_dwordx4 a[116:119], v5, s[12:15], s63 offen sc0 sc1
  buffer_load_dwordx4 a[124:127], v3, s[20:23], s62 offen sc0 sc1
  s_waitcnt vmcnt(30)
  v_mfma_f32_32x32x16_bf16 v[64:79], a[0:3], a[8:11], v[64:79]
  s_waitcnt vmcnt(29)
  v_mfma_f32_32x32x16_bf16 v[80:95], a[4:7], a[8:11], v[80:95]
  s_waitcnt vmcnt(28)
  v_mfma_f32_32x32x16_bf16 v[112:127], a[4:7], a[12:15], v[112:127]
  v_mfma_f32_32x32x16_bf16 v[96:111], a[0:3], a[12:15], v[96:111]
  s_lshl_b32 s60, s59, 10
  s_add_u32 s61, s60, s45
  s_add_u32 s62, s60, s46
  s_lshl_b32 s60, s59, 11
  s_add_u32 s63, s60, s47
  buffer_load_dwordx4 a[8:11], v3, s[20:23], s61 offen sc0 sc1
  buffer_load_dwordx4 a[0:3], v4, s[12:15], s63 offen sc0 sc1
  s_add_u32 s59, s59, 4
  s_sub_u32 s60, s59, 256
  s_cselect_b32 s59, s59, s60
  buffer_load_dwordx4 a[4:7], v5, s[12:15], s63 offen sc0 sc1
  buffer_load_dwordx4 a[12:15], v3, s[20:23], s62 offen sc0 sc1
  s_waitcnt vmcnt(30)
  v_mfma_f32_32x32x16_bf16 v[64:79], a[16:19], a[24:27], v[64:79]
  s_waitcnt vmcnt(29)
  v_mfma_f32_32x32x16_bf16 v[80:95], a[20:23], a[24:27], v[80:95]
  s_waitcnt vmcnt(28)
  v_mfma_f32_32x32x16_bf16 v[112:127], a[20:23], a[28:31], v[112:127]
  v_mfma_f32_32x32x16_bf16 v[96:111], a[16:19], a[28:31], v[96:111]
  s_lshl_b32 s60, s59, 10
  s_add_u32 s61, s60, s45
  s_add_u32 s62, s60, s46
  s_lshl_b32 s60, s59, 11
  s_add_u32 s63, s60, s47
  buffer_load_dwordx4 a[24:27], v3, s[20:23], s61 offen sc0 sc1
  buffer_load_dwordx4 a[16:19], v4, s[12:15], s63 offen sc0 sc1
  s_add_u32 s59, s59, 4
  s_sub_u32 s60, s59, 256
  s_cselect_b32 s59, s59, s60
  buffer_load_dwordx4 a[20:23], v5, s[12:15], s63 offen sc0 sc1
  buffer_load_dwordx4 a[28:31], v3, s[20:23], s62 offen sc0 sc1
  s_waitcnt vmcnt(30)
  v_mfma_f32_32x32x16_bf16 v[64:79], a[32:35], a[40:43], v[64:79]
  s_waitcnt vmcnt(29)
  v_mfma_f32_32x32x16_bf16 v[80:95], a[36:39], a[40:43], v[80:95]
  s_waitcnt vmcnt(28)
  v_mfma_f32_32x32x16_bf16 v[112:127], a[36:39], a[44:47], v[112:127]
  v_mfma_f32_32x32x16_bf16 v[96:111], a[32:35], a[44:47], v[96:111]
  s_lshl_b32 s60, s59, 10
  s_add_u32 s61, s60, s45
  s_add_u32 s62, s60, s46
  s_lshl_b32 s60, s59, 11
  s_add_u32 s63, s60, s47
  buffer_load_dwordx4 a[40:43], v3, s[20:23], s61 offen sc0 sc1
  buffer_load_dwordx4 a[32:35], v4, s[12:15], s63 offen sc0 sc1
  s_add_u32 s59, s59, 4
  s_sub_u32 s60, s59, 256
  s_cselect_b32 s59, s59, s60
  buffer_load_dwordx4 a[36:39], v5, s[12:15], s63 offen sc0 sc1
  buffer_load_dwordx4 a[44:47], v3, s[20:23], s62 offen sc0 sc1
  s_waitcnt vmcnt(52)
  s_barrier
  s_cmp_lg_u32 s40, 0
  s_cbranch_scc1 attn_kernel_noflag7
  s_lshl_b32 s80, s2, 2
  s_add_u32 s80, s80, 1024
  v_mov_b32 v252, 1
  v_mov_b32 v253, 0
  s_mov_b64 exec, 1
  buffer_store_dword v252, v253, s[76:79], s80 offen sc0 sc1
  s_mov_b64 exec, -1
attn_kernel_noflag7:
  s_waitcnt vmcnt(30)
  v_mfma_f32_32x32x16_bf16 v[64:79], a[48:51], a[56:59], v[64:79]
  s_waitcnt vmcnt(29)
  v_mfma_f32_32x32x16_bf16 v[80:95], a[52:55], a[56:59], v[80:95]
  s_waitcnt vmcnt(28)
  v_mfma_f32_32x32x16_bf16 v[112:127], a[52:55], a[60:63], v[112:127]
  v_mfma_f32_32x32x16_bf16 v[96:111], a[48:51], a[60:63], v[96:111]
  s_lshl_b32 s60, s59, 10
  s_add_u32 s61, s60, s45
  s_add_u32 s62, s60, s46
  s_lshl_b32 s60, s59, 11
  s_add_u32 s63, s60, s47
  buffer_load_dwordx4 a[56:59], v3, s[20:23], s61 offen sc0 sc1
  buffer_load_dwordx4 a[48:51], v4, s[12:15], s63 offen sc0 sc1
  s_add_u32 s59, s59, 4
  s_sub_u32 s60, s59, 256
  s_cselect_b32 s59, s59, s60
  buffer_load_dwordx4 a[52:55], v5, s[12:15], s63 offen sc0 sc1
  buffer_load_dwordx4 a[60:63], v3, s[20:23], s62 offen sc0 sc1
  s_waitcnt vmcnt(30)
  v_mfma_f32_32x32x16_bf16 v[64:79], a[64:67], a[72:75], v[64:79]
  s_waitcnt vmcnt(29)
  v_mfma_f32_32x32x16_bf16 v[80:95], a[68:71], a[72:75], v[80:95]
  s_waitcnt vmcnt(28)
  v_mfma_f32_32x32x16_bf16 v[112:127], a[68:71], a[76:79], v[112:127]
  v_mfma_f32_32x32x16_bf16 v[96:111], a[64:67], a[76:79], v[96:111]
  s_lshl_b32 s60, s59, 10
  s_add_u32 s61, s60, s45
  s_add_u32 s62, s60, s46
  s_lshl_b32 s60, s59, 11
  s_add_u32 s63, s60, s47
  buffer_load_dwordx4 a[72:75], v3, s[20:23], s61 offen sc0 sc1
  buffer_load_dwordx4 a[64:67], v4, s[12:15], s63 offen sc0 sc1
  s_add_u32 s59, s59, 4
  s_sub_u32 s60, s59, 256
  s_cselect_b32 s59, s59, s60
  buffer_load_dwordx4 a[68:71], v5, s[12:15], s63 offen sc0 sc1
  buffer_load_dwordx4 a[76:79], v3, s[20:23], s62 offen sc0 sc1
  s_waitcnt vmcnt(30)
  v_mfma_f32_32x32x16_bf16 v[64:79], a[80:83], a[88:91], v[64:79]
  s_waitcnt vmcnt(29)
  v_mfma_f32_32x32x16_bf16 v[80:95], a[84:87], a[88:91], v[80:95]
  s_waitcnt vmcnt(28)
  v_mfma_f32_32x32x16_bf16 v[112:127], a[84:87], a[92:95], v[112:127]
  v_mfma_f32_32x32x16_bf16 v[96:111], a[80:83], a[92:95], v[96:111]
  s_lshl_b32 s60, s59, 10
  s_add_u32 s61, s60, s45
  s_add_u32 s62, s60, s46
  s_lshl_b32 s60, s59, 11
  s_add_u32 s63, s60, s47
  buffer_load_dwordx4 a[88:91], v3, s[20:23], s61 offen sc0 sc1
  buffer_load_dwordx4 a[80:83], v4, s[12:15], s63 offen sc0 sc1
  s_add_u32 s59, s59, 4
  s_sub_u32 s60, s59, 256
  s_cselect_b32 s59, s59, s60
  buffer_load_dwordx4 a[84:87], v5, s[12:15], s63 offen sc0 sc1
  buffer_load_dwordx4 a[92:95], v3, s[20:23], s62 offen sc0 sc1
  s_waitcnt vmcnt(30)
  v_mfma_f32_32x32x16_bf16 v[64:79], a[96:99], a[104:107], v[64:79]
  s_waitcnt vmcnt(29)
  v_mfma_f32_32x32x16_bf16 v[80:95], a[100:103], a[104:107], v[80:95]
  s_waitcnt vmcnt(28)
  v_mfma_f32_32x32x16_bf16 v[112:127], a[100:103], a[108:111], v[112:127]
  v_mfma_f32_32x32x16_bf16 v[96:111], a[96:99], a[108:111], v[96:111]
  s_lshl_b32 s60, s59, 10
  s_add_u32 s61, s60, s45
  s_add_u32 s62, s60, s46
  s_lshl_b32 s60, s59, 11
  s_add_u32 s63, s60, s47
  buffer_load_dwordx4 a[104:107], v3, s[20:23], s61 offen sc0 sc1
  buffer_load_dwordx4 a[96:99], v4, s[12:15], s63 offen sc0 sc1
  s_add_u32 s59, s59, 4
  s_sub_u32 s60, s59, 256
  s_cselect_b32 s59, s59, s60
  buffer_load_dwordx4 a[100:103], v5, s[12:15], s63 offen sc0 sc1
  buffer_load_dwordx4 a[108:111], v3, s[20:23], s62 offen sc0 sc1
  s_waitcnt vmcnt(30)
  v_mfma_f32_32x32x16_bf16 v[64:79], a[112:115], a[120:123], v[64:79]
  s_waitcnt vmcnt(29)
  v_mfma_f32_32x32x16_bf16 v[80:95], a[116:119], a[120:123], v[80:95]
  s_waitcnt vmcnt(28)
  v_mfma_f32_32x32x16_bf16 v[112:127], a[116:119], a[124:127], v[112:127]
  v_mfma_f32_32x32x16_bf16 v[96:111], a[112:115], a[124:127], v[96:111]
  s_lshl_b32 s60, s59, 10
  s_add_u32 s61, s60, s45
  s_add_u32 s62, s60, s46
  s_lshl_b32 s60, s59, 11
  s_add_u32 s63, s60, s47
  buffer_load_dwordx4 a[120:123], v3, s[20:23], s61 offen sc0 sc1
  buffer_load_dwordx4 a[112:115], v4, s[12:15], s63 offen sc0 sc1
  s_add_u32 s59, s59, 4
  s_sub_u32 s60, s59, 256
  s_cselect_b32 s59, s59, s60
  buffer_load_dwordx4 a[116:119], v5, s[12:15], s63 offen sc0 sc1
  buffer_load_dwordx4 a[124:127], v3, s[20:23], s62 offen sc0 sc1
  s_waitcnt vmcnt(30)
  v_mfma_f32_32x32x16_bf16 v[64:79], a[0:3], a[8:11], v[64:79]
  s_waitcnt vmcnt(29)
  v_mfma_f32_32x32x16_bf16 v[80:95], a[4:7], a[8:11], v[80:95]
  s_waitcnt vmcnt(28)
  v_mfma_f32_32x32x16_bf16 v[112:127], a[4:7], a[12:15], v[112:127]
  v_mfma_f32_32x32x16_bf16 v[96:111], a[0:3], a[12:15], v[96:111]
  s_mov_b32 s32, s10
  s_and_b32 s33, s11, 0xffff
  s_mov_b32 s34, 0x200000
  s_mov_b32 s35, 0x20000
  buffer_load_dwordx4 v[16:19], v15, s[24:27], s53 offen offset:0 sc0 sc1
  buffer_load_dwordx4 v[20:23], v15, s[24:27], s53 offen offset:16 sc0 sc1
  buffer_load_dwordx4 v[24:27], v15, s[24:27], s53 offen offset:64 sc0 sc1
  buffer_load_dwordx4 v[28:31], v15, s[24:27], s53 offen offset:80 sc0 sc1
  buffer_load_dwordx4 v[32:35], v40, s[32:35], s55 offen
  buffer_load_dwordx4 v[36:39], v40, s[32:35], s55 offen offset:32
  s_waitcnt vmcnt(32)
  v_mfma_f32_32x32x16_bf16 v[64:79], a[16:19], a[24:27], v[64:79]
  s_waitcnt vmcnt(31)
  v_mfma_f32_32x32x16_bf16 v[80:95], a[20:23], a[24:27], v[80:95]
  s_waitcnt vmcnt(30)
  v_mfma_f32_32x32x16_bf16 v[112:127], a[20:23], a[28:31], v[112:127]
  v_mfma_f32_32x32x16_bf16 v[96:111], a[16:19], a[28:31], v[96:111]
  s_waitcnt vmcnt(28)
  v_mfma_f32_32x32x16_bf16 v[64:79], a[32:35], a[40:43], v[64:79]
  s_waitcnt vmcnt(27)
  v_mfma_f32_32x32x16_bf16 v[80:95], a[36:39], a[40:43], v[80:95]
  s_waitcnt vmcnt(26)
  v_mfma_f32_32x32x16_bf16 v[112:127], a[36:39], a[44:47], v[112:127]
  v_mfma_f32_32x32x16_bf16 v[96:111], a[32:35], a[44:47], v[96:111]
  s_waitcnt vmcnt(24)
  v_mfma_f32_32x32x16_bf16 v[64:79], a[48:51], a[56:59], v[64:79]
  s_waitcnt vmcnt(23)
  v_mfma_f32_32x32x16_bf16 v[80:95], a[52:55], a[56:59], v[80:95]
  s_waitcnt vmcnt(22)
  v_mfma_f32_32x32x16_bf16 v[112:127], a[52:55], a[60:63], v[112:127]
  v_mfma_f32_32x32x16_bf16 v[96:111], a[48:51], a[60:63], v[96:111]
  s_waitcnt vmcnt(20)
  v_mfma_f32_32x32x16_bf16 v[64:79], a[64:67], a[72:75], v[64:79]
  s_waitcnt vmcnt(19)
  v_mfma_f32_32x32x16_bf16 v[80:95], a[68:71], a[72:75], v[80:95]
  s_waitcnt vmcnt(18)
  v_mfma_f32_32x32x16_bf16 v[112:127], a[68:71], a[76:79], v[112:127]
  v_mfma_f32_32x32x16_bf16 v[96:111], a[64:67], a[76:79], v[96:111]
  s_waitcnt vmcnt(16)
  v_mfma_f32_32x32x16_bf16 v[64:79], a[80:83], a[88:91], v[64:79]
  s_waitcnt vmcnt(15)
  v_mfma_f32_32x32x16_bf16 v[80:95], a[84:87], a[88:91], v[80:95]
  s_waitcnt vmcnt(14)
  v_mfma_f32_32x32x16_bf16 v[112:127], a[84:87], a[92:95], v[112:127]
  v_mfma_f32_32x32x16_bf16 v[96:111], a[80:83], a[92:95], v[96:111]
  s_waitcnt vmcnt(12)
  v_mfma_f32_32x32x16_bf16 v[64:79], a[96:99], a[104:107], v[64:79]
  s_waitcnt vmcnt(11)
  v_mfma_f32_32x32x16_bf16 v[80:95], a[100:103], a[104:107], v[80:95]
  s_waitcnt vmcnt(10)
  v_mfma_f32_32x32x16_bf16 v[112:127], a[100:103], a[108:111], v[112:127]
  v_mfma_f32_32x32x16_bf16 v[96:111], a[96:99], a[108:111], v[96:111]
  s_waitcnt vmcnt(8)
  v_mfma_f32_32x32x16_bf16 v[64:79], a[112:115], a[120:123], v[64:79]
  s_waitcnt vmcnt(7)
  v_mfma_f32_32x32x16_bf16 v[80:95], a[116:119], a[120:123], v[80:95]
  s_waitcnt vmcnt(6)
  v_mfma_f32_32x32x16_bf16 v[112:127], a[116:119], a[124:127], v[112:127]
  v_mfma_f32_32x32x16_bf16 v[96:111], a[112:115], a[124:127], v[96:111]
  s_waitcnt vmcnt(1)
  v_lshlrev_b32 v44, 16, v32
  v_and_b32 v45, 0xffff0000, v32
  v_lshlrev_b32 v46, 16, v33
  v_and_b32 v47, 0xffff0000, v33
  v_lshlrev_b32 v48, 16, v34
  v_and_b32 v49, 0xffff0000, v34
  v_lshlrev_b32 v50, 16, v35
  v_and_b32 v51, 0xffff0000, v35
  s_waitcnt vmcnt(0)
  v_lshlrev_b32 v52, 16, v36
  v_and_b32 v53, 0xffff0000, v36
  v_lshlrev_b32 v54, 16, v37
  v_and_b32 v55, 0xffff0000, v37
  v_lshlrev_b32 v56, 16, v38
  v_and_b32 v57, 0xffff0000, v38
  v_lshlrev_b32 v58, 16, v39
  v_and_b32 v59, 0xffff0000, v39
  s_lshl_b32 s70, s40, 8
  s_add_u32 s70, s70, 53248
  v_lshlrev_b32 v7, 2, v1
  v_add_u32 v7, s70, v7
  ds_write_b128 v9, v[80:83] offset:0
  ds_write_b128 v9, v[84:87] offset:1024
  ds_write_b128 v9, v[88:91] offset:2048
  ds_write_b128 v9, v[92:95] offset:3072
  ds_write_b128 v11, v[112:115] offset:8192
  ds_write_b128 v11, v[116:119] offset:9216
  ds_write_b128 v11, v[120:123] offset:10240
  ds_write_b128 v11, v[124:127] offset:11264
  ds_write_b128 v10, v[96:99] offset:4096
  ds_write_b128 v10, v[100:103] offset:5120
  ds_write_b128 v10, v[104:107] offset:6144
  ds_write_b128 v10, v[108:111] offset:7168
  s_waitcnt lgkmcnt(0)
  s_barrier
  ds_read_b128 v[80:83], v8 offset:0
  ds_read_b128 v[84:87], v8 offset:1024
  ds_read_b128 v[88:91], v8 offset:2048
  ds_read_b128 v[92:95], v8 offset:3072
  ds_read_b128 v[96:99], v8 offset:4096
  ds_read_b128 v[100:103], v8 offset:5120
  ds_read_b128 v[104:107], v8 offset:6144
  ds_read_b128 v[108:111], v8 offset:7168
  ds_read_b128 v[112:115], v8 offset:8192
  ds_read_b128 v[116:119], v8 offset:9216
  ds_read_b128 v[120:123], v8 offset:10240
  ds_read_b128 v[124:127], v8 offset:11264
  s_waitcnt lgkmcnt(11)
  v_add_f32 v64, v64, v80
  v_add_f32 v65, v65, v81
  v_add_f32 v66, v66, v82
  v_add_f32 v67, v67, v83
  s_waitcnt lgkmcnt(10)
  v_add_f32 v68, v68, v84
  v_add_f32 v69, v69, v85
  v_add_f32 v70, v70, v86
  v_add_f32 v71, v71, v87
  s_waitcnt lgkmcnt(9)
  v_add_f32 v72, v72, v88
  v_add_f32 v73, v73, v89
  v_add_f32 v74, v74, v90
  v_add_f32 v75, v75, v91
  s_waitcnt lgkmcnt(8)
  v_add_f32 v76, v76, v92
  v_add_f32 v77, v77, v93
  v_add_f32 v78, v78, v94
  v_add_f32 v79, v79, v95
  s_waitcnt lgkmcnt(7)
  v_add_f32 v64, v64, v96
  v_add_f32 v65, v65, v97
  v_add_f32 v66, v66, v98
  v_add_f32 v67, v67, v99
  s_waitcnt lgkmcnt(6)
  v_add_f32 v68, v68, v100
  v_add_f32 v69, v69, v101
  v_add_f32 v70, v70, v102
  v_add_f32 v71, v71, v103
  s_waitcnt lgkmcnt(5)
  v_add_f32 v72, v72, v104
  v_add_f32 v73, v73, v105
  v_add_f32 v74, v74, v106
  v_add_f32 v75, v75, v107
  s_waitcnt lgkmcnt(4)
  v_add_f32 v76, v76, v108
  v_add_f32 v77, v77, v109
  v_add_f32 v78, v78, v110
  v_add_f32 v79, v79, v111
  s_waitcnt lgkmcnt(3)
  v_add_f32 v64, v64, v112
  v_add_f32 v65, v65, v113
  v_add_f32 v66, v66, v114
  v_add_f32 v67, v67, v115
  s_waitcnt lgkmcnt(2)
  v_add_f32 v68, v68, v116
  v_add_f32 v69, v69, v117
  v_add_f32 v70, v70, v118
  v_add_f32 v71, v71, v119
  s_waitcnt lgkmcnt(1)
  v_add_f32 v72, v72, v120
  v_add_f32 v73, v73, v121
  v_add_f32 v74, v74, v122
  v_add_f32 v75, v75, v123
  s_waitcnt lgkmcnt(0)
  v_add_f32 v76, v76, v124
  v_add_f32 v77, v77, v125
  v_add_f32 v78, v78, v126
  v_add_f32 v79, v79, v127
  v_fma_f32 v64, v16, v64, v44
  v_fma_f32 v65, v17, v65, v45
  v_fma_f32 v66, v18, v66, v46
  v_fma_f32 v67, v19, v67, v47
  v_fma_f32 v68, v20, v68, v48
  v_fma_f32 v69, v21, v69, v49
  v_fma_f32 v70, v22, v70, v50
  v_fma_f32 v71, v23, v71, v51
  v_fma_f32 v72, v24, v72, v52
  v_fma_f32 v73, v25, v73, v53
  v_fma_f32 v74, v26, v74, v54
  v_fma_f32 v75, v27, v75, v55
  v_fma_f32 v76, v28, v76, v56
  v_fma_f32 v77, v29, v77, v57
  v_fma_f32 v78, v30, v78, v58
  v_fma_f32 v79, v31, v79, v59
  v_cvt_pk_bf16_f32 v80, v64, v65
  v_cvt_pk_bf16_f32 v81, v66, v67
  v_cvt_pk_bf16_f32 v82, v68, v69
  v_cvt_pk_bf16_f32 v83, v70, v71
  v_cvt_pk_bf16_f32 v84, v72, v73
  v_cvt_pk_bf16_f32 v85, v74, v75
  v_cvt_pk_bf16_f32 v86, v76, v77
  v_cvt_pk_bf16_f32 v87, v78, v79
  buffer_store_dwordx4 v[80:83], v3, s[28:31], s56 offen sc0 sc1
  buffer_store_dwordx4 v[84:87], v3, s[28:31], s56 offen offset:1024 sc0 sc1
  v_lshlrev_b32 v64, 16, v80
  v_and_b32 v65, 0xffff0000, v80
  v_lshlrev_b32 v66, 16, v81
  v_and_b32 v67, 0xffff0000, v81
  v_lshlrev_b32 v68, 16, v82
  v_and_b32 v69, 0xffff0000, v82
  v_lshlrev_b32 v70, 16, v83
  v_and_b32 v71, 0xffff0000, v83
  v_lshlrev_b32 v72, 16, v84
  v_and_b32 v73, 0xffff0000, v84
  v_lshlrev_b32 v74, 16, v85
  v_and_b32 v75, 0xffff0000, v85
  v_lshlrev_b32 v76, 16, v86
  v_and_b32 v77, 0xffff0000, v86
  v_lshlrev_b32 v78, 16, v87
  v_and_b32 v79, 0xffff0000, v87
  v_add_f32 v16, v64, v65
  v_mul_f32 v17, v64, v64
  v_add_f32 v18, v66, v67
  v_mul_f32 v19, v65, v65
  v_fmac_f32 v17, v66, v66
  v_fmac_f32 v19, v67, v67
  v_add_f32 v16, v16, v68
  v_fmac_f32 v17, v68, v68
  v_add_f32 v18, v18, v69
  v_fmac_f32 v19, v69, v69
  v_add_f32 v16, v16, v70
  v_fmac_f32 v17, v70, v70
  v_add_f32 v18, v18, v71
  v_fmac_f32 v19, v71, v71
  v_add_f32 v16, v16, v72
  v_fmac_f32 v17, v72, v72
  v_add_f32 v18, v18, v73
  v_fmac_f32 v19, v73, v73
  v_add_f32 v16, v16, v74
  v_fmac_f32 v17, v74, v74
  v_add_f32 v18, v18, v75
  v_fmac_f32 v19, v75, v75
  v_add_f32 v16, v16, v76
  v_fmac_f32 v17, v76, v76
  v_add_f32 v18, v18, v77
  v_fmac_f32 v19, v77, v77
  v_add_f32 v16, v16, v78
  v_fmac_f32 v17, v78, v78
  v_add_f32 v18, v18, v79
  v_fmac_f32 v19, v79, v79
  v_add_f32 v16, v16, v18
  v_add_f32 v17, v17, v19
  v_mov_b32 v18, v16
  v_mov_b32 v19, v17
  s_nop 1
  v_permlane32_swap_b32 v16, v18
  v_permlane32_swap_b32 v17, v19
  v_add_f32 v16, v16, v18
  v_add_f32 v17, v17, v19
  s_add_u32 s24, s8, 0x40000
  s_addc_u32 s25, s9, 0
  s_and_b32 s25, s25, 0xffff
  s_mov_b32 s26, 0x40000
  s_mov_b32 s27, 0x20000
  v_lshlrev_b32 v18, 3, v1
  s_lshl_b32 s53, s52, 12
  s_lshl_b32 s54, s42, 9
  s_add_u32 s53, s53, s54
  s_lshl_b32 s54, s50, 8
  s_add_u32 s53, s53, s54
  s_mov_b64 exec, 0xffffffff
  buffer_store_dwordx2 v[16:17], v18, s[24:27], s53 offen sc0 sc1
  s_mov_b64 exec, -1
  s_waitcnt vmcnt(0) lgkmcnt(0)
  s_barrier
  s_cmp_lg_u32 s40, 0
  s_cbranch_scc1 attn_kernel_noflag8
  s_lshl_b32 s80, s41, 5
  s_lshr_b32 s81, s41, 1
  s_lshl_b32 s81, s81, 6
  s_add_u32 s80, s80, s81
  s_lshl_b32 s81, s42, 2
  s_add_u32 s80, s80, s81
  s_add_u32 s80, s80, 3072
  v_mov_b32 v252, 1
  v_mov_b32 v253, 0
  s_mov_b64 exec, 1
  buffer_store_dword v252, v253, s[76:79], s80 offen sc0 sc1
  s_mov_b64 exec, -1
attn_kernel_noflag8:
phase2:
  v_mbcnt_lo_u32_b32 v0, -1, 0
  v_mbcnt_hi_u32_b32 v0, -1, v0
  s_lshl_b32 s80, s40, 6
  v_add_u32 v0, s80, v0
  s_load_dwordx2 s[8:9], s[0:1], 104
  v_and_b32 v1, 63, v0
  v_lshrrev_b32 v2, 6, v0
  v_lshlrev_b32 v3, 4, v1
  v_readfirstlane_b32 s40, v2
  s_and_b32 s41, s2, 1
  s_lshl_b32 s41, s41, 3
  s_bfe_u32 s43, s2, 0x30003
  s_add_u32 s41, s41, s43
  s_bfe_u32 s42, s2, 0x20001
  s_lshl_b32 s42, s42, 2
  s_lshr_b32 s43, s2, 6
  s_add_u32 s42, s42, s43
  s_lshl_b32 s44, s41, 2
  s_add_u32 s44, s44, s40
  s_lshl_b32 s45, s44, 15
  s_lshl_b32 s46, s40, 13
  s_mul_i32 s47, s42, 229376
  s_add_u32 s47, s47, s46
  v_and_b32 v4, 31, v1
  v_lshlrev_b32 v4, 3, v4
  v_lshrrev_b32 v5, 5, v1
  v_lshl_add_u32 v4, v5, 11, v4
  s_lshl_b32 s48, s44, 12
  s_waitcnt lgkmcnt(0)
  s_add_u32 s12, s8, 0x2000000
  s_addc_u32 s13, s9, 0
  s_and_b32 s13, s13, 0xffff
  s_mov_b32 s14, 0x380000
  s_mov_b32 s15, 0x20000
  s_add_u32 s16, s8, 0x300000
  s_addc_u32 s17, s9, 0
  s_and_b32 s17, s17, 0xffff
  s_mov_b32 s18, 0x200000
  s_mov_b32 s19, 0x20000
  s_lshl_b32 s46, s40, 11
  s_mul_i32 s47, s42, 229376
  s_add_u32 s47, s47, s46
  s_cmp_lg_u32 s40, 0
  s_cbranch_scc1 attn_kernel_nopoll9
  s_mov_b32 s80, 0x40000
  s_movk_i32 s75, 1024
attn_kernel_poll10:
  buffer_load_dwordx4 v[248:251], v3, s[76:79], s75 offen sc0 sc1
  s_waitcnt vmcnt(0)
  v_min_u32 v248, v248, v249
  v_min3_u32 v248, v248, v250, v251
  v_cmp_eq_u32 vcc, 0, v248
  s_cbranch_vccz attn_kernel_nopoll9
  s_sub_u32 s80, s80, 1
  s_cbranch_scc1 attn_kernel_nopoll9
  s_sleep 4
  s_branch attn_kernel_poll10
attn_kernel_nopoll9:
  s_barrier
  s_add_u32 m0, s46, 0
  s_add_u32 s49, s47, 0
  buffer_load_dwordx4 v3, s[12:15], s49 offen offset:0 sc0 sc1 lds
  buffer_load_dwordx4 v3, s[12:15], s49 offen offset:1024 sc0 sc1 lds
  s_add_u32 m0, s46, 32768
  s_add_u32 s49, s47, 32768
  buffer_load_dwordx4 v3, s[12:15], s49 offen offset:0 sc0 sc1 lds
  buffer_load_dwordx4 v3, s[12:15], s49 offen offset:1024 sc0 sc1 lds
  s_add_u32 m0, s46, 65536
  s_add_u32 s49, s47, 65536
  buffer_load_dwordx4 v3, s[12:15], s49 offen offset:0 sc0 sc1 lds
  buffer_load_dwordx4 v3, s[12:15], s49 offen offset:1024 sc0 sc1 lds
  s_add_u32 m0, s46, 8192
  s_add_u32 s49, s47, 8192
  buffer_load_dwordx4 v3, s[12:15], s49 offen offset:0 sc0 sc1 lds
  buffer_load_dwordx4 v3, s[12:15], s49 offen offset:1024 sc0 sc1 lds
  s_add_u32 m0, s46, 40960
  s_add_u32 s49, s47, 40960
  buffer_load_dwordx4 v3, s[12:15], s49 offen offset:0 sc0 sc1 lds
  buffer_load_dwordx4 v3, s[12:15], s49 offen offset:1024 sc0 sc1 lds
  s_add_u32 m0, s46, 73728
  s_add_u32 s49, s47, 73728
  buffer_load_dwordx4 v3, s[12:15], s49 offen offset:0 sc0 sc1 lds
  buffer_load_dwordx4 v3, s[12:15], s49 offen offset:1024 sc0 sc1 lds
  s_add_u32 m0, s46, 16384
  s_add_u32 s49, s47, 16384
  buffer_load_dwordx4 v3, s[12:15], s49 offen offset:0 sc0 sc1 lds
  buffer_load_dwordx4 v3, s[12:15], s49 offen offset:1024 sc0 sc1 lds
  s_add_u32 m0, s46, 49152
  s_add_u32 s49, s47, 49152
  buffer_load_dwordx4 v3, s[12:15], s49 offen offset:0 sc0 sc1 lds
  buffer_load_dwordx4 v3, s[12:15], s49 offen offset:1024 sc0 sc1 lds
  s_add_u32 m0, s46, 81920
  s_add_u32 s49, s47, 81920
  buffer_load_dwordx4 v3, s[12:15], s49 offen offset:0 sc0 sc1 lds
  buffer_load_dwordx4 v3, s[12:15], s49 offen offset:1024 sc0 sc1 lds
  s_add_u32 m0, s46, 24576
  s_add_u32 s49, s47, 24576
  buffer_load_dwordx4 v3, s[12:15], s49 offen offset:0 sc0 sc1 lds
  buffer_load_dwordx4 v3, s[12:15], s49 offen offset:1024 sc0 sc1 lds
  s_add_u32 m0, s46, 57344
  s_add_u32 s49, s47, 57344
  buffer_load_dwordx4 v3, s[12:15], s49 offen offset:0 sc0 sc1 lds
  buffer_load_dwordx4 v3, s[12:15], s49 offen offset:1024 sc0 sc1 lds
  s_add_u32 m0, s46, 90112
  s_add_u32 s49, s47, 90112
  buffer_load_dwordx4 v3, s[12:15], s49 offen offset:0 sc0 sc1 lds
  buffer_load_dwordx4 v3, s[12:15], s49 offen offset:1024 sc0 sc1 lds
  s_add_u32 m0, s46, 98304
  s_add_u32 s49, s47, 98304
  buffer_load_dwordx4 v3, s[12:15], s49 offen offset:0 sc0 sc1 lds
  buffer_load_dwordx4 v3, s[12:15], s49 offen offset:1024 sc0 sc1 lds
  s_add_u32 m0, s46, 106496
  s_add_u32 s49, s47, 106496
  buffer_load_dwordx4 v3, s[12:15], s49 offen offset:0 sc0 sc1 lds
  buffer_load_dwordx4 v3, s[12:15], s49 offen offset:1024 sc0 sc1 lds
  s_add_u32 m0, s46, 114688
  s_add_u32 s49, s47, 114688
  buffer_load_dwordx4 v3, s[12:15], s49 offen offset:0 sc0 sc1 lds
  buffer_load_dwordx4 v3, s[12:15], s49 offen offset:1024 sc0 sc1 lds
  s_add_u32 m0, s46, 122880
  s_add_u32 s49, s47, 122880
  buffer_load_dwordx4 v3, s[12:15], s49 offen offset:0 sc0 sc1 lds
  buffer_load_dwordx4 v3, s[12:15], s49 offen offset:1024 sc0 sc1 lds
  s_add_u32 s20, s8, 0x40000
  s_addc_u32 s21, s9, 0
  s_and_b32 s21, s21, 0xffff
  s_mov_b32 s22, 0x40000
  s_mov_b32 s23, 0x20000
  s_add_u32 s24, s8, 0xc0000
  s_addc_u32 s25, s9, 0
  s_and_b32 s25, s25, 0xffff
  s_mov_b32 s26, 0x38000
  s_mov_b32 s27, 0x20000
  s_mul_i32 s52, s42, 14336
  s_lshl_b32 s51, s40, 12
  s_add_u32 s52, s52, s51
  v_and_b32 v10, 15, v1
  v_lshlrev_b32 v10, 4, v10
  s_lshl_b32 s51, s40, 9
  s_add_u32 s51, s51, 131072
  v_add_u32 v10, s51, v10
  s_cmp_lg_u32 s40, 0
  s_cbranch_scc1 attn_kernel_nopoll11
  s_mov_b32 s80, 0x40000
  s_lshr_b32 s81, s41, 0
  s_lshl_b32 s81, s81, 7
  s_add_u32 s81, s81, 3072
  v_and_b32 v253, 15, v1
  v_lshlrev_b32 v253, 2, v253
attn_kernel_poll12:
  buffer_load_dword v252, v253, s[76:79], s81 offen sc0 sc1
  s_waitcnt vmcnt(0)
  v_cmp_eq_u32 vcc, 0, v252
  s_cbranch_vccz attn_kernel_nopoll11
  s_sub_u32 s80, s80, 1
  s_cbranch_scc1 attn_kernel_nopoll11
  s_sleep 1
  s_branch attn_kernel_poll12
attn_kernel_nopoll11:
  s_barrier
  s_add_u32 s50, s45, 0
  buffer_load_dwordx4 a[0:3], v3, s[16:19], s50 offen offset:0 sc0 sc1
  buffer_load_dwordx4 a[4:7], v3, s[16:19], s50 offen offset:1024 sc0 sc1
  buffer_load_dwordx4 a[8:11], v3, s[16:19], s50 offen offset:2048 sc0 sc1
  buffer_load_dwordx4 a[12:15], v3, s[16:19], s50 offen offset:3072 sc0 sc1
  s_add_u32 s50, s45, 4096
  buffer_load_dwordx4 a[16:19], v3, s[16:19], s50 offen offset:0 sc0 sc1
  buffer_load_dwordx4 a[20:23], v3, s[16:19], s50 offen offset:1024 sc0 sc1
  buffer_load_dwordx4 a[24:27], v3, s[16:19], s50 offen offset:2048 sc0 sc1
  buffer_load_dwordx4 a[28:31], v3, s[16:19], s50 offen offset:3072 sc0 sc1
  s_add_u32 s50, s45, 8192
  buffer_load_dwordx4 a[32:35], v3, s[16:19], s50 offen offset:0 sc0 sc1
  buffer_load_dwordx4 a[36:39], v3, s[16:19], s50 offen offset:1024 sc0 sc1
  buffer_load_dwordx4 a[40:43], v3, s[16:19], s50 offen offset:2048 sc0 sc1
  buffer_load_dwordx4 a[44:47], v3, s[16:19], s50 offen offset:3072 sc0 sc1
  s_add_u32 s50, s45, 12288
  buffer_load_dwordx4 a[48:51], v3, s[16:19], s50 offen offset:0 sc0 sc1
  buffer_load_dwordx4 a[52:55], v3, s[16:19], s50 offen offset:1024 sc0 sc1
  buffer_load_dwordx4 a[56:59], v3, s[16:19], s50 offen offset:2048 sc0 sc1
  buffer_load_dwordx4 a[60:63], v3, s[16:19], s50 offen offset:3072 sc0 sc1
  s_add_u32 s50, s45, 16384
  buffer_load_dwordx4 a[64:67], v3, s[16:19], s50 offen offset:0 sc0 sc1
  buffer_load_dwordx4 a[68:71], v3, s[16:19], s50 offen offset:1024 sc0 sc1
  buffer_load_dwordx4 a[72:75], v3, s[16:19], s50 offen offset:2048 sc0 sc1
  buffer_load_dwordx4 a[76:79], v3, s[16:19], s50 offen offset:3072 sc0 sc1
  s_add_u32 s50, s45, 20480
  buffer_load_dwordx4 a[80:83], v3, s[16:19], s50 offen offset:0 sc0 sc1
  buffer_load_dwordx4 a[84:87], v3, s[16:19], s50 offen offset:1024 sc0 sc1
  buffer_load_dwordx4 a[88:91], v3, s[16:19], s50 offen offset:2048 sc0 sc1
  buffer_load_dwordx4 a[92:95], v3, s[16:19], s50 offen offset:3072 sc0 sc1
  s_add_u32 s28, s8, 0x800000
  s_addc_u32 s29, s9, 0
  s_and_b32 s29, s29, 0xffff
  s_mov_b32 s30, 0x700000
  s_mov_b32 s31, 0x20000
  s_mul_i32 s53, s44, 114688
  s_mul_i32 s54, s42, 7168
  s_add_u32 s53, s53, s54
  s_add_u32 s54, s53, 4096
  v_add_u32 v6, 0x10000, v3
  v_lshlrev_b32 v7, 4, v5
  v_add_u32 v7, 131072, v7
  s_waitcnt vmcnt(50)
  s_barrier
  ds_read_b128 a[128:131], v3 offset:0
  ds_read_b128 a[132:135], v3 offset:32768
  ds_read_b128 a[136:139], v6 offset:0
  ds_read_b128 a[140:143], v3 offset:1024
  ds_read_b128 a[144:147], v3 offset:33792
  ds_read_b128 a[148:151], v6 offset:1024
  ds_read_b128 a[152:155], v3 offset:2048
  ds_read_b128 a[156:159], v3 offset:34816
  s_waitcnt lgkmcnt(4)
  s_waitcnt vmcnt(23)
  v_mfma_f32_32x32x16_bf16 v[64:79], a[128:131], a[0:3], 0
  ds_read_b128 a[160:163], v6 offset:2048
  s_add_u32 s50, s45, 24576
  buffer_load_dwordx4 a[96:99], v3, s[16:19], s50 offen offset:0 sc0 sc1
  v_mfma_f32_32x32x16_bf16 v[80:95], a[132:135], a[0:3], 0
  ds_read_b128 a[164:167], v3 offset:3072
  buffer_load_dwordx4 a[100:103], v3, s[16:19], s50 offen offset:1024 sc0 sc1
  v_mfma_f32_32x32x16_bf16 v[96:111], a[136:139], a[0:3], 0
  ds_read_b128 a[168:171], v3 offset:35840
  s_waitcnt vmcnt(24)
  v_mfma_f32_32x32x16_bf16 v[64:79], a[140:143], a[4:7], v[64:79]
  ds_read_b128 a[172:175], v6 offset:3072
  buffer_load_dwordx4 a[104:107], v3, s[16:19], s50 offen offset:2048 sc0 sc1
  s_waitcnt lgkmcnt(4)
  v_mfma_f32_32x32x16_bf16 v[80:95], a[144:147], a[4:7], v[80:95]
  ds_read_b128 a[176:179], v3 offset:4096
  v_mfma_f32_32x32x16_bf16 v[96:111], a[148:151], a[4:7], v[96:111]
  ds_read_b128 a[180:183], v3 offset:36864
  buffer_load_dwordx4 a[108:111], v3, s[16:19], s50 offen offset:3072 sc0 sc1
  s_waitcnt vmcnt(25)
  v_mfma_f32_32x32x16_bf16 v[64:79], a[152:155], a[8:11], v[64:79]
  ds_read_b128 a[184:187], v6 offset:4096
  v_mfma_f32_32x32x16_bf16 v[80:95], a[156:159], a[8:11], v[80:95]
  ds_read_b128 a[188:191], v3 offset:5120
  s_add_u32 s50, s45, 28672
  buffer_load_dwordx4 a[112:115], v3, s[16:19], s50 offen offset:0 sc0 sc1
  s_waitcnt lgkmcnt(4)
  v_mfma_f32_32x32x16_bf16 v[96:111], a[160:163], a[8:11], v[96:111]
  ds_read_b128 a[128:131], v3 offset:37888
  buffer_load_dwordx4 a[116:119], v3, s[16:19], s50 offen offset:1024 sc0 sc1
  s_waitcnt vmcnt(26)
  v_mfma_f32_32x32x16_bf16 v[64:79], a[164:167], a[12:15], v[64:79]
  ds_read_b128 a[132:135], v6 offset:5120
  v_mfma_f32_32x32x16_bf16 v[80:95], a[168:171], a[12:15], v[80:95]
  ds_read_b128 a[136:139], v3 offset:6144
  ds_read_b128 a[140:143], v3 offset:38912
  buffer_load_dwordx4 a[120:123], v3, s[16:19], s50 offen offset:2048 sc0 sc1
  v_mfma_f32_32x32x16_bf16 v[96:111], a[172:175], a[12:15], v[96:111]
  ds_read_b128 a[144:147], v6 offset:6144
  ds_read_b128 a[148:151], v3 offset:7168
  s_waitcnt lgkmcnt(6)
  s_waitcnt vmcnt(26)
  v_mfma_f32_32x32x16_bf16 v[64:79], a[176:179], a[16:19], v[64:79]
  ds_read_b128 a[152:155], v3 offset:39936
  ds_read_b128 a[156:159], v6 offset:7168
  buffer_load_dwordx4 a[124:127], v3, s[16:19], s50 offen offset:3072 sc0 sc1
  v_mfma_f32_32x32x16_bf16 v[80:95], a[180:183], a[16:19], v[80:95]
  v_mfma_f32_32x32x16_bf16 v[96:111], a[184:187], a[16:19], v[96:111]
  s_waitcnt vmcnt(26)
  v_mfma_f32_32x32x16_bf16 v[64:79], a[188:191], a[20:23], v[64:79]
  s_waitcnt vmcnt(52) lgkmcnt(0)
  s_barrier
  v_mfma_f32_32x32x16_bf16 v[80:95], a[128:131], a[20:23], v[80:95]
  ds_read_b128 a[160:163], v3 offset:8192
  v_mfma_f32_32x32x16_bf16 v[96:111], a[132:135], a[20:23], v[96:111]
  ds_read_b128 a[164:167], v3 offset:40960
  s_waitcnt vmcnt(25)
  v_mfma_f32_32x32x16_bf16 v[64:79], a[136:139], a[24:27], v[64:79]
  ds_read_b128 a[168:171], v6 offset:8192
  v_mfma_f32_32x32x16_bf16 v[80:95], a[140:143], a[24:27], v[80:95]
  ds_read_b128 a[172:175], v3 offset:9216
  v_mfma_f32_32x32x16_bf16 v[96:111], a[144:147], a[24:27], v[96:111]
  ds_read_b128 a[176:179], v3 offset:41984
  s_waitcnt vmcnt(24)
  v_mfma_f32_32x32x16_bf16 v[64:79], a[148:151], a[28:31], v[64:79]
  ds_read_b128 a[180:183], v6 offset:9216
  v_mfma_f32_32x32x16_bf16 v[80:95], a[152:155], a[28:31], v[80:95]
  ds_read_b128 a[184:187], v3 offset:10240
  v_mfma_f32_32x32x16_bf16 v[96:111], a[156:159], a[28:31], v[96:111]
  ds_read_b128 a[188:191], v3 offset:43008
  s_waitcnt lgkmcnt(4)
  s_waitcnt vmcnt(23)
  v_mfma_f32_32x32x16_bf16 v[64:79], a[160:163], a[32:35], v[64:79]
  ds_read_b128 a[128:131], v6 offset:10240
  buffer_load_dwordx2 v[16:17], v4, s[20:23], s48 offen offset:0 sc0 sc1
  buffer_load_dwordx2 v[18:19], v4, s[20:23], s48 offen offset:256 sc0 sc1
  v_mfma_f32_32x32x16_bf16 v[80:95], a[164:167], a[32:35], v[80:95]
  ds_read_b128 a[132:135], v3 offset:11264
  buffer_load_dwordx2 v[20:21], v4, s[20:23], s48 offen offset:512 sc0 sc1
  v_mfma_f32_32x32x16_bf16 v[96:111], a[168:171], a[32:35], v[96:111]
  ds_read_b128 a[136:139], v3 offset:44032
  buffer_load_dwordx2 v[22:23], v4, s[20:23], s48 offen offset:768 sc0 sc1
  s_waitcnt vmcnt(26)
  v_mfma_f32_32x32x16_bf16 v[64:79], a[172:175], a[36:39], v[64:79]
  ds_read_b128 a[140:143], v6 offset:11264
  buffer_load_dwordx2 v[24:25], v4, s[20:23], s48 offen offset:1024 sc0 sc1
  buffer_load_dwordx2 v[26:27], v4, s[20:23], s48 offen offset:1280 sc0 sc1
  s_waitcnt lgkmcnt(4)
  v_mfma_f32_32x32x16_bf16 v[80:95], a[176:179], a[36:39], v[80:95]
  ds_read_b128 a[144:147], v3 offset:12288
  buffer_load_dwordx2 v[28:29], v4, s[20:23], s48 offen offset:1536 sc0 sc1
  v_mfma_f32_32x32x16_bf16 v[96:111], a[180:183], a[36:39], v[96:111]
  ds_read_b128 a[148:151], v3 offset:45056
  buffer_load_dwordx2 v[30:31], v4, s[20:23], s48 offen offset:1792 sc0 sc1
  s_waitcnt vmcnt(29)
  v_mfma_f32_32x32x16_bf16 v[64:79], a[184:187], a[40:43], v[64:79]
  ds_read_b128 a[152:155], v6 offset:12288
  buffer_load_dwordx4 v[32:35], v3, s[24:27], s52 offen offset:0 sc0 sc1
  v_mfma_f32_32x32x16_bf16 v[80:95], a[188:191], a[40:43], v[80:95]
  ds_read_b128 a[156:159], v3 offset:13312
  buffer_load_dwordx4 v[36:39], v3, s[24:27], s52 offen offset:1024 sc0 sc1
  buffer_load_dwordx4 v[40:43], v3, s[24:27], s52 offen offset:2048 sc0 sc1
  s_waitcnt lgkmcnt(4)
  v_mfma_f32_32x32x16_bf16 v[96:111], a[128:131], a[40:43], v[96:111]
  ds_read_b128 a[160:163], v3 offset:46080
  buffer_load_dwordx4 v[44:47], v3, s[24:27], s52 offen offset:3072 sc0 sc1
  s_waitcnt vmcnt(32)
  v_mfma_f32_32x32x16_bf16 v[64:79], a[132:135], a[44:47], v[64:79]
  ds_read_b128 a[164:167], v6 offset:13312
  s_add_u32 m0, s46, 0
  s_add_u32 s49, s47, 131072
  buffer_load_dwordx4 v3, s[12:15], s49 offen offset:0 sc0 sc1 lds
  v_mfma_f32_32x32x16_bf16 v[80:95], a[136:139], a[44:47], v[80:95]
  ds_read_b128 a[168:171], v3 offset:14336
  ds_read_b128 a[172:175], v3 offset:47104
  buffer_load_dwordx4 v3, s[12:15], s49 offen offset:1024 sc0 sc1 lds
  s_add_u32 m0, s46, 32768
  s_add_u32 s49, s47, 163840
  buffer_load_dwordx4 v3, s[12:15], s49 offen offset:0 sc0 sc1 lds
  v_mfma_f32_32x32x16_bf16 v[96:111], a[140:143], a[44:47], v[96:111]
  ds_read_b128 a[176:179], v6 offset:14336
  ds_read_b128 a[180:183], v3 offset:15360
  buffer_load_dwordx4 v3, s[12:15], s49 offen offset:1024 sc0 sc1 lds
  s_waitcnt lgkmcnt(6)
  s_waitcnt vmcnt(35)
  v_mfma_f32_32x32x16_bf16 v[64:79], a[144:147], a[48:51], v[64:79]
  ds_read_b128 a[184:187], v3 offset:48128
  ds_read_b128 a[188:191], v6 offset:15360
  s_add_u32 m0, s46, 65536
  s_add_u32 s49, s47, 196608
  buffer_load_dwordx4 v3, s[12:15], s49 offen offset:0 sc0 sc1 lds
  v_mfma_f32_32x32x16_bf16 v[80:95], a[148:151], a[48:51], v[80:95]
  buffer_load_dwordx4 v3, s[12:15], s49 offen offset:1024 sc0 sc1 lds
  v_mfma_f32_32x32x16_bf16 v[96:111], a[152:155], a[48:51], v[96:111]
  s_waitcnt vmcnt(36)
  v_mfma_f32_32x32x16_bf16 v[64:79], a[156:159], a[52:55], v[64:79]
  s_waitcnt vmcnt(56) lgkmcnt(0)
  s_barrier
  v_mfma_f32_32x32x16_bf16 v[80:95], a[160:163], a[52:55], v[80:95]
  ds_read_b128 a[128:131], v3 offset:16384
  v_mfma_f32_32x32x16_bf16 v[96:111], a[164:167], a[52:55], v[96:111]
  ds_read_b128 a[132:135], v3 offset:49152
  s_add_u32 m0, s46, 8192
  s_add_u32 s49, s47, 139264
  buffer_load_dwordx4 v3, s[12:15], s49 offen offset:0 sc0 sc1 lds
  s_waitcnt vmcnt(36)
  v_mfma_f32_32x32x16_bf16 v[64:79], a[168:171], a[56:59], v[64:79]
  ds_read_b128 a[136:139], v6 offset:16384
  buffer_load_dwordx4 v3, s[12:15], s49 offen offset:1024 sc0 sc1 lds
  v_mfma_f32_32x32x16_bf16 v[80:95], a[172:175], a[56:59], v[80:95]
  ds_read_b128 a[140:143], v3 offset:17408
  s_add_u32 m0, s46, 40960
  s_add_u32 s49, s47, 172032
  buffer_load_dwordx4 v3, s[12:15], s49 offen offset:0 sc0 sc1 lds
  v_mfma_f32_32x32x16_bf16 v[96:111], a[176:179], a[56:59], v[96:111]
  ds_read_b128 a[144:147], v3 offset:50176
  buffer_load_dwordx4 v3, s[12:15], s49 offen offset:1024 sc0 sc1 lds
  s_waitcnt vmcnt(38)
  v_mfma_f32_32x32x16_bf16 v[64:79], a[180:183], a[60:63], v[64:79]
  ds_read_b128 a[148:151], v6 offset:17408
  s_add_u32 m0, s46, 73728
  s_add_u32 s49, s47, 204800
  buffer_load_dwordx4 v3, s[12:15], s49 offen offset:0 sc0 sc1 lds
  v_mfma_f32_32x32x16_bf16 v[80:95], a[184:187], a[60:63], v[80:95]
  ds_read_b128 a[152:155], v3 offset:18432
  buffer_load_dwordx4 v3, s[12:15], s49 offen offset:1024 sc0 sc1 lds
  v_mfma_f32_32x32x16_bf16 v[96:111], a[188:191], a[60:63], v[96:111]
  ds_read_b128 a[156:159], v3 offset:51200
  s_waitcnt lgkmcnt(4)
  s_waitcnt vmcnt(39)
  v_mfma_f32_32x32x16_bf16 v[64:79], a[128:131], a[64:67], v[64:79]
  ds_read_b128 a[160:163], v6 offset:18432
  v_mfma_f32_32x32x16_bf16 v[80:95], a[132:135], a[64:67], v[80:95]
  ds_read_b128 a[164:167], v3 offset:19456
  v_mfma_f32_32x32x16_bf16 v[96:111], a[136:139], a[64:67], v[96:111]
  ds_read_b128 a[168:171], v3 offset:52224
  s_waitcnt vmcnt(38)
  v_mfma_f32_32x32x16_bf16 v[64:79], a[140:143], a[68:71], v[64:79]
  ds_read_b128 a[172:175], v6 offset:19456
  s_waitcnt lgkmcnt(4)
  v_mfma_f32_32x32x16_bf16 v[80:95], a[144:147], a[68:71], v[80:95]
  ds_read_b128 a[176:179], v3 offset:20480
  v_mfma_f32_32x32x16_bf16 v[96:111], a[148:151], a[68:71], v[96:111]
  ds_read_b128 a[180:183], v3 offset:53248
  s_waitcnt vmcnt(37)
  v_mfma_f32_32x32x16_bf16 v[64:79], a[152:155], a[72:75], v[64:79]
  ds_read_b128 a[184:187], v6 offset:20480
  v_mfma_f32_32x32x16_bf16 v[80:95], a[156:159], a[72:75], v[80:95]
  ds_read_b128 a[188:191], v3 offset:21504
  s_waitcnt lgkmcnt(4)
  v_mfma_f32_32x32x16_bf16 v[96:111], a[160:163], a[72:75], v[96:111]
  ds_read_b128 a[128:131], v3 offset:54272
  s_waitcnt vmcnt(36)
  v_mfma_f32_32x32x16_bf16 v[64:79], a[164:167], a[76:79], v[64:79]
  ds_read_b128 a[132:135], v6 offset:21504
  v_mfma_f32_32x32x16_bf16 v[80:95], a[168:171], a[76:79], v[80:95]
  ds_read_b128 a[136:139], v3 offset:22528
  ds_read_b128 a[140:143], v3 offset:55296
  v_mfma_f32_32x32x16_bf16 v[96:111], a[172:175], a[76:79], v[96:111]
  ds_read_b128 a[144:147], v6 offset:22528
  ds_read_b128 a[148:151], v3 offset:23552
  s_waitcnt lgkmcnt(6)
  s_waitcnt vmcnt(35)
  v_mfma_f32_32x32x16_bf16 v[64:79], a[176:179], a[80:83], v[64:79]
  ds_read_b128 a[152:155], v3 offset:56320
  ds_read_b128 a[156:159], v6 offset:23552
  v_mfma_f32_32x32x16_bf16 v[80:95], a[180:183], a[80:83], v[80:95]
  v_mfma_f32_32x32x16_bf16 v[96:111], a[184:187], a[80:83], v[96:111]
  s_waitcnt vmcnt(34)
  v_mfma_f32_32x32x16_bf16 v[64:79], a[188:191], a[84:87], v[64:79]
  s_waitcnt vmcnt(56) lgkmcnt(0)
  s_barrier
  v_mfma_f32_32x32x16_bf16 v[80:95], a[128:131], a[84:87], v[80:95]
  ds_read_b128 a[160:163], v3 offset:24576
  v_mfma_f32_32x32x16_bf16 v[96:111], a[132:135], a[84:87], v[96:111]
  ds_read_b128 a[164:167], v3 offset:57344
  s_add_u32 m0, s46, 16384
  s_add_u32 s49, s47, 147456
  buffer_load_dwordx4 v3, s[12:15], s49 offen offset:0 sc0 sc1 lds
  s_waitcnt vmcnt(23)
  v_add_f32 v16, v16, v18
  v_add_f32 v17, v17, v19
  s_waitcnt vmcnt(22)
  v_add_f32 v16, v16, v20
  v_add_f32 v17, v17, v21
  v_mfma_f32_32x32x16_bf16 v[64:79], a[136:139], a[88:91], v[64:79]
  ds_read_b128 a[168:171], v6 offset:24576
  buffer_load_dwordx4 v3, s[12:15], s49 offen offset:1024 sc0 sc1 lds
  s_waitcnt vmcnt(22)
  v_add_f32 v16, v16, v22
  v_add_f32 v17, v17, v23
  s_waitcnt vmcnt(21)
  v_add_f32 v16, v16, v24
  v_add_f32 v17, v17, v25
  v_mfma_f32_32x32x16_bf16 v[80:95], a[140:143], a[88:91], v[80:95]
  ds_read_b128 a[172:175], v3 offset:25600
  s_add_u32 m0, s46, 49152
  s_add_u32 s49, s47, 180224
  buffer_load_dwordx4 v3, s[12:15], s49 offen offset:0 sc0 sc1 lds
  s_waitcnt vmcnt(21)
  v_add_f32 v16, v16, v26
  v_add_f32 v17, v17, v27
  s_waitcnt vmcnt(20)
  v_add_f32 v16, v16, v28
  v_add_f32 v17, v17, v29
  v_mfma_f32_32x32x16_bf16 v[96:111], a[144:147], a[88:91], v[96:111]
  ds_read_b128 a[176:179], v3 offset:58368
  buffer_load_dwordx4 v3, s[12:15], s49 offen offset:1024 sc0 sc1 lds
  s_waitcnt vmcnt(20)
  v_add_f32 v16, v16, v30
  v_add_f32 v17, v17, v31
  v_mov_b32 v18, v16
  v_mov_b32 v19, v17
  v_mfma_f32_32x32x16_bf16 v[64:79], a[148:151], a[92:95], v[64:79]
  ds_read_b128 a[180:183], v6 offset:25600
  s_add_u32 m0, s46, 81920
  s_add_u32 s49, s47, 212992
  buffer_load_dwordx4 v3, s[12:15], s49 offen offset:0 sc0 sc1 lds
  s_nop 1
  v_permlane32_swap_b32 v16, v18
  v_permlane32_swap_b32 v17, v19
  v_add_f32 v16, v16, v18
  v_mfma_f32_32x32x16_bf16 v[80:95], a[152:155], a[92:95], v[80:95]
  ds_read_b128 a[184:187], v3 offset:26624
  buffer_load_dwordx4 v3, s[12:15], s49 offen offset:1024 sc0 sc1 lds
  v_add_f32 v17, v17, v19
  v_mul_f32 v8, 0xbb000000, v16
  v_mul_f32 v17, 0x3b000000, v17
  v_fma_f32 v17, -v8, v8, v17
  v_mfma_f32_32x32x16_bf16 v[96:111], a[156:159], a[92:95], v[96:111]
  ds_read_b128 a[188:191], v3 offset:59392
  v_max_f32 v17, 0, v17
  v_add_f32 v17, 0x3727c5ac, v17
  v_rsq_f32 v9, v17
  s_waitcnt vmcnt(20)
  v_add_f32 v32, v32, v36
  s_waitcnt lgkmcnt(4)
  v_mfma_f32_32x32x16_bf16 v[64:79], a[160:163], a[96:99], v[64:79]
  ds_read_b128 a[128:131], v6 offset:26624
  v_add_f32 v33, v33, v37
  v_add_f32 v34, v34, v38
  v_add_f32 v35, v35, v39
  v_mov_b32 v36, v32
  v_mfma_f32_32x32x16_bf16 v[80:95], a[164:167], a[96:99], v[80:95]
  ds_read_b128 a[132:135], v3 offset:27648
  v_mov_b32 v37, v33
  v_mov_b32 v38, v34
  v_mov_b32 v39, v35
  s_nop 0
  v_mfma_f32_32x32x16_bf16 v[96:111], a[168:171], a[96:99], v[96:111]
  ds_read_b128 a[136:139], v3 offset:60416
  v_permlane32_swap_b32 v32, v36
  v_permlane32_swap_b32 v33, v37
  v_permlane32_swap_b32 v34, v38
  v_permlane32_swap_b32 v35, v39
  v_mfma_f32_32x32x16_bf16 v[64:79], a[172:175], a[100:103], v[64:79]
  ds_read_b128 a[140:143], v6 offset:27648
  v_add_f32 v32, v32, v36
  v_add_f32 v33, v33, v37
  v_add_f32 v34, v34, v38
  v_add_f32 v35, v35, v39
  v_mov_b32 v36, v32
  s_waitcnt lgkmcnt(4)
  v_mfma_f32_32x32x16_bf16 v[80:95], a[176:179], a[100:103], v[80:95]
  ds_read_b128 a[144:147], v3 offset:28672
  v_mov_b32 v37, v33
  v_mov_b32 v38, v34
  v_mov_b32 v39, v35
  s_nop 0
  v_mfma_f32_32x32x16_bf16 v[96:111], a[180:183], a[100:103], v[96:111]
  ds_read_b128 a[148:151], v3 offset:61440
  v_permlane16_swap_b32 v32, v36
  v_permlane16_swap_b32 v33, v37
  v_permlane16_swap_b32 v34, v38
  v_permlane16_swap_b32 v35, v39
  v_mfma_f32_32x32x16_bf16 v[64:79], a[184:187], a[104:107], v[64:79]
  ds_read_b128 a[152:155], v6 offset:28672
  v_add_f32 v32, v32, v36
  v_add_f32 v33, v33, v37
  v_add_f32 v34, v34, v38
  v_add_f32 v35, v35, v39
  v_mfma_f32_32x32x16_bf16 v[80:95], a[188:191], a[104:107], v[80:95]
  ds_read_b128 a[156:159], v3 offset:29696
  ds_write_b128 v10, v[32:35] offset:0
  s_waitcnt vmcnt(18)
  v_add_f32 v40, v40, v44
  v_add_f32 v41, v41, v45
  v_add_f32 v42, v42, v46
  s_waitcnt lgkmcnt(5)
  v_mfma_f32_32x32x16_bf16 v[96:111], a[128:131], a[104:107], v[96:111]
  ds_read_b128 a[160:163], v3 offset:62464
  v_add_f32 v43, v43, v47
  v_mov_b32 v44, v40
  v_mov_b32 v45, v41
  v_mov_b32 v46, v42
  v_mfma_f32_32x32x16_bf16 v[64:79], a[132:135], a[108:111], v[64:79]
  ds_read_b128 a[164:167], v6 offset:29696
  v_mov_b32 v47, v43
  s_nop 0
  v_permlane32_swap_b32 v40, v44
  v_permlane32_swap_b32 v41, v45
  v_mfma_f32_32x32x16_bf16 v[80:95], a[136:139], a[108:111], v[80:95]
  ds_read_b128 a[168:171], v3 offset:30720
  ds_read_b128 a[172:175], v3 offset:63488
  v_permlane32_swap_b32 v42, v46
  v_permlane32_swap_b32 v43, v47
  v_add_f32 v40, v40, v44
  v_add_f32 v41, v41, v45
  v_mfma_f32_32x32x16_bf16 v[96:111], a[140:143], a[108:111], v[96:111]
  ds_read_b128 a[176:179], v6 offset:30720
  ds_read_b128 a[180:183], v3 offset:31744
  v_add_f32 v42, v42, v46
  v_add_f32 v43, v43, v47
  v_mov_b32 v44, v40
  v_mov_b32 v45, v41
  s_waitcnt lgkmcnt(7)
  v_mfma_f32_32x32x16_bf16 v[64:79], a[144:147], a[112:115], v[64:79]
  ds_read_b128 a[184:187], v3 offset:64512
  ds_read_b128 a[188:191], v6 offset:31744
  v_mov_b32 v46, v42
  v_mov_b32 v47, v43
  s_nop 0
  v_permlane16_swap_b32 v40, v44
  v_mfma_f32_32x32x16_bf16 v[80:95], a[148:151], a[112:115], v[80:95]
  v_permlane16_swap_b32 v41, v45
  v_permlane16_swap_b32 v42, v46
  v_permlane16_swap_b32 v43, v47
  v_add_f32 v40, v40, v44
  v_mfma_f32_32x32x16_bf16 v[96:111], a[152:155], a[112:115], v[96:111]
  v_add_f32 v41, v41, v45
  v_add_f32 v42, v42, v46
  v_add_f32 v43, v43, v47
  ds_write_b128 v10, v[40:43] offset:256
  v_mfma_f32_32x32x16_bf16 v[64:79], a[156:159], a[116:119], v[64:79]
  s_waitcnt vmcnt(56) lgkmcnt(0)
  s_barrier
  v_mfma_f32_32x32x16_bf16 v[80:95], a[160:163], a[116:119], v[80:95]
  ds_read_b128 a[128:131], v6 offset:32768
  v_mfma_f32_32x32x16_bf16 v[96:111], a[164:167], a[116:119], v[96:111]
  ds_read_b128 a[132:135], v6 offset:33792
  s_add_u32 m0, s46, 24576
  s_add_u32 s49, s47, 155648
  buffer_load_dwordx4 v3, s[12:15], s49 offen offset:0 sc0 sc1 lds
  v_mfma_f32_32x32x16_bf16 v[64:79], a[168:171], a[120:123], v[64:79]
  ds_read_b128 a[136:139], v6 offset:34816
  buffer_load_dwordx4 v3, s[12:15], s49 offen offset:1024 sc0 sc1 lds
  v_mfma_f32_32x32x16_bf16 v[80:95], a[172:175], a[120:123], v[80:95]
  ds_read_b128 a[140:143], v6 offset:35840
  s_add_u32 m0, s46, 57344
  s_add_u32 s49, s47, 188416
  buffer_load_dwordx4 v3, s[12:15], s49 offen offset:0 sc0 sc1 lds
  v_mfma_f32_32x32x16_bf16 v[96:111], a[176:179], a[120:123], v[96:111]
  ds_read_b128 a[144:147], v6 offset:36864
  buffer_load_dwordx4 v3, s[12:15], s49 offen offset:1024 sc0 sc1 lds
  v_mfma_f32_32x32x16_bf16 v[64:79], a[180:183], a[124:127], v[64:79]
  ds_read_b128 a[148:151], v6 offset:37888
  s_add_u32 m0, s46, 90112
  s_add_u32 s49, s47, 221184
  buffer_load_dwordx4 v3, s[12:15], s49 offen offset:0 sc0 sc1 lds
  v_mfma_f32_32x32x16_bf16 v[80:95], a[184:187], a[124:127], v[80:95]
  ds_read_b128 a[152:155], v6 offset:38912
  buffer_load_dwordx4 v3, s[12:15], s49 offen offset:1024 sc0 sc1 lds
  v_mfma_f32_32x32x16_bf16 v[96:111], a[188:191], a[124:127], v[96:111]
  ds_read_b128 a[156:159], v6 offset:39936
  ds_read_b128 v[176:179], v7 offset:0
  ds_read_b128 v[180:183], v7 offset:32
  s_waitcnt lgkmcnt(6)
  v_mfma_f32_32x32x16_bf16 v[112:127], a[128:131], a[0:3], 0
  ds_read_b128 a[160:163], v6 offset:40960
  ds_read_b128 v[184:187], v7 offset:64
  ds_read_b128 v[188:191], v7 offset:96
  v_mfma_f32_32x32x16_bf16 v[112:127], a[132:135], a[4:7], v[112:127]
  ds_read_b128 a[164:167], v6 offset:41984
  ds_read_b128 v[192:195], v7 offset:128
  ds_read_b128 v[196:199], v7 offset:160
  v_mfma_f32_32x32x16_bf16 v[112:127], a[136:139], a[8:11], v[112:127]
  ds_read_b128 a[168:171], v6 offset:43008
  ds_read_b128 v[200:203], v7 offset:192
  ds_read_b128 v[204:207], v7 offset:224
  v_mfma_f32_32x32x16_bf16 v[112:127], a[140:143], a[12:15], v[112:127]
  ds_read_b128 a[172:175], v6 offset:44032
  s_waitcnt lgkmcnt(12)
  v_mfma_f32_32x32x16_bf16 v[112:127], a[144:147], a[16:19], v[112:127]
  ds_read_b128 a[176:179], v6 offset:45056
  s_waitcnt lgkmcnt(12)
  v_fmac_f32 v64, v8, v176
  v_fmac_f32 v65, v8, v177
  v_fmac_f32 v66, v8, v178
  v_fmac_f32 v67, v8, v179
  s_waitcnt lgkmcnt(11)
  v_fmac_f32 v68, v8, v180
  v_mfma_f32_32x32x16_bf16 v[112:127], a[148:151], a[20:23], v[112:127]
  ds_read_b128 a[180:183], v6 offset:46080
  v_fmac_f32 v69, v8, v181
  v_fmac_f32 v70, v8, v182
  v_fmac_f32 v71, v8, v183
  s_waitcnt lgkmcnt(10)
  v_fmac_f32 v72, v8, v184
  v_mfma_f32_32x32x16_bf16 v[112:127], a[152:155], a[24:27], v[112:127]
  ds_read_b128 a[184:187], v6 offset:47104
  v_fmac_f32 v73, v8, v185
  v_fmac_f32 v74, v8, v186
  v_fmac_f32 v75, v8, v187
  s_waitcnt lgkmcnt(10)
  v_fmac_f32 v76, v8, v188
  v_fmac_f32 v77, v8, v189
  v_mfma_f32_32x32x16_bf16 v[112:127], a[156:159], a[28:31], v[112:127]
  ds_read_b128 a[188:191], v6 offset:48128
  v_fmac_f32 v78, v8, v190
  v_fmac_f32 v79, v8, v191
  s_waitcnt lgkmcnt(9)
  v_fma_f32 v64, v64, v9, v192
  v_fma_f32 v65, v65, v9, v193
  s_waitcnt lgkmcnt(4)
  v_mfma_f32_32x32x16_bf16 v[112:127], a[160:163], a[32:35], v[112:127]
  ds_read_b128 a[128:131], v6 offset:49152
  v_fma_f32 v66, v66, v9, v194
  v_fma_f32 v67, v67, v9, v195
  v_fma_f32 v68, v68, v9, v196
  v_fma_f32 v69, v69, v9, v197
  v_fma_f32 v70, v70, v9, v198
  v_mfma_f32_32x32x16_bf16 v[112:127], a[164:167], a[36:39], v[112:127]
  ds_read_b128 a[132:135], v6 offset:50176
  v_fma_f32 v71, v71, v9, v199
  v_fma_f32 v72, v72, v9, v200
  v_fma_f32 v73, v73, v9, v201
  v_fma_f32 v74, v74, v9, v202
  v_fma_f32 v75, v75, v9, v203
  v_mfma_f32_32x32x16_bf16 v[112:127], a[168:171], a[40:43], v[112:127]
  ds_read_b128 a[136:139], v6 offset:51200
  v_fma_f32 v76, v76, v9, v204
  v_fma_f32 v77, v77, v9, v205
  v_fma_f32 v78, v78, v9, v206
  v_fma_f32 v79, v79, v9, v207
  v_mfma_f32_32x32x16_bf16 v[112:127], a[172:175], a[44:47], v[112:127]
  ds_read_b128 a[140:143], v6 offset:52224
  v_exp_f32 v208, v64
  v_exp_f32 v209, v65
  s_waitcnt lgkmcnt(4)
  v_mfma_f32_32x32x16_bf16 v[112:127], a[176:179], a[48:51], v[112:127]
  ds_read_b128 a[144:147], v6 offset:53248
  v_exp_f32 v210, v66
  v_exp_f32 v211, v67
  v_mfma_f32_32x32x16_bf16 v[112:127], a[180:183], a[52:55], v[112:127]
  ds_read_b128 a[148:151], v6 offset:54272
  v_exp_f32 v212, v68
  v_exp_f32 v213, v69
  v_mfma_f32_32x32x16_bf16 v[112:127], a[184:187], a[56:59], v[112:127]
  ds_read_b128 a[152:155], v6 offset:55296
  v_exp_f32 v214, v70
  v_exp_f32 v215, v71
  v_mul_f32 v64, v64, v72
  v_mfma_f32_32x32x16_bf16 v[112:127], a[188:191], a[60:63], v[112:127]
  ds_read_b128 a[156:159], v6 offset:56320
  v_mul_f32 v65, v65, v73
  v_mul_f32 v66, v66, v74
  v_mul_f32 v67, v67, v75
  v_mul_f32 v68, v68, v76
  s_waitcnt lgkmcnt(4)
  v_mfma_f32_32x32x16_bf16 v[112:127], a[128:131], a[64:67], v[112:127]
  ds_read_b128 a[160:163], v6 offset:57344
  v_mul_f32 v69, v69, v77
  v_mul_f32 v70, v70, v78
  v_mul_f32 v71, v71, v79
  v_add_f32 v208, 1.0, v208
  v_add_f32 v209, 1.0, v209
  v_mfma_f32_32x32x16_bf16 v[112:127], a[132:135], a[68:71], v[112:127]
  ds_read_b128 a[164:167], v6 offset:58368
  v_add_f32 v210, 1.0, v210
  v_add_f32 v211, 1.0, v211
  v_add_f32 v212, 1.0, v212
  v_add_f32 v213, 1.0, v213
  v_add_f32 v214, 1.0, v214
  v_mfma_f32_32x32x16_bf16 v[112:127], a[136:139], a[72:75], v[112:127]
  ds_read_b128 a[168:171], v6 offset:59392
  ds_read_b128 a[172:175], v6 offset:60416
  v_add_f32 v215, 1.0, v215
  v_rcp_f32 v208, v208
  v_mfma_f32_32x32x16_bf16 v[112:127], a[140:143], a[76:79], v[112:127]
  ds_read_b128 a[176:179], v6 offset:61440
  ds_read_b128 a[180:183], v6 offset:62464
  v_rcp_f32 v209, v209
  s_waitcnt lgkmcnt(6)
  v_mfma_f32_32x32x16_bf16 v[112:127], a[144:147], a[80:83], v[112:127]
  ds_read_b128 a[184:187], v6 offset:63488
  ds_read_b128 a[188:191], v6 offset:64512
  ds_read_b128 v[16:19], v7 offset:256
  ds_read_b128 v[20:23], v7 offset:288
  v_rcp_f32 v210, v210
  v_rcp_f32 v211, v211
  v_mfma_f32_32x32x16_bf16 v[112:127], a[148:151], a[84:87], v[112:127]
  ds_read_b128 v[24:27], v7 offset:320
  ds_read_b128 v[28:31], v7 offset:352
  v_rcp_f32 v212, v212
  v_rcp_f32 v213, v213
  v_rcp_f32 v214, v214
  v_mfma_f32_32x32x16_bf16 v[112:127], a[152:155], a[88:91], v[112:127]
  ds_read_b128 v[32:35], v7 offset:384
  ds_read_b128 v[36:39], v7 offset:416
  ds_read_b128 v[40:43], v7 offset:448
  ds_read_b128 v[44:47], v7 offset:480
  v_rcp_f32 v215, v215
  v_mul_f32 v64, v64, v208
  v_mul_f32 v65, v65, v209
  v_mul_f32 v66, v66, v210
  v_mul_f32 v67, v67, v211
  v_mfma_f32_32x32x16_bf16 v[112:127], a[156:159], a[92:95], v[112:127]
  s_waitcnt vmcnt(4) lgkmcnt(0)
  s_barrier
  v_mfma_f32_32x32x16_bf16 v[112:127], a[160:163], a[96:99], v[112:127]
  ds_read_b128 a[128:131], v3 offset:0
  v_mul_f32 v68, v68, v212
  v_mul_f32 v69, v69, v213
  v_mul_f32 v70, v70, v214
  v_mul_f32 v71, v71, v215
  v_cvt_pk_bf16_f32 v216, v64, v65
  v_mfma_f32_32x32x16_bf16 v[112:127], a[164:167], a[100:103], v[112:127]
  ds_read_b128 a[132:135], v3 offset:1024
  v_cvt_pk_bf16_f32 v217, v66, v67
  v_cvt_pk_bf16_f32 v218, v68, v69
  v_cvt_pk_bf16_f32 v219, v70, v71
  buffer_store_dwordx4 v[216:219], v3, s[28:31], s53 offen offset:0 sc0 sc1
  v_fmac_f32 v80, v8, v16
  v_mfma_f32_32x32x16_bf16 v[112:127], a[168:171], a[104:107], v[112:127]
  ds_read_b128 a[136:139], v3 offset:2048
  v_fmac_f32 v81, v8, v17
  v_fmac_f32 v82, v8, v18
  v_fmac_f32 v83, v8, v19
  v_fmac_f32 v84, v8, v20
  v_fmac_f32 v85, v8, v21
  v_mfma_f32_32x32x16_bf16 v[112:127], a[172:175], a[108:111], v[112:127]
  ds_read_b128 a[140:143], v3 offset:3072
  v_fmac_f32 v86, v8, v22
  v_fmac_f32 v87, v8, v23
  v_fmac_f32 v88, v8, v24
  v_fmac_f32 v89, v8, v25
  v_mfma_f32_32x32x16_bf16 v[112:127], a[176:179], a[112:115], v[112:127]
  ds_read_b128 a[144:147], v3 offset:4096
  v_fmac_f32 v90, v8, v26
  v_fmac_f32 v91, v8, v27
  v_fmac_f32 v92, v8, v28
  v_fmac_f32 v93, v8, v29
  v_fmac_f32 v94, v8, v30
  v_mfma_f32_32x32x16_bf16 v[112:127], a[180:183], a[116:119], v[112:127]
  ds_read_b128 a[148:151], v3 offset:5120
  v_fmac_f32 v95, v8, v31
  v_fma_f32 v80, v80, v9, v32
  v_fma_f32 v81, v81, v9, v33
  v_fma_f32 v82, v82, v9, v34
  v_fma_f32 v83, v83, v9, v35
  v_mfma_f32_32x32x16_bf16 v[112:127], a[184:187], a[120:123], v[112:127]
  ds_read_b128 a[152:155], v3 offset:6144
  v_fma_f32 v84, v84, v9, v36
  v_fma_f32 v85, v85, v9, v37
  v_fma_f32 v86, v86, v9, v38
  v_fma_f32 v87, v87, v9, v39
  v_fma_f32 v88, v88, v9, v40
  v_mfma_f32_32x32x16_bf16 v[112:127], a[188:191], a[124:127], v[112:127]
  ds_read_b128 a[156:159], v3 offset:7168
  v_fma_f32 v89, v89, v9, v41
  v_fma_f32 v90, v90, v9, v42
  v_fma_f32 v91, v91, v9, v43
  v_fma_f32 v92, v92, v9, v44
  s_waitcnt lgkmcnt(4)
  v_mfma_f32_32x32x16_bf16 v[128:143], a[128:131], a[0:3], 0
  ds_read_b128 a[160:163], v3 offset:8192
  v_fma_f32 v93, v93, v9, v45
  v_fma_f32 v94, v94, v9, v46
  v_fma_f32 v95, v95, v9, v47
  v_exp_f32 v208, v80
  v_mfma_f32_32x32x16_bf16 v[128:143], a[132:135], a[4:7], v[128:143]
  ds_read_b128 a[164:167], v3 offset:9216
  v_exp_f32 v209, v81
  v_exp_f32 v210, v82
  v_mfma_f32_32x32x16_bf16 v[128:143], a[136:139], a[8:11], v[128:143]
  ds_read_b128 a[168:171], v3 offset:10240
  v_exp_f32 v211, v83
  v_exp_f32 v212, v84
  v_mfma_f32_32x32x16_bf16 v[128:143], a[140:143], a[12:15], v[128:143]
  ds_read_b128 a[172:175], v3 offset:11264
  v_exp_f32 v213, v85
  v_exp_f32 v214, v86
  s_waitcnt lgkmcnt(4)
  v_mfma_f32_32x32x16_bf16 v[128:143], a[144:147], a[16:19], v[128:143]
  ds_read_b128 a[176:179], v3 offset:12288
  v_exp_f32 v215, v87
  v_mul_f32 v80, v80, v88
  v_mul_f32 v81, v81, v89
  v_mul_f32 v82, v82, v90
  v_mfma_f32_32x32x16_bf16 v[128:143], a[148:151], a[20:23], v[128:143]
  ds_read_b128 a[180:183], v3 offset:13312
  v_mul_f32 v83, v83, v91
  v_mul_f32 v84, v84, v92
  v_mul_f32 v85, v85, v93
  v_mul_f32 v86, v86, v94
  v_mul_f32 v87, v87, v95
  v_mfma_f32_32x32x16_bf16 v[128:143], a[152:155], a[24:27], v[128:143]
  ds_read_b128 a[184:187], v3 offset:14336
  v_add_f32 v208, 1.0, v208
  v_add_f32 v209, 1.0, v209
  v_add_f32 v210, 1.0, v210
  v_add_f32 v211, 1.0, v211
  v_add_f32 v212, 1.0, v212
  v_mfma_f32_32x32x16_bf16 v[128:143], a[156:159], a[28:31], v[128:143]
  ds_read_b128 a[188:191], v3 offset:15360
  v_add_f32 v213, 1.0, v213
  v_add_f32 v214, 1.0, v214
  v_add_f32 v215, 1.0, v215
  s_waitcnt lgkmcnt(4)
  v_mfma_f32_32x32x16_bf16 v[128:143], a[160:163], a[32:35], v[128:143]
  ds_read_b128 a[128:131], v3 offset:16384
  v_rcp_f32 v208, v208
  v_rcp_f32 v209, v209
  v_mfma_f32_32x32x16_bf16 v[128:143], a[164:167], a[36:39], v[128:143]
  ds_read_b128 a[132:135], v3 offset:17408
  ds_read_b128 v[176:179], v7 offset:512
  ds_read_b128 v[180:183], v7 offset:544
  v_rcp_f32 v210, v210
  v_rcp_f32 v211, v211
  v_mfma_f32_32x32x16_bf16 v[128:143], a[168:171], a[40:43], v[128:143]
  ds_read_b128 a[136:139], v3 offset:18432
  ds_read_b128 v[184:187], v7 offset:576
  ds_read_b128 v[188:191], v7 offset:608
  v_rcp_f32 v212, v212
  v_rcp_f32 v213, v213
  v_mfma_f32_32x32x16_bf16 v[128:143], a[172:175], a[44:47], v[128:143]
  ds_read_b128 a[140:143], v3 offset:19456
  ds_read_b128 v[192:195], v7 offset:640
  ds_read_b128 v[196:199], v7 offset:672
  v_rcp_f32 v214, v214
  v_rcp_f32 v215, v215
  s_waitcnt lgkmcnt(10)
  v_mfma_f32_32x32x16_bf16 v[128:143], a[176:179], a[48:51], v[128:143]
  ds_read_b128 a[144:147], v3 offset:20480
  ds_read_b128 v[200:203], v7 offset:704
  ds_read_b128 v[204:207], v7 offset:736
  v_mul_f32 v80, v80, v208
  v_mul_f32 v81, v81, v209
  v_mul_f32 v82, v82, v210
  v_mul_f32 v83, v83, v211
  v_mul_f32 v84, v84, v212
  v_mfma_f32_32x32x16_bf16 v[128:143], a[180:183], a[52:55], v[128:143]
  ds_read_b128 a[148:151], v3 offset:21504
  v_mul_f32 v85, v85, v213
  v_mul_f32 v86, v86, v214
  v_mul_f32 v87, v87, v215
  v_cvt_pk_bf16_f32 v220, v80, v81
  v_cvt_pk_bf16_f32 v221, v82, v83
  v_mfma_f32_32x32x16_bf16 v[128:143], a[184:187], a[56:59], v[128:143]
  ds_read_b128 a[152:155], v3 offset:22528
  v_cvt_pk_bf16_f32 v222, v84, v85
  v_cvt_pk_bf16_f32 v223, v86, v87
  buffer_store_dwordx4 v[220:223], v3, s[28:31], s53 offen offset:1024 sc0 sc1
  s_waitcnt lgkmcnt(12)
  v_fmac_f32 v96, v8, v176
  v_fmac_f32 v97, v8, v177
  v_mfma_f32_32x32x16_bf16 v[128:143], a[188:191], a[60:63], v[128:143]
  ds_read_b128 a[156:159], v3 offset:23552
  v_fmac_f32 v98, v8, v178
  v_fmac_f32 v99, v8, v179
  s_waitcnt lgkmcnt(12)
  v_fmac_f32 v100, v8, v180
  v_fmac_f32 v101, v8, v181
  s_waitcnt lgkmcnt(8)
  v_mfma_f32_32x32x16_bf16 v[128:143], a[128:131], a[64:67], v[128:143]
  ds_read_b128 a[160:163], v3 offset:24576
  v_fmac_f32 v102, v8, v182
  v_fmac_f32 v103, v8, v183
  v_fmac_f32 v104, v8, v184
  v_fmac_f32 v105, v8, v185
  v_fmac_f32 v106, v8, v186
  v_mfma_f32_32x32x16_bf16 v[128:143], a[132:135], a[68:71], v[128:143]
  ds_read_b128 a[164:167], v3 offset:25600
  v_fmac_f32 v107, v8, v187
  v_fmac_f32 v108, v8, v188
  v_fmac_f32 v109, v8, v189
  v_fmac_f32 v110, v8, v190
  v_fmac_f32 v111, v8, v191
  v_mfma_f32_32x32x16_bf16 v[128:143], a[136:139], a[72:75], v[128:143]
  ds_read_b128 a[168:171], v3 offset:26624
  ds_read_b128 a[172:175], v3 offset:27648
  s_waitcnt lgkmcnt(11)
  v_fma_f32 v96, v96, v9, v192
  v_fma_f32 v97, v97, v9, v193
  v_fma_f32 v98, v98, v9, v194
  v_fma_f32 v99, v99, v9, v195
  v_mfma_f32_32x32x16_bf16 v[128:143], a[140:143], a[76:79], v[128:143]
  ds_read_b128 a[176:179], v3 offset:28672
  ds_read_b128 a[180:183], v3 offset:29696
  s_waitcnt lgkmcnt(12)
  v_fma_f32 v100, v100, v9, v196
  v_fma_f32 v101, v101, v9, v197
  v_fma_f32 v102, v102, v9, v198
  s_waitcnt lgkmcnt(6)
  v_mfma_f32_32x32x16_bf16 v[128:143], a[144:147], a[80:83], v[128:143]
  ds_read_b128 a[184:187], v3 offset:30720
  ds_read_b128 a[188:191], v3 offset:31744
  v_fma_f32 v103, v103, v9, v199
  v_fma_f32 v104, v104, v9, v200
  v_fma_f32 v105, v105, v9, v201
  v_fma_f32 v106, v106, v9, v202
  v_mfma_f32_32x32x16_bf16 v[128:143], a[148:151], a[84:87], v[128:143]
  v_fma_f32 v107, v107, v9, v203
  v_fma_f32 v108, v108, v9, v204
  v_fma_f32 v109, v109, v9, v205
  v_fma_f32 v110, v110, v9, v206
  v_fma_f32 v111, v111, v9, v207
  v_mfma_f32_32x32x16_bf16 v[128:143], a[152:155], a[88:91], v[128:143]
  v_exp_f32 v208, v96
  v_exp_f32 v209, v97
  v_exp_f32 v210, v98
  v_mfma_f32_32x32x16_bf16 v[128:143], a[156:159], a[92:95], v[128:143]
  s_waitcnt vmcnt(4) lgkmcnt(0)
  s_barrier
  v_mfma_f32_32x32x16_bf16 v[128:143], a[160:163], a[96:99], v[128:143]
  ds_read_b128 a[128:131], v3 offset:32768
  v_exp_f32 v211, v99
  v_exp_f32 v212, v100
  v_mfma_f32_32x32x16_bf16 v[128:143], a[164:167], a[100:103], v[128:143]
  ds_read_b128 a[132:135], v3 offset:33792
  v_exp_f32 v213, v101
  v_exp_f32 v214, v102
  v_mfma_f32_32x32x16_bf16 v[128:143], a[168:171], a[104:107], v[128:143]
  ds_read_b128 a[136:139], v3 offset:34816
  v_exp_f32 v215, v103
  v_mul_f32 v96, v96, v104
  v_mul_f32 v97, v97, v105
  v_mul_f32 v98, v98, v106
  v_mfma_f32_32x32x16_bf16 v[128:143], a[172:175], a[108:111], v[128:143]
  ds_read_b128 a[140:143], v3 offset:35840
  v_mul_f32 v99, v99, v107
  v_mul_f32 v100, v100, v108
  v_mul_f32 v101, v101, v109
  v_mul_f32 v102, v102, v110
  v_mfma_f32_32x32x16_bf16 v[128:143], a[176:179], a[112:115], v[128:143]
  ds_read_b128 a[144:147], v3 offset:36864
  v_mul_f32 v103, v103, v111
  v_add_f32 v208, 1.0, v208
  v_add_f32 v209, 1.0, v209
  v_add_f32 v210, 1.0, v210
  v_add_f32 v211, 1.0, v211
  v_mfma_f32_32x32x16_bf16 v[128:143], a[180:183], a[116:119], v[128:143]
  ds_read_b128 a[148:151], v3 offset:37888
  v_add_f32 v212, 1.0, v212
  v_add_f32 v213, 1.0, v213
  v_add_f32 v214, 1.0, v214
  v_add_f32 v215, 1.0, v215
  v_mfma_f32_32x32x16_bf16 v[128:143], a[184:187], a[120:123], v[128:143]
  ds_read_b128 a[152:155], v3 offset:38912
  v_rcp_f32 v208, v208
  v_rcp_f32 v209, v209
  v_mfma_f32_32x32x16_bf16 v[128:143], a[188:191], a[124:127], v[128:143]
  ds_read_b128 a[156:159], v3 offset:39936
  ds_read_b128 v[16:19], v7 offset:768
  ds_read_b128 v[20:23], v7 offset:800
  v_rcp_f32 v210, v210
  v_rcp_f32 v211, v211
  s_waitcnt lgkmcnt(6)
  v_mfma_f32_32x32x16_bf16 v[144:159], a[128:131], a[0:3], 0
  ds_read_b128 a[160:163], v3 offset:40960
  ds_read_b128 v[24:27], v7 offset:832
  ds_read_b128 v[28:31], v7 offset:864
  v_rcp_f32 v212, v212
  v_rcp_f32 v213, v213
  v_mfma_f32_32x32x16_bf16 v[144:159], a[132:135], a[4:7], v[144:159]
  ds_read_b128 a[164:167], v3 offset:41984
  ds_read_b128 v[32:35], v7 offset:896
  ds_read_b128 v[36:39], v7 offset:928
  v_rcp_f32 v214, v214
  v_rcp_f32 v215, v215
  v_mul_f32 v96, v96, v208
  v_mfma_f32_32x32x16_bf16 v[144:159], a[136:139], a[8:11], v[144:159]
  ds_read_b128 a[168:171], v3 offset:43008
  ds_read_b128 v[40:43], v7 offset:960
  ds_read_b128 v[44:47], v7 offset:992
  v_mul_f32 v97, v97, v209
  v_mul_f32 v98, v98, v210
  v_mul_f32 v99, v99, v211
  v_mul_f32 v100, v100, v212
  v_mul_f32 v101, v101, v213
  v_mfma_f32_32x32x16_bf16 v[144:159], a[140:143], a[12:15], v[144:159]
  ds_read_b128 a[172:175], v3 offset:44032
  v_mul_f32 v102, v102, v214
  v_mul_f32 v103, v103, v215
  v_cvt_pk_bf16_f32 v216, v96, v97
  v_cvt_pk_bf16_f32 v217, v98, v99
  s_waitcnt lgkmcnt(12)
  v_mfma_f32_32x32x16_bf16 v[144:159], a[144:147], a[16:19], v[144:159]
  ds_read_b128 a[176:179], v3 offset:45056
  v_cvt_pk_bf16_f32 v218, v100, v101
  v_cvt_pk_bf16_f32 v219, v102, v103
  buffer_store_dwordx4 v[216:219], v3, s[28:31], s53 offen offset:2048 sc0 sc1
  s_waitcnt lgkmcnt(12)
  v_fmac_f32 v112, v8, v16
  v_fmac_f32 v113, v8, v17
  v_mfma_f32_32x32x16_bf16 v[144:159], a[148:151], a[20:23], v[144:159]
  ds_read_b128 a[180:183], v3 offset:46080
  v_fmac_f32 v114, v8, v18
  v_fmac_f32 v115, v8, v19
  s_waitcnt lgkmcnt(12)
  v_fmac_f32 v116, v8, v20
  v_fmac_f32 v117, v8, v21
  v_fmac_f32 v118, v8, v22
  v_mfma_f32_32x32x16_bf16 v[144:159], a[152:155], a[24:27], v[144:159]
  ds_read_b128 a[184:187], v3 offset:47104
  v_fmac_f32 v119, v8, v23
  s_waitcnt lgkmcnt(11)
  v_fmac_f32 v120, v8, v24
  v_fmac_f32 v121, v8, v25
  v_fmac_f32 v122, v8, v26
  v_fmac_f32 v123, v8, v27
  v_mfma_f32_32x32x16_bf16 v[144:159], a[156:159], a[28:31], v[144:159]
  ds_read_b128 a[188:191], v3 offset:48128
  s_waitcnt lgkmcnt(11)
  v_fmac_f32 v124, v8, v28
  v_fmac_f32 v125, v8, v29
  v_fmac_f32 v126, v8, v30
  v_fmac_f32 v127, v8, v31
  s_waitcnt lgkmcnt(4)
  v_mfma_f32_32x32x16_bf16 v[144:159], a[160:163], a[32:35], v[144:159]
  ds_read_b128 a[128:131], v3 offset:49152
  v_fma_f32 v112, v112, v9, v32
  v_fma_f32 v113, v113, v9, v33
  v_fma_f32 v114, v114, v9, v34
  v_fma_f32 v115, v115, v9, v35
  v_fma_f32 v116, v116, v9, v36
  v_mfma_f32_32x32x16_bf16 v[144:159], a[164:167], a[36:39], v[144:159]
  ds_read_b128 a[132:135], v3 offset:50176
  v_fma_f32 v117, v117, v9, v37
  v_fma_f32 v118, v118, v9, v38
  v_fma_f32 v119, v119, v9, v39
  v_fma_f32 v120, v120, v9, v40
  v_fma_f32 v121, v121, v9, v41
  v_mfma_f32_32x32x16_bf16 v[144:159], a[168:171], a[40:43], v[144:159]
  ds_read_b128 a[136:139], v3 offset:51200
  v_fma_f32 v122, v122, v9, v42
  v_fma_f32 v123, v123, v9, v43
  v_fma_f32 v124, v124, v9, v44
  v_fma_f32 v125, v125, v9, v45
  v_fma_f32 v126, v126, v9, v46
  v_mfma_f32_32x32x16_bf16 v[144:159], a[172:175], a[44:47], v[144:159]
  ds_read_b128 a[140:143], v3 offset:52224
  v_fma_f32 v127, v127, v9, v47
  v_exp_f32 v208, v112
  s_waitcnt lgkmcnt(4)
  v_mfma_f32_32x32x16_bf16 v[144:159], a[176:179], a[48:51], v[144:159]
  ds_read_b128 a[144:147], v3 offset:53248
  v_exp_f32 v209, v113
  v_exp_f32 v210, v114
  v_mfma_f32_32x32x16_bf16 v[144:159], a[180:183], a[52:55], v[144:159]
  ds_read_b128 a[148:151], v3 offset:54272
  v_exp_f32 v211, v115
  v_exp_f32 v212, v116
  v_mfma_f32_32x32x16_bf16 v[144:159], a[184:187], a[56:59], v[144:159]
  ds_read_b128 a[152:155], v3 offset:55296
  v_exp_f32 v213, v117
  v_exp_f32 v214, v118
  v_mfma_f32_32x32x16_bf16 v[144:159], a[188:191], a[60:63], v[144:159]
  ds_read_b128 a[156:159], v3 offset:56320
  v_exp_f32 v215, v119
  v_mul_f32 v112, v112, v120
  v_mul_f32 v113, v113, v121
  s_waitcnt lgkmcnt(4)
  v_mfma_f32_32x32x16_bf16 v[144:159], a[128:131], a[64:67], v[144:159]
  ds_read_b128 a[160:163], v3 offset:57344
  v_mul_f32 v114, v114, v122
  v_mul_f32 v115, v115, v123
  v_mul_f32 v116, v116, v124
  v_mul_f32 v117, v117, v125
  v_mul_f32 v118, v118, v126
  v_mfma_f32_32x32x16_bf16 v[144:159], a[132:135], a[68:71], v[144:159]
  ds_read_b128 a[164:167], v3 offset:58368
  v_mul_f32 v119, v119, v127
  v_add_f32 v208, 1.0, v208
  v_add_f32 v209, 1.0, v209
  v_add_f32 v210, 1.0, v210
  v_add_f32 v211, 1.0, v211
  v_mfma_f32_32x32x16_bf16 v[144:159], a[136:139], a[72:75], v[144:159]
  ds_read_b128 a[168:171], v3 offset:59392
  ds_read_b128 a[172:175], v3 offset:60416
  v_add_f32 v212, 1.0, v212
  v_add_f32 v213, 1.0, v213
  v_add_f32 v214, 1.0, v214
  v_add_f32 v215, 1.0, v215
  v_mfma_f32_32x32x16_bf16 v[144:159], a[140:143], a[76:79], v[144:159]
  ds_read_b128 a[176:179], v3 offset:61440
  ds_read_b128 a[180:183], v3 offset:62464
  v_rcp_f32 v208, v208
  s_waitcnt lgkmcnt(6)
  v_mfma_f32_32x32x16_bf16 v[144:159], a[144:147], a[80:83], v[144:159]
  ds_read_b128 a[184:187], v3 offset:63488
  ds_read_b128 a[188:191], v3 offset:64512
  v_rcp_f32 v209, v209
  v_rcp_f32 v210, v210
  v_mfma_f32_32x32x16_bf16 v[144:159], a[148:151], a[84:87], v[144:159]
  ds_read_b128 v[176:179], v7 offset:1024
  ds_read_b128 v[180:183], v7 offset:1056
  v_rcp_f32 v211, v211
  v_rcp_f32 v212, v212
  v_rcp_f32 v213, v213
  v_mfma_f32_32x32x16_bf16 v[144:159], a[152:155], a[88:91], v[144:159]
  ds_read_b128 v[184:187], v7 offset:1088
  ds_read_b128 v[188:191], v7 offset:1120
  ds_read_b128 v[192:195], v7 offset:1152
  ds_read_b128 v[196:199], v7 offset:1184
  v_rcp_f32 v214, v214
  v_rcp_f32 v215, v215
  v_mul_f32 v112, v112, v208
  v_mul_f32 v113, v113, v209
  v_mfma_f32_32x32x16_bf16 v[144:159], a[156:159], a[92:95], v[144:159]
  s_waitcnt vmcnt(3) lgkmcnt(0)
  s_barrier
  v_mfma_f32_32x32x16_bf16 v[144:159], a[160:163], a[96:99], v[144:159]
  ds_read_b128 a[128:131], v6 offset:0
  ds_read_b128 v[200:203], v7 offset:1216
  ds_read_b128 v[204:207], v7 offset:1248
  v_mul_f32 v114, v114, v210
  v_mul_f32 v115, v115, v211
  v_mul_f32 v116, v116, v212
  v_mul_f32 v117, v117, v213
  v_mul_f32 v118, v118, v214
  v_mfma_f32_32x32x16_bf16 v[144:159], a[164:167], a[100:103], v[144:159]
  ds_read_b128 a[132:135], v6 offset:1024
  v_mul_f32 v119, v119, v215
  v_cvt_pk_bf16_f32 v220, v112, v113
  v_cvt_pk_bf16_f32 v221, v114, v115
  v_cvt_pk_bf16_f32 v222, v116, v117
  v_cvt_pk_bf16_f32 v223, v118, v119
  v_mfma_f32_32x32x16_bf16 v[144:159], a[168:171], a[104:107], v[144:159]
  ds_read_b128 a[136:139], v6 offset:2048
  buffer_store_dwordx4 v[220:223], v3, s[28:31], s53 offen offset:3072 sc0 sc1
  v_fmac_f32 v128, v8, v176
  v_fmac_f32 v129, v8, v177
  v_fmac_f32 v130, v8, v178
  v_fmac_f32 v131, v8, v179
  v_mfma_f32_32x32x16_bf16 v[144:159], a[172:175], a[108:111], v[144:159]
  ds_read_b128 a[140:143], v6 offset:3072
  v_fmac_f32 v132, v8, v180
  v_fmac_f32 v133, v8, v181
  v_fmac_f32 v134, v8, v182
  v_fmac_f32 v135, v8, v183
  v_mfma_f32_32x32x16_bf16 v[144:159], a[176:179], a[112:115], v[144:159]
  ds_read_b128 a[144:147], v6 offset:4096
  v_fmac_f32 v136, v8, v184
  v_fmac_f32 v137, v8, v185
  v_fmac_f32 v138, v8, v186
  v_fmac_f32 v139, v8, v187
  v_fmac_f32 v140, v8, v188
  v_mfma_f32_32x32x16_bf16 v[144:159], a[180:183], a[116:119], v[144:159]
  ds_read_b128 a[148:151], v6 offset:5120
  v_fmac_f32 v141, v8, v189
  v_fmac_f32 v142, v8, v190
  v_fmac_f32 v143, v8, v191
  v_fma_f32 v128, v128, v9, v192
  v_fma_f32 v129, v129, v9, v193
  v_mfma_f32_32x32x16_bf16 v[144:159], a[184:187], a[120:123], v[144:159]
  ds_read_b128 a[152:155], v6 offset:6144
  v_fma_f32 v130, v130, v9, v194
  v_fma_f32 v131, v131, v9, v195
  v_fma_f32 v132, v132, v9, v196
  v_fma_f32 v133, v133, v9, v197
  v_fma_f32 v134, v134, v9, v198
  v_mfma_f32_32x32x16_bf16 v[144:159], a[188:191], a[124:127], v[144:159]
  ds_read_b128 a[156:159], v6 offset:7168
  v_fma_f32 v135, v135, v9, v199
  s_waitcnt lgkmcnt(8)
  v_fma_f32 v136, v136, v9, v200
  v_fma_f32 v137, v137, v9, v201
  v_fma_f32 v138, v138, v9, v202
  s_waitcnt lgkmcnt(4)
  v_mfma_f32_32x32x16_bf16 v[160:175], a[128:131], a[0:3], 0
  ds_read_b128 a[160:163], v6 offset:8192
  v_fma_f32 v139, v139, v9, v203
  v_fma_f32 v140, v140, v9, v204
  v_fma_f32 v141, v141, v9, v205
  v_fma_f32 v142, v142, v9, v206
  v_fma_f32 v143, v143, v9, v207
  v_mfma_f32_32x32x16_bf16 v[160:175], a[132:135], a[4:7], v[160:175]
  ds_read_b128 a[164:167], v6 offset:9216
  v_exp_f32 v208, v128
  v_exp_f32 v209, v129
  v_mfma_f32_32x32x16_bf16 v[160:175], a[136:139], a[8:11], v[160:175]
  ds_read_b128 a[168:171], v6 offset:10240
  v_exp_f32 v210, v130
  v_exp_f32 v211, v131
  v_mfma_f32_32x32x16_bf16 v[160:175], a[140:143], a[12:15], v[160:175]
  ds_read_b128 a[172:175], v6 offset:11264
  v_exp_f32 v212, v132
  v_exp_f32 v213, v133
  s_waitcnt lgkmcnt(4)
  v_mfma_f32_32x32x16_bf16 v[160:175], a[144:147], a[16:19], v[160:175]
  ds_read_b128 a[176:179], v6 offset:12288
  v_exp_f32 v214, v134
  v_exp_f32 v215, v135
  v_mul_f32 v128, v128, v136
  v_mfma_f32_32x32x16_bf16 v[160:175], a[148:151], a[20:23], v[160:175]
  ds_read_b128 a[180:183], v6 offset:13312
  v_mul_f32 v129, v129, v137
  v_mul_f32 v130, v130, v138
  v_mul_f32 v131, v131, v139
  v_mul_f32 v132, v132, v140
  v_mul_f32 v133, v133, v141
  v_mfma_f32_32x32x16_bf16 v[160:175], a[152:155], a[24:27], v[160:175]
  ds_read_b128 a[184:187], v6 offset:14336
  v_mul_f32 v134, v134, v142
  v_mul_f32 v135, v135, v143
  v_add_f32 v208, 1.0, v208
  v_add_f32 v209, 1.0, v209
  v_add_f32 v210, 1.0, v210
  v_mfma_f32_32x32x16_bf16 v[160:175], a[156:159], a[28:31], v[160:175]
  ds_read_b128 a[188:191], v6 offset:15360
  v_add_f32 v211, 1.0, v211
  v_add_f32 v212, 1.0, v212
  v_add_f32 v213, 1.0, v213
  v_add_f32 v214, 1.0, v214
  s_waitcnt lgkmcnt(4)
  v_mfma_f32_32x32x16_bf16 v[160:175], a[160:163], a[32:35], v[160:175]
  ds_read_b128 a[128:131], v6 offset:16384
  v_add_f32 v215, 1.0, v215
  v_rcp_f32 v208, v208
  v_rcp_f32 v209, v209
  v_mfma_f32_32x32x16_bf16 v[160:175], a[164:167], a[36:39], v[160:175]
  ds_read_b128 a[132:135], v6 offset:17408
  ds_read_b128 v[16:19], v7 offset:1280
  ds_read_b128 v[20:23], v7 offset:1312
  v_rcp_f32 v210, v210
  v_rcp_f32 v211, v211
  v_mfma_f32_32x32x16_bf16 v[160:175], a[168:171], a[40:43], v[160:175]
  ds_read_b128 a[136:139], v6 offset:18432
  ds_read_b128 v[24:27], v7 offset:1344
  ds_read_b128 v[28:31], v7 offset:1376
  v_rcp_f32 v212, v212
  v_rcp_f32 v213, v213
  v_mfma_f32_32x32x16_bf16 v[160:175], a[172:175], a[44:47], v[160:175]
  ds_read_b128 a[140:143], v6 offset:19456
  ds_read_b128 v[32:35], v7 offset:1408
  ds_read_b128 v[36:39], v7 offset:1440
  v_rcp_f32 v214, v214
  v_rcp_f32 v215, v215
  s_waitcnt lgkmcnt(10)
  v_mfma_f32_32x32x16_bf16 v[160:175], a[176:179], a[48:51], v[160:175]
  ds_read_b128 a[144:147], v6 offset:20480
  ds_read_b128 v[40:43], v7 offset:1472
  ds_read_b128 v[44:47], v7 offset:1504
  v_mul_f32 v128, v128, v208
  v_mul_f32 v129, v129, v209
  v_mul_f32 v130, v130, v210
  v_mul_f32 v131, v131, v211
  v_mul_f32 v132, v132, v212
  v_mfma_f32_32x32x16_bf16 v[160:175], a[180:183], a[52:55], v[160:175]
  ds_read_b128 a[148:151], v6 offset:21504
  v_mul_f32 v133, v133, v213
  v_mul_f32 v134, v134, v214
  v_mul_f32 v135, v135, v215
  v_cvt_pk_bf16_f32 v216, v128, v129
  v_cvt_pk_bf16_f32 v217, v130, v131
  v_mfma_f32_32x32x16_bf16 v[160:175], a[184:187], a[56:59], v[160:175]
  ds_read_b128 a[152:155], v6 offset:22528
  v_cvt_pk_bf16_f32 v218, v132, v133
  v_cvt_pk_bf16_f32 v219, v134, v135
  buffer_store_dwordx4 v[216:219], v3, s[28:31], s54 offen offset:0 sc0 sc1
  s_waitcnt lgkmcnt(12)
  v_fmac_f32 v144, v8, v16
  v_fmac_f32 v145, v8, v17
  v_mfma_f32_32x32x16_bf16 v[160:175], a[188:191], a[60:63], v[160:175]
  ds_read_b128 a[156:159], v6 offset:23552
  v_fmac_f32 v146, v8, v18
  v_fmac_f32 v147, v8, v19
  s_waitcnt lgkmcnt(12)
  v_fmac_f32 v148, v8, v20
  v_fmac_f32 v149, v8, v21
  s_waitcnt lgkmcnt(8)
  v_mfma_f32_32x32x16_bf16 v[160:175], a[128:131], a[64:67], v[160:175]
  ds_read_b128 a[160:163], v6 offset:24576
  v_fmac_f32 v150, v8, v22
  v_fmac_f32 v151, v8, v23
  v_fmac_f32 v152, v8, v24
  v_fmac_f32 v153, v8, v25
  v_fmac_f32 v154, v8, v26
  v_mfma_f32_32x32x16_bf16 v[160:175], a[132:135], a[68:71], v[160:175]
  ds_read_b128 a[164:167], v6 offset:25600
  v_fmac_f32 v155, v8, v27
  v_fmac_f32 v156, v8, v28
  v_fmac_f32 v157, v8, v29
  v_fmac_f32 v158, v8, v30
  v_fmac_f32 v159, v8, v31
  v_mfma_f32_32x32x16_bf16 v[160:175], a[136:139], a[72:75], v[160:175]
  ds_read_b128 a[168:171], v6 offset:26624
  s_waitcnt lgkmcnt(10)
  v_fma_f32 v144, v144, v9, v32
  v_fma_f32 v145, v145, v9, v33
  v_fma_f32 v146, v146, v9, v34
  v_fma_f32 v147, v147, v9, v35
  s_waitcnt lgkmcnt(9)
  v_fma_f32 v148, v148, v9, v36
  v_mfma_f32_32x32x16_bf16 v[160:175], a[140:143], a[76:79], v[160:175]
  ds_read_b128 a[172:175], v6 offset:27648
  v_fma_f32 v149, v149, v9, v37
  v_fma_f32 v150, v150, v9, v38
  v_fma_f32 v151, v151, v9, v39
  s_waitcnt lgkmcnt(8)
  v_fma_f32 v152, v152, v9, v40
  s_waitcnt lgkmcnt(4)
  v_mfma_f32_32x32x16_bf16 v[160:175], a[144:147], a[80:83], v[160:175]
  ds_read_b128 a[176:179], v6 offset:28672
  v_fma_f32 v153, v153, v9, v41
  v_fma_f32 v154, v154, v9, v42
  v_fma_f32 v155, v155, v9, v43
  v_fma_f32 v156, v156, v9, v44
  v_fma_f32 v157, v157, v9, v45
  v_mfma_f32_32x32x16_bf16 v[160:175], a[148:151], a[84:87], v[160:175]
  ds_read_b128 a[180:183], v6 offset:29696
  v_fma_f32 v158, v158, v9, v46
  v_fma_f32 v159, v159, v9, v47
  v_exp_f32 v208, v144
  v_mfma_f32_32x32x16_bf16 v[160:175], a[152:155], a[88:91], v[160:175]
  ds_read_b128 a[184:187], v6 offset:30720
  v_exp_f32 v209, v145
  v_exp_f32 v210, v146
  v_mfma_f32_32x32x16_bf16 v[160:175], a[156:159], a[92:95], v[160:175]
  ds_read_b128 a[188:191], v6 offset:31744
  v_exp_f32 v211, v147
  v_exp_f32 v212, v148
  s_waitcnt lgkmcnt(4)
  v_mfma_f32_32x32x16_bf16 v[160:175], a[160:163], a[96:99], v[160:175]
  v_exp_f32 v213, v149
  v_exp_f32 v214, v150
  v_exp_f32 v215, v151
  v_mfma_f32_32x32x16_bf16 v[160:175], a[164:167], a[100:103], v[160:175]
  v_mul_f32 v144, v144, v152
  v_mul_f32 v145, v145, v153
  v_mul_f32 v146, v146, v154
  v_mul_f32 v147, v147, v155
  v_mul_f32 v148, v148, v156
  v_mul_f32 v149, v149, v157
  v_mfma_f32_32x32x16_bf16 v[160:175], a[168:171], a[104:107], v[160:175]
  v_mul_f32 v150, v150, v158
  v_mul_f32 v151, v151, v159
  v_add_f32 v208, 1.0, v208
  v_add_f32 v209, 1.0, v209
  v_add_f32 v210, 1.0, v210
  v_add_f32 v211, 1.0, v211
  v_mfma_f32_32x32x16_bf16 v[160:175], a[172:175], a[108:111], v[160:175]
  v_add_f32 v212, 1.0, v212
  v_add_f32 v213, 1.0, v213
  v_add_f32 v214, 1.0, v214
  v_add_f32 v215, 1.0, v215
  s_waitcnt lgkmcnt(0)
  v_mfma_f32_32x32x16_bf16 v[160:175], a[176:179], a[112:115], v[160:175]
  v_rcp_f32 v208, v208
  v_rcp_f32 v209, v209
  v_rcp_f32 v210, v210
  v_mfma_f32_32x32x16_bf16 v[160:175], a[180:183], a[116:119], v[160:175]
  v_rcp_f32 v211, v211
  v_rcp_f32 v212, v212
  v_rcp_f32 v213, v213
  v_mfma_f32_32x32x16_bf16 v[160:175], a[184:187], a[120:123], v[160:175]
  v_rcp_f32 v214, v214
  v_rcp_f32 v215, v215
  v_mul_f32 v144, v144, v208
  v_mul_f32 v145, v145, v209
  v_mfma_f32_32x32x16_bf16 v[160:175], a[188:191], a[124:127], v[160:175]
  v_mul_f32 v146, v146, v210
  v_mul_f32 v147, v147, v211
  v_mul_f32 v148, v148, v212
  v_mul_f32 v149, v149, v213
  v_mul_f32 v150, v150, v214
  v_mul_f32 v151, v151, v215
  v_cvt_pk_bf16_f32 v220, v144, v145
  v_cvt_pk_bf16_f32 v221, v146, v147
  v_cvt_pk_bf16_f32 v222, v148, v149
  v_cvt_pk_bf16_f32 v223, v150, v151
  buffer_store_dwordx4 v[220:223], v3, s[28:31], s54 offen offset:1024 sc0 sc1
  ds_read_b128 v[176:179], v7 offset:1536
  ds_read_b128 v[180:183], v7 offset:1568
  ds_read_b128 v[184:187], v7 offset:1600
  ds_read_b128 v[188:191], v7 offset:1632
  ds_read_b128 v[192:195], v7 offset:1664
  ds_read_b128 v[196:199], v7 offset:1696
  ds_read_b128 v[200:203], v7 offset:1728
  ds_read_b128 v[204:207], v7 offset:1760
  s_nop 3
  s_waitcnt lgkmcnt(7)
  v_fmac_f32 v160, v8, v176
  v_fmac_f32 v161, v8, v177
  v_fmac_f32 v162, v8, v178
  v_fmac_f32 v163, v8, v179
  s_waitcnt lgkmcnt(6)
  v_fmac_f32 v164, v8, v180
  v_fmac_f32 v165, v8, v181
  v_fmac_f32 v166, v8, v182
  v_fmac_f32 v167, v8, v183
  s_waitcnt lgkmcnt(5)
  v_fmac_f32 v168, v8, v184
  v_fmac_f32 v169, v8, v185
  v_fmac_f32 v170, v8, v186
  v_fmac_f32 v171, v8, v187
  s_waitcnt lgkmcnt(4)
  v_fmac_f32 v172, v8, v188
  v_fmac_f32 v173, v8, v189
  v_fmac_f32 v174, v8, v190
  v_fmac_f32 v175, v8, v191
  s_waitcnt lgkmcnt(3)
  v_fma_f32 v160, v160, v9, v192
  v_fma_f32 v161, v161, v9, v193
  v_fma_f32 v162, v162, v9, v194
  v_fma_f32 v163, v163, v9, v195
  s_waitcnt lgkmcnt(2)
  v_fma_f32 v164, v164, v9, v196
  v_fma_f32 v165, v165, v9, v197
  v_fma_f32 v166, v166, v9, v198
  v_fma_f32 v167, v167, v9, v199
  s_waitcnt lgkmcnt(1)
  v_fma_f32 v168, v168, v9, v200
  v_fma_f32 v169, v169, v9, v201
  v_fma_f32 v170, v170, v9, v202
  v_fma_f32 v171, v171, v9, v203
  s_waitcnt lgkmcnt(0)
  v_fma_f32 v172, v172, v9, v204
  v_fma_f32 v173, v173, v9, v205
  v_fma_f32 v174, v174, v9, v206
  v_fma_f32 v175, v175, v9, v207
  v_exp_f32 v208, v160
  v_exp_f32 v209, v161
  v_exp_f32 v210, v162
  v_exp_f32 v211, v163
  v_exp_f32 v212, v164
  v_exp_f32 v213, v165
  v_exp_f32 v214, v166
  v_exp_f32 v215, v167
  v_mul_f32 v160, v160, v168
  v_mul_f32 v161, v161, v169
  v_mul_f32 v162, v162, v170
  v_mul_f32 v163, v163, v171
  v_mul_f32 v164, v164, v172
  v_mul_f32 v165, v165, v173
  v_mul_f32 v166, v166, v174
  v_mul_f32 v167, v167, v175
  v_add_f32 v208, 1.0, v208
  v_add_f32 v209, 1.0, v209
  v_add_f32 v210, 1.0, v210
  v_add_f32 v211, 1.0, v211
  v_add_f32 v212, 1.0, v212
  v_add_f32 v213, 1.0, v213
  v_add_f32 v214, 1.0, v214
  v_add_f32 v215, 1.0, v215
  v_rcp_f32 v208, v208
  v_rcp_f32 v209, v209
  v_rcp_f32 v210, v210
  v_rcp_f32 v211, v211
  v_rcp_f32 v212, v212
  v_rcp_f32 v213, v213
  v_rcp_f32 v214, v214
  v_rcp_f32 v215, v215
  v_mul_f32 v160, v160, v208
  v_mul_f32 v161, v161, v209
  v_mul_f32 v162, v162, v210
  v_mul_f32 v163, v163, v211
  v_mul_f32 v164, v164, v212
  v_mul_f32 v165, v165, v213
  v_mul_f32 v166, v166, v214
  v_mul_f32 v167, v167, v215
  v_cvt_pk_bf16_f32 v216, v160, v161
  v_cvt_pk_bf16_f32 v217, v162, v163
  v_cvt_pk_bf16_f32 v218, v164, v165
  v_cvt_pk_bf16_f32 v219, v166, v167
  buffer_store_dwordx4 v[216:219], v3, s[28:31], s54 offen offset:2048 sc0 sc1
  s_mov_b64 exec, -1
  s_waitcnt vmcnt(0) lgkmcnt(0)
  s_barrier
  s_cmp_lg_u32 s40, 0
  s_cbranch_scc1 attn_kernel_noflag13
  s_lshl_b32 s80, s41, 7
  s_lshl_b32 s81, s42, 2
  s_add_u32 s80, s80, s81
  s_add_u32 s80, s80, 5120
  v_mov_b32 v252, 1
  v_mov_b32 v253, 0
  s_mov_b64 exec, 1
  buffer_store_dword v252, v253, s[76:79], s80 offen sc0 sc1
  s_mov_b64 exec, -1
attn_kernel_noflag13:
phase3:
  v_mbcnt_lo_u32_b32 v0, -1, 0
  v_mbcnt_hi_u32_b32 v0, -1, v0
  s_lshl_b32 s80, s40, 6
  v_add_u32 v0, s80, v0
  s_load_dwordx2 s[8:9], s[0:1], 104
  s_load_dwordx2 s[10:11], s[0:1], 88
  v_and_b32 v1, 63, v0
  v_lshrrev_b32 v2, 6, v0
  v_lshlrev_b32 v3, 4, v1
  v_readfirstlane_b32 s40, v2
  s_and_b32 s41, s2, 7
  s_lshl_b32 s41, s41, 2
  s_bfe_u32 s42, s2, 0x20003
  s_add_u32 s41, s41, s42
  s_lshr_b32 s42, s2, 5
  s_and_b32 s50, s40, 1
  s_lshr_b32 s51, s40, 1
  s_lshl_b32 s52, s41, 1
  s_add_u32 s52, s52, s51
  s_mul_i32 s45, s52, 114688
  s_xor_b32 s46, s52, 1
  s_mul_i32 s46, s46, 114688
  s_mul_i32 s47, s42, 229376
  s_lshl_b32 s43, s50, 10
  v_add_u32 v4, s43, v3
  v_xor_b32 v5, 1024, v4
  s_and_b32 s59, s2, 7
  s_mul_i32 s59, s59, 12
  s_add_u32 s59, s59, s40
  s_waitcnt lgkmcnt(0)
  s_add_u32 s12, s8, 0x2800000
  s_addc_u32 s13, s9, 0
  s_and_b32 s13, s13, 0xffff
  s_mov_b32 s14, 0x1c0000
  s_mov_b32 s15, 0x20000
  s_add_u32 s20, s8, 0x800000
  s_addc_u32 s21, s9, 0
  s_and_b32 s21, s21, 0xffff
  s_mov_b32 s22, 0x700000
  s_mov_b32 s23, 0x20000
  s_add_u32 s24, s8, 0x20000
  s_addc_u32 s25, s9, 0
  s_and_b32 s25, s25, 0xffff
  s_mov_b32 s26, 0x3000
  s_mov_b32 s27, 0x20000
  s_mov_b32 s72, s59
  s_lshl_b32 s60, s59, 10
  s_add_u32 s61, s60, s45
  s_add_u32 s62, s60, s46
  s_lshl_b32 s60, s59, 11
  s_add_u32 s63, s60, s47
  buffer_load_dwordx4 a[0:3], v4, s[12:15], s63 offen sc0 sc1
  s_add_u32 s59, s59, 4
  s_sub_u32 s60, s59, 112
  s_cselect_b32 s59, s59, s60
  buffer_load_dwordx4 a[4:7], v5, s[12:15], s63 offen sc0 sc1
  s_lshl_b32 s60, s59, 10
  s_add_u32 s61, s60, s45
  s_add_u32 s62, s60, s46
  s_lshl_b32 s60, s59, 11
  s_add_u32 s63, s60, s47
  buffer_load_dwordx4 a[16:19], v4, s[12:15], s63 offen sc0 sc1
  s_add_u32 s59, s59, 4
  s_sub_u32 s60, s59, 112
  s_cselect_b32 s59, s59, s60
  buffer_load_dwordx4 a[20:23], v5, s[12:15], s63 offen sc0 sc1
  s_add_u32 s28, s8, 0x300000
  s_addc_u32 s29, s9, 0
  s_and_b32 s29, s29, 0xffff
  s_mov_b32 s30, 0x200000
  s_mov_b32 s31, 0x20000
  v_lshrrev_b32 v15, 5, v1
  v_lshlrev_b32 v15, 5, v15
  s_lshl_b32 s53, s42, 8
  s_lshl_b32 s54, s50, 7
  s_add_u32 s53, s53, s54
  s_add_u32 s53, s53, 10240
  v_and_b32 v40, 31, v1
  v_lshlrev_b32 v40, 10, v40
  v_lshrrev_b32 v41, 5, v1
  v_lshl_add_u32 v40, v41, 4, v40
  s_lshl_b32 s55, s52, 15
  s_lshl_b32 s56, s42, 7
  s_add_u32 s55, s55, s56
  s_lshl_b32 s56, s50, 6
  s_add_u32 s55, s55, s56
  s_lshl_b32 s56, s52, 15
  s_lshl_b32 s57, s42, 12
  s_add_u32 s56, s56, s57
  s_lshl_b32 s57, s50, 11
  s_add_u32 s56, s56, s57
  s_xor_b32 s58, s40, 1
  s_mul_i32 s58, s58, 12288
  v_add_u32 v9, s58, v3
  s_xor_b32 s58, s40, 2
  s_mul_i32 s58, s58, 12288
  v_add_u32 v10, s58, v3
  s_xor_b32 s58, s40, 3
  s_mul_i32 s58, s58, 12288
  v_add_u32 v11, s58, v3
  s_mul_i32 s58, s40, 12288
  v_add_u32 v8, s58, v3
  s_lshl_b32 s60, s59, 10
  s_add_u32 s61, s60, s45
  s_add_u32 s62, s60, s46
  s_lshl_b32 s60, s59, 11
  s_add_u32 s63, s60, s47
  buffer_load_dwordx4 a[32:35], v4, s[12:15], s63 offen sc0 sc1
  s_add_u32 s59, s59, 4
  s_sub_u32 s60, s59, 112
  s_cselect_b32 s59, s59, s60
  buffer_load_dwordx4 a[36:39], v5, s[12:15], s63 offen sc0 sc1
  s_lshl_b32 s60, s59, 10
  s_add_u32 s61, s60, s45
  s_add_u32 s62, s60, s46
  s_lshl_b32 s60, s59, 11
  s_add_u32 s63, s60, s47
  buffer_load_dwordx4 a[48:51], v4, s[12:15], s63 offen sc0 sc1
  s_add_u32 s59, s59, 4
  s_sub_u32 s60, s59, 112
  s_cselect_b32 s59, s59, s60
  buffer_load_dwordx4 a[52:55], v5, s[12:15], s63 offen sc0 sc1
  s_lshl_b32 s60, s59, 10
  s_add_u32 s61, s60, s45
  s_add_u32 s62, s60, s46
  s_lshl_b32 s60, s59, 11
  s_add_u32 s63, s60, s47
  buffer_load_dwordx4 a[64:67], v4, s[12:15], s63 offen sc0 sc1
  s_add_u32 s59, s59, 4
  s_sub_u32 s60, s59, 112
  s_cselect_b32 s59, s59, s60
  buffer_load_dwordx4 a[68:71], v5, s[12:15], s63 offen sc0 sc1
  s_lshl_b32 s60, s59, 10
  s_add_u32 s61, s60, s45
  s_add_u32 s62, s60, s46
  s_lshl_b32 s60, s59, 11
  s_add_u32 s63, s60, s47
  buffer_load_dwordx4 a[80:83], v4, s[12:15], s63 offen sc0 sc1
  s_add_u32 s59, s59, 4
  s_sub_u32 s60, s59, 112
  s_cselect_b32 s59, s59, s60
  buffer_load_dwordx4 a[84:87], v5, s[12:15], s63 offen sc0 sc1
  s_lshl_b32 s60, s59, 10
  s_add_u32 s61, s60, s45
  s_add_u32 s62, s60, s46
  s_lshl_b32 s60, s59, 11
  s_add_u32 s63, s60, s47
  buffer_load_dwordx4 a[96:99], v4, s[12:15], s63 offen sc0 sc1
  s_add_u32 s59, s59, 4
  s_sub_u32 s60, s59, 112
  s_cselect_b32 s59, s59, s60
  buffer_load_dwordx4 a[100:103], v5, s[12:15], s63 offen sc0 sc1
  s_lshl_b32 s60, s59, 10
  s_add_u32 s61, s60, s45
  s_add_u32 s62, s60, s46
  s_lshl_b32 s60, s59, 11
  s_add_u32 s63, s60, s47
  buffer_load_dwordx4 a[112:115], v4, s[12:15], s63 offen sc0 sc1
  s_add_u32 s59, s59, 4
  s_sub_u32 s60, s59, 112
  s_cselect_b32 s59, s59, s60
  buffer_load_dwordx4 a[116:119], v5, s[12:15], s63 offen sc0 sc1
  s_mov_b32 s59, s72
  s_cmp_lg_u32 s40, 0
  s_cbranch_scc1 attn_kernel_nopoll14
  s_mov_b32 s80, 0x40000
  s_lshr_b32 s81, s41, 1
  s_lshl_b32 s81, s81, 7
  s_add_u32 s81, s81, 5120
  v_and_b32 v253, 15, v1
  v_lshlrev_b32 v253, 2, v253
attn_kernel_poll15:
  buffer_load_dword v252, v253, s[76:79], s81 offen sc0 sc1
  s_waitcnt vmcnt(0)
  v_cmp_eq_u32 vcc, 0, v252
  s_cbranch_vccz attn_kernel_nopoll14
  s_sub_u32 s80, s80, 1
  s_cbranch_scc1 attn_kernel_nopoll14
  s_sleep 1
  s_branch attn_kernel_poll15
attn_kernel_nopoll14:
  s_barrier
  s_lshl_b32 s60, s59, 10
  s_add_u32 s61, s60, s45
  s_add_u32 s62, s60, s46
  s_lshl_b32 s60, s59, 11
  s_add_u32 s63, s60, s47
  buffer_load_dwordx4 a[8:11], v3, s[20:23], s61 offen sc0 sc1
  s_add_u32 s59, s59, 4
  s_sub_u32 s60, s59, 112
  s_cselect_b32 s59, s59, s60
  buffer_load_dwordx4 a[12:15], v3, s[20:23], s62 offen sc0 sc1
  s_lshl_b32 s60, s59, 10
  s_add_u32 s61, s60, s45
  s_add_u32 s62, s60, s46
  s_lshl_b32 s60, s59, 11
  s_add_u32 s63, s60, s47
  buffer_load_dwordx4 a[24:27], v3, s[20:23], s61 offen sc0 sc1
  s_add_u32 s59, s59, 4
  s_sub_u32 s60, s59, 112
  s_cselect_b32 s59, s59, s60
  buffer_load_dwordx4 a[28:31], v3, s[20:23], s62 offen sc0 sc1
  s_lshl_b32 s60, s59, 10
  s_add_u32 s61, s60, s45
  s_add_u32 s62, s60, s46
  s_lshl_b32 s60, s59, 11
  s_add_u32 s63, s60, s47
  buffer_load_dwordx4 a[40:43], v3, s[20:23], s61 offen sc0 sc1
  s_add_u32 s59, s59, 4
  s_sub_u32 s60, s59, 112
  s_cselect_b32 s59, s59, s60
  buffer_load_dwordx4 a[44:47], v3, s[20:23], s62 offen sc0 sc1
  s_lshl_b32 s60, s59, 10
  s_add_u32 s61, s60, s45
  s_add_u32 s62, s60, s46
  s_lshl_b32 s60, s59, 11
  s_add_u32 s63, s60, s47
  buffer_load_dwordx4 a[56:59], v3, s[20:23], s61 offen sc0 sc1
  s_add_u32 s59, s59, 4
  s_sub_u32 s60, s59, 112
  s_cselect_b32 s59, s59, s60
  buffer_load_dwordx4 a[60:63], v3, s[20:23], s62 offen sc0 sc1
  s_lshl_b32 s60, s59, 10
  s_add_u32 s61, s60, s45
  s_add_u32 s62, s60, s46
  s_lshl_b32 s60, s59, 11
  s_add_u32 s63, s60, s47
  buffer_load_dwordx4 a[72:75], v3, s[20:23], s61 offen sc0 sc1
  s_add_u32 s59, s59, 4
  s_sub_u32 s60, s59, 112
  s_cselect_b32 s59, s59, s60
  buffer_load_dwordx4 a[76:79], v3, s[20:23], s62 offen sc0 sc1
  s_lshl_b32 s60, s59, 10
  s_add_u32 s61, s60, s45
  s_add_u32 s62, s60, s46
  s_lshl_b32 s60, s59, 11
  s_add_u32 s63, s60, s47
  buffer_load_dwordx4 a[88:91], v3, s[20:23], s61 offen sc0 sc1
  s_add_u32 s59, s59, 4
  s_sub_u32 s60, s59, 112
  s_cselect_b32 s59, s59, s60
  buffer_load_dwordx4 a[92:95], v3, s[20:23], s62 offen sc0 sc1
  s_lshl_b32 s60, s59, 10
  s_add_u32 s61, s60, s45
  s_add_u32 s62, s60, s46
  s_lshl_b32 s60, s59, 11
  s_add_u32 s63, s60, s47
  buffer_load_dwordx4 a[104:107], v3, s[20:23], s61 offen sc0 sc1
  s_add_u32 s59, s59, 4
  s_sub_u32 s60, s59, 112
  s_cselect_b32 s59, s59, s60
  buffer_load_dwordx4 a[108:111], v3, s[20:23], s62 offen sc0 sc1
  s_lshl_b32 s60, s59, 10
  s_add_u32 s61, s60, s45
  s_add_u32 s62, s60, s46
  s_lshl_b32 s60, s59, 11
  s_add_u32 s63, s60, s47
  buffer_load_dwordx4 a[120:123], v3, s[20:23], s61 offen sc0 sc1
  s_add_u32 s59, s59, 4
  s_sub_u32 s60, s59, 112
  s_cselect_b32 s59, s59, s60
  buffer_load_dwordx4 a[124:127], v3, s[20:23], s62 offen sc0 sc1
  s_waitcnt vmcnt(15)
  v_mfma_f32_32x32x16_bf16 v[64:79], a[0:3], a[8:11], 0
  v_mfma_f32_32x32x16_bf16 v[80:95], a[4:7], a[8:11], 0
  s_waitcnt vmcnt(14)
  v_mfma_f32_32x32x16_bf16 v[112:127], a[4:7], a[12:15], 0
  v_mfma_f32_32x32x16_bf16 v[96:111], a[0:3], a[12:15], 0
  s_lshl_b32 s60, s59, 10
  s_add_u32 s61, s60, s45
  s_add_u32 s62, s60, s46
  s_lshl_b32 s60, s59, 11
  s_add_u32 s63, s60, s47
  buffer_load_dwordx4 a[8:11], v3, s[20:23], s61 offen sc0 sc1
  buffer_load_dwordx4 a[0:3], v4, s[12:15], s63 offen sc0 sc1
  s_add_u32 s59, s59, 4
  s_sub_u32 s60, s59, 112
  s_cselect_b32 s59, s59, s60
  buffer_load_dwordx4 a[4:7], v5, s[12:15], s63 offen sc0 sc1
  buffer_load_dwordx4 a[12:15], v3, s[20:23], s62 offen sc0 sc1
  s_waitcnt vmcnt(17)
  v_mfma_f32_32x32x16_bf16 v[64:79], a[16:19], a[24:27], v[64:79]
  v_mfma_f32_32x32x16_bf16 v[80:95], a[20:23], a[24:27], v[80:95]
  s_waitcnt vmcnt(16)
  v_mfma_f32_32x32x16_bf16 v[112:127], a[20:23], a[28:31], v[112:127]
  v_mfma_f32_32x32x16_bf16 v[96:111], a[16:19], a[28:31], v[96:111]
  s_lshl_b32 s60, s59, 10
  s_add_u32 s61, s60, s45
  s_add_u32 s62, s60, s46
  s_lshl_b32 s60, s59, 11
  s_add_u32 s63, s60, s47
  buffer_load_dwordx4 a[24:27], v3, s[20:23], s61 offen sc0 sc1
  buffer_load_dwordx4 a[16:19], v4, s[12:15], s63 offen sc0 sc1
  s_add_u32 s59, s59, 4
  s_sub_u32 s60, s59, 112
  s_cselect_b32 s59, s59, s60
  buffer_load_dwordx4 a[20:23], v5, s[12:15], s63 offen sc0 sc1
  buffer_load_dwordx4 a[28:31], v3, s[20:23], s62 offen sc0 sc1
  s_waitcnt vmcnt(19)
  v_mfma_f32_32x32x16_bf16 v[64:79], a[32:35], a[40:43], v[64:79]
  v_mfma_f32_32x32x16_bf16 v[80:95], a[36:39], a[40:43], v[80:95]
  s_waitcnt vmcnt(18)
  v_mfma_f32_32x32x16_bf16 v[112:127], a[36:39], a[44:47], v[112:127]
  v_mfma_f32_32x32x16_bf16 v[96:111], a[32:35], a[44:47], v[96:111]
  s_lshl_b32 s60, s59, 10
  s_add_u32 s61, s60, s45
  s_add_u32 s62, s60, s46
  s_lshl_b32 s60, s59, 11
  s_add_u32 s63, s60, s47
  buffer_load_dwordx4 a[40:43], v3, s[20:23], s61 offen sc0 sc1
  buffer_load_dwordx4 a[32:35], v4, s[12:15], s63 offen sc0 sc1
  s_add_u32 s59, s59, 4
  s_sub_u32 s60, s59, 112
  s_cselect_b32 s59, s59, s60
  buffer_load_dwordx4 a[36:39], v5, s[12:15], s63 offen sc0 sc1
  buffer_load_dwordx4 a[44:47], v3, s[20:23], s62 offen sc0 sc1
  s_waitcnt vmcnt(21)
  v_mfma_f32_32x32x16_bf16 v[64:79], a[48:51], a[56:59], v[64:79]
  v_mfma_f32_32x32x16_bf16 v[80:95], a[52:55], a[56:59], v[80:95]
  s_waitcnt vmcnt(20)
  v_mfma_f32_32x32x16_bf16 v[112:127], a[52:55], a[60:63], v[112:127]
  v_mfma_f32_32x32x16_bf16 v[96:111], a[48:51], a[60:63], v[96:111]
  s_lshl_b32 s60, s59, 10
  s_add_u32 s61, s60, s45
  s_add_u32 s62, s60, s46
  s_lshl_b32 s60, s59, 11
  s_add_u32 s63, s60, s47
  buffer_load_dwordx4 a[56:59], v3, s[20:23], s61 offen sc0 sc1
  buffer_load_dwordx4 a[48:51], v4, s[12:15], s63 offen sc0 sc1
  s_add_u32 s59, s59, 4
  s_sub_u32 s60, s59, 112
  s_cselect_b32 s59, s59, s60
  buffer_load_dwordx4 a[52:55], v5, s[12:15], s63 offen sc0 sc1
  buffer_load_dwordx4 a[60:63], v3, s[20:23], s62 offen sc0 sc1
  s_waitcnt vmcnt(23)
  v_mfma_f32_32x32x16_bf16 v[64:79], a[64:67], a[72:75], v[64:79]
  v_mfma_f32_32x32x16_bf16 v[80:95], a[68:71], a[72:75], v[80:95]
  s_waitcnt vmcnt(22)
  v_mfma_f32_32x32x16_bf16 v[112:127], a[68:71], a[76:79], v[112:127]
  v_mfma_f32_32x32x16_bf16 v[96:111], a[64:67], a[76:79], v[96:111]
  s_lshl_b32 s60, s59, 10
  s_add_u32 s61, s60, s45
  s_add_u32 s62, s60, s46
  s_lshl_b32 s60, s59, 11
  s_add_u32 s63, s60, s47
  buffer_load_dwordx4 a[72:75], v3, s[20:23], s61 offen sc0 sc1
  buffer_load_dwordx4 a[64:67], v4, s[12:15], s63 offen sc0 sc1
  s_add_u32 s59, s59, 4
  s_sub_u32 s60, s59, 112
  s_cselect_b32 s59, s59, s60
  buffer_load_dwordx4 a[68:71], v5, s[12:15], s63 offen sc0 sc1
  buffer_load_dwordx4 a[76:79], v3, s[20:23], s62 offen sc0 sc1
  s_waitcnt vmcnt(25)
  v_mfma_f32_32x32x16_bf16 v[64:79], a[80:83], a[88:91], v[64:79]
  v_mfma_f32_32x32x16_bf16 v[80:95], a[84:87], a[88:91], v[80:95]
  s_waitcnt vmcnt(24)
  v_mfma_f32_32x32x16_bf16 v[112:127], a[84:87], a[92:95], v[112:127]
  v_mfma_f32_32x32x16_bf16 v[96:111], a[80:83], a[92:95], v[96:111]
  s_lshl_b32 s60, s59, 10
  s_add_u32 s61, s60, s45
  s_add_u32 s62, s60, s46
  s_lshl_b32 s60, s59, 11
  s_add_u32 s63, s60, s47
  buffer_load_dwordx4 a[88:91], v3, s[20:23], s61 offen sc0 sc1
  buffer_load_dwordx4 a[80:83], v4, s[12:15], s63 offen sc0 sc1
  s_add_u32 s59, s59, 4
  s_sub_u32 s60, s59, 112
  s_cselect_b32 s59, s59, s60
  buffer_load_dwordx4 a[84:87], v5, s[12:15], s63 offen sc0 sc1
  buffer_load_dwordx4 a[92:95], v3, s[20:23], s62 offen sc0 sc1
  s_waitcnt vmcnt(27)
  v_mfma_f32_32x32x16_bf16 v[64:79], a[96:99], a[104:107], v[64:79]
  v_mfma_f32_32x32x16_bf16 v[80:95], a[100:103], a[104:107], v[80:95]
  s_waitcnt vmcnt(26)
  v_mfma_f32_32x32x16_bf16 v[112:127], a[100:103], a[108:111], v[112:127]
  v_mfma_f32_32x32x16_bf16 v[96:111], a[96:99], a[108:111], v[96:111]
  s_lshl_b32 s60, s59, 10
  s_add_u32 s61, s60, s45
  s_add_u32 s62, s60, s46
  s_lshl_b32 s60, s59, 11
  s_add_u32 s63, s60, s47
  buffer_load_dwordx4 a[104:107], v3, s[20:23], s61 offen sc0 sc1
  buffer_load_dwordx4 a[96:99], v4, s[12:15], s63 offen sc0 sc1
  s_add_u32 s59, s59, 4
  s_sub_u32 s60, s59, 112
  s_cselect_b32 s59, s59, s60
  buffer_load_dwordx4 a[100:103], v5, s[12:15], s63 offen sc0 sc1
  buffer_load_dwordx4 a[108:111], v3, s[20:23], s62 offen sc0 sc1
  s_waitcnt vmcnt(29)
  v_mfma_f32_32x32x16_bf16 v[64:79], a[112:115], a[120:123], v[64:79]
  v_mfma_f32_32x32x16_bf16 v[80:95], a[116:119], a[120:123], v[80:95]
  s_waitcnt vmcnt(28)
  v_mfma_f32_32x32x16_bf16 v[112:127], a[116:119], a[124:127], v[112:127]
  v_mfma_f32_32x32x16_bf16 v[96:111], a[112:115], a[124:127], v[96:111]
  s_lshl_b32 s60, s59, 10
  s_add_u32 s61, s60, s45
  s_add_u32 s62, s60, s46
  s_lshl_b32 s60, s59, 11
  s_add_u32 s63, s60, s47
  buffer_load_dwordx4 a[120:123], v3, s[20:23], s61 offen sc0 sc1
  buffer_load_dwordx4 a[112:115], v4, s[12:15], s63 offen sc0 sc1
  s_add_u32 s59, s59, 4
  s_sub_u32 s60, s59, 112
  s_cselect_b32 s59, s59, s60
  buffer_load_dwordx4 a[116:119], v5, s[12:15], s63 offen sc0 sc1
  buffer_load_dwordx4 a[124:127], v3, s[20:23], s62 offen sc0 sc1
  s_waitcnt vmcnt(30)
  v_mfma_f32_32x32x16_bf16 v[64:79], a[0:3], a[8:11], v[64:79]
  s_waitcnt vmcnt(29)
  v_mfma_f32_32x32x16_bf16 v[80:95], a[4:7], a[8:11], v[80:95]
  s_waitcnt vmcnt(28)
  v_mfma_f32_32x32x16_bf16 v[112:127], a[4:7], a[12:15], v[112:127]
  v_mfma_f32_32x32x16_bf16 v[96:111], a[0:3], a[12:15], v[96:111]
  s_lshl_b32 s60, s59, 10
  s_add_u32 s61, s60, s45
  s_add_u32 s62, s60, s46
  s_lshl_b32 s60, s59, 11
  s_add_u32 s63, s60, s47
  buffer_load_dwordx4 a[8:11], v3, s[20:23], s61 offen sc0 sc1
  buffer_load_dwordx4 a[0:3], v4, s[12:15], s63 offen sc0 sc1
  s_add_u32 s59, s59, 4
  s_sub_u32 s60, s59, 112
  s_cselect_b32 s59, s59, s60
  buffer_load_dwordx4 a[4:7], v5, s[12:15], s63 offen sc0 sc1
  buffer_load_dwordx4 a[12:15], v3, s[20:23], s62 offen sc0 sc1
  s_waitcnt vmcnt(30)
  v_mfma_f32_32x32x16_bf16 v[64:79], a[16:19], a[24:27], v[64:79]
  s_waitcnt vmcnt(29)
  v_mfma_f32_32x32x16_bf16 v[80:95], a[20:23], a[24:27], v[80:95]
  s_waitcnt vmcnt(28)
  v_mfma_f32_32x32x16_bf16 v[112:127], a[20:23], a[28:31], v[112:127]
  v_mfma_f32_32x32x16_bf16 v[96:111], a[16:19], a[28:31], v[96:111]
  s_lshl_b32 s60, s59, 10
  s_add_u32 s61, s60, s45
  s_add_u32 s62, s60, s46
  s_lshl_b32 s60, s59, 11
  s_add_u32 s63, s60, s47
  buffer_load_dwordx4 a[24:27], v3, s[20:23], s61 offen sc0 sc1
  buffer_load_dwordx4 a[16:19], v4, s[12:15], s63 offen sc0 sc1
  s_add_u32 s59, s59, 4
  s_sub_u32 s60, s59, 112
  s_cselect_b32 s59, s59, s60
  buffer_load_dwordx4 a[20:23], v5, s[12:15], s63 offen sc0 sc1
  buffer_load_dwordx4 a[28:31], v3, s[20:23], s62 offen sc0 sc1
  s_waitcnt vmcnt(30)
  v_mfma_f32_32x32x16_bf16 v[64:79], a[32:35], a[40:43], v[64:79]
  s_waitcnt vmcnt(29)
  v_mfma_f32_32x32x16_bf16 v[80:95], a[36:39], a[40:43], v[80:95]
  s_waitcnt vmcnt(28)
  v_mfma_f32_32x32x16_bf16 v[112:127], a[36:39], a[44:47], v[112:127]
  v_mfma_f32_32x32x16_bf16 v[96:111], a[32:35], a[44:47], v[96:111]
  s_lshl_b32 s60, s59, 10
  s_add_u32 s61, s60, s45
  s_add_u32 s62, s60, s46
  s_lshl_b32 s60, s59, 11
  s_add_u32 s63, s60, s47
  buffer_load_dwordx4 a[40:43], v3, s[20:23], s61 offen sc0 sc1
  buffer_load_dwordx4 a[32:35], v4, s[12:15], s63 offen sc0 sc1
  s_add_u32 s59, s59, 4
  s_sub_u32 s60, s59, 112
  s_cselect_b32 s59, s59, s60
  buffer_load_dwordx4 a[36:39], v5, s[12:15], s63 offen sc0 sc1
  buffer_load_dwordx4 a[44:47], v3, s[20:23], s62 offen sc0 sc1
  s_waitcnt vmcnt(30)
  v_mfma_f32_32x32x16_bf16 v[64:79], a[48:51], a[56:59], v[64:79]
  s_waitcnt vmcnt(29)
  v_mfma_f32_32x32x16_bf16 v[80:95], a[52:55], a[56:59], v[80:95]
  s_waitcnt vmcnt(28)
  v_mfma_f32_32x32x16_bf16 v[112:127], a[52:55], a[60:63], v[112:127]
  v_mfma_f32_32x32x16_bf16 v[96:111], a[48:51], a[60:63], v[96:111]
  s_lshl_b32 s60, s59, 10
  s_add_u32 s61, s60, s45
  s_add_u32 s62, s60, s46
  s_lshl_b32 s60, s59, 11
  s_add_u32 s63, s60, s47
  buffer_load_dwordx4 a[56:59], v3, s[20:23], s61 offen sc0 sc1
  buffer_load_dwordx4 a[48:51], v4, s[12:15], s63 offen sc0 sc1
  s_add_u32 s59, s59, 4
  s_sub_u32 s60, s59, 112
  s_cselect_b32 s59, s59, s60
  buffer_load_dwordx4 a[52:55], v5, s[12:15], s63 offen sc0 sc1
  buffer_load_dwordx4 a[60:63], v3, s[20:23], s62 offen sc0 sc1
  s_waitcnt vmcnt(30)
  v_mfma_f32_32x32x16_bf16 v[64:79], a[64:67], a[72:75], v[64:79]
  s_waitcnt vmcnt(29)
  v_mfma_f32_32x32x16_bf16 v[80:95], a[68:71], a[72:75], v[80:95]
  s_waitcnt vmcnt(28)
  v_mfma_f32_32x32x16_bf16 v[112:127], a[68:71], a[76:79], v[112:127]
  v_mfma_f32_32x32x16_bf16 v[96:111], a[64:67], a[76:79], v[96:111]
  s_lshl_b32 s60, s59, 10
  s_add_u32 s61, s60, s45
  s_add_u32 s62, s60, s46
  s_lshl_b32 s60, s59, 11
  s_add_u32 s63, s60, s47
  buffer_load_dwordx4 a[72:75], v3, s[20:23], s61 offen sc0 sc1
  buffer_load_dwordx4 a[64:67], v4, s[12:15], s63 offen sc0 sc1
  s_add_u32 s59, s59, 4
  s_sub_u32 s60, s59, 112
  s_cselect_b32 s59, s59, s60
  buffer_load_dwordx4 a[68:71], v5, s[12:15], s63 offen sc0 sc1
  buffer_load_dwordx4 a[76:79], v3, s[20:23], s62 offen sc0 sc1
  s_waitcnt vmcnt(30)
  v_mfma_f32_32x32x16_bf16 v[64:79], a[80:83], a[88:91], v[64:79]
  s_waitcnt vmcnt(29)
  v_mfma_f32_32x32x16_bf16 v[80:95], a[84:87], a[88:91], v[80:95]
  s_waitcnt vmcnt(28)
  v_mfma_f32_32x32x16_bf16 v[112:127], a[84:87], a[92:95], v[112:127]
  v_mfma_f32_32x32x16_bf16 v[96:111], a[80:83], a[92:95], v[96:111]
  s_lshl_b32 s60, s59, 10
  s_add_u32 s61, s60, s45
  s_add_u32 s62, s60, s46
  s_lshl_b32 s60, s59, 11
  s_add_u32 s63, s60, s47
  buffer_load_dwordx4 a[88:91], v3, s[20:23], s61 offen sc0 sc1
  buffer_load_dwordx4 a[80:83], v4, s[12:15], s63 offen sc0 sc1
  s_add_u32 s59, s59, 4
  s_sub_u32 s60, s59, 112
  s_cselect_b32 s59, s59, s60
  buffer_load_dwordx4 a[84:87], v5, s[12:15], s63 offen sc0 sc1
  buffer_load_dwordx4 a[92:95], v3, s[20:23], s62 offen sc0 sc1
  s_waitcnt vmcnt(30)
  v_mfma_f32_32x32x16_bf16 v[64:79], a[96:99], a[104:107], v[64:79]
  s_waitcnt vmcnt(29)
  v_mfma_f32_32x32x16_bf16 v[80:95], a[100:103], a[104:107], v[80:95]
  s_waitcnt vmcnt(28)
  v_mfma_f32_32x32x16_bf16 v[112:127], a[100:103], a[108:111], v[112:127]
  v_mfma_f32_32x32x16_bf16 v[96:111], a[96:99], a[108:111], v[96:111]
  s_lshl_b32 s60, s59, 10
  s_add_u32 s61, s60, s45
  s_add_u32 s62, s60, s46
  s_lshl_b32 s60, s59, 11
  s_add_u32 s63, s60, s47
  buffer_load_dwordx4 a[104:107], v3, s[20:23], s61 offen sc0 sc1
  buffer_load_dwordx4 a[96:99], v4, s[12:15], s63 offen sc0 sc1
  s_add_u32 s59, s59, 4
  s_sub_u32 s60, s59, 112
  s_cselect_b32 s59, s59, s60
  buffer_load_dwordx4 a[100:103], v5, s[12:15], s63 offen sc0 sc1
  buffer_load_dwordx4 a[108:111], v3, s[20:23], s62 offen sc0 sc1
  s_waitcnt vmcnt(30)
  v_mfma_f32_32x32x16_bf16 v[64:79], a[112:115], a[120:123], v[64:79]
  s_waitcnt vmcnt(29)
  v_mfma_f32_32x32x16_bf16 v[80:95], a[116:119], a[120:123], v[80:95]
  s_waitcnt vmcnt(28)
  v_mfma_f32_32x32x16_bf16 v[112:127], a[116:119], a[124:127], v[112:127]
  v_mfma_f32_32x32x16_bf16 v[96:111], a[112:115], a[124:127], v[96:111]
  s_lshl_b32 s60, s59, 10
  s_add_u32 s61, s60, s45
  s_add_u32 s62, s60, s46
  s_lshl_b32 s60, s59, 11
  s_add_u32 s63, s60, s47
  buffer_load_dwordx4 a[120:123], v3, s[20:23], s61 offen sc0 sc1
  buffer_load_dwordx4 a[112:115], v4, s[12:15], s63 offen sc0 sc1
  s_add_u32 s59, s59, 4
  s_sub_u32 s60, s59, 112
  s_cselect_b32 s59, s59, s60
  buffer_load_dwordx4 a[116:119], v5, s[12:15], s63 offen sc0 sc1
  buffer_load_dwordx4 a[124:127], v3, s[20:23], s62 offen sc0 sc1
  s_waitcnt vmcnt(30)
  v_mfma_f32_32x32x16_bf16 v[64:79], a[0:3], a[8:11], v[64:79]
  s_waitcnt vmcnt(29)
  v_mfma_f32_32x32x16_bf16 v[80:95], a[4:7], a[8:11], v[80:95]
  s_waitcnt vmcnt(28)
  v_mfma_f32_32x32x16_bf16 v[112:127], a[4:7], a[12:15], v[112:127]
  v_mfma_f32_32x32x16_bf16 v[96:111], a[0:3], a[12:15], v[96:111]
  s_lshl_b32 s60, s59, 10
  s_add_u32 s61, s60, s45
  s_add_u32 s62, s60, s46
  s_lshl_b32 s60, s59, 11
  s_add_u32 s63, s60, s47
  buffer_load_dwordx4 a[8:11], v3, s[20:23], s61 offen sc0 sc1
  buffer_load_dwordx4 a[0:3], v4, s[12:15], s63 offen sc0 sc1
  s_add_u32 s59, s59, 4
  s_sub_u32 s60, s59, 112
  s_cselect_b32 s59, s59, s60
  buffer_load_dwordx4 a[4:7], v5, s[12:15], s63 offen sc0 sc1
  buffer_load_dwordx4 a[12:15], v3, s[20:23], s62 offen sc0 sc1
  s_waitcnt vmcnt(30)
  v_mfma_f32_32x32x16_bf16 v[64:79], a[16:19], a[24:27], v[64:79]
  s_waitcnt vmcnt(29)
  v_mfma_f32_32x32x16_bf16 v[80:95], a[20:23], a[24:27], v[80:95]
  s_waitcnt vmcnt(28)
  v_mfma_f32_32x32x16_bf16 v[112:127], a[20:23], a[28:31], v[112:127]
  v_mfma_f32_32x32x16_bf16 v[96:111], a[16:19], a[28:31], v[96:111]
  s_lshl_b32 s60, s59, 10
  s_add_u32 s61, s60, s45
  s_add_u32 s62, s60, s46
  s_lshl_b32 s60, s59, 11
  s_add_u32 s63, s60, s47
  buffer_load_dwordx4 a[24:27], v3, s[20:23], s61 offen sc0 sc1
  buffer_load_dwordx4 a[16:19], v4, s[12:15], s63 offen sc0 sc1
  s_add_u32 s59, s59, 4
  s_sub_u32 s60, s59, 112
  s_cselect_b32 s59, s59, s60
  buffer_load_dwordx4 a[20:23], v5, s[12:15], s63 offen sc0 sc1
  buffer_load_dwordx4 a[28:31], v3, s[20:23], s62 offen sc0 sc1
  s_waitcnt vmcnt(30)
  v_mfma_f32_32x32x16_bf16 v[64:79], a[32:35], a[40:43], v[64:79]
  s_waitcnt vmcnt(29)
  v_mfma_f32_32x32x16_bf16 v[80:95], a[36:39], a[40:43], v[80:95]
  s_waitcnt vmcnt(28)
  v_mfma_f32_32x32x16_bf16 v[112:127], a[36:39], a[44:47], v[112:127]
  v_mfma_f32_32x32x16_bf16 v[96:111], a[32:35], a[44:47], v[96:111]
  s_lshl_b32 s60, s59, 10
  s_add_u32 s61, s60, s45
  s_add_u32 s62, s60, s46
  s_lshl_b32 s60, s59, 11
  s_add_u32 s63, s60, s47
  buffer_load_dwordx4 a[40:43], v3, s[20:23], s61 offen sc0 sc1
  buffer_load_dwordx4 a[32:35], v4, s[12:15], s63 offen sc0 sc1
  s_add_u32 s59, s59, 4
  s_sub_u32 s60, s59, 112
  s_cselect_b32 s59, s59, s60
  buffer_load_dwordx4 a[36:39], v5, s[12:15], s63 offen sc0 sc1
  buffer_load_dwordx4 a[44:47], v3, s[20:23], s62 offen sc0 sc1
  s_waitcnt vmcnt(30)
  v_mfma_f32_32x32x16_bf16 v[64:79], a[48:51], a[56:59], v[64:79]
  s_waitcnt vmcnt(29)
  v_mfma_f32_32x32x16_bf16 v[80:95], a[52:55], a[56:59], v[80:95]
  s_waitcnt vmcnt(28)
  v_mfma_f32_32x32x16_bf16 v[112:127], a[52:55], a[60:63], v[112:127]
  v_mfma_f32_32x32x16_bf16 v[96:111], a[48:51], a[60:63], v[96:111]
  s_lshl_b32 s60, s59, 10
  s_add_u32 s61, s60, s45
  s_add_u32 s62, s60, s46
  s_lshl_b32 s60, s59, 11
  s_add_u32 s63, s60, s47
  buffer_load_dwordx4 a[56:59], v3, s[20:23], s61 offen sc0 sc1
  buffer_load_dwordx4 a[48:51], v4, s[12:15], s63 offen sc0 sc1
  s_add_u32 s59, s59, 4
  s_sub_u32 s60, s59, 112
  s_cselect_b32 s59, s59, s60
  buffer_load_dwordx4 a[52:55], v5, s[12:15], s63 offen sc0 sc1
  buffer_load_dwordx4 a[60:63], v3, s[20:23], s62 offen sc0 sc1
  s_waitcnt vmcnt(30)
  v_mfma_f32_32x32x16_bf16 v[64:79], a[64:67], a[72:75], v[64:79]
  s_waitcnt vmcnt(29)
  v_mfma_f32_32x32x16_bf16 v[80:95], a[68:71], a[72:75], v[80:95]
  s_waitcnt vmcnt(28)
  v_mfma_f32_32x32x16_bf16 v[112:127], a[68:71], a[76:79], v[112:127]
  v_mfma_f32_32x32x16_bf16 v[96:111], a[64:67], a[76:79], v[96:111]
  s_mov_b32 s32, s10
  s_and_b32 s33, s11, 0xffff
  s_mov_b32 s34, 0x200000
  s_mov_b32 s35, 0x20000
  buffer_load_dwordx4 v[16:19], v15, s[24:27], s53 offen offset:0 sc0 sc1
  buffer_load_dwordx4 v[20:23], v15, s[24:27], s53 offen offset:16 sc0 sc1
  buffer_load_dwordx4 v[24:27], v15, s[24:27], s53 offen offset:64 sc0 sc1
  buffer_load_dwordx4 v[28:31], v15, s[24:27], s53 offen offset:80 sc0 sc1
  buffer_load_dwordx4 v[32:35], v3, s[28:31], s56 offen sc0 sc1
  buffer_load_dwordx4 v[36:39], v3, s[28:31], s56 offen offset:1024 sc0 sc1
  s_waitcnt vmcnt(32)
  v_mfma_f32_32x32x16_bf16 v[64:79], a[80:83], a[88:91], v[64:79]
  s_waitcnt vmcnt(31)
  v_mfma_f32_32x32x16_bf16 v[80:95], a[84:87], a[88:91], v[80:95]
  s_waitcnt vmcnt(30)
  v_mfma_f32_32x32x16_bf16 v[112:127], a[84:87], a[92:95], v[112:127]
  v_mfma_f32_32x32x16_bf16 v[96:111], a[80:83], a[92:95], v[96:111]
  s_waitcnt vmcnt(28)
  v_mfma_f32_32x32x16_bf16 v[64:79], a[96:99], a[104:107], v[64:79]
  s_waitcnt vmcnt(27)
  v_mfma_f32_32x32x16_bf16 v[80:95], a[100:103], a[104:107], v[80:95]
  s_waitcnt vmcnt(26)
  v_mfma_f32_32x32x16_bf16 v[112:127], a[100:103], a[108:111], v[112:127]
  v_mfma_f32_32x32x16_bf16 v[96:111], a[96:99], a[108:111], v[96:111]
  s_waitcnt vmcnt(24)
  v_mfma_f32_32x32x16_bf16 v[64:79], a[112:115], a[120:123], v[64:79]
  s_waitcnt vmcnt(23)
  v_mfma_f32_32x32x16_bf16 v[80:95], a[116:119], a[120:123], v[80:95]
  s_waitcnt vmcnt(22)
  v_mfma_f32_32x32x16_bf16 v[112:127], a[116:119], a[124:127], v[112:127]
  v_mfma_f32_32x32x16_bf16 v[96:111], a[112:115], a[124:127], v[96:111]
  s_waitcnt vmcnt(20)
  v_mfma_f32_32x32x16_bf16 v[64:79], a[0:3], a[8:11], v[64:79]
  s_waitcnt vmcnt(19)
  v_mfma_f32_32x32x16_bf16 v[80:95], a[4:7], a[8:11], v[80:95]
  s_waitcnt vmcnt(18)
  v_mfma_f32_32x32x16_bf16 v[112:127], a[4:7], a[12:15], v[112:127]
  v_mfma_f32_32x32x16_bf16 v[96:111], a[0:3], a[12:15], v[96:111]
  s_waitcnt vmcnt(16)
  v_mfma_f32_32x32x16_bf16 v[64:79], a[16:19], a[24:27], v[64:79]
  s_waitcnt vmcnt(15)
  v_mfma_f32_32x32x16_bf16 v[80:95], a[20:23], a[24:27], v[80:95]
  s_waitcnt vmcnt(14)
  v_mfma_f32_32x32x16_bf16 v[112:127], a[20:23], a[28:31], v[112:127]
  v_mfma_f32_32x32x16_bf16 v[96:111], a[16:19], a[28:31], v[96:111]
  s_waitcnt vmcnt(12)
  v_mfma_f32_32x32x16_bf16 v[64:79], a[32:35], a[40:43], v[64:79]
  s_waitcnt vmcnt(11)
  v_mfma_f32_32x32x16_bf16 v[80:95], a[36:39], a[40:43], v[80:95]
  s_waitcnt vmcnt(10)
  v_mfma_f32_32x32x16_bf16 v[112:127], a[36:39], a[44:47], v[112:127]
  v_mfma_f32_32x32x16_bf16 v[96:111], a[32:35], a[44:47], v[96:111]
  s_waitcnt vmcnt(8)
  v_mfma_f32_32x32x16_bf16 v[64:79], a[48:51], a[56:59], v[64:79]
  s_waitcnt vmcnt(7)
  v_mfma_f32_32x32x16_bf16 v[80:95], a[52:55], a[56:59], v[80:95]
  s_waitcnt vmcnt(6)
  v_mfma_f32_32x32x16_bf16 v[112:127], a[52:55], a[60:63], v[112:127]
  v_mfma_f32_32x32x16_bf16 v[96:111], a[48:51], a[60:63], v[96:111]
  s_waitcnt vmcnt(1)
  v_lshlrev_b32 v44, 16, v32
  v_and_b32 v45, 0xffff0000, v32
  v_lshlrev_b32 v46, 16, v33
  v_and_b32 v47, 0xffff0000, v33
  v_lshlrev_b32 v48, 16, v34
  v_and_b32 v49, 0xffff0000, v34
  v_lshlrev_b32 v50, 16, v35
  v_and_b32 v51, 0xffff0000, v35
  s_waitcnt vmcnt(0)
  v_lshlrev_b32 v52, 16, v36
  v_and_b32 v53, 0xffff0000, v36
  v_lshlrev_b32 v54, 16, v37
  v_and_b32 v55, 0xffff0000, v37
  v_lshlrev_b32 v56, 16, v38
  v_and_b32 v57, 0xffff0000, v38
  v_lshlrev_b32 v58, 16, v39
  v_and_b32 v59, 0xffff0000, v39
  ds_write_b128 v9, v[80:83] offset:0
  ds_write_b128 v9, v[84:87] offset:1024
  ds_write_b128 v9, v[88:91] offset:2048
  ds_write_b128 v9, v[92:95] offset:3072
  ds_write_b128 v11, v[112:115] offset:8192
  ds_write_b128 v11, v[116:119] offset:9216
  ds_write_b128 v11, v[120:123] offset:10240
  ds_write_b128 v11, v[124:127] offset:11264
  ds_write_b128 v10, v[96:99] offset:4096
  ds_write_b128 v10, v[100:103] offset:5120
  ds_write_b128 v10, v[104:107] offset:6144
  ds_write_b128 v10, v[108:111] offset:7168
  s_waitcnt lgkmcnt(0)
  s_barrier
  ds_read_b128 v[80:83], v8 offset:0
  ds_read_b128 v[84:87], v8 offset:1024
  ds_read_b128 v[88:91], v8 offset:2048
  ds_read_b128 v[92:95], v8 offset:3072
  ds_read_b128 v[96:99], v8 offset:4096
  ds_read_b128 v[100:103], v8 offset:5120
  ds_read_b128 v[104:107], v8 offset:6144
  ds_read_b128 v[108:111], v8 offset:7168
  ds_read_b128 v[112:115], v8 offset:8192
  ds_read_b128 v[116:119], v8 offset:9216
  ds_read_b128 v[120:123], v8 offset:10240
  ds_read_b128 v[124:127], v8 offset:11264
  s_waitcnt lgkmcnt(11)
  v_add_f32 v64, v64, v80
  v_add_f32 v65, v65, v81
  v_add_f32 v66, v66, v82
  v_add_f32 v67, v67, v83
  s_waitcnt lgkmcnt(10)
  v_add_f32 v68, v68, v84
  v_add_f32 v69, v69, v85
  v_add_f32 v70, v70, v86
  v_add_f32 v71, v71, v87
  s_waitcnt lgkmcnt(9)
  v_add_f32 v72, v72, v88
  v_add_f32 v73, v73, v89
  v_add_f32 v74, v74, v90
  v_add_f32 v75, v75, v91
  s_waitcnt lgkmcnt(8)
  v_add_f32 v76, v76, v92
  v_add_f32 v77, v77, v93
  v_add_f32 v78, v78, v94
  v_add_f32 v79, v79, v95
  s_waitcnt lgkmcnt(7)
  v_add_f32 v64, v64, v96
  v_add_f32 v65, v65, v97
  v_add_f32 v66, v66, v98
  v_add_f32 v67, v67, v99
  s_waitcnt lgkmcnt(6)
  v_add_f32 v68, v68, v100
  v_add_f32 v69, v69, v101
  v_add_f32 v70, v70, v102
  v_add_f32 v71, v71, v103
  s_waitcnt lgkmcnt(5)
  v_add_f32 v72, v72, v104
  v_add_f32 v73, v73, v105
  v_add_f32 v74, v74, v106
  v_add_f32 v75, v75, v107
  s_waitcnt lgkmcnt(4)
  v_add_f32 v76, v76, v108
  v_add_f32 v77, v77, v109
  v_add_f32 v78, v78, v110
  v_add_f32 v79, v79, v111
  s_waitcnt lgkmcnt(3)
  v_add_f32 v64, v64, v112
  v_add_f32 v65, v65, v113
  v_add_f32 v66, v66, v114
  v_add_f32 v67, v67, v115
  s_waitcnt lgkmcnt(2)
  v_add_f32 v68, v68, v116
  v_add_f32 v69, v69, v117
  v_add_f32 v70, v70, v118
  v_add_f32 v71, v71, v119
  s_waitcnt lgkmcnt(1)
  v_add_f32 v72, v72, v120
  v_add_f32 v73, v73, v121
  v_add_f32 v74, v74, v122
  v_add_f32 v75, v75, v123
  s_waitcnt lgkmcnt(0)
  v_add_f32 v76, v76, v124
  v_add_f32 v77, v77, v125
  v_add_f32 v78, v78, v126
  v_add_f32 v79, v79, v127
  v_fma_f32 v64, v16, v64, v44
  v_fma_f32 v65, v17, v65, v45
  v_fma_f32 v66, v18, v66, v46
  v_fma_f32 v67, v19, v67, v47
  v_fma_f32 v68, v20, v68, v48
  v_fma_f32 v69, v21, v69, v49
  v_fma_f32 v70, v22, v70, v50
  v_fma_f32 v71, v23, v71, v51
  v_fma_f32 v72, v24, v72, v52
  v_fma_f32 v73, v25, v73, v53
  v_fma_f32 v74, v26, v74, v54
  v_fma_f32 v75, v27, v75, v55
  v_fma_f32 v76, v28, v76, v56
  v_fma_f32 v77, v29, v77, v57
  v_fma_f32 v78, v30, v78, v58
  v_fma_f32 v79, v31, v79, v59
  v_cvt_pk_bf16_f32 v80, v64, v65
  v_cvt_pk_bf16_f32 v81, v66, v67
  v_cvt_pk_bf16_f32 v82, v68, v69
  v_cvt_pk_bf16_f32 v83, v70, v71
  v_cvt_pk_bf16_f32 v84, v72, v73
  v_cvt_pk_bf16_f32 v85, v74, v75
  v_cvt_pk_bf16_f32 v86, v76, v77
  v_cvt_pk_bf16_f32 v87, v78, v79
  buffer_store_dwordx4 v[80:83], v40, s[32:35], s55 offen
  buffer_store_dwordx4 v[84:87], v40, s[32:35], s55 offen offset:32
mega_end:
attn_kernel_done1:
  s_endpgm
attn_kernel_slow4:
  s_call_b64 s[82:83], attn_kernel_fix45
  s_branch attn_kernel_ret5
attn_kernel_slow6:
  s_call_b64 s[82:83], attn_kernel_fix46
  s_branch attn_kernel_ret7
attn_kernel_slow9:
  s_call_b64 s[82:83], attn_kernel_fix45
  s_branch attn_kernel_ret10
attn_kernel_slow11:
  s_call_b64 s[82:83], attn_kernel_fix46
  s_branch attn_kernel_ret12
attn_kernel_slow13:
  s_call_b64 s[82:83], attn_kernel_fix45
  s_branch attn_kernel_ret14
attn_kernel_slow15:
  s_call_b64 s[82:83], attn_kernel_fix46
  s_branch attn_kernel_ret16
attn_kernel_slow17:
  s_call_b64 s[82:83], attn_kernel_fix45
  s_branch attn_kernel_ret18
attn_kernel_slow19:
  s_call_b64 s[82:83], attn_kernel_fix46
  s_branch attn_kernel_ret20
attn_kernel_slow21:
  s_call_b64 s[82:83], attn_kernel_fix45
  s_branch attn_kernel_ret22
attn_kernel_slow23:
  s_call_b64 s[82:83], attn_kernel_fix46
  s_branch attn_kernel_ret24
attn_kernel_slow25:
  s_call_b64 s[82:83], attn_kernel_fix47
  s_branch attn_kernel_ret26
attn_kernel_slow27:
  s_call_b64 s[82:83], attn_kernel_fix48
  s_branch attn_kernel_ret28
attn_kernel_slow29:
  s_call_b64 s[82:83], attn_kernel_fix47
  s_branch attn_kernel_ret30
attn_kernel_slow31:
  s_call_b64 s[82:83], attn_kernel_fix48
  s_branch attn_kernel_ret32
attn_kernel_slow33:
  s_call_b64 s[82:83], attn_kernel_fix49
  s_branch attn_kernel_ret34
attn_kernel_slow35:
  s_call_b64 s[82:83], attn_kernel_fix50
  s_branch attn_kernel_ret36
attn_kernel_slow37:
  s_call_b64 s[82:83], attn_kernel_fix51
  s_branch attn_kernel_ret38
attn_kernel_slow39:
  s_call_b64 s[82:83], attn_kernel_fix49
  s_branch attn_kernel_ret40
attn_kernel_slow41:
  s_call_b64 s[82:83], attn_kernel_fix51
  s_branch attn_kernel_ret42
attn_kernel_slow43:
  s_call_b64 s[82:83], attn_kernel_fix52
  s_branch attn_kernel_ret44
attn_kernel_fix45:
  s_nop 15
  v_max3_f32 v26, v96, v97, v98
  v_max3_f32 v27, v99, v100, v101
  v_max3_f32 v26, v26, v102, v103
  v_max3_f32 v27, v27, v104, v105
  v_max3_f32 v26, v26, v106, v107
  v_max3_f32 v27, v27, v108, v109
  v_max3_f32 v26, v26, v110, v111
  v_max_f32 v26, v26, v27
  v_mov_b32 v27, v26
  s_nop 1
  v_permlane32_swap_b32 v26, v27
  v_max_f32 v26, v26, v27
  v_add_f32 v26, 0x42cc0000, v26
  v_max_f32 v26, 0, v26
  v_mul_f32 v27, -0.5, v26
  v_exp_f32 v27, v27
  v_sub_f32 v160, v160, v26
  v_sub_f32 v161, v161, v26
  v_sub_f32 v162, v162, v26
  v_sub_f32 v163, v163, v26
  v_sub_f32 v164, v164, v26
  v_sub_f32 v165, v165, v26
  v_sub_f32 v166, v166, v26
  v_sub_f32 v167, v167, v26
  v_sub_f32 v168, v168, v26
  v_sub_f32 v169, v169, v26
  v_sub_f32 v170, v170, v26
  v_sub_f32 v171, v171, v26
  v_sub_f32 v172, v172, v26
  v_sub_f32 v173, v173, v26
  v_sub_f32 v174, v174, v26
  v_sub_f32 v175, v175, v26
  v_sub_f32 v64, v64, v26
  v_sub_f32 v65, v65, v26
  v_sub_f32 v66, v66, v26
  v_sub_f32 v67, v67, v26
  v_sub_f32 v68, v68, v26
  v_sub_f32 v69, v69, v26
  v_sub_f32 v70, v70, v26
  v_sub_f32 v71, v71, v26
  v_sub_f32 v72, v72, v26
  v_sub_f32 v73, v73, v26
  v_sub_f32 v74, v74, v26
  v_sub_f32 v75, v75, v26
  v_sub_f32 v76, v76, v26
  v_sub_f32 v77, v77, v26
  v_sub_f32 v78, v78, v26
  v_sub_f32 v79, v79, v26
  v_sub_f32 v96, v96, v26
  v_sub_f32 v97, v97, v26
  v_sub_f32 v98, v98, v26
  v_sub_f32 v99, v99, v26
  v_sub_f32 v100, v100, v26
  v_sub_f32 v101, v101, v26
  v_sub_f32 v102, v102, v26
  v_sub_f32 v103, v103, v26
  v_sub_f32 v104, v104, v26
  v_sub_f32 v105, v105, v26
  v_sub_f32 v106, v106, v26
  v_sub_f32 v107, v107, v26
  v_sub_f32 v108, v108, v26
  v_sub_f32 v109, v109, v26
  v_sub_f32 v110, v110, v26
  v_sub_f32 v111, v111, v26
  v_mul_f32 v20, v20, v27
  v_mul_f32 v20, v20, v27
  v_exp_f32 v32, v96
  v_exp_f32 v33, v97
  v_exp_f32 v34, v98
  v_add_f32 v22, v32, v33
  v_exp_f32 v35, v99
  v_cvt_pk_bf16_f32 v144, v32, v33
  v_exp_f32 v36, v100
  v_add_f32 v22, v22, v34
  v_exp_f32 v37, v101
  v_add_f32 v22, v22, v35
  v_cvt_pk_bf16_f32 v145, v34, v35
  v_exp_f32 v38, v102
  v_add_f32 v22, v22, v36
  v_exp_f32 v39, v103
  v_add_f32 v22, v22, v37
  v_cvt_pk_bf16_f32 v146, v36, v37
  v_exp_f32 v32, v104
  v_add_f32 v22, v22, v38
  v_exp_f32 v33, v105
  v_add_f32 v22, v22, v39
  v_cvt_pk_bf16_f32 v147, v38, v39
  v_exp_f32 v34, v106
  v_add_f32 v22, v22, v32
  v_exp_f32 v35, v107
  v_add_f32 v22, v22, v33
  v_cvt_pk_bf16_f32 v148, v32, v33
  v_exp_f32 v36, v108
  v_add_f32 v22, v22, v34
  v_exp_f32 v37, v109
  v_add_f32 v22, v22, v35
  v_cvt_pk_bf16_f32 v149, v34, v35
  v_exp_f32 v38, v110
  v_add_f32 v22, v22, v36
  v_exp_f32 v39, v111
  v_add_f32 v22, v22, v37
  v_cvt_pk_bf16_f32 v150, v36, v37
  v_add_f32 v22, v22, v38
  v_add_f32 v22, v22, v39
  v_cvt_pk_bf16_f32 v151, v38, v39
  v_accvgpr_read_b32 v48, a0
  v_accvgpr_read_b32 v49, a1
  v_accvgpr_read_b32 v50, a2
  v_accvgpr_read_b32 v51, a3
  v_accvgpr_read_b32 v52, a4
  v_accvgpr_read_b32 v53, a5
  v_accvgpr_read_b32 v54, a6
  v_accvgpr_read_b32 v55, a7
  v_mul_f32 v48, v48, v27
  v_mul_f32 v49, v49, v27
  v_mul_f32 v50, v50, v27
  v_mul_f32 v51, v51, v27
  v_mul_f32 v52, v52, v27
  v_mul_f32 v53, v53, v27
  v_mul_f32 v54, v54, v27
  v_mul_f32 v55, v55, v27
  v_mul_f32 v48, v48, v27
  v_mul_f32 v49, v49, v27
  v_mul_f32 v50, v50, v27
  v_mul_f32 v51, v51, v27
  v_mul_f32 v52, v52, v27
  v_mul_f32 v53, v53, v27
  v_mul_f32 v54, v54, v27
  v_mul_f32 v55, v55, v27
  v_accvgpr_write_b32 a0, v48
  v_accvgpr_write_b32 a1, v49
  v_accvgpr_write_b32 a2, v50
  v_accvgpr_write_b32 a3, v51
  v_accvgpr_write_b32 a4, v52
  v_accvgpr_write_b32 a5, v53
  v_accvgpr_write_b32 a6, v54
  v_accvgpr_write_b32 a7, v55
  v_accvgpr_read_b32 v48, a8
  v_accvgpr_read_b32 v49, a9
  v_accvgpr_read_b32 v50, a10
  v_accvgpr_read_b32 v51, a11
  v_accvgpr_read_b32 v52, a12
  v_accvgpr_read_b32 v53, a13
  v_accvgpr_read_b32 v54, a14
  v_accvgpr_read_b32 v55, a15
  v_mul_f32 v48, v48, v27
  v_mul_f32 v49, v49, v27
  v_mul_f32 v50, v50, v27
  v_mul_f32 v51, v51, v27
  v_mul_f32 v52, v52, v27
  v_mul_f32 v53, v53, v27
  v_mul_f32 v54, v54, v27
  v_mul_f32 v55, v55, v27
  v_mul_f32 v48, v48, v27
  v_mul_f32 v49, v49, v27
  v_mul_f32 v50, v50, v27
  v_mul_f32 v51, v51, v27
  v_mul_f32 v52, v52, v27
  v_mul_f32 v53, v53, v27
  v_mul_f32 v54, v54, v27
  v_mul_f32 v55, v55, v27
  v_accvgpr_write_b32 a8, v48
  v_accvgpr_write_b32 a9, v49
  v_accvgpr_write_b32 a10, v50
  v_accvgpr_write_b32 a11, v51
  v_accvgpr_write_b32 a12, v52
  v_accvgpr_write_b32 a13, v53
  v_accvgpr_write_b32 a14, v54
  v_accvgpr_write_b32 a15, v55
  v_accvgpr_read_b32 v48, a16
  v_accvgpr_read_b32 v49, a17
  v_accvgpr_read_b32 v50, a18
  v_accvgpr_read_b32 v51, a19
  v_accvgpr_read_b32 v52, a20
  v_accvgpr_read_b32 v53, a21
  v_accvgpr_read_b32 v54, a22
  v_accvgpr_read_b32 v55, a23
  v_mul_f32 v48, v48, v27
  v_mul_f32 v49, v49, v27
  v_mul_f32 v50, v50, v27
  v_mul_f32 v51, v51, v27
  v_mul_f32 v52, v52, v27
  v_mul_f32 v53, v53, v27
  v_mul_f32 v54, v54, v27
  v_mul_f32 v55, v55, v27
  v_mul_f32 v48, v48, v27
  v_mul_f32 v49, v49, v27
  v_mul_f32 v50, v50, v27
  v_mul_f32 v51, v51, v27
  v_mul_f32 v52, v52, v27
  v_mul_f32 v53, v53, v27
  v_mul_f32 v54, v54, v27
  v_mul_f32 v55, v55, v27
  v_accvgpr_write_b32 a16, v48
  v_accvgpr_write_b32 a17, v49
  v_accvgpr_write_b32 a18, v50
  v_accvgpr_write_b32 a19, v51
  v_accvgpr_write_b32 a20, v52
  v_accvgpr_write_b32 a21, v53
  v_accvgpr_write_b32 a22, v54
  v_accvgpr_write_b32 a23, v55
  v_accvgpr_read_b32 v48, a24
  v_accvgpr_read_b32 v49, a25
  v_accvgpr_read_b32 v50, a26
  v_accvgpr_read_b32 v51, a27
  v_accvgpr_read_b32 v52, a28
  v_accvgpr_read_b32 v53, a29
  v_accvgpr_read_b32 v54, a30
  v_accvgpr_read_b32 v55, a31
  v_mul_f32 v48, v48, v27
  v_mul_f32 v49, v49, v27
  v_mul_f32 v50, v50, v27
  v_mul_f32 v51, v51, v27
  v_mul_f32 v52, v52, v27
  v_mul_f32 v53, v53, v27
  v_mul_f32 v54, v54, v27
  v_mul_f32 v55, v55, v27
  v_mul_f32 v48, v48, v27
  v_mul_f32 v49, v49, v27
  v_mul_f32 v50, v50, v27
  v_mul_f32 v51, v51, v27
  v_mul_f32 v52, v52, v27
  v_mul_f32 v53, v53, v27
  v_mul_f32 v54, v54, v27
  v_mul_f32 v55, v55, v27
  v_accvgpr_write_b32 a24, v48
  v_accvgpr_write_b32 a25, v49
  v_accvgpr_write_b32 a26, v50
  v_accvgpr_write_b32 a27, v51
  v_accvgpr_write_b32 a28, v52
  v_accvgpr_write_b32 a29, v53
  v_accvgpr_write_b32 a30, v54
  v_accvgpr_write_b32 a31, v55
  v_accvgpr_read_b32 v48, a32
  v_accvgpr_read_b32 v49, a33
  v_accvgpr_read_b32 v50, a34
  v_accvgpr_read_b32 v51, a35
  v_accvgpr_read_b32 v52, a36
  v_accvgpr_read_b32 v53, a37
  v_accvgpr_read_b32 v54, a38
  v_accvgpr_read_b32 v55, a39
  v_mul_f32 v48, v48, v27
  v_mul_f32 v49, v49, v27
  v_mul_f32 v50, v50, v27
  v_mul_f32 v51, v51, v27
  v_mul_f32 v52, v52, v27
  v_mul_f32 v53, v53, v27
  v_mul_f32 v54, v54, v27
  v_mul_f32 v55, v55, v27
  v_mul_f32 v48, v48, v27
  v_mul_f32 v49, v49, v27
  v_mul_f32 v50, v50, v27
  v_mul_f32 v51, v51, v27
  v_mul_f32 v52, v52, v27
  v_mul_f32 v53, v53, v27
  v_mul_f32 v54, v54, v27
  v_mul_f32 v55, v55, v27
  v_accvgpr_write_b32 a32, v48
  v_accvgpr_write_b32 a33, v49
  v_accvgpr_write_b32 a34, v50
  v_accvgpr_write_b32 a35, v51
  v_accvgpr_write_b32 a36, v52
  v_accvgpr_write_b32 a37, v53
  v_accvgpr_write_b32 a38, v54
  v_accvgpr_write_b32 a39, v55
  v_accvgpr_read_b32 v48, a40
  v_accvgpr_read_b32 v49, a41
  v_accvgpr_read_b32 v50, a42
  v_accvgpr_read_b32 v51, a43
  v_accvgpr_read_b32 v52, a44
  v_accvgpr_read_b32 v53, a45
  v_accvgpr_read_b32 v54, a46
  v_accvgpr_read_b32 v55, a47
  v_mul_f32 v48, v48, v27
  v_mul_f32 v49, v49, v27
  v_mul_f32 v50, v50, v27
  v_mul_f32 v51, v51, v27
  v_mul_f32 v52, v52, v27
  v_mul_f32 v53, v53, v27
  v_mul_f32 v54, v54, v27
  v_mul_f32 v55, v55, v27
  v_mul_f32 v48, v48, v27
  v_mul_f32 v49, v49, v27
  v_mul_f32 v50, v50, v27
  v_mul_f32 v51, v51, v27
  v_mul_f32 v52, v52, v27
  v_mul_f32 v53, v53, v27
  v_mul_f32 v54, v54, v27
  v_mul_f32 v55, v55, v27
  v_accvgpr_write_b32 a40, v48
  v_accvgpr_write_b32 a41, v49
  v_accvgpr_write_b32 a42, v50
  v_accvgpr_write_b32 a43, v51
  v_accvgpr_write_b32 a44, v52
  v_accvgpr_write_b32 a45, v53
  v_accvgpr_write_b32 a46, v54
  v_accvgpr_write_b32 a47, v55
  v_accvgpr_read_b32 v48, a48
  v_accvgpr_read_b32 v49, a49
  v_accvgpr_read_b32 v50, a50
  v_accvgpr_read_b32 v51, a51
  v_accvgpr_read_b32 v52, a52
  v_accvgpr_read_b32 v53, a53
  v_accvgpr_read_b32 v54, a54
  v_accvgpr_read_b32 v55, a55
  v_mul_f32 v48, v48, v27
  v_mul_f32 v49, v49, v27
  v_mul_f32 v50, v50, v27
  v_mul_f32 v51, v51, v27
  v_mul_f32 v52, v52, v27
  v_mul_f32 v53, v53, v27
  v_mul_f32 v54, v54, v27
  v_mul_f32 v55, v55, v27
  v_mul_f32 v48, v48, v27
  v_mul_f32 v49, v49, v27
  v_mul_f32 v50, v50, v27
  v_mul_f32 v51, v51, v27
  v_mul_f32 v52, v52, v27
  v_mul_f32 v53, v53, v27
  v_mul_f32 v54, v54, v27
  v_mul_f32 v55, v55, v27
  v_accvgpr_write_b32 a48, v48
  v_accvgpr_write_b32 a49, v49
  v_accvgpr_write_b32 a50, v50
  v_accvgpr_write_b32 a51, v51
  v_accvgpr_write_b32 a52, v52
  v_accvgpr_write_b32 a53, v53
  v_accvgpr_write_b32 a54, v54
  v_accvgpr_write_b32 a55, v55
  v_accvgpr_read_b32 v48, a56
  v_accvgpr_read_b32 v49, a57
  v_accvgpr_read_b32 v50, a58
  v_accvgpr_read_b32 v51, a59
  v_accvgpr_read_b32 v52, a60
  v_accvgpr_read_b32 v53, a61
  v_accvgpr_read_b32 v54, a62
  v_accvgpr_read_b32 v55, a63
  v_mul_f32 v48, v48, v27
  v_mul_f32 v49, v49, v27
  v_mul_f32 v50, v50, v27
  v_mul_f32 v51, v51, v27
  v_mul_f32 v52, v52, v27
  v_mul_f32 v53, v53, v27
  v_mul_f32 v54, v54, v27
  v_mul_f32 v55, v55, v27
  v_mul_f32 v48, v48, v27
  v_mul_f32 v49, v49, v27
  v_mul_f32 v50, v50, v27
  v_mul_f32 v51, v51, v27
  v_mul_f32 v52, v52, v27
  v_mul_f32 v53, v53, v27
  v_mul_f32 v54, v54, v27
  v_mul_f32 v55, v55, v27
  v_accvgpr_write_b32 a56, v48
  v_accvgpr_write_b32 a57, v49
  v_accvgpr_write_b32 a58, v50
  v_accvgpr_write_b32 a59, v51
  v_accvgpr_write_b32 a60, v52
  v_accvgpr_write_b32 a61, v53
  v_accvgpr_write_b32 a62, v54
  v_accvgpr_write_b32 a63, v55
  v_max3_f32 v26, v112, v113, v114
  v_max3_f32 v27, v115, v116, v117
  v_max3_f32 v26, v26, v118, v119
  v_max3_f32 v27, v27, v120, v121
  v_max3_f32 v26, v26, v122, v123
  v_max3_f32 v27, v27, v124, v125
  v_max3_f32 v26, v26, v126, v127
  v_max_f32 v26, v26, v27
  v_mov_b32 v27, v26
  s_nop 1
  v_permlane32_swap_b32 v26, v27
  v_max_f32 v26, v26, v27
  v_add_f32 v26, 0x42cc0000, v26
  v_max_f32 v26, 0, v26
  v_mul_f32 v27, -0.5, v26
  v_exp_f32 v27, v27
  v_sub_f32 v176, v176, v26
  v_sub_f32 v177, v177, v26
  v_sub_f32 v178, v178, v26
  v_sub_f32 v179, v179, v26
  v_sub_f32 v180, v180, v26
  v_sub_f32 v181, v181, v26
  v_sub_f32 v182, v182, v26
  v_sub_f32 v183, v183, v26
  v_sub_f32 v184, v184, v26
  v_sub_f32 v185, v185, v26
  v_sub_f32 v186, v186, v26
  v_sub_f32 v187, v187, v26
  v_sub_f32 v188, v188, v26
  v_sub_f32 v189, v189, v26
  v_sub_f32 v190, v190, v26
  v_sub_f32 v191, v191, v26
  v_sub_f32 v80, v80, v26
  v_sub_f32 v81, v81, v26
  v_sub_f32 v82, v82, v26
  v_sub_f32 v83, v83, v26
  v_sub_f32 v84, v84, v26
  v_sub_f32 v85, v85, v26
  v_sub_f32 v86, v86, v26
  v_sub_f32 v87, v87, v26
  v_sub_f32 v88, v88, v26
  v_sub_f32 v89, v89, v26
  v_sub_f32 v90, v90, v26
  v_sub_f32 v91, v91, v26
  v_sub_f32 v92, v92, v26
  v_sub_f32 v93, v93, v26
  v_sub_f32 v94, v94, v26
  v_sub_f32 v95, v95, v26
  v_sub_f32 v112, v112, v26
  v_sub_f32 v113, v113, v26
  v_sub_f32 v114, v114, v26
  v_sub_f32 v115, v115, v26
  v_sub_f32 v116, v116, v26
  v_sub_f32 v117, v117, v26
  v_sub_f32 v118, v118, v26
  v_sub_f32 v119, v119, v26
  v_sub_f32 v120, v120, v26
  v_sub_f32 v121, v121, v26
  v_sub_f32 v122, v122, v26
  v_sub_f32 v123, v123, v26
  v_sub_f32 v124, v124, v26
  v_sub_f32 v125, v125, v26
  v_sub_f32 v126, v126, v26
  v_sub_f32 v127, v127, v26
  v_mul_f32 v21, v21, v27
  v_mul_f32 v21, v21, v27
  v_exp_f32 v40, v112
  v_exp_f32 v41, v113
  v_exp_f32 v42, v114
  v_add_f32 v23, v40, v41
  v_exp_f32 v43, v115
  v_cvt_pk_bf16_f32 v152, v40, v41
  v_exp_f32 v44, v116
  v_add_f32 v23, v23, v42
  v_exp_f32 v45, v117
  v_add_f32 v23, v23, v43
  v_cvt_pk_bf16_f32 v153, v42, v43
  v_exp_f32 v46, v118
  v_add_f32 v23, v23, v44
  v_exp_f32 v47, v119
  v_add_f32 v23, v23, v45
  v_cvt_pk_bf16_f32 v154, v44, v45
  v_exp_f32 v40, v120
  v_add_f32 v23, v23, v46
  v_exp_f32 v41, v121
  v_add_f32 v23, v23, v47
  v_cvt_pk_bf16_f32 v155, v46, v47
  v_exp_f32 v42, v122
  v_add_f32 v23, v23, v40
  v_exp_f32 v43, v123
  v_add_f32 v23, v23, v41
  v_cvt_pk_bf16_f32 v156, v40, v41
  v_exp_f32 v44, v124
  v_add_f32 v23, v23, v42
  v_exp_f32 v45, v125
  v_add_f32 v23, v23, v43
  v_cvt_pk_bf16_f32 v157, v42, v43
  v_exp_f32 v46, v126
  v_add_f32 v23, v23, v44
  v_exp_f32 v47, v127
  v_add_f32 v23, v23, v45
  v_cvt_pk_bf16_f32 v158, v44, v45
  v_add_f32 v23, v23, v46
  v_add_f32 v23, v23, v47
  v_cvt_pk_bf16_f32 v159, v46, v47
  v_accvgpr_read_b32 v48, a64
  v_accvgpr_read_b32 v49, a65
  v_accvgpr_read_b32 v50, a66
  v_accvgpr_read_b32 v51, a67
  v_accvgpr_read_b32 v52, a68
  v_accvgpr_read_b32 v53, a69
  v_accvgpr_read_b32 v54, a70
  v_accvgpr_read_b32 v55, a71
  v_mul_f32 v48, v48, v27
  v_mul_f32 v49, v49, v27
  v_mul_f32 v50, v50, v27
  v_mul_f32 v51, v51, v27
  v_mul_f32 v52, v52, v27
  v_mul_f32 v53, v53, v27
  v_mul_f32 v54, v54, v27
  v_mul_f32 v55, v55, v27
  v_mul_f32 v48, v48, v27
  v_mul_f32 v49, v49, v27
  v_mul_f32 v50, v50, v27
  v_mul_f32 v51, v51, v27
  v_mul_f32 v52, v52, v27
  v_mul_f32 v53, v53, v27
  v_mul_f32 v54, v54, v27
  v_mul_f32 v55, v55, v27
  v_accvgpr_write_b32 a64, v48
  v_accvgpr_write_b32 a65, v49
  v_accvgpr_write_b32 a66, v50
  v_accvgpr_write_b32 a67, v51
  v_accvgpr_write_b32 a68, v52
  v_accvgpr_write_b32 a69, v53
  v_accvgpr_write_b32 a70, v54
  v_accvgpr_write_b32 a71, v55
  v_accvgpr_read_b32 v48, a72
  v_accvgpr_read_b32 v49, a73
  v_accvgpr_read_b32 v50, a74
  v_accvgpr_read_b32 v51, a75
  v_accvgpr_read_b32 v52, a76
  v_accvgpr_read_b32 v53, a77
  v_accvgpr_read_b32 v54, a78
  v_accvgpr_read_b32 v55, a79
  v_mul_f32 v48, v48, v27
  v_mul_f32 v49, v49, v27
  v_mul_f32 v50, v50, v27
  v_mul_f32 v51, v51, v27
  v_mul_f32 v52, v52, v27
  v_mul_f32 v53, v53, v27
  v_mul_f32 v54, v54, v27
  v_mul_f32 v55, v55, v27
  v_mul_f32 v48, v48, v27
  v_mul_f32 v49, v49, v27
  v_mul_f32 v50, v50, v27
  v_mul_f32 v51, v51, v27
  v_mul_f32 v52, v52, v27
  v_mul_f32 v53, v53, v27
  v_mul_f32 v54, v54, v27
  v_mul_f32 v55, v55, v27
  v_accvgpr_write_b32 a72, v48
  v_accvgpr_write_b32 a73, v49
  v_accvgpr_write_b32 a74, v50
  v_accvgpr_write_b32 a75, v51
  v_accvgpr_write_b32 a76, v52
  v_accvgpr_write_b32 a77, v53
  v_accvgpr_write_b32 a78, v54
  v_accvgpr_write_b32 a79, v55
  v_accvgpr_read_b32 v48, a80
  v_accvgpr_read_b32 v49, a81
  v_accvgpr_read_b32 v50, a82
  v_accvgpr_read_b32 v51, a83
  v_accvgpr_read_b32 v52, a84
  v_accvgpr_read_b32 v53, a85
  v_accvgpr_read_b32 v54, a86
  v_accvgpr_read_b32 v55, a87
  v_mul_f32 v48, v48, v27
  v_mul_f32 v49, v49, v27
  v_mul_f32 v50, v50, v27
  v_mul_f32 v51, v51, v27
  v_mul_f32 v52, v52, v27
  v_mul_f32 v53, v53, v27
  v_mul_f32 v54, v54, v27
  v_mul_f32 v55, v55, v27
  v_mul_f32 v48, v48, v27
  v_mul_f32 v49, v49, v27
  v_mul_f32 v50, v50, v27
  v_mul_f32 v51, v51, v27
  v_mul_f32 v52, v52, v27
  v_mul_f32 v53, v53, v27
  v_mul_f32 v54, v54, v27
  v_mul_f32 v55, v55, v27
  v_accvgpr_write_b32 a80, v48
  v_accvgpr_write_b32 a81, v49
  v_accvgpr_write_b32 a82, v50
  v_accvgpr_write_b32 a83, v51
  v_accvgpr_write_b32 a84, v52
  v_accvgpr_write_b32 a85, v53
  v_accvgpr_write_b32 a86, v54
  v_accvgpr_write_b32 a87, v55
  v_accvgpr_read_b32 v48, a88
  v_accvgpr_read_b32 v49, a89
  v_accvgpr_read_b32 v50, a90
  v_accvgpr_read_b32 v51, a91
  v_accvgpr_read_b32 v52, a92
  v_accvgpr_read_b32 v53, a93
  v_accvgpr_read_b32 v54, a94
  v_accvgpr_read_b32 v55, a95
  v_mul_f32 v48, v48, v27
  v_mul_f32 v49, v49, v27
  v_mul_f32 v50, v50, v27
  v_mul_f32 v51, v51, v27
  v_mul_f32 v52, v52, v27
  v_mul_f32 v53, v53, v27
  v_mul_f32 v54, v54, v27
  v_mul_f32 v55, v55, v27
  v_mul_f32 v48, v48, v27
  v_mul_f32 v49, v49, v27
  v_mul_f32 v50, v50, v27
  v_mul_f32 v51, v51, v27
  v_mul_f32 v52, v52, v27
  v_mul_f32 v53, v53, v27
  v_mul_f32 v54, v54, v27
  v_mul_f32 v55, v55, v27
  v_accvgpr_write_b32 a88, v48
  v_accvgpr_write_b32 a89, v49
  v_accvgpr_write_b32 a90, v50
  v_accvgpr_write_b32 a91, v51
  v_accvgpr_write_b32 a92, v52
  v_accvgpr_write_b32 a93, v53
  v_accvgpr_write_b32 a94, v54
  v_accvgpr_write_b32 a95, v55
  v_accvgpr_read_b32 v48, a96
  v_accvgpr_read_b32 v49, a97
  v_accvgpr_read_b32 v50, a98
  v_accvgpr_read_b32 v51, a99
  v_accvgpr_read_b32 v52, a100
  v_accvgpr_read_b32 v53, a101
  v_accvgpr_read_b32 v54, a102
  v_accvgpr_read_b32 v55, a103
  v_mul_f32 v48, v48, v27
  v_mul_f32 v49, v49, v27
  v_mul_f32 v50, v50, v27
  v_mul_f32 v51, v51, v27
  v_mul_f32 v52, v52, v27
  v_mul_f32 v53, v53, v27
  v_mul_f32 v54, v54, v27
  v_mul_f32 v55, v55, v27
  v_mul_f32 v48, v48, v27
  v_mul_f32 v49, v49, v27
  v_mul_f32 v50, v50, v27
  v_mul_f32 v51, v51, v27
  v_mul_f32 v52, v52, v27
  v_mul_f32 v53, v53, v27
  v_mul_f32 v54, v54, v27
  v_mul_f32 v55, v55, v27
  v_accvgpr_write_b32 a96, v48
  v_accvgpr_write_b32 a97, v49
  v_accvgpr_write_b32 a98, v50
  v_accvgpr_write_b32 a99, v51
  v_accvgpr_write_b32 a100, v52
  v_accvgpr_write_b32 a101, v53
  v_accvgpr_write_b32 a102, v54
  v_accvgpr_write_b32 a103, v55
  v_accvgpr_read_b32 v48, a104
  v_accvgpr_read_b32 v49, a105
  v_accvgpr_read_b32 v50, a106
  v_accvgpr_read_b32 v51, a107
  v_accvgpr_read_b32 v52, a108
  v_accvgpr_read_b32 v53, a109
  v_accvgpr_read_b32 v54, a110
  v_accvgpr_read_b32 v55, a111
  v_mul_f32 v48, v48, v27
  v_mul_f32 v49, v49, v27
  v_mul_f32 v50, v50, v27
  v_mul_f32 v51, v51, v27
  v_mul_f32 v52, v52, v27
  v_mul_f32 v53, v53, v27
  v_mul_f32 v54, v54, v27
  v_mul_f32 v55, v55, v27
  v_mul_f32 v48, v48, v27
  v_mul_f32 v49, v49, v27
  v_mul_f32 v50, v50, v27
  v_mul_f32 v51, v51, v27
  v_mul_f32 v52, v52, v27
  v_mul_f32 v53, v53, v27
  v_mul_f32 v54, v54, v27
  v_mul_f32 v55, v55, v27
  v_accvgpr_write_b32 a104, v48
  v_accvgpr_write_b32 a105, v49
  v_accvgpr_write_b32 a106, v50
  v_accvgpr_write_b32 a107, v51
  v_accvgpr_write_b32 a108, v52
  v_accvgpr_write_b32 a109, v53
  v_accvgpr_write_b32 a110, v54
  v_accvgpr_write_b32 a111, v55
  v_accvgpr_read_b32 v48, a112
  v_accvgpr_read_b32 v49, a113
  v_accvgpr_read_b32 v50, a114
  v_accvgpr_read_b32 v51, a115
  v_accvgpr_read_b32 v52, a116
  v_accvgpr_read_b32 v53, a117
  v_accvgpr_read_b32 v54, a118
  v_accvgpr_read_b32 v55, a119
  v_mul_f32 v48, v48, v27
  v_mul_f32 v49, v49, v27
  v_mul_f32 v50, v50, v27
  v_mul_f32 v51, v51, v27
  v_mul_f32 v52, v52, v27
  v_mul_f32 v53, v53, v27
  v_mul_f32 v54, v54, v27
  v_mul_f32 v55, v55, v27
  v_mul_f32 v48, v48, v27
  v_mul_f32 v49, v49, v27
  v_mul_f32 v50, v50, v27
  v_mul_f32 v51, v51, v27
  v_mul_f32 v52, v52, v27
  v_mul_f32 v53, v53, v27
  v_mul_f32 v54, v54, v27
  v_mul_f32 v55, v55, v27
  v_accvgpr_write_b32 a112, v48
  v_accvgpr_write_b32 a113, v49
  v_accvgpr_write_b32 a114, v50
  v_accvgpr_write_b32 a115, v51
  v_accvgpr_write_b32 a116, v52
  v_accvgpr_write_b32 a117, v53
  v_accvgpr_write_b32 a118, v54
  v_accvgpr_write_b32 a119, v55
  v_accvgpr_read_b32 v48, a120
  v_accvgpr_read_b32 v49, a121
  v_accvgpr_read_b32 v50, a122
  v_accvgpr_read_b32 v51, a123
  v_accvgpr_read_b32 v52, a124
  v_accvgpr_read_b32 v53, a125
  v_accvgpr_read_b32 v54, a126
  v_accvgpr_read_b32 v55, a127
  v_mul_f32 v48, v48, v27
  v_mul_f32 v49, v49, v27
  v_mul_f32 v50, v50, v27
  v_mul_f32 v51, v51, v27
  v_mul_f32 v52, v52, v27
  v_mul_f32 v53, v53, v27
  v_mul_f32 v54, v54, v27
  v_mul_f32 v55, v55, v27
  v_mul_f32 v48, v48, v27
  v_mul_f32 v49, v49, v27
  v_mul_f32 v50, v50, v27
  v_mul_f32 v51, v51, v27
  v_mul_f32 v52, v52, v27
  v_mul_f32 v53, v53, v27
  v_mul_f32 v54, v54, v27
  v_mul_f32 v55, v55, v27
  v_accvgpr_write_b32 a120, v48
  v_accvgpr_write_b32 a121, v49
  v_accvgpr_write_b32 a122, v50
  v_accvgpr_write_b32 a123, v51
  v_accvgpr_write_b32 a124, v52
  v_accvgpr_write_b32 a125, v53
  v_accvgpr_write_b32 a126, v54
  v_accvgpr_write_b32 a127, v55
  s_nop 1
  s_setpc_b64 s[82:83]
attn_kernel_fix46:
  s_nop 15
  v_max3_f32 v26, v64, v65, v66
  v_max3_f32 v27, v67, v68, v69
  v_max3_f32 v26, v26, v70, v71
  v_max3_f32 v27, v27, v72, v73
  v_max3_f32 v26, v26, v74, v75
  v_max3_f32 v27, v27, v76, v77
  v_max3_f32 v26, v26, v78, v79
  v_max_f32 v26, v26, v27
  v_mov_b32 v27, v26
  s_nop 1
  v_permlane32_swap_b32 v26, v27
  v_max_f32 v26, v26, v27
  v_add_f32 v26, 0x42cc0000, v26
  v_max_f32 v26, 0, v26
  v_mul_f32 v27, -0.5, v26
  v_exp_f32 v27, v27
  v_sub_f32 v160, v160, v26
  v_sub_f32 v161, v161, v26
  v_sub_f32 v162, v162, v26
  v_sub_f32 v163, v163, v26
  v_sub_f32 v164, v164, v26
  v_sub_f32 v165, v165, v26
  v_sub_f32 v166, v166, v26
  v_sub_f32 v167, v167, v26
  v_sub_f32 v168, v168, v26
  v_sub_f32 v169, v169, v26
  v_sub_f32 v170, v170, v26
  v_sub_f32 v171, v171, v26
  v_sub_f32 v172, v172, v26
  v_sub_f32 v173, v173, v26
  v_sub_f32 v174, v174, v26
  v_sub_f32 v175, v175, v26
  v_sub_f32 v96, v96, v26
  v_sub_f32 v97, v97, v26
  v_sub_f32 v98, v98, v26
  v_sub_f32 v99, v99, v26
  v_sub_f32 v100, v100, v26
  v_sub_f32 v101, v101, v26
  v_sub_f32 v102, v102, v26
  v_sub_f32 v103, v103, v26
  v_sub_f32 v104, v104, v26
  v_sub_f32 v105, v105, v26
  v_sub_f32 v106, v106, v26
  v_sub_f32 v107, v107, v26
  v_sub_f32 v108, v108, v26
  v_sub_f32 v109, v109, v26
  v_sub_f32 v110, v110, v26
  v_sub_f32 v111, v111, v26
  v_sub_f32 v64, v64, v26
  v_sub_f32 v65, v65, v26
  v_sub_f32 v66, v66, v26
  v_sub_f32 v67, v67, v26
  v_sub_f32 v68, v68, v26
  v_sub_f32 v69, v69, v26
  v_sub_f32 v70, v70, v26
  v_sub_f32 v71, v71, v26
  v_sub_f32 v72, v72, v26
  v_sub_f32 v73, v73, v26
  v_sub_f32 v74, v74, v26
  v_sub_f32 v75, v75, v26
  v_sub_f32 v76, v76, v26
  v_sub_f32 v77, v77, v26
  v_sub_f32 v78, v78, v26
  v_sub_f32 v79, v79, v26
  v_mul_f32 v20, v20, v27
  v_mul_f32 v20, v20, v27
  v_exp_f32 v32, v64
  v_exp_f32 v33, v65
  v_exp_f32 v34, v66
  v_add_f32 v22, v32, v33
  v_exp_f32 v35, v67
  v_cvt_pk_bf16_f32 v128, v32, v33
  v_exp_f32 v36, v68
  v_add_f32 v22, v22, v34
  v_exp_f32 v37, v69
  v_add_f32 v22, v22, v35
  v_cvt_pk_bf16_f32 v129, v34, v35
  v_exp_f32 v38, v70
  v_add_f32 v22, v22, v36
  v_exp_f32 v39, v71
  v_add_f32 v22, v22, v37
  v_cvt_pk_bf16_f32 v130, v36, v37
  v_exp_f32 v32, v72
  v_add_f32 v22, v22, v38
  v_exp_f32 v33, v73
  v_add_f32 v22, v22, v39
  v_cvt_pk_bf16_f32 v131, v38, v39
  v_exp_f32 v34, v74
  v_add_f32 v22, v22, v32
  v_exp_f32 v35, v75
  v_add_f32 v22, v22, v33
  v_cvt_pk_bf16_f32 v132, v32, v33
  v_exp_f32 v36, v76
  v_add_f32 v22, v22, v34
  v_exp_f32 v37, v77
  v_add_f32 v22, v22, v35
  v_cvt_pk_bf16_f32 v133, v34, v35
  v_exp_f32 v38, v78
  v_add_f32 v22, v22, v36
  v_exp_f32 v39, v79
  v_add_f32 v22, v22, v37
  v_cvt_pk_bf16_f32 v134, v36, v37
  v_add_f32 v22, v22, v38
  v_add_f32 v22, v22, v39
  v_cvt_pk_bf16_f32 v135, v38, v39
  v_accvgpr_read_b32 v48, a0
  v_accvgpr_read_b32 v49, a1
  v_accvgpr_read_b32 v50, a2
  v_accvgpr_read_b32 v51, a3
  v_accvgpr_read_b32 v52, a4
  v_accvgpr_read_b32 v53, a5
  v_accvgpr_read_b32 v54, a6
  v_accvgpr_read_b32 v55, a7
  v_mul_f32 v48, v48, v27
  v_mul_f32 v49, v49, v27
  v_mul_f32 v50, v50, v27
  v_mul_f32 v51, v51, v27
  v_mul_f32 v52, v52, v27
  v_mul_f32 v53, v53, v27
  v_mul_f32 v54, v54, v27
  v_mul_f32 v55, v55, v27
  v_mul_f32 v48, v48, v27
  v_mul_f32 v49, v49, v27
  v_mul_f32 v50, v50, v27
  v_mul_f32 v51, v51, v27
  v_mul_f32 v52, v52, v27
  v_mul_f32 v53, v53, v27
  v_mul_f32 v54, v54, v27
  v_mul_f32 v55, v55, v27
  v_accvgpr_write_b32 a0, v48
  v_accvgpr_write_b32 a1, v49
  v_accvgpr_write_b32 a2, v50
  v_accvgpr_write_b32 a3, v51
  v_accvgpr_write_b32 a4, v52
  v_accvgpr_write_b32 a5, v53
  v_accvgpr_write_b32 a6, v54
  v_accvgpr_write_b32 a7, v55
  v_accvgpr_read_b32 v48, a8
  v_accvgpr_read_b32 v49, a9
  v_accvgpr_read_b32 v50, a10
  v_accvgpr_read_b32 v51, a11
  v_accvgpr_read_b32 v52, a12
  v_accvgpr_read_b32 v53, a13
  v_accvgpr_read_b32 v54, a14
  v_accvgpr_read_b32 v55, a15
  v_mul_f32 v48, v48, v27
  v_mul_f32 v49, v49, v27
  v_mul_f32 v50, v50, v27
  v_mul_f32 v51, v51, v27
  v_mul_f32 v52, v52, v27
  v_mul_f32 v53, v53, v27
  v_mul_f32 v54, v54, v27
  v_mul_f32 v55, v55, v27
  v_mul_f32 v48, v48, v27
  v_mul_f32 v49, v49, v27
  v_mul_f32 v50, v50, v27
  v_mul_f32 v51, v51, v27
  v_mul_f32 v52, v52, v27
  v_mul_f32 v53, v53, v27
  v_mul_f32 v54, v54, v27
  v_mul_f32 v55, v55, v27
  v_accvgpr_write_b32 a8, v48
  v_accvgpr_write_b32 a9, v49
  v_accvgpr_write_b32 a10, v50
  v_accvgpr_write_b32 a11, v51
  v_accvgpr_write_b32 a12, v52
  v_accvgpr_write_b32 a13, v53
  v_accvgpr_write_b32 a14, v54
  v_accvgpr_write_b32 a15, v55
  v_accvgpr_read_b32 v48, a16
  v_accvgpr_read_b32 v49, a17
  v_accvgpr_read_b32 v50, a18
  v_accvgpr_read_b32 v51, a19
  v_accvgpr_read_b32 v52, a20
  v_accvgpr_read_b32 v53, a21
  v_accvgpr_read_b32 v54, a22
  v_accvgpr_read_b32 v55, a23
  v_mul_f32 v48, v48, v27
  v_mul_f32 v49, v49, v27
  v_mul_f32 v50, v50, v27
  v_mul_f32 v51, v51, v27
  v_mul_f32 v52, v52, v27
  v_mul_f32 v53, v53, v27
  v_mul_f32 v54, v54, v27
  v_mul_f32 v55, v55, v27
  v_mul_f32 v48, v48, v27
  v_mul_f32 v49, v49, v27
  v_mul_f32 v50, v50, v27
  v_mul_f32 v51, v51, v27
  v_mul_f32 v52, v52, v27
  v_mul_f32 v53, v53, v27
  v_mul_f32 v54, v54, v27
  v_mul_f32 v55, v55, v27
  v_accvgpr_write_b32 a16, v48
  v_accvgpr_write_b32 a17, v49
  v_accvgpr_write_b32 a18, v50
  v_accvgpr_write_b32 a19, v51
  v_accvgpr_write_b32 a20, v52
  v_accvgpr_write_b32 a21, v53
  v_accvgpr_write_b32 a22, v54
  v_accvgpr_write_b32 a23, v55
  v_accvgpr_read_b32 v48, a24
  v_accvgpr_read_b32 v49, a25
  v_accvgpr_read_b32 v50, a26
  v_accvgpr_read_b32 v51, a27
  v_accvgpr_read_b32 v52, a28
  v_accvgpr_read_b32 v53, a29
  v_accvgpr_read_b32 v54, a30
  v_accvgpr_read_b32 v55, a31
  v_mul_f32 v48, v48, v27
  v_mul_f32 v49, v49, v27
  v_mul_f32 v50, v50, v27
  v_mul_f32 v51, v51, v27
  v_mul_f32 v52, v52, v27
  v_mul_f32 v53, v53, v27
  v_mul_f32 v54, v54, v27
  v_mul_f32 v55, v55, v27
  v_mul_f32 v48, v48, v27
  v_mul_f32 v49, v49, v27
  v_mul_f32 v50, v50, v27
  v_mul_f32 v51, v51, v27
  v_mul_f32 v52, v52, v27
  v_mul_f32 v53, v53, v27
  v_mul_f32 v54, v54, v27
  v_mul_f32 v55, v55, v27
  v_accvgpr_write_b32 a24, v48
  v_accvgpr_write_b32 a25, v49
  v_accvgpr_write_b32 a26, v50
  v_accvgpr_write_b32 a27, v51
  v_accvgpr_write_b32 a28, v52
  v_accvgpr_write_b32 a29, v53
  v_accvgpr_write_b32 a30, v54
  v_accvgpr_write_b32 a31, v55
  v_accvgpr_read_b32 v48, a32
  v_accvgpr_read_b32 v49, a33
  v_accvgpr_read_b32 v50, a34
  v_accvgpr_read_b32 v51, a35
  v_accvgpr_read_b32 v52, a36
  v_accvgpr_read_b32 v53, a37
  v_accvgpr_read_b32 v54, a38
  v_accvgpr_read_b32 v55, a39
  v_mul_f32 v48, v48, v27
  v_mul_f32 v49, v49, v27
  v_mul_f32 v50, v50, v27
  v_mul_f32 v51, v51, v27
  v_mul_f32 v52, v52, v27
  v_mul_f32 v53, v53, v27
  v_mul_f32 v54, v54, v27
  v_mul_f32 v55, v55, v27
  v_mul_f32 v48, v48, v27
  v_mul_f32 v49, v49, v27
  v_mul_f32 v50, v50, v27
  v_mul_f32 v51, v51, v27
  v_mul_f32 v52, v52, v27
  v_mul_f32 v53, v53, v27
  v_mul_f32 v54, v54, v27
  v_mul_f32 v55, v55, v27
  v_accvgpr_write_b32 a32, v48
  v_accvgpr_write_b32 a33, v49
  v_accvgpr_write_b32 a34, v50
  v_accvgpr_write_b32 a35, v51
  v_accvgpr_write_b32 a36, v52
  v_accvgpr_write_b32 a37, v53
  v_accvgpr_write_b32 a38, v54
  v_accvgpr_write_b32 a39, v55
  v_accvgpr_read_b32 v48, a40
  v_accvgpr_read_b32 v49, a41
  v_accvgpr_read_b32 v50, a42
  v_accvgpr_read_b32 v51, a43
  v_accvgpr_read_b32 v52, a44
  v_accvgpr_read_b32 v53, a45
  v_accvgpr_read_b32 v54, a46
  v_accvgpr_read_b32 v55, a47
  v_mul_f32 v48, v48, v27
  v_mul_f32 v49, v49, v27
  v_mul_f32 v50, v50, v27
  v_mul_f32 v51, v51, v27
  v_mul_f32 v52, v52, v27
  v_mul_f32 v53, v53, v27
  v_mul_f32 v54, v54, v27
  v_mul_f32 v55, v55, v27
  v_mul_f32 v48, v48, v27
  v_mul_f32 v49, v49, v27
  v_mul_f32 v50, v50, v27
  v_mul_f32 v51, v51, v27
  v_mul_f32 v52, v52, v27
  v_mul_f32 v53, v53, v27
  v_mul_f32 v54, v54, v27
  v_mul_f32 v55, v55, v27
  v_accvgpr_write_b32 a40, v48
  v_accvgpr_write_b32 a41, v49
  v_accvgpr_write_b32 a42, v50
  v_accvgpr_write_b32 a43, v51
  v_accvgpr_write_b32 a44, v52
  v_accvgpr_write_b32 a45, v53
  v_accvgpr_write_b32 a46, v54
  v_accvgpr_write_b32 a47, v55
  v_accvgpr_read_b32 v48, a48
  v_accvgpr_read_b32 v49, a49
  v_accvgpr_read_b32 v50, a50
  v_accvgpr_read_b32 v51, a51
  v_accvgpr_read_b32 v52, a52
  v_accvgpr_read_b32 v53, a53
  v_accvgpr_read_b32 v54, a54
  v_accvgpr_read_b32 v55, a55
  v_mul_f32 v48, v48, v27
  v_mul_f32 v49, v49, v27
  v_mul_f32 v50, v50, v27
  v_mul_f32 v51, v51, v27
  v_mul_f32 v52, v52, v27
  v_mul_f32 v53, v53, v27
  v_mul_f32 v54, v54, v27
  v_mul_f32 v55, v55, v27
  v_mul_f32 v48, v48, v27
  v_mul_f32 v49, v49, v27
  v_mul_f32 v50, v50, v27
  v_mul_f32 v51, v51, v27
  v_mul_f32 v52, v52, v27
  v_mul_f32 v53, v53, v27
  v_mul_f32 v54, v54, v27
  v_mul_f32 v55, v55, v27
  v_accvgpr_write_b32 a48, v48
  v_accvgpr_write_b32 a49, v49
  v_accvgpr_write_b32 a50, v50
  v_accvgpr_write_b32 a51, v51
  v_accvgpr_write_b32 a52, v52
  v_accvgpr_write_b32 a53, v53
  v_accvgpr_write_b32 a54, v54
  v_accvgpr_write_b32 a55, v55
  v_accvgpr_read_b32 v48, a56
  v_accvgpr_read_b32 v49, a57
  v_accvgpr_read_b32 v50, a58
  v_accvgpr_read_b32 v51, a59
  v_accvgpr_read_b32 v52, a60
  v_accvgpr_read_b32 v53, a61
  v_accvgpr_read_b32 v54, a62
  v_accvgpr_read_b32 v55, a63
  v_mul_f32 v48, v48, v27
  v_mul_f32 v49, v49, v27
  v_mul_f32 v50, v50, v27
  v_mul_f32 v51, v51, v27
  v_mul_f32 v52, v52, v27
  v_mul_f32 v53, v53, v27
  v_mul_f32 v54, v54, v27
  v_mul_f32 v55, v55, v27
  v_mul_f32 v48, v48, v27
  v_mul_f32 v49, v49, v27
  v_mul_f32 v50, v50, v27
  v_mul_f32 v51, v51, v27
  v_mul_f32 v52, v52, v27
  v_mul_f32 v53, v53, v27
  v_mul_f32 v54, v54, v27
  v_mul_f32 v55, v55, v27
  v_accvgpr_write_b32 a56, v48
  v_accvgpr_write_b32 a57, v49
  v_accvgpr_write_b32 a58, v50
  v_accvgpr_write_b32 a59, v51
  v_accvgpr_write_b32 a60, v52
  v_accvgpr_write_b32 a61, v53
  v_accvgpr_write_b32 a62, v54
  v_accvgpr_write_b32 a63, v55
  v_max3_f32 v26, v80, v81, v82
  v_max3_f32 v27, v83, v84, v85
  v_max3_f32 v26, v26, v86, v87
  v_max3_f32 v27, v27, v88, v89
  v_max3_f32 v26, v26, v90, v91
  v_max3_f32 v27, v27, v92, v93
  v_max3_f32 v26, v26, v94, v95
  v_max_f32 v26, v26, v27
  v_mov_b32 v27, v26
  s_nop 1
  v_permlane32_swap_b32 v26, v27
  v_max_f32 v26, v26, v27
  v_add_f32 v26, 0x42cc0000, v26
  v_max_f32 v26, 0, v26
  v_mul_f32 v27, -0.5, v26
  v_exp_f32 v27, v27
  v_sub_f32 v176, v176, v26
  v_sub_f32 v177, v177, v26
  v_sub_f32 v178, v178, v26
  v_sub_f32 v179, v179, v26
  v_sub_f32 v180, v180, v26
  v_sub_f32 v181, v181, v26
  v_sub_f32 v182, v182, v26
  v_sub_f32 v183, v183, v26
  v_sub_f32 v184, v184, v26
  v_sub_f32 v185, v185, v26
  v_sub_f32 v186, v186, v26
  v_sub_f32 v187, v187, v26
  v_sub_f32 v188, v188, v26
  v_sub_f32 v189, v189, v26
  v_sub_f32 v190, v190, v26
  v_sub_f32 v191, v191, v26
  v_sub_f32 v112, v112, v26
  v_sub_f32 v113, v113, v26
  v_sub_f32 v114, v114, v26
  v_sub_f32 v115, v115, v26
  v_sub_f32 v116, v116, v26
  v_sub_f32 v117, v117, v26
  v_sub_f32 v118, v118, v26
  v_sub_f32 v119, v119, v26
  v_sub_f32 v120, v120, v26
  v_sub_f32 v121, v121, v26
  v_sub_f32 v122, v122, v26
  v_sub_f32 v123, v123, v26
  v_sub_f32 v124, v124, v26
  v_sub_f32 v125, v125, v26
  v_sub_f32 v126, v126, v26
  v_sub_f32 v127, v127, v26
  v_sub_f32 v80, v80, v26
  v_sub_f32 v81, v81, v26
  v_sub_f32 v82, v82, v26
  v_sub_f32 v83, v83, v26
  v_sub_f32 v84, v84, v26
  v_sub_f32 v85, v85, v26
  v_sub_f32 v86, v86, v26
  v_sub_f32 v87, v87, v26
  v_sub_f32 v88, v88, v26
  v_sub_f32 v89, v89, v26
  v_sub_f32 v90, v90, v26
  v_sub_f32 v91, v91, v26
  v_sub_f32 v92, v92, v26
  v_sub_f32 v93, v93, v26
  v_sub_f32 v94, v94, v26
  v_sub_f32 v95, v95, v26
  v_mul_f32 v21, v21, v27
  v_mul_f32 v21, v21, v27
  v_exp_f32 v40, v80
  v_exp_f32 v41, v81
  v_exp_f32 v42, v82
  v_add_f32 v23, v40, v41
  v_exp_f32 v43, v83
  v_cvt_pk_bf16_f32 v136, v40, v41
  v_exp_f32 v44, v84
  v_add_f32 v23, v23, v42
  v_exp_f32 v45, v85
  v_add_f32 v23, v23, v43
  v_cvt_pk_bf16_f32 v137, v42, v43
  v_exp_f32 v46, v86
  v_add_f32 v23, v23, v44
  v_exp_f32 v47, v87
  v_add_f32 v23, v23, v45
  v_cvt_pk_bf16_f32 v138, v44, v45
  v_exp_f32 v40, v88
  v_add_f32 v23, v23, v46
  v_exp_f32 v41, v89
  v_add_f32 v23, v23, v47
  v_cvt_pk_bf16_f32 v139, v46, v47
  v_exp_f32 v42, v90
  v_add_f32 v23, v23, v40
  v_exp_f32 v43, v91
  v_add_f32 v23, v23, v41
  v_cvt_pk_bf16_f32 v140, v40, v41
  v_exp_f32 v44, v92
  v_add_f32 v23, v23, v42
  v_exp_f32 v45, v93
  v_add_f32 v23, v23, v43
  v_cvt_pk_bf16_f32 v141, v42, v43
  v_exp_f32 v46, v94
  v_add_f32 v23, v23, v44
  v_exp_f32 v47, v95
  v_add_f32 v23, v23, v45
  v_cvt_pk_bf16_f32 v142, v44, v45
  v_add_f32 v23, v23, v46
  v_add_f32 v23, v23, v47
  v_cvt_pk_bf16_f32 v143, v46, v47
  v_accvgpr_read_b32 v48, a64
  v_accvgpr_read_b32 v49, a65
  v_accvgpr_read_b32 v50, a66
  v_accvgpr_read_b32 v51, a67
  v_accvgpr_read_b32 v52, a68
  v_accvgpr_read_b32 v53, a69
  v_accvgpr_read_b32 v54, a70
  v_accvgpr_read_b32 v55, a71
  v_mul_f32 v48, v48, v27
  v_mul_f32 v49, v49, v27
  v_mul_f32 v50, v50, v27
  v_mul_f32 v51, v51, v27
  v_mul_f32 v52, v52, v27
  v_mul_f32 v53, v53, v27
  v_mul_f32 v54, v54, v27
  v_mul_f32 v55, v55, v27
  v_mul_f32 v48, v48, v27
  v_mul_f32 v49, v49, v27
  v_mul_f32 v50, v50, v27
  v_mul_f32 v51, v51, v27
  v_mul_f32 v52, v52, v27
  v_mul_f32 v53, v53, v27
  v_mul_f32 v54, v54, v27
  v_mul_f32 v55, v55, v27
  v_accvgpr_write_b32 a64, v48
  v_accvgpr_write_b32 a65, v49
  v_accvgpr_write_b32 a66, v50
  v_accvgpr_write_b32 a67, v51
  v_accvgpr_write_b32 a68, v52
  v_accvgpr_write_b32 a69, v53
  v_accvgpr_write_b32 a70, v54
  v_accvgpr_write_b32 a71, v55
  v_accvgpr_read_b32 v48, a72
  v_accvgpr_read_b32 v49, a73
  v_accvgpr_read_b32 v50, a74
  v_accvgpr_read_b32 v51, a75
  v_accvgpr_read_b32 v52, a76
  v_accvgpr_read_b32 v53, a77
  v_accvgpr_read_b32 v54, a78
  v_accvgpr_read_b32 v55, a79
  v_mul_f32 v48, v48, v27
  v_mul_f32 v49, v49, v27
  v_mul_f32 v50, v50, v27
  v_mul_f32 v51, v51, v27
  v_mul_f32 v52, v52, v27
  v_mul_f32 v53, v53, v27
  v_mul_f32 v54, v54, v27
  v_mul_f32 v55, v55, v27
  v_mul_f32 v48, v48, v27
  v_mul_f32 v49, v49, v27
  v_mul_f32 v50, v50, v27
  v_mul_f32 v51, v51, v27
  v_mul_f32 v52, v52, v27
  v_mul_f32 v53, v53, v27
  v_mul_f32 v54, v54, v27
  v_mul_f32 v55, v55, v27
  v_accvgpr_write_b32 a72, v48
  v_accvgpr_write_b32 a73, v49
  v_accvgpr_write_b32 a74, v50
  v_accvgpr_write_b32 a75, v51
  v_accvgpr_write_b32 a76, v52
  v_accvgpr_write_b32 a77, v53
  v_accvgpr_write_b32 a78, v54
  v_accvgpr_write_b32 a79, v55
  v_accvgpr_read_b32 v48, a80
  v_accvgpr_read_b32 v49, a81
  v_accvgpr_read_b32 v50, a82
  v_accvgpr_read_b32 v51, a83
  v_accvgpr_read_b32 v52, a84
  v_accvgpr_read_b32 v53, a85
  v_accvgpr_read_b32 v54, a86
  v_accvgpr_read_b32 v55, a87
  v_mul_f32 v48, v48, v27
  v_mul_f32 v49, v49, v27
  v_mul_f32 v50, v50, v27
  v_mul_f32 v51, v51, v27
  v_mul_f32 v52, v52, v27
  v_mul_f32 v53, v53, v27
  v_mul_f32 v54, v54, v27
  v_mul_f32 v55, v55, v27
  v_mul_f32 v48, v48, v27
  v_mul_f32 v49, v49, v27
  v_mul_f32 v50, v50, v27
  v_mul_f32 v51, v51, v27
  v_mul_f32 v52, v52, v27
  v_mul_f32 v53, v53, v27
  v_mul_f32 v54, v54, v27
  v_mul_f32 v55, v55, v27
  v_accvgpr_write_b32 a80, v48
  v_accvgpr_write_b32 a81, v49
  v_accvgpr_write_b32 a82, v50
  v_accvgpr_write_b32 a83, v51
  v_accvgpr_write_b32 a84, v52
  v_accvgpr_write_b32 a85, v53
  v_accvgpr_write_b32 a86, v54
  v_accvgpr_write_b32 a87, v55
  v_accvgpr_read_b32 v48, a88
  v_accvgpr_read_b32 v49, a89
  v_accvgpr_read_b32 v50, a90
  v_accvgpr_read_b32 v51, a91
  v_accvgpr_read_b32 v52, a92
  v_accvgpr_read_b32 v53, a93
  v_accvgpr_read_b32 v54, a94
  v_accvgpr_read_b32 v55, a95
  v_mul_f32 v48, v48, v27
  v_mul_f32 v49, v49, v27
  v_mul_f32 v50, v50, v27
  v_mul_f32 v51, v51, v27
  v_mul_f32 v52, v52, v27
  v_mul_f32 v53, v53, v27
  v_mul_f32 v54, v54, v27
  v_mul_f32 v55, v55, v27
  v_mul_f32 v48, v48, v27
  v_mul_f32 v49, v49, v27
  v_mul_f32 v50, v50, v27
  v_mul_f32 v51, v51, v27
  v_mul_f32 v52, v52, v27
  v_mul_f32 v53, v53, v27
  v_mul_f32 v54, v54, v27
  v_mul_f32 v55, v55, v27
  v_accvgpr_write_b32 a88, v48
  v_accvgpr_write_b32 a89, v49
  v_accvgpr_write_b32 a90, v50
  v_accvgpr_write_b32 a91, v51
  v_accvgpr_write_b32 a92, v52
  v_accvgpr_write_b32 a93, v53
  v_accvgpr_write_b32 a94, v54
  v_accvgpr_write_b32 a95, v55
  v_accvgpr_read_b32 v48, a96
  v_accvgpr_read_b32 v49, a97
  v_accvgpr_read_b32 v50, a98
  v_accvgpr_read_b32 v51, a99
  v_accvgpr_read_b32 v52, a100
  v_accvgpr_read_b32 v53, a101
  v_accvgpr_read_b32 v54, a102
  v_accvgpr_read_b32 v55, a103
  v_mul_f32 v48, v48, v27
  v_mul_f32 v49, v49, v27
  v_mul_f32 v50, v50, v27
  v_mul_f32 v51, v51, v27
  v_mul_f32 v52, v52, v27
  v_mul_f32 v53, v53, v27
  v_mul_f32 v54, v54, v27
  v_mul_f32 v55, v55, v27
  v_mul_f32 v48, v48, v27
  v_mul_f32 v49, v49, v27
  v_mul_f32 v50, v50, v27
  v_mul_f32 v51, v51, v27
  v_mul_f32 v52, v52, v27
  v_mul_f32 v53, v53, v27
  v_mul_f32 v54, v54, v27
  v_mul_f32 v55, v55, v27
  v_accvgpr_write_b32 a96, v48
  v_accvgpr_write_b32 a97, v49
  v_accvgpr_write_b32 a98, v50
  v_accvgpr_write_b32 a99, v51
  v_accvgpr_write_b32 a100, v52
  v_accvgpr_write_b32 a101, v53
  v_accvgpr_write_b32 a102, v54
  v_accvgpr_write_b32 a103, v55
  v_accvgpr_read_b32 v48, a104
  v_accvgpr_read_b32 v49, a105
  v_accvgpr_read_b32 v50, a106
  v_accvgpr_read_b32 v51, a107
  v_accvgpr_read_b32 v52, a108
  v_accvgpr_read_b32 v53, a109
  v_accvgpr_read_b32 v54, a110
  v_accvgpr_read_b32 v55, a111
  v_mul_f32 v48, v48, v27
  v_mul_f32 v49, v49, v27
  v_mul_f32 v50, v50, v27
  v_mul_f32 v51, v51, v27
  v_mul_f32 v52, v52, v27
  v_mul_f32 v53, v53, v27
  v_mul_f32 v54, v54, v27
  v_mul_f32 v55, v55, v27
  v_mul_f32 v48, v48, v27
  v_mul_f32 v49, v49, v27
  v_mul_f32 v50, v50, v27
  v_mul_f32 v51, v51, v27
  v_mul_f32 v52, v52, v27
  v_mul_f32 v53, v53, v27
  v_mul_f32 v54, v54, v27
  v_mul_f32 v55, v55, v27
  v_accvgpr_write_b32 a104, v48
  v_accvgpr_write_b32 a105, v49
  v_accvgpr_write_b32 a106, v50
  v_accvgpr_write_b32 a107, v51
  v_accvgpr_write_b32 a108, v52
  v_accvgpr_write_b32 a109, v53
  v_accvgpr_write_b32 a110, v54
  v_accvgpr_write_b32 a111, v55
  v_accvgpr_read_b32 v48, a112
  v_accvgpr_read_b32 v49, a113
  v_accvgpr_read_b32 v50, a114
  v_accvgpr_read_b32 v51, a115
  v_accvgpr_read_b32 v52, a116
  v_accvgpr_read_b32 v53, a117
  v_accvgpr_read_b32 v54, a118
  v_accvgpr_read_b32 v55, a119
  v_mul_f32 v48, v48, v27
  v_mul_f32 v49, v49, v27
  v_mul_f32 v50, v50, v27
  v_mul_f32 v51, v51, v27
  v_mul_f32 v52, v52, v27
  v_mul_f32 v53, v53, v27
  v_mul_f32 v54, v54, v27
  v_mul_f32 v55, v55, v27
  v_mul_f32 v48, v48, v27
  v_mul_f32 v49, v49, v27
  v_mul_f32 v50, v50, v27
  v_mul_f32 v51, v51, v27
  v_mul_f32 v52, v52, v27
  v_mul_f32 v53, v53, v27
  v_mul_f32 v54, v54, v27
  v_mul_f32 v55, v55, v27
  v_accvgpr_write_b32 a112, v48
  v_accvgpr_write_b32 a113, v49
  v_accvgpr_write_b32 a114, v50
  v_accvgpr_write_b32 a115, v51
  v_accvgpr_write_b32 a116, v52
  v_accvgpr_write_b32 a117, v53
  v_accvgpr_write_b32 a118, v54
  v_accvgpr_write_b32 a119, v55
  v_accvgpr_read_b32 v48, a120
  v_accvgpr_read_b32 v49, a121
  v_accvgpr_read_b32 v50, a122
  v_accvgpr_read_b32 v51, a123
  v_accvgpr_read_b32 v52, a124
  v_accvgpr_read_b32 v53, a125
  v_accvgpr_read_b32 v54, a126
  v_accvgpr_read_b32 v55, a127
  v_mul_f32 v48, v48, v27
  v_mul_f32 v49, v49, v27
  v_mul_f32 v50, v50, v27
  v_mul_f32 v51, v51, v27
  v_mul_f32 v52, v52, v27
  v_mul_f32 v53, v53, v27
  v_mul_f32 v54, v54, v27
  v_mul_f32 v55, v55, v27
  v_mul_f32 v48, v48, v27
  v_mul_f32 v49, v49, v27
  v_mul_f32 v50, v50, v27
  v_mul_f32 v51, v51, v27
  v_mul_f32 v52, v52, v27
  v_mul_f32 v53, v53, v27
  v_mul_f32 v54, v54, v27
  v_mul_f32 v55, v55, v27
  v_accvgpr_write_b32 a120, v48
  v_accvgpr_write_b32 a121, v49
  v_accvgpr_write_b32 a122, v50
  v_accvgpr_write_b32 a123, v51
  v_accvgpr_write_b32 a124, v52
  v_accvgpr_write_b32 a125, v53
  v_accvgpr_write_b32 a126, v54
  v_accvgpr_write_b32 a127, v55
  s_nop 1
  s_setpc_b64 s[82:83]
attn_kernel_fix47:
  s_nop 15
  v_max3_f32 v26, v96, v97, v98
  v_max3_f32 v27, v99, v100, v101
  v_max3_f32 v26, v26, v102, v103
  v_max3_f32 v27, v27, v104, v105
  v_max3_f32 v26, v26, v106, v107
  v_max3_f32 v27, v27, v108, v109
  v_max3_f32 v26, v26, v110, v111
  v_max_f32 v26, v26, v27
  v_mov_b32 v27, v26
  s_nop 1
  v_permlane32_swap_b32 v26, v27
  v_max_f32 v26, v26, v27
  v_add_f32 v26, 0x42cc0000, v26
  v_max_f32 v26, 0, v26
  v_mul_f32 v27, -0.5, v26
  v_exp_f32 v27, v27
  v_sub_f32 v160, v160, v26
  v_sub_f32 v161, v161, v26
  v_sub_f32 v162, v162, v26
  v_sub_f32 v163, v163, v26
  v_sub_f32 v164, v164, v26
  v_sub_f32 v165, v165, v26
  v_sub_f32 v166, v166, v26
  v_sub_f32 v167, v167, v26
  v_sub_f32 v168, v168, v26
  v_sub_f32 v169, v169, v26
  v_sub_f32 v170, v170, v26
  v_sub_f32 v171, v171, v26
  v_sub_f32 v172, v172, v26
  v_sub_f32 v173, v173, v26
  v_sub_f32 v174, v174, v26
  v_sub_f32 v175, v175, v26
  v_sub_f32 v64, v64, v26
  v_sub_f32 v65, v65, v26
  v_sub_f32 v66, v66, v26
  v_sub_f32 v67, v67, v26
  v_sub_f32 v68, v68, v26
  v_sub_f32 v69, v69, v26
  v_sub_f32 v70, v70, v26
  v_sub_f32 v71, v71, v26
  v_sub_f32 v72, v72, v26
  v_sub_f32 v73, v73, v26
  v_sub_f32 v74, v74, v26
  v_sub_f32 v75, v75, v26
  v_sub_f32 v76, v76, v26
  v_sub_f32 v77, v77, v26
  v_sub_f32 v78, v78, v26
  v_sub_f32 v79, v79, v26
  v_sub_f32 v96, v96, v26
  v_sub_f32 v97, v97, v26
  v_sub_f32 v98, v98, v26
  v_sub_f32 v99, v99, v26
  v_sub_f32 v100, v100, v26
  v_sub_f32 v101, v101, v26
  v_sub_f32 v102, v102, v26
  v_sub_f32 v103, v103, v26
  v_sub_f32 v104, v104, v26
  v_sub_f32 v105, v105, v26
  v_sub_f32 v106, v106, v26
  v_sub_f32 v107, v107, v26
  v_sub_f32 v108, v108, v26
  v_sub_f32 v109, v109, v26
  v_sub_f32 v110, v110, v26
  v_sub_f32 v111, v111, v26
  v_mul_f32 v20, v20, v27
  v_mul_f32 v20, v20, v27
  v_exp_f32 v32, v96
  v_exp_f32 v33, v97
  v_exp_f32 v34, v98
  v_add_f32 v22, v32, v33
  v_exp_f32 v35, v99
  v_cvt_pk_bf16_f32 v144, v32, v33
  v_exp_f32 v36, v100
  v_add_f32 v22, v22, v34
  v_exp_f32 v37, v101
  v_add_f32 v22, v22, v35
  v_cvt_pk_bf16_f32 v145, v34, v35
  v_exp_f32 v38, v102
  v_add_f32 v22, v22, v36
  v_exp_f32 v39, v103
  v_add_f32 v22, v22, v37
  v_cvt_pk_bf16_f32 v146, v36, v37
  v_exp_f32 v32, v104
  v_add_f32 v22, v22, v38
  v_exp_f32 v33, v105
  v_add_f32 v22, v22, v39
  v_cvt_pk_bf16_f32 v147, v38, v39
  v_exp_f32 v34, v106
  v_add_f32 v22, v22, v32
  v_exp_f32 v35, v107
  v_add_f32 v22, v22, v33
  v_cvt_pk_bf16_f32 v148, v32, v33
  v_exp_f32 v36, v108
  v_add_f32 v22, v22, v34
  v_exp_f32 v37, v109
  v_add_f32 v22, v22, v35
  v_cvt_pk_bf16_f32 v149, v34, v35
  v_exp_f32 v38, v110
  v_add_f32 v22, v22, v36
  v_exp_f32 v39, v111
  v_add_f32 v22, v22, v37
  v_cvt_pk_bf16_f32 v150, v36, v37
  v_add_f32 v22, v22, v38
  v_add_f32 v22, v22, v39
  v_cvt_pk_bf16_f32 v151, v38, v39
  v_accvgpr_read_b32 v48, a0
  v_accvgpr_read_b32 v49, a1
  v_accvgpr_read_b32 v50, a2
  v_accvgpr_read_b32 v51, a3
  v_accvgpr_read_b32 v52, a4
  v_accvgpr_read_b32 v53, a5
  v_accvgpr_read_b32 v54, a6
  v_accvgpr_read_b32 v55, a7
  v_mul_f32 v48, v48, v27
  v_mul_f32 v49, v49, v27
  v_mul_f32 v50, v50, v27
  v_mul_f32 v51, v51, v27
  v_mul_f32 v52, v52, v27
  v_mul_f32 v53, v53, v27
  v_mul_f32 v54, v54, v27
  v_mul_f32 v55, v55, v27
  v_mul_f32 v48, v48, v27
  v_mul_f32 v49, v49, v27
  v_mul_f32 v50, v50, v27
  v_mul_f32 v51, v51, v27
  v_mul_f32 v52, v52, v27
  v_mul_f32 v53, v53, v27
  v_mul_f32 v54, v54, v27
  v_mul_f32 v55, v55, v27
  v_accvgpr_write_b32 a0, v48
  v_accvgpr_write_b32 a1, v49
  v_accvgpr_write_b32 a2, v50
  v_accvgpr_write_b32 a3, v51
  v_accvgpr_write_b32 a4, v52
  v_accvgpr_write_b32 a5, v53
  v_accvgpr_write_b32 a6, v54
  v_accvgpr_write_b32 a7, v55
  v_accvgpr_read_b32 v48, a8
  v_accvgpr_read_b32 v49, a9
  v_accvgpr_read_b32 v50, a10
  v_accvgpr_read_b32 v51, a11
  v_accvgpr_read_b32 v52, a12
  v_accvgpr_read_b32 v53, a13
  v_accvgpr_read_b32 v54, a14
  v_accvgpr_read_b32 v55, a15
  v_mul_f32 v48, v48, v27
  v_mul_f32 v49, v49, v27
  v_mul_f32 v50, v50, v27
  v_mul_f32 v51, v51, v27
  v_mul_f32 v52, v52, v27
  v_mul_f32 v53, v53, v27
  v_mul_f32 v54, v54, v27
  v_mul_f32 v55, v55, v27
  v_mul_f32 v48, v48, v27
  v_mul_f32 v49, v49, v27
  v_mul_f32 v50, v50, v27
  v_mul_f32 v51, v51, v27
  v_mul_f32 v52, v52, v27
  v_mul_f32 v53, v53, v27
  v_mul_f32 v54, v54, v27
  v_mul_f32 v55, v55, v27
  v_accvgpr_write_b32 a8, v48
  v_accvgpr_write_b32 a9, v49
  v_accvgpr_write_b32 a10, v50
  v_accvgpr_write_b32 a11, v51
  v_accvgpr_write_b32 a12, v52
  v_accvgpr_write_b32 a13, v53
  v_accvgpr_write_b32 a14, v54
  v_accvgpr_write_b32 a15, v55
  v_accvgpr_read_b32 v48, a16
  v_accvgpr_read_b32 v49, a17
  v_accvgpr_read_b32 v50, a18
  v_accvgpr_read_b32 v51, a19
  v_accvgpr_read_b32 v52, a20
  v_accvgpr_read_b32 v53, a21
  v_accvgpr_read_b32 v54, a22
  v_accvgpr_read_b32 v55, a23
  v_mul_f32 v48, v48, v27
  v_mul_f32 v49, v49, v27
  v_mul_f32 v50, v50, v27
  v_mul_f32 v51, v51, v27
  v_mul_f32 v52, v52, v27
  v_mul_f32 v53, v53, v27
  v_mul_f32 v54, v54, v27
  v_mul_f32 v55, v55, v27
  v_mul_f32 v48, v48, v27
  v_mul_f32 v49, v49, v27
  v_mul_f32 v50, v50, v27
  v_mul_f32 v51, v51, v27
  v_mul_f32 v52, v52, v27
  v_mul_f32 v53, v53, v27
  v_mul_f32 v54, v54, v27
  v_mul_f32 v55, v55, v27
  v_accvgpr_write_b32 a16, v48
  v_accvgpr_write_b32 a17, v49
  v_accvgpr_write_b32 a18, v50
  v_accvgpr_write_b32 a19, v51
  v_accvgpr_write_b32 a20, v52
  v_accvgpr_write_b32 a21, v53
  v_accvgpr_write_b32 a22, v54
  v_accvgpr_write_b32 a23, v55
  v_accvgpr_read_b32 v48, a24
  v_accvgpr_read_b32 v49, a25
  v_accvgpr_read_b32 v50, a26
  v_accvgpr_read_b32 v51, a27
  v_accvgpr_read_b32 v52, a28
  v_accvgpr_read_b32 v53, a29
  v_accvgpr_read_b32 v54, a30
  v_accvgpr_read_b32 v55, a31
  v_mul_f32 v48, v48, v27
  v_mul_f32 v49, v49, v27
  v_mul_f32 v50, v50, v27
  v_mul_f32 v51, v51, v27
  v_mul_f32 v52, v52, v27
  v_mul_f32 v53, v53, v27
  v_mul_f32 v54, v54, v27
  v_mul_f32 v55, v55, v27
  v_mul_f32 v48, v48, v27
  v_mul_f32 v49, v49, v27
  v_mul_f32 v50, v50, v27
  v_mul_f32 v51, v51, v27
  v_mul_f32 v52, v52, v27
  v_mul_f32 v53, v53, v27
  v_mul_f32 v54, v54, v27
  v_mul_f32 v55, v55, v27
  v_accvgpr_write_b32 a24, v48
  v_accvgpr_write_b32 a25, v49
  v_accvgpr_write_b32 a26, v50
  v_accvgpr_write_b32 a27, v51
  v_accvgpr_write_b32 a28, v52
  v_accvgpr_write_b32 a29, v53
  v_accvgpr_write_b32 a30, v54
  v_accvgpr_write_b32 a31, v55
  v_accvgpr_read_b32 v48, a32
  v_accvgpr_read_b32 v49, a33
  v_accvgpr_read_b32 v50, a34
  v_accvgpr_read_b32 v51, a35
  v_accvgpr_read_b32 v52, a36
  v_accvgpr_read_b32 v53, a37
  v_accvgpr_read_b32 v54, a38
  v_accvgpr_read_b32 v55, a39
  v_mul_f32 v48, v48, v27
  v_mul_f32 v49, v49, v27
  v_mul_f32 v50, v50, v27
  v_mul_f32 v51, v51, v27
  v_mul_f32 v52, v52, v27
  v_mul_f32 v53, v53, v27
  v_mul_f32 v54, v54, v27
  v_mul_f32 v55, v55, v27
  v_mul_f32 v48, v48, v27
  v_mul_f32 v49, v49, v27
  v_mul_f32 v50, v50, v27
  v_mul_f32 v51, v51, v27
  v_mul_f32 v52, v52, v27
  v_mul_f32 v53, v53, v27
  v_mul_f32 v54, v54, v27
  v_mul_f32 v55, v55, v27
  v_accvgpr_write_b32 a32, v48
  v_accvgpr_write_b32 a33, v49
  v_accvgpr_write_b32 a34, v50
  v_accvgpr_write_b32 a35, v51
  v_accvgpr_write_b32 a36, v52
  v_accvgpr_write_b32 a37, v53
  v_accvgpr_write_b32 a38, v54
  v_accvgpr_write_b32 a39, v55
  v_accvgpr_read_b32 v48, a40
  v_accvgpr_read_b32 v49, a41
  v_accvgpr_read_b32 v50, a42
  v_accvgpr_read_b32 v51, a43
  v_accvgpr_read_b32 v52, a44
  v_accvgpr_read_b32 v53, a45
  v_accvgpr_read_b32 v54, a46
  v_accvgpr_read_b32 v55, a47
  v_mul_f32 v48, v48, v27
  v_mul_f32 v49, v49, v27
  v_mul_f32 v50, v50, v27
  v_mul_f32 v51, v51, v27
  v_mul_f32 v52, v52, v27
  v_mul_f32 v53, v53, v27
  v_mul_f32 v54, v54, v27
  v_mul_f32 v55, v55, v27
  v_mul_f32 v48, v48, v27
  v_mul_f32 v49, v49, v27
  v_mul_f32 v50, v50, v27
  v_mul_f32 v51, v51, v27
  v_mul_f32 v52, v52, v27
  v_mul_f32 v53, v53, v27
  v_mul_f32 v54, v54, v27
  v_mul_f32 v55, v55, v27
  v_accvgpr_write_b32 a40, v48
  v_accvgpr_write_b32 a41, v49
  v_accvgpr_write_b32 a42, v50
  v_accvgpr_write_b32 a43, v51
  v_accvgpr_write_b32 a44, v52
  v_accvgpr_write_b32 a45, v53
  v_accvgpr_write_b32 a46, v54
  v_accvgpr_write_b32 a47, v55
  v_accvgpr_read_b32 v48, a48
  v_accvgpr_read_b32 v49, a49
  v_accvgpr_read_b32 v50, a50
  v_accvgpr_read_b32 v51, a51
  v_accvgpr_read_b32 v52, a52
  v_accvgpr_read_b32 v53, a53
  v_accvgpr_read_b32 v54, a54
  v_accvgpr_read_b32 v55, a55
  v_mul_f32 v48, v48, v27
  v_mul_f32 v49, v49, v27
  v_mul_f32 v50, v50, v27
  v_mul_f32 v51, v51, v27
  v_mul_f32 v52, v52, v27
  v_mul_f32 v53, v53, v27
  v_mul_f32 v54, v54, v27
  v_mul_f32 v55, v55, v27
  v_mul_f32 v48, v48, v27
  v_mul_f32 v49, v49, v27
  v_mul_f32 v50, v50, v27
  v_mul_f32 v51, v51, v27
  v_mul_f32 v52, v52, v27
  v_mul_f32 v53, v53, v27
  v_mul_f32 v54, v54, v27
  v_mul_f32 v55, v55, v27
  v_accvgpr_write_b32 a48, v48
  v_accvgpr_write_b32 a49, v49
  v_accvgpr_write_b32 a50, v50
  v_accvgpr_write_b32 a51, v51
  v_accvgpr_write_b32 a52, v52
  v_accvgpr_write_b32 a53, v53
  v_accvgpr_write_b32 a54, v54
  v_accvgpr_write_b32 a55, v55
  v_accvgpr_read_b32 v48, a56
  v_accvgpr_read_b32 v49, a57
  v_accvgpr_read_b32 v50, a58
  v_accvgpr_read_b32 v51, a59
  v_accvgpr_read_b32 v52, a60
  v_accvgpr_read_b32 v53, a61
  v_accvgpr_read_b32 v54, a62
  v_accvgpr_read_b32 v55, a63
  v_mul_f32 v48, v48, v27
  v_mul_f32 v49, v49, v27
  v_mul_f32 v50, v50, v27
  v_mul_f32 v51, v51, v27
  v_mul_f32 v52, v52, v27
  v_mul_f32 v53, v53, v27
  v_mul_f32 v54, v54, v27
  v_mul_f32 v55, v55, v27
  v_mul_f32 v48, v48, v27
  v_mul_f32 v49, v49, v27
  v_mul_f32 v50, v50, v27
  v_mul_f32 v51, v51, v27
  v_mul_f32 v52, v52, v27
  v_mul_f32 v53, v53, v27
  v_mul_f32 v54, v54, v27
  v_mul_f32 v55, v55, v27
  v_accvgpr_write_b32 a56, v48
  v_accvgpr_write_b32 a57, v49
  v_accvgpr_write_b32 a58, v50
  v_accvgpr_write_b32 a59, v51
  v_accvgpr_write_b32 a60, v52
  v_accvgpr_write_b32 a61, v53
  v_accvgpr_write_b32 a62, v54
  v_accvgpr_write_b32 a63, v55
  s_nop 1
  s_setpc_b64 s[82:83]
attn_kernel_fix48:
  s_nop 15
  v_max3_f32 v26, v64, v65, v66
  v_max3_f32 v27, v67, v68, v69
  v_max3_f32 v26, v26, v70, v71
  v_max3_f32 v27, v27, v72, v73
  v_max3_f32 v26, v26, v74, v75
  v_max3_f32 v27, v27, v76, v77
  v_max3_f32 v26, v26, v78, v79
  v_max_f32 v26, v26, v27
  v_mov_b32 v27, v26
  s_nop 1
  v_permlane32_swap_b32 v26, v27
  v_max_f32 v26, v26, v27
  v_add_f32 v26, 0x42cc0000, v26
  v_max_f32 v26, 0, v26
  v_mul_f32 v27, -0.5, v26
  v_exp_f32 v27, v27
  v_sub_f32 v160, v160, v26
  v_sub_f32 v161, v161, v26
  v_sub_f32 v162, v162, v26
  v_sub_f32 v163, v163, v26
  v_sub_f32 v164, v164, v26
  v_sub_f32 v165, v165, v26
  v_sub_f32 v166, v166, v26
  v_sub_f32 v167, v167, v26
  v_sub_f32 v168, v168, v26
  v_sub_f32 v169, v169, v26
  v_sub_f32 v170, v170, v26
  v_sub_f32 v171, v171, v26
  v_sub_f32 v172, v172, v26
  v_sub_f32 v173, v173, v26
  v_sub_f32 v174, v174, v26
  v_sub_f32 v175, v175, v26
  v_sub_f32 v96, v96, v26
  v_sub_f32 v97, v97, v26
  v_sub_f32 v98, v98, v26
  v_sub_f32 v99, v99, v26
  v_sub_f32 v100, v100, v26
  v_sub_f32 v101, v101, v26
  v_sub_f32 v102, v102, v26
  v_sub_f32 v103, v103, v26
  v_sub_f32 v104, v104, v26
  v_sub_f32 v105, v105, v26
  v_sub_f32 v106, v106, v26
  v_sub_f32 v107, v107, v26
  v_sub_f32 v108, v108, v26
  v_sub_f32 v109, v109, v26
  v_sub_f32 v110, v110, v26
  v_sub_f32 v111, v111, v26
  v_sub_f32 v64, v64, v26
  v_sub_f32 v65, v65, v26
  v_sub_f32 v66, v66, v26
  v_sub_f32 v67, v67, v26
  v_sub_f32 v68, v68, v26
  v_sub_f32 v69, v69, v26
  v_sub_f32 v70, v70, v26
  v_sub_f32 v71, v71, v26
  v_sub_f32 v72, v72, v26
  v_sub_f32 v73, v73, v26
  v_sub_f32 v74, v74, v26
  v_sub_f32 v75, v75, v26
  v_sub_f32 v76, v76, v26
  v_sub_f32 v77, v77, v26
  v_sub_f32 v78, v78, v26
  v_sub_f32 v79, v79, v26
  v_mul_f32 v20, v20, v27
  v_mul_f32 v20, v20, v27
  v_exp_f32 v32, v64
  v_exp_f32 v33, v65
  v_exp_f32 v34, v66
  v_add_f32 v22, v32, v33
  v_exp_f32 v35, v67
  v_cvt_pk_bf16_f32 v128, v32, v33
  v_exp_f32 v36, v68
  v_add_f32 v22, v22, v34
  v_exp_f32 v37, v69
  v_add_f32 v22, v22, v35
  v_cvt_pk_bf16_f32 v129, v34, v35
  v_exp_f32 v38, v70
  v_add_f32 v22, v22, v36
  v_exp_f32 v39, v71
  v_add_f32 v22, v22, v37
  v_cvt_pk_bf16_f32 v130, v36, v37
  v_exp_f32 v32, v72
  v_add_f32 v22, v22, v38
  v_exp_f32 v33, v73
  v_add_f32 v22, v22, v39
  v_cvt_pk_bf16_f32 v131, v38, v39
  v_exp_f32 v34, v74
  v_add_f32 v22, v22, v32
  v_exp_f32 v35, v75
  v_add_f32 v22, v22, v33
  v_cvt_pk_bf16_f32 v132, v32, v33
  v_exp_f32 v36, v76
  v_add_f32 v22, v22, v34
  v_exp_f32 v37, v77
  v_add_f32 v22, v22, v35
  v_cvt_pk_bf16_f32 v133, v34, v35
  v_exp_f32 v38, v78
  v_add_f32 v22, v22, v36
  v_exp_f32 v39, v79
  v_add_f32 v22, v22, v37
  v_cvt_pk_bf16_f32 v134, v36, v37
  v_add_f32 v22, v22, v38
  v_add_f32 v22, v22, v39
  v_cvt_pk_bf16_f32 v135, v38, v39
  v_accvgpr_read_b32 v48, a0
  v_accvgpr_read_b32 v49, a1
  v_accvgpr_read_b32 v50, a2
  v_accvgpr_read_b32 v51, a3
  v_accvgpr_read_b32 v52, a4
  v_accvgpr_read_b32 v53, a5
  v_accvgpr_read_b32 v54, a6
  v_accvgpr_read_b32 v55, a7
  v_mul_f32 v48, v48, v27
  v_mul_f32 v49, v49, v27
  v_mul_f32 v50, v50, v27
  v_mul_f32 v51, v51, v27
  v_mul_f32 v52, v52, v27
  v_mul_f32 v53, v53, v27
  v_mul_f32 v54, v54, v27
  v_mul_f32 v55, v55, v27
  v_mul_f32 v48, v48, v27
  v_mul_f32 v49, v49, v27
  v_mul_f32 v50, v50, v27
  v_mul_f32 v51, v51, v27
  v_mul_f32 v52, v52, v27
  v_mul_f32 v53, v53, v27
  v_mul_f32 v54, v54, v27
  v_mul_f32 v55, v55, v27
  v_accvgpr_write_b32 a0, v48
  v_accvgpr_write_b32 a1, v49
  v_accvgpr_write_b32 a2, v50
  v_accvgpr_write_b32 a3, v51
  v_accvgpr_write_b32 a4, v52
  v_accvgpr_write_b32 a5, v53
  v_accvgpr_write_b32 a6, v54
  v_accvgpr_write_b32 a7, v55
  v_accvgpr_read_b32 v48, a8
  v_accvgpr_read_b32 v49, a9
  v_accvgpr_read_b32 v50, a10
  v_accvgpr_read_b32 v51, a11
  v_accvgpr_read_b32 v52, a12
  v_accvgpr_read_b32 v53, a13
  v_accvgpr_read_b32 v54, a14
  v_accvgpr_read_b32 v55, a15
  v_mul_f32 v48, v48, v27
  v_mul_f32 v49, v49, v27
  v_mul_f32 v50, v50, v27
  v_mul_f32 v51, v51, v27
  v_mul_f32 v52, v52, v27
  v_mul_f32 v53, v53, v27
  v_mul_f32 v54, v54, v27
  v_mul_f32 v55, v55, v27
  v_mul_f32 v48, v48, v27
  v_mul_f32 v49, v49, v27
  v_mul_f32 v50, v50, v27
  v_mul_f32 v51, v51, v27
  v_mul_f32 v52, v52, v27
  v_mul_f32 v53, v53, v27
  v_mul_f32 v54, v54, v27
  v_mul_f32 v55, v55, v27
  v_accvgpr_write_b32 a8, v48
  v_accvgpr_write_b32 a9, v49
  v_accvgpr_write_b32 a10, v50
  v_accvgpr_write_b32 a11, v51
  v_accvgpr_write_b32 a12, v52
  v_accvgpr_write_b32 a13, v53
  v_accvgpr_write_b32 a14, v54
  v_accvgpr_write_b32 a15, v55
  v_accvgpr_read_b32 v48, a16
  v_accvgpr_read_b32 v49, a17
  v_accvgpr_read_b32 v50, a18
  v_accvgpr_read_b32 v51, a19
  v_accvgpr_read_b32 v52, a20
  v_accvgpr_read_b32 v53, a21
  v_accvgpr_read_b32 v54, a22
  v_accvgpr_read_b32 v55, a23
  v_mul_f32 v48, v48, v27
  v_mul_f32 v49, v49, v27
  v_mul_f32 v50, v50, v27
  v_mul_f32 v51, v51, v27
  v_mul_f32 v52, v52, v27
  v_mul_f32 v53, v53, v27
  v_mul_f32 v54, v54, v27
  v_mul_f32 v55, v55, v27
  v_mul_f32 v48, v48, v27
  v_mul_f32 v49, v49, v27
  v_mul_f32 v50, v50, v27
  v_mul_f32 v51, v51, v27
  v_mul_f32 v52, v52, v27
  v_mul_f32 v53, v53, v27
  v_mul_f32 v54, v54, v27
  v_mul_f32 v55, v55, v27
  v_accvgpr_write_b32 a16, v48
  v_accvgpr_write_b32 a17, v49
  v_accvgpr_write_b32 a18, v50
  v_accvgpr_write_b32 a19, v51
  v_accvgpr_write_b32 a20, v52
  v_accvgpr_write_b32 a21, v53
  v_accvgpr_write_b32 a22, v54
  v_accvgpr_write_b32 a23, v55
  v_accvgpr_read_b32 v48, a24
  v_accvgpr_read_b32 v49, a25
  v_accvgpr_read_b32 v50, a26
  v_accvgpr_read_b32 v51, a27
  v_accvgpr_read_b32 v52, a28
  v_accvgpr_read_b32 v53, a29
  v_accvgpr_read_b32 v54, a30
  v_accvgpr_read_b32 v55, a31
  v_mul_f32 v48, v48, v27
  v_mul_f32 v49, v49, v27
  v_mul_f32 v50, v50, v27
  v_mul_f32 v51, v51, v27
  v_mul_f32 v52, v52, v27
  v_mul_f32 v53, v53, v27
  v_mul_f32 v54, v54, v27
  v_mul_f32 v55, v55, v27
  v_mul_f32 v48, v48, v27
  v_mul_f32 v49, v49, v27
  v_mul_f32 v50, v50, v27
  v_mul_f32 v51, v51, v27
  v_mul_f32 v52, v52, v27
  v_mul_f32 v53, v53, v27
  v_mul_f32 v54, v54, v27
  v_mul_f32 v55, v55, v27
  v_accvgpr_write_b32 a24, v48
  v_accvgpr_write_b32 a25, v49
  v_accvgpr_write_b32 a26, v50
  v_accvgpr_write_b32 a27, v51
  v_accvgpr_write_b32 a28, v52
  v_accvgpr_write_b32 a29, v53
  v_accvgpr_write_b32 a30, v54
  v_accvgpr_write_b32 a31, v55
  v_accvgpr_read_b32 v48, a32
  v_accvgpr_read_b32 v49, a33
  v_accvgpr_read_b32 v50, a34
  v_accvgpr_read_b32 v51, a35
  v_accvgpr_read_b32 v52, a36
  v_accvgpr_read_b32 v53, a37
  v_accvgpr_read_b32 v54, a38
  v_accvgpr_read_b32 v55, a39
  v_mul_f32 v48, v48, v27
  v_mul_f32 v49, v49, v27
  v_mul_f32 v50, v50, v27
  v_mul_f32 v51, v51, v27
  v_mul_f32 v52, v52, v27
  v_mul_f32 v53, v53, v27
  v_mul_f32 v54, v54, v27
  v_mul_f32 v55, v55, v27
  v_mul_f32 v48, v48, v27
  v_mul_f32 v49, v49, v27
  v_mul_f32 v50, v50, v27
  v_mul_f32 v51, v51, v27
  v_mul_f32 v52, v52, v27
  v_mul_f32 v53, v53, v27
  v_mul_f32 v54, v54, v27
  v_mul_f32 v55, v55, v27
  v_accvgpr_write_b32 a32, v48
  v_accvgpr_write_b32 a33, v49
  v_accvgpr_write_b32 a34, v50
  v_accvgpr_write_b32 a35, v51
  v_accvgpr_write_b32 a36, v52
  v_accvgpr_write_b32 a37, v53
  v_accvgpr_write_b32 a38, v54
  v_accvgpr_write_b32 a39, v55
  v_accvgpr_read_b32 v48, a40
  v_accvgpr_read_b32 v49, a41
  v_accvgpr_read_b32 v50, a42
  v_accvgpr_read_b32 v51, a43
  v_accvgpr_read_b32 v52, a44
  v_accvgpr_read_b32 v53, a45
  v_accvgpr_read_b32 v54, a46
  v_accvgpr_read_b32 v55, a47
  v_mul_f32 v48, v48, v27
  v_mul_f32 v49, v49, v27
  v_mul_f32 v50, v50, v27
  v_mul_f32 v51, v51, v27
  v_mul_f32 v52, v52, v27
  v_mul_f32 v53, v53, v27
  v_mul_f32 v54, v54, v27
  v_mul_f32 v55, v55, v27
  v_mul_f32 v48, v48, v27
  v_mul_f32 v49, v49, v27
  v_mul_f32 v50, v50, v27
  v_mul_f32 v51, v51, v27
  v_mul_f32 v52, v52, v27
  v_mul_f32 v53, v53, v27
  v_mul_f32 v54, v54, v27
  v_mul_f32 v55, v55, v27
  v_accvgpr_write_b32 a40, v48
  v_accvgpr_write_b32 a41, v49
  v_accvgpr_write_b32 a42, v50
  v_accvgpr_write_b32 a43, v51
  v_accvgpr_write_b32 a44, v52
  v_accvgpr_write_b32 a45, v53
  v_accvgpr_write_b32 a46, v54
  v_accvgpr_write_b32 a47, v55
  v_accvgpr_read_b32 v48, a48
  v_accvgpr_read_b32 v49, a49
  v_accvgpr_read_b32 v50, a50
  v_accvgpr_read_b32 v51, a51
  v_accvgpr_read_b32 v52, a52
  v_accvgpr_read_b32 v53, a53
  v_accvgpr_read_b32 v54, a54
  v_accvgpr_read_b32 v55, a55
  v_mul_f32 v48, v48, v27
  v_mul_f32 v49, v49, v27
  v_mul_f32 v50, v50, v27
  v_mul_f32 v51, v51, v27
  v_mul_f32 v52, v52, v27
  v_mul_f32 v53, v53, v27
  v_mul_f32 v54, v54, v27
  v_mul_f32 v55, v55, v27
  v_mul_f32 v48, v48, v27
  v_mul_f32 v49, v49, v27
  v_mul_f32 v50, v50, v27
  v_mul_f32 v51, v51, v27
  v_mul_f32 v52, v52, v27
  v_mul_f32 v53, v53, v27
  v_mul_f32 v54, v54, v27
  v_mul_f32 v55, v55, v27
  v_accvgpr_write_b32 a48, v48
  v_accvgpr_write_b32 a49, v49
  v_accvgpr_write_b32 a50, v50
  v_accvgpr_write_b32 a51, v51
  v_accvgpr_write_b32 a52, v52
  v_accvgpr_write_b32 a53, v53
  v_accvgpr_write_b32 a54, v54
  v_accvgpr_write_b32 a55, v55
  v_accvgpr_read_b32 v48, a56
  v_accvgpr_read_b32 v49, a57
  v_accvgpr_read_b32 v50, a58
  v_accvgpr_read_b32 v51, a59
  v_accvgpr_read_b32 v52, a60
  v_accvgpr_read_b32 v53, a61
  v_accvgpr_read_b32 v54, a62
  v_accvgpr_read_b32 v55, a63
  v_mul_f32 v48, v48, v27
  v_mul_f32 v49, v49, v27
  v_mul_f32 v50, v50, v27
  v_mul_f32 v51, v51, v27
  v_mul_f32 v52, v52, v27
  v_mul_f32 v53, v53, v27
  v_mul_f32 v54, v54, v27
  v_mul_f32 v55, v55, v27
  v_mul_f32 v48, v48, v27
  v_mul_f32 v49, v49, v27
  v_mul_f32 v50, v50, v27
  v_mul_f32 v51, v51, v27
  v_mul_f32 v52, v52, v27
  v_mul_f32 v53, v53, v27
  v_mul_f32 v54, v54, v27
  v_mul_f32 v55, v55, v27
  v_accvgpr_write_b32 a56, v48
  v_accvgpr_write_b32 a57, v49
  v_accvgpr_write_b32 a58, v50
  v_accvgpr_write_b32 a59, v51
  v_accvgpr_write_b32 a60, v52
  v_accvgpr_write_b32 a61, v53
  v_accvgpr_write_b32 a62, v54
  v_accvgpr_write_b32 a63, v55
  s_nop 1
  s_setpc_b64 s[82:83]
attn_kernel_fix49:
  s_nop 15
  v_max3_f32 v26, v112, v113, v114
  v_max3_f32 v27, v115, v116, v117
  v_max3_f32 v26, v26, v118, v119
  v_max3_f32 v27, v27, v120, v121
  v_max3_f32 v26, v26, v122, v123
  v_max3_f32 v27, v27, v124, v125
  v_max3_f32 v26, v26, v126, v127
  v_max_f32 v26, v26, v27
  v_mov_b32 v27, v26
  s_nop 1
  v_permlane32_swap_b32 v26, v27
  v_max_f32 v26, v26, v27
  v_add_f32 v26, 0x42cc0000, v26
  v_max_f32 v26, 0, v26
  v_mul_f32 v27, -0.5, v26
  v_exp_f32 v27, v27
  v_sub_f32 v176, v176, v26
  v_sub_f32 v177, v177, v26
  v_sub_f32 v178, v178, v26
  v_sub_f32 v179, v179, v26
  v_sub_f32 v180, v180, v26
  v_sub_f32 v181, v181, v26
  v_sub_f32 v182, v182, v26
  v_sub_f32 v183, v183, v26
  v_sub_f32 v184, v184, v26
  v_sub_f32 v185, v185, v26
  v_sub_f32 v186, v186, v26
  v_sub_f32 v187, v187, v26
  v_sub_f32 v188, v188, v26
  v_sub_f32 v189, v189, v26
  v_sub_f32 v190, v190, v26
  v_sub_f32 v191, v191, v26
  v_sub_f32 v80, v80, v26
  v_sub_f32 v81, v81, v26
  v_sub_f32 v82, v82, v26
  v_sub_f32 v83, v83, v26
  v_sub_f32 v84, v84, v26
  v_sub_f32 v85, v85, v26
  v_sub_f32 v86, v86, v26
  v_sub_f32 v87, v87, v26
  v_sub_f32 v88, v88, v26
  v_sub_f32 v89, v89, v26
  v_sub_f32 v90, v90, v26
  v_sub_f32 v91, v91, v26
  v_sub_f32 v92, v92, v26
  v_sub_f32 v93, v93, v26
  v_sub_f32 v94, v94, v26
  v_sub_f32 v95, v95, v26
  v_sub_f32 v112, v112, v26
  v_sub_f32 v113, v113, v26
  v_sub_f32 v114, v114, v26
  v_sub_f32 v115, v115, v26
  v_sub_f32 v116, v116, v26
  v_sub_f32 v117, v117, v26
  v_sub_f32 v118, v118, v26
  v_sub_f32 v119, v119, v26
  v_sub_f32 v120, v120, v26
  v_sub_f32 v121, v121, v26
  v_sub_f32 v122, v122, v26
  v_sub_f32 v123, v123, v26
  v_sub_f32 v124, v124, v26
  v_sub_f32 v125, v125, v26
  v_sub_f32 v126, v126, v26
  v_sub_f32 v127, v127, v26
  v_mul_f32 v21, v21, v27
  v_mul_f32 v21, v21, v27
  v_exp_f32 v40, v112
  v_exp_f32 v41, v113
  v_exp_f32 v42, v114
  v_add_f32 v23, v40, v41
  v_exp_f32 v43, v115
  v_cvt_pk_bf16_f32 v152, v40, v41
  v_exp_f32 v44, v116
  v_add_f32 v23, v23, v42
  v_exp_f32 v45, v117
  v_add_f32 v23, v23, v43
  v_cvt_pk_bf16_f32 v153, v42, v43
  v_exp_f32 v46, v118
  v_add_f32 v23, v23, v44
  v_exp_f32 v47, v119
  v_add_f32 v23, v23, v45
  v_cvt_pk_bf16_f32 v154, v44, v45
  v_exp_f32 v40, v120
  v_add_f32 v23, v23, v46
  v_exp_f32 v41, v121
  v_add_f32 v23, v23, v47
  v_cvt_pk_bf16_f32 v155, v46, v47
  v_exp_f32 v42, v122
  v_add_f32 v23, v23, v40
  v_exp_f32 v43, v123
  v_add_f32 v23, v23, v41
  v_cvt_pk_bf16_f32 v156, v40, v41
  v_exp_f32 v44, v124
  v_add_f32 v23, v23, v42
  v_exp_f32 v45, v125
  v_add_f32 v23, v23, v43
  v_cvt_pk_bf16_f32 v157, v42, v43
  v_exp_f32 v46, v126
  v_add_f32 v23, v23, v44
  v_exp_f32 v47, v127
  v_add_f32 v23, v23, v45
  v_cvt_pk_bf16_f32 v158, v44, v45
  v_add_f32 v23, v23, v46
  v_add_f32 v23, v23, v47
  v_cvt_pk_bf16_f32 v159, v46, v47
  v_accvgpr_read_b32 v48, a64
  v_accvgpr_read_b32 v49, a65
  v_accvgpr_read_b32 v50, a66
  v_accvgpr_read_b32 v51, a67
  v_accvgpr_read_b32 v52, a68
  v_accvgpr_read_b32 v53, a69
  v_accvgpr_read_b32 v54, a70
  v_accvgpr_read_b32 v55, a71
  v_mul_f32 v48, v48, v27
  v_mul_f32 v49, v49, v27
  v_mul_f32 v50, v50, v27
  v_mul_f32 v51, v51, v27
  v_mul_f32 v52, v52, v27
  v_mul_f32 v53, v53, v27
  v_mul_f32 v54, v54, v27
  v_mul_f32 v55, v55, v27
  v_mul_f32 v48, v48, v27
  v_mul_f32 v49, v49, v27
  v_mul_f32 v50, v50, v27
  v_mul_f32 v51, v51, v27
  v_mul_f32 v52, v52, v27
  v_mul_f32 v53, v53, v27
  v_mul_f32 v54, v54, v27
  v_mul_f32 v55, v55, v27
  v_accvgpr_write_b32 a64, v48
  v_accvgpr_write_b32 a65, v49
  v_accvgpr_write_b32 a66, v50
  v_accvgpr_write_b32 a67, v51
  v_accvgpr_write_b32 a68, v52
  v_accvgpr_write_b32 a69, v53
  v_accvgpr_write_b32 a70, v54
  v_accvgpr_write_b32 a71, v55
  v_accvgpr_read_b32 v48, a72
  v_accvgpr_read_b32 v49, a73
  v_accvgpr_read_b32 v50, a74
  v_accvgpr_read_b32 v51, a75
  v_accvgpr_read_b32 v52, a76
  v_accvgpr_read_b32 v53, a77
  v_accvgpr_read_b32 v54, a78
  v_accvgpr_read_b32 v55, a79
  v_mul_f32 v48, v48, v27
  v_mul_f32 v49, v49, v27
  v_mul_f32 v50, v50, v27
  v_mul_f32 v51, v51, v27
  v_mul_f32 v52, v52, v27
  v_mul_f32 v53, v53, v27
  v_mul_f32 v54, v54, v27
  v_mul_f32 v55, v55, v27
  v_mul_f32 v48, v48, v27
  v_mul_f32 v49, v49, v27
  v_mul_f32 v50, v50, v27
  v_mul_f32 v51, v51, v27
  v_mul_f32 v52, v52, v27
  v_mul_f32 v53, v53, v27
  v_mul_f32 v54, v54, v27
  v_mul_f32 v55, v55, v27
  v_accvgpr_write_b32 a72, v48
  v_accvgpr_write_b32 a73, v49
  v_accvgpr_write_b32 a74, v50
  v_accvgpr_write_b32 a75, v51
  v_accvgpr_write_b32 a76, v52
  v_accvgpr_write_b32 a77, v53
  v_accvgpr_write_b32 a78, v54
  v_accvgpr_write_b32 a79, v55
  v_accvgpr_read_b32 v48, a80
  v_accvgpr_read_b32 v49, a81
  v_accvgpr_read_b32 v50, a82
  v_accvgpr_read_b32 v51, a83
  v_accvgpr_read_b32 v52, a84
  v_accvgpr_read_b32 v53, a85
  v_accvgpr_read_b32 v54, a86
  v_accvgpr_read_b32 v55, a87
  v_mul_f32 v48, v48, v27
  v_mul_f32 v49, v49, v27
  v_mul_f32 v50, v50, v27
  v_mul_f32 v51, v51, v27
  v_mul_f32 v52, v52, v27
  v_mul_f32 v53, v53, v27
  v_mul_f32 v54, v54, v27
  v_mul_f32 v55, v55, v27
  v_mul_f32 v48, v48, v27
  v_mul_f32 v49, v49, v27
  v_mul_f32 v50, v50, v27
  v_mul_f32 v51, v51, v27
  v_mul_f32 v52, v52, v27
  v_mul_f32 v53, v53, v27
  v_mul_f32 v54, v54, v27
  v_mul_f32 v55, v55, v27
  v_accvgpr_write_b32 a80, v48
  v_accvgpr_write_b32 a81, v49
  v_accvgpr_write_b32 a82, v50
  v_accvgpr_write_b32 a83, v51
  v_accvgpr_write_b32 a84, v52
  v_accvgpr_write_b32 a85, v53
  v_accvgpr_write_b32 a86, v54
  v_accvgpr_write_b32 a87, v55
  v_accvgpr_read_b32 v48, a88
  v_accvgpr_read_b32 v49, a89
  v_accvgpr_read_b32 v50, a90
  v_accvgpr_read_b32 v51, a91
  v_accvgpr_read_b32 v52, a92
  v_accvgpr_read_b32 v53, a93
  v_accvgpr_read_b32 v54, a94
  v_accvgpr_read_b32 v55, a95
  v_mul_f32 v48, v48, v27
  v_mul_f32 v49, v49, v27
  v_mul_f32 v50, v50, v27
  v_mul_f32 v51, v51, v27
  v_mul_f32 v52, v52, v27
  v_mul_f32 v53, v53, v27
  v_mul_f32 v54, v54, v27
  v_mul_f32 v55, v55, v27
  v_mul_f32 v48, v48, v27
  v_mul_f32 v49, v49, v27
  v_mul_f32 v50, v50, v27
  v_mul_f32 v51, v51, v27
  v_mul_f32 v52, v52, v27
  v_mul_f32 v53, v53, v27
  v_mul_f32 v54, v54, v27
  v_mul_f32 v55, v55, v27
  v_accvgpr_write_b32 a88, v48
  v_accvgpr_write_b32 a89, v49
  v_accvgpr_write_b32 a90, v50
  v_accvgpr_write_b32 a91, v51
  v_accvgpr_write_b32 a92, v52
  v_accvgpr_write_b32 a93, v53
  v_accvgpr_write_b32 a94, v54
  v_accvgpr_write_b32 a95, v55
  v_accvgpr_read_b32 v48, a96
  v_accvgpr_read_b32 v49, a97
  v_accvgpr_read_b32 v50, a98
  v_accvgpr_read_b32 v51, a99
  v_accvgpr_read_b32 v52, a100
  v_accvgpr_read_b32 v53, a101
  v_accvgpr_read_b32 v54, a102
  v_accvgpr_read_b32 v55, a103
  v_mul_f32 v48, v48, v27
  v_mul_f32 v49, v49, v27
  v_mul_f32 v50, v50, v27
  v_mul_f32 v51, v51, v27
  v_mul_f32 v52, v52, v27
  v_mul_f32 v53, v53, v27
  v_mul_f32 v54, v54, v27
  v_mul_f32 v55, v55, v27
  v_mul_f32 v48, v48, v27
  v_mul_f32 v49, v49, v27
  v_mul_f32 v50, v50, v27
  v_mul_f32 v51, v51, v27
  v_mul_f32 v52, v52, v27
  v_mul_f32 v53, v53, v27
  v_mul_f32 v54, v54, v27
  v_mul_f32 v55, v55, v27
  v_accvgpr_write_b32 a96, v48
  v_accvgpr_write_b32 a97, v49
  v_accvgpr_write_b32 a98, v50
  v_accvgpr_write_b32 a99, v51
  v_accvgpr_write_b32 a100, v52
  v_accvgpr_write_b32 a101, v53
  v_accvgpr_write_b32 a102, v54
  v_accvgpr_write_b32 a103, v55
  v_accvgpr_read_b32 v48, a104
  v_accvgpr_read_b32 v49, a105
  v_accvgpr_read_b32 v50, a106
  v_accvgpr_read_b32 v51, a107
  v_accvgpr_read_b32 v52, a108
  v_accvgpr_read_b32 v53, a109
  v_accvgpr_read_b32 v54, a110
  v_accvgpr_read_b32 v55, a111
  v_mul_f32 v48, v48, v27
  v_mul_f32 v49, v49, v27
  v_mul_f32 v50, v50, v27
  v_mul_f32 v51, v51, v27
  v_mul_f32 v52, v52, v27
  v_mul_f32 v53, v53, v27
  v_mul_f32 v54, v54, v27
  v_mul_f32 v55, v55, v27
  v_mul_f32 v48, v48, v27
  v_mul_f32 v49, v49, v27
  v_mul_f32 v50, v50, v27
  v_mul_f32 v51, v51, v27
  v_mul_f32 v52, v52, v27
  v_mul_f32 v53, v53, v27
  v_mul_f32 v54, v54, v27
  v_mul_f32 v55, v55, v27
  v_accvgpr_write_b32 a104, v48
  v_accvgpr_write_b32 a105, v49
  v_accvgpr_write_b32 a106, v50
  v_accvgpr_write_b32 a107, v51
  v_accvgpr_write_b32 a108, v52
  v_accvgpr_write_b32 a109, v53
  v_accvgpr_write_b32 a110, v54
  v_accvgpr_write_b32 a111, v55
  v_accvgpr_read_b32 v48, a112
  v_accvgpr_read_b32 v49, a113
  v_accvgpr_read_b32 v50, a114
  v_accvgpr_read_b32 v51, a115
  v_accvgpr_read_b32 v52, a116
  v_accvgpr_read_b32 v53, a117
  v_accvgpr_read_b32 v54, a118
  v_accvgpr_read_b32 v55, a119
  v_mul_f32 v48, v48, v27
  v_mul_f32 v49, v49, v27
  v_mul_f32 v50, v50, v27
  v_mul_f32 v51, v51, v27
  v_mul_f32 v52, v52, v27
  v_mul_f32 v53, v53, v27
  v_mul_f32 v54, v54, v27
  v_mul_f32 v55, v55, v27
  v_mul_f32 v48, v48, v27
  v_mul_f32 v49, v49, v27
  v_mul_f32 v50, v50, v27
  v_mul_f32 v51, v51, v27
  v_mul_f32 v52, v52, v27
  v_mul_f32 v53, v53, v27
  v_mul_f32 v54, v54, v27
  v_mul_f32 v55, v55, v27
  v_accvgpr_write_b32 a112, v48
  v_accvgpr_write_b32 a113, v49
  v_accvgpr_write_b32 a114, v50
  v_accvgpr_write_b32 a115, v51
  v_accvgpr_write_b32 a116, v52
  v_accvgpr_write_b32 a117, v53
  v_accvgpr_write_b32 a118, v54
  v_accvgpr_write_b32 a119, v55
  v_accvgpr_read_b32 v48, a120
  v_accvgpr_read_b32 v49, a121
  v_accvgpr_read_b32 v50, a122
  v_accvgpr_read_b32 v51, a123
  v_accvgpr_read_b32 v52, a124
  v_accvgpr_read_b32 v53, a125
  v_accvgpr_read_b32 v54, a126
  v_accvgpr_read_b32 v55, a127
  v_mul_f32 v48, v48, v27
  v_mul_f32 v49, v49, v27
  v_mul_f32 v50, v50, v27
  v_mul_f32 v51, v51, v27
  v_mul_f32 v52, v52, v27
  v_mul_f32 v53, v53, v27
  v_mul_f32 v54, v54, v27
  v_mul_f32 v55, v55, v27
  v_mul_f32 v48, v48, v27
  v_mul_f32 v49, v49, v27
  v_mul_f32 v50, v50, v27
  v_mul_f32 v51, v51, v27
  v_mul_f32 v52, v52, v27
  v_mul_f32 v53, v53, v27
  v_mul_f32 v54, v54, v27
  v_mul_f32 v55, v55, v27
  v_accvgpr_write_b32 a120, v48
  v_accvgpr_write_b32 a121, v49
  v_accvgpr_write_b32 a122, v50
  v_accvgpr_write_b32 a123, v51
  v_accvgpr_write_b32 a124, v52
  v_accvgpr_write_b32 a125, v53
  v_accvgpr_write_b32 a126, v54
  v_accvgpr_write_b32 a127, v55
  s_nop 1
  s_setpc_b64 s[82:83]
attn_kernel_fix50:
  s_nop 15
  v_max3_f32 v26, v96, v97, v98
  v_max3_f32 v27, v99, v100, v101
  v_max3_f32 v26, v26, v102, v103
  v_max3_f32 v27, v27, v104, v105
  v_max3_f32 v26, v26, v106, v107
  v_max3_f32 v27, v27, v108, v109
  v_max3_f32 v26, v26, v110, v111
  v_max_f32 v26, v26, v27
  v_mov_b32 v27, v26
  s_nop 1
  v_permlane32_swap_b32 v26, v27
  v_max_f32 v26, v26, v27
  v_add_f32 v26, 0x42cc0000, v26
  v_max_f32 v26, 0, v26
  v_mul_f32 v27, -0.5, v26
  v_exp_f32 v27, v27
  v_sub_f32 v160, v160, v26
  v_sub_f32 v161, v161, v26
  v_sub_f32 v162, v162, v26
  v_sub_f32 v163, v163, v26
  v_sub_f32 v164, v164, v26
  v_sub_f32 v165, v165, v26
  v_sub_f32 v166, v166, v26
  v_sub_f32 v167, v167, v26
  v_sub_f32 v168, v168, v26
  v_sub_f32 v169, v169, v26
  v_sub_f32 v170, v170, v26
  v_sub_f32 v171, v171, v26
  v_sub_f32 v172, v172, v26
  v_sub_f32 v173, v173, v26
  v_sub_f32 v174, v174, v26
  v_sub_f32 v175, v175, v26
  v_sub_f32 v96, v96, v26
  v_sub_f32 v97, v97, v26
  v_sub_f32 v98, v98, v26
  v_sub_f32 v99, v99, v26
  v_sub_f32 v100, v100, v26
  v_sub_f32 v101, v101, v26
  v_sub_f32 v102, v102, v26
  v_sub_f32 v103, v103, v26
  v_sub_f32 v104, v104, v26
  v_sub_f32 v105, v105, v26
  v_sub_f32 v106, v106, v26
  v_sub_f32 v107, v107, v26
  v_sub_f32 v108, v108, v26
  v_sub_f32 v109, v109, v26
  v_sub_f32 v110, v110, v26
  v_sub_f32 v111, v111, v26
  v_mul_f32 v20, v20, v27
  v_mul_f32 v20, v20, v27
  v_exp_f32 v32, v96
  v_exp_f32 v33, v97
  v_exp_f32 v34, v98
  v_add_f32 v22, v32, v33
  v_exp_f32 v35, v99
  v_cvt_pk_bf16_f32 v144, v32, v33
  v_exp_f32 v36, v100
  v_add_f32 v22, v22, v34
  v_exp_f32 v37, v101
  v_add_f32 v22, v22, v35
  v_cvt_pk_bf16_f32 v145, v34, v35
  v_exp_f32 v38, v102
  v_add_f32 v22, v22, v36
  v_exp_f32 v39, v103
  v_add_f32 v22, v22, v37
  v_cvt_pk_bf16_f32 v146, v36, v37
  v_exp_f32 v32, v104
  v_add_f32 v22, v22, v38
  v_exp_f32 v33, v105
  v_add_f32 v22, v22, v39
  v_cvt_pk_bf16_f32 v147, v38, v39
  v_exp_f32 v34, v106
  v_add_f32 v22, v22, v32
  v_exp_f32 v35, v107
  v_add_f32 v22, v22, v33
  v_cvt_pk_bf16_f32 v148, v32, v33
  v_exp_f32 v36, v108
  v_add_f32 v22, v22, v34
  v_exp_f32 v37, v109
  v_add_f32 v22, v22, v35
  v_cvt_pk_bf16_f32 v149, v34, v35
  v_exp_f32 v38, v110
  v_add_f32 v22, v22, v36
  v_exp_f32 v39, v111
  v_add_f32 v22, v22, v37
  v_cvt_pk_bf16_f32 v150, v36, v37
  v_add_f32 v22, v22, v38
  v_add_f32 v22, v22, v39
  v_cvt_pk_bf16_f32 v151, v38, v39
  v_accvgpr_read_b32 v48, a0
  v_accvgpr_read_b32 v49, a1
  v_accvgpr_read_b32 v50, a2
  v_accvgpr_read_b32 v51, a3
  v_accvgpr_read_b32 v52, a4
  v_accvgpr_read_b32 v53, a5
  v_accvgpr_read_b32 v54, a6
  v_accvgpr_read_b32 v55, a7
  v_mul_f32 v48, v48, v27
  v_mul_f32 v49, v49, v27
  v_mul_f32 v50, v50, v27
  v_mul_f32 v51, v51, v27
  v_mul_f32 v52, v52, v27
  v_mul_f32 v53, v53, v27
  v_mul_f32 v54, v54, v27
  v_mul_f32 v55, v55, v27
  v_mul_f32 v48, v48, v27
  v_mul_f32 v49, v49, v27
  v_mul_f32 v50, v50, v27
  v_mul_f32 v51, v51, v27
  v_mul_f32 v52, v52, v27
  v_mul_f32 v53, v53, v27
  v_mul_f32 v54, v54, v27
  v_mul_f32 v55, v55, v27
  v_accvgpr_write_b32 a0, v48
  v_accvgpr_write_b32 a1, v49
  v_accvgpr_write_b32 a2, v50
  v_accvgpr_write_b32 a3, v51
  v_accvgpr_write_b32 a4, v52
  v_accvgpr_write_b32 a5, v53
  v_accvgpr_write_b32 a6, v54
  v_accvgpr_write_b32 a7, v55
  v_accvgpr_read_b32 v48, a8
  v_accvgpr_read_b32 v49, a9
  v_accvgpr_read_b32 v50, a10
  v_accvgpr_read_b32 v51, a11
  v_accvgpr_read_b32 v52, a12
  v_accvgpr_read_b32 v53, a13
  v_accvgpr_read_b32 v54, a14
  v_accvgpr_read_b32 v55, a15
  v_mul_f32 v48, v48, v27
  v_mul_f32 v49, v49, v27
  v_mul_f32 v50, v50, v27
  v_mul_f32 v51, v51, v27
  v_mul_f32 v52, v52, v27
  v_mul_f32 v53, v53, v27
  v_mul_f32 v54, v54, v27
  v_mul_f32 v55, v55, v27
  v_mul_f32 v48, v48, v27
  v_mul_f32 v49, v49, v27
  v_mul_f32 v50, v50, v27
  v_mul_f32 v51, v51, v27
  v_mul_f32 v52, v52, v27
  v_mul_f32 v53, v53, v27
  v_mul_f32 v54, v54, v27
  v_mul_f32 v55, v55, v27
  v_accvgpr_write_b32 a8, v48
  v_accvgpr_write_b32 a9, v49
  v_accvgpr_write_b32 a10, v50
  v_accvgpr_write_b32 a11, v51
  v_accvgpr_write_b32 a12, v52
  v_accvgpr_write_b32 a13, v53
  v_accvgpr_write_b32 a14, v54
  v_accvgpr_write_b32 a15, v55
  v_accvgpr_read_b32 v48, a16
  v_accvgpr_read_b32 v49, a17
  v_accvgpr_read_b32 v50, a18
  v_accvgpr_read_b32 v51, a19
  v_accvgpr_read_b32 v52, a20
  v_accvgpr_read_b32 v53, a21
  v_accvgpr_read_b32 v54, a22
  v_accvgpr_read_b32 v55, a23
  v_mul_f32 v48, v48, v27
  v_mul_f32 v49, v49, v27
  v_mul_f32 v50, v50, v27
  v_mul_f32 v51, v51, v27
  v_mul_f32 v52, v52, v27
  v_mul_f32 v53, v53, v27
  v_mul_f32 v54, v54, v27
  v_mul_f32 v55, v55, v27
  v_mul_f32 v48, v48, v27
  v_mul_f32 v49, v49, v27
  v_mul_f32 v50, v50, v27
  v_mul_f32 v51, v51, v27
  v_mul_f32 v52, v52, v27
  v_mul_f32 v53, v53, v27
  v_mul_f32 v54, v54, v27
  v_mul_f32 v55, v55, v27
  v_accvgpr_write_b32 a16, v48
  v_accvgpr_write_b32 a17, v49
  v_accvgpr_write_b32 a18, v50
  v_accvgpr_write_b32 a19, v51
  v_accvgpr_write_b32 a20, v52
  v_accvgpr_write_b32 a21, v53
  v_accvgpr_write_b32 a22, v54
  v_accvgpr_write_b32 a23, v55
  v_accvgpr_read_b32 v48, a24
  v_accvgpr_read_b32 v49, a25
  v_accvgpr_read_b32 v50, a26
  v_accvgpr_read_b32 v51, a27
  v_accvgpr_read_b32 v52, a28
  v_accvgpr_read_b32 v53, a29
  v_accvgpr_read_b32 v54, a30
  v_accvgpr_read_b32 v55, a31
  v_mul_f32 v48, v48, v27
  v_mul_f32 v49, v49, v27
  v_mul_f32 v50, v50, v27
  v_mul_f32 v51, v51, v27
  v_mul_f32 v52, v52, v27
  v_mul_f32 v53, v53, v27
  v_mul_f32 v54, v54, v27
  v_mul_f32 v55, v55, v27
  v_mul_f32 v48, v48, v27
  v_mul_f32 v49, v49, v27
  v_mul_f32 v50, v50, v27
  v_mul_f32 v51, v51, v27
  v_mul_f32 v52, v52, v27
  v_mul_f32 v53, v53, v27
  v_mul_f32 v54, v54, v27
  v_mul_f32 v55, v55, v27
  v_accvgpr_write_b32 a24, v48
  v_accvgpr_write_b32 a25, v49
  v_accvgpr_write_b32 a26, v50
  v_accvgpr_write_b32 a27, v51
  v_accvgpr_write_b32 a28, v52
  v_accvgpr_write_b32 a29, v53
  v_accvgpr_write_b32 a30, v54
  v_accvgpr_write_b32 a31, v55
  v_accvgpr_read_b32 v48, a32
  v_accvgpr_read_b32 v49, a33
  v_accvgpr_read_b32 v50, a34
  v_accvgpr_read_b32 v51, a35
  v_accvgpr_read_b32 v52, a36
  v_accvgpr_read_b32 v53, a37
  v_accvgpr_read_b32 v54, a38
  v_accvgpr_read_b32 v55, a39
  v_mul_f32 v48, v48, v27
  v_mul_f32 v49, v49, v27
  v_mul_f32 v50, v50, v27
  v_mul_f32 v51, v51, v27
  v_mul_f32 v52, v52, v27
  v_mul_f32 v53, v53, v27
  v_mul_f32 v54, v54, v27
  v_mul_f32 v55, v55, v27
  v_mul_f32 v48, v48, v27
  v_mul_f32 v49, v49, v27
  v_mul_f32 v50, v50, v27
  v_mul_f32 v51, v51, v27
  v_mul_f32 v52, v52, v27
  v_mul_f32 v53, v53, v27
  v_mul_f32 v54, v54, v27
  v_mul_f32 v55, v55, v27
  v_accvgpr_write_b32 a32, v48
  v_accvgpr_write_b32 a33, v49
  v_accvgpr_write_b32 a34, v50
  v_accvgpr_write_b32 a35, v51
  v_accvgpr_write_b32 a36, v52
  v_accvgpr_write_b32 a37, v53
  v_accvgpr_write_b32 a38, v54
  v_accvgpr_write_b32 a39, v55
  v_accvgpr_read_b32 v48, a40
  v_accvgpr_read_b32 v49, a41
  v_accvgpr_read_b32 v50, a42
  v_accvgpr_read_b32 v51, a43
  v_accvgpr_read_b32 v52, a44
  v_accvgpr_read_b32 v53, a45
  v_accvgpr_read_b32 v54, a46
  v_accvgpr_read_b32 v55, a47
  v_mul_f32 v48, v48, v27
  v_mul_f32 v49, v49, v27
  v_mul_f32 v50, v50, v27
  v_mul_f32 v51, v51, v27
  v_mul_f32 v52, v52, v27
  v_mul_f32 v53, v53, v27
  v_mul_f32 v54, v54, v27
  v_mul_f32 v55, v55, v27
  v_mul_f32 v48, v48, v27
  v_mul_f32 v49, v49, v27
  v_mul_f32 v50, v50, v27
  v_mul_f32 v51, v51, v27
  v_mul_f32 v52, v52, v27
  v_mul_f32 v53, v53, v27
  v_mul_f32 v54, v54, v27
  v_mul_f32 v55, v55, v27
  v_accvgpr_write_b32 a40, v48
  v_accvgpr_write_b32 a41, v49
  v_accvgpr_write_b32 a42, v50
  v_accvgpr_write_b32 a43, v51
  v_accvgpr_write_b32 a44, v52
  v_accvgpr_write_b32 a45, v53
  v_accvgpr_write_b32 a46, v54
  v_accvgpr_write_b32 a47, v55
  v_accvgpr_read_b32 v48, a48
  v_accvgpr_read_b32 v49, a49
  v_accvgpr_read_b32 v50, a50
  v_accvgpr_read_b32 v51, a51
  v_accvgpr_read_b32 v52, a52
  v_accvgpr_read_b32 v53, a53
  v_accvgpr_read_b32 v54, a54
  v_accvgpr_read_b32 v55, a55
  v_mul_f32 v48, v48, v27
  v_mul_f32 v49, v49, v27
  v_mul_f32 v50, v50, v27
  v_mul_f32 v51, v51, v27
  v_mul_f32 v52, v52, v27
  v_mul_f32 v53, v53, v27
  v_mul_f32 v54, v54, v27
  v_mul_f32 v55, v55, v27
  v_mul_f32 v48, v48, v27
  v_mul_f32 v49, v49, v27
  v_mul_f32 v50, v50, v27
  v_mul_f32 v51, v51, v27
  v_mul_f32 v52, v52, v27
  v_mul_f32 v53, v53, v27
  v_mul_f32 v54, v54, v27
  v_mul_f32 v55, v55, v27
  v_accvgpr_write_b32 a48, v48
  v_accvgpr_write_b32 a49, v49
  v_accvgpr_write_b32 a50, v50
  v_accvgpr_write_b32 a51, v51
  v_accvgpr_write_b32 a52, v52
  v_accvgpr_write_b32 a53, v53
  v_accvgpr_write_b32 a54, v54
  v_accvgpr_write_b32 a55, v55
  v_accvgpr_read_b32 v48, a56
  v_accvgpr_read_b32 v49, a57
  v_accvgpr_read_b32 v50, a58
  v_accvgpr_read_b32 v51, a59
  v_accvgpr_read_b32 v52, a60
  v_accvgpr_read_b32 v53, a61
  v_accvgpr_read_b32 v54, a62
  v_accvgpr_read_b32 v55, a63
  v_mul_f32 v48, v48, v27
  v_mul_f32 v49, v49, v27
  v_mul_f32 v50, v50, v27
  v_mul_f32 v51, v51, v27
  v_mul_f32 v52, v52, v27
  v_mul_f32 v53, v53, v27
  v_mul_f32 v54, v54, v27
  v_mul_f32 v55, v55, v27
  v_mul_f32 v48, v48, v27
  v_mul_f32 v49, v49, v27
  v_mul_f32 v50, v50, v27
  v_mul_f32 v51, v51, v27
  v_mul_f32 v52, v52, v27
  v_mul_f32 v53, v53, v27
  v_mul_f32 v54, v54, v27
  v_mul_f32 v55, v55, v27
  v_accvgpr_write_b32 a56, v48
  v_accvgpr_write_b32 a57, v49
  v_accvgpr_write_b32 a58, v50
  v_accvgpr_write_b32 a59, v51
  v_accvgpr_write_b32 a60, v52
  v_accvgpr_write_b32 a61, v53
  v_accvgpr_write_b32 a62, v54
  v_accvgpr_write_b32 a63, v55
  s_nop 1
  s_setpc_b64 s[82:83]
attn_kernel_fix51:
  s_nop 15
  v_max3_f32 v26, v80, v81, v82
  v_max3_f32 v27, v83, v84, v85
  v_max3_f32 v26, v26, v86, v87
  v_max3_f32 v27, v27, v88, v89
  v_max3_f32 v26, v26, v90, v91
  v_max3_f32 v27, v27, v92, v93
  v_max3_f32 v26, v26, v94, v95
  v_max_f32 v26, v26, v27
  v_mov_b32 v27, v26
  s_nop 1
  v_permlane32_swap_b32 v26, v27
  v_max_f32 v26, v26, v27
  v_add_f32 v26, 0x42cc0000, v26
  v_max_f32 v26, 0, v26
  v_mul_f32 v27, -0.5, v26
  v_exp_f32 v27, v27
  v_sub_f32 v176, v176, v26
  v_sub_f32 v177, v177, v26
  v_sub_f32 v178, v178, v26
  v_sub_f32 v179, v179, v26
  v_sub_f32 v180, v180, v26
  v_sub_f32 v181, v181, v26
  v_sub_f32 v182, v182, v26
  v_sub_f32 v183, v183, v26
  v_sub_f32 v184, v184, v26
  v_sub_f32 v185, v185, v26
  v_sub_f32 v186, v186, v26
  v_sub_f32 v187, v187, v26
  v_sub_f32 v188, v188, v26
  v_sub_f32 v189, v189, v26
  v_sub_f32 v190, v190, v26
  v_sub_f32 v191, v191, v26
  v_sub_f32 v112, v112, v26
  v_sub_f32 v113, v113, v26
  v_sub_f32 v114, v114, v26
  v_sub_f32 v115, v115, v26
  v_sub_f32 v116, v116, v26
  v_sub_f32 v117, v117, v26
  v_sub_f32 v118, v118, v26
  v_sub_f32 v119, v119, v26
  v_sub_f32 v120, v120, v26
  v_sub_f32 v121, v121, v26
  v_sub_f32 v122, v122, v26
  v_sub_f32 v123, v123, v26
  v_sub_f32 v124, v124, v26
  v_sub_f32 v125, v125, v26
  v_sub_f32 v126, v126, v26
  v_sub_f32 v127, v127, v26
  v_sub_f32 v80, v80, v26
  v_sub_f32 v81, v81, v26
  v_sub_f32 v82, v82, v26
  v_sub_f32 v83, v83, v26
  v_sub_f32 v84, v84, v26
  v_sub_f32 v85, v85, v26
  v_sub_f32 v86, v86, v26
  v_sub_f32 v87, v87, v26
  v_sub_f32 v88, v88, v26
  v_sub_f32 v89, v89, v26
  v_sub_f32 v90, v90, v26
  v_sub_f32 v91, v91, v26
  v_sub_f32 v92, v92, v26
  v_sub_f32 v93, v93, v26
  v_sub_f32 v94, v94, v26
  v_sub_f32 v95, v95, v26
  v_mul_f32 v21, v21, v27
  v_mul_f32 v21, v21, v27
  v_exp_f32 v40, v80
  v_exp_f32 v41, v81
  v_exp_f32 v42, v82
  v_add_f32 v23, v40, v41
  v_exp_f32 v43, v83
  v_cvt_pk_bf16_f32 v136, v40, v41
  v_exp_f32 v44, v84
  v_add_f32 v23, v23, v42
  v_exp_f32 v45, v85
  v_add_f32 v23, v23, v43
  v_cvt_pk_bf16_f32 v137, v42, v43
  v_exp_f32 v46, v86
  v_add_f32 v23, v23, v44
  v_exp_f32 v47, v87
  v_add_f32 v23, v23, v45
  v_cvt_pk_bf16_f32 v138, v44, v45
  v_exp_f32 v40, v88
  v_add_f32 v23, v23, v46
  v_exp_f32 v41, v89
  v_add_f32 v23, v23, v47
  v_cvt_pk_bf16_f32 v139, v46, v47
  v_exp_f32 v42, v90
  v_add_f32 v23, v23, v40
  v_exp_f32 v43, v91
  v_add_f32 v23, v23, v41
  v_cvt_pk_bf16_f32 v140, v40, v41
  v_exp_f32 v44, v92
  v_add_f32 v23, v23, v42
  v_exp_f32 v45, v93
  v_add_f32 v23, v23, v43
  v_cvt_pk_bf16_f32 v141, v42, v43
  v_exp_f32 v46, v94
  v_add_f32 v23, v23, v44
  v_exp_f32 v47, v95
  v_add_f32 v23, v23, v45
  v_cvt_pk_bf16_f32 v142, v44, v45
  v_add_f32 v23, v23, v46
  v_add_f32 v23, v23, v47
  v_cvt_pk_bf16_f32 v143, v46, v47
  v_accvgpr_read_b32 v48, a64
  v_accvgpr_read_b32 v49, a65
  v_accvgpr_read_b32 v50, a66
  v_accvgpr_read_b32 v51, a67
  v_accvgpr_read_b32 v52, a68
  v_accvgpr_read_b32 v53, a69
  v_accvgpr_read_b32 v54, a70
  v_accvgpr_read_b32 v55, a71
  v_mul_f32 v48, v48, v27
  v_mul_f32 v49, v49, v27
  v_mul_f32 v50, v50, v27
  v_mul_f32 v51, v51, v27
  v_mul_f32 v52, v52, v27
  v_mul_f32 v53, v53, v27
  v_mul_f32 v54, v54, v27
  v_mul_f32 v55, v55, v27
  v_mul_f32 v48, v48, v27
  v_mul_f32 v49, v49, v27
  v_mul_f32 v50, v50, v27
  v_mul_f32 v51, v51, v27
  v_mul_f32 v52, v52, v27
  v_mul_f32 v53, v53, v27
  v_mul_f32 v54, v54, v27
  v_mul_f32 v55, v55, v27
  v_accvgpr_write_b32 a64, v48
  v_accvgpr_write_b32 a65, v49
  v_accvgpr_write_b32 a66, v50
  v_accvgpr_write_b32 a67, v51
  v_accvgpr_write_b32 a68, v52
  v_accvgpr_write_b32 a69, v53
  v_accvgpr_write_b32 a70, v54
  v_accvgpr_write_b32 a71, v55
  v_accvgpr_read_b32 v48, a72
  v_accvgpr_read_b32 v49, a73
  v_accvgpr_read_b32 v50, a74
  v_accvgpr_read_b32 v51, a75
  v_accvgpr_read_b32 v52, a76
  v_accvgpr_read_b32 v53, a77
  v_accvgpr_read_b32 v54, a78
  v_accvgpr_read_b32 v55, a79
  v_mul_f32 v48, v48, v27
  v_mul_f32 v49, v49, v27
  v_mul_f32 v50, v50, v27
  v_mul_f32 v51, v51, v27
  v_mul_f32 v52, v52, v27
  v_mul_f32 v53, v53, v27
  v_mul_f32 v54, v54, v27
  v_mul_f32 v55, v55, v27
  v_mul_f32 v48, v48, v27
  v_mul_f32 v49, v49, v27
  v_mul_f32 v50, v50, v27
  v_mul_f32 v51, v51, v27
  v_mul_f32 v52, v52, v27
  v_mul_f32 v53, v53, v27
  v_mul_f32 v54, v54, v27
  v_mul_f32 v55, v55, v27
  v_accvgpr_write_b32 a72, v48
  v_accvgpr_write_b32 a73, v49
  v_accvgpr_write_b32 a74, v50
  v_accvgpr_write_b32 a75, v51
  v_accvgpr_write_b32 a76, v52
  v_accvgpr_write_b32 a77, v53
  v_accvgpr_write_b32 a78, v54
  v_accvgpr_write_b32 a79, v55
  v_accvgpr_read_b32 v48, a80
  v_accvgpr_read_b32 v49, a81
  v_accvgpr_read_b32 v50, a82
  v_accvgpr_read_b32 v51, a83
  v_accvgpr_read_b32 v52, a84
  v_accvgpr_read_b32 v53, a85
  v_accvgpr_read_b32 v54, a86
  v_accvgpr_read_b32 v55, a87
  v_mul_f32 v48, v48, v27
  v_mul_f32 v49, v49, v27
  v_mul_f32 v50, v50, v27
  v_mul_f32 v51, v51, v27
  v_mul_f32 v52, v52, v27
  v_mul_f32 v53, v53, v27
  v_mul_f32 v54, v54, v27
  v_mul_f32 v55, v55, v27
  v_mul_f32 v48, v48, v27
  v_mul_f32 v49, v49, v27
  v_mul_f32 v50, v50, v27
  v_mul_f32 v51, v51, v27
  v_mul_f32 v52, v52, v27
  v_mul_f32 v53, v53, v27
  v_mul_f32 v54, v54, v27
  v_mul_f32 v55, v55, v27
  v_accvgpr_write_b32 a80, v48
  v_accvgpr_write_b32 a81, v49
  v_accvgpr_write_b32 a82, v50
  v_accvgpr_write_b32 a83, v51
  v_accvgpr_write_b32 a84, v52
  v_accvgpr_write_b32 a85, v53
  v_accvgpr_write_b32 a86, v54
  v_accvgpr_write_b32 a87, v55
  v_accvgpr_read_b32 v48, a88
  v_accvgpr_read_b32 v49, a89
  v_accvgpr_read_b32 v50, a90
  v_accvgpr_read_b32 v51, a91
  v_accvgpr_read_b32 v52, a92
  v_accvgpr_read_b32 v53, a93
  v_accvgpr_read_b32 v54, a94
  v_accvgpr_read_b32 v55, a95
  v_mul_f32 v48, v48, v27
  v_mul_f32 v49, v49, v27
  v_mul_f32 v50, v50, v27
  v_mul_f32 v51, v51, v27
  v_mul_f32 v52, v52, v27
  v_mul_f32 v53, v53, v27
  v_mul_f32 v54, v54, v27
  v_mul_f32 v55, v55, v27
  v_mul_f32 v48, v48, v27
  v_mul_f32 v49, v49, v27
  v_mul_f32 v50, v50, v27
  v_mul_f32 v51, v51, v27
  v_mul_f32 v52, v52, v27
  v_mul_f32 v53, v53, v27
  v_mul_f32 v54, v54, v27
  v_mul_f32 v55, v55, v27
  v_accvgpr_write_b32 a88, v48
  v_accvgpr_write_b32 a89, v49
  v_accvgpr_write_b32 a90, v50
  v_accvgpr_write_b32 a91, v51
  v_accvgpr_write_b32 a92, v52
  v_accvgpr_write_b32 a93, v53
  v_accvgpr_write_b32 a94, v54
  v_accvgpr_write_b32 a95, v55
  v_accvgpr_read_b32 v48, a96
  v_accvgpr_read_b32 v49, a97
  v_accvgpr_read_b32 v50, a98
  v_accvgpr_read_b32 v51, a99
  v_accvgpr_read_b32 v52, a100
  v_accvgpr_read_b32 v53, a101
  v_accvgpr_read_b32 v54, a102
  v_accvgpr_read_b32 v55, a103
  v_mul_f32 v48, v48, v27
  v_mul_f32 v49, v49, v27
  v_mul_f32 v50, v50, v27
  v_mul_f32 v51, v51, v27
  v_mul_f32 v52, v52, v27
  v_mul_f32 v53, v53, v27
  v_mul_f32 v54, v54, v27
  v_mul_f32 v55, v55, v27
  v_mul_f32 v48, v48, v27
  v_mul_f32 v49, v49, v27
  v_mul_f32 v50, v50, v27
  v_mul_f32 v51, v51, v27
  v_mul_f32 v52, v52, v27
  v_mul_f32 v53, v53, v27
  v_mul_f32 v54, v54, v27
  v_mul_f32 v55, v55, v27
  v_accvgpr_write_b32 a96, v48
  v_accvgpr_write_b32 a97, v49
  v_accvgpr_write_b32 a98, v50
  v_accvgpr_write_b32 a99, v51
  v_accvgpr_write_b32 a100, v52
  v_accvgpr_write_b32 a101, v53
  v_accvgpr_write_b32 a102, v54
  v_accvgpr_write_b32 a103, v55
  v_accvgpr_read_b32 v48, a104
  v_accvgpr_read_b32 v49, a105
  v_accvgpr_read_b32 v50, a106
  v_accvgpr_read_b32 v51, a107
  v_accvgpr_read_b32 v52, a108
  v_accvgpr_read_b32 v53, a109
  v_accvgpr_read_b32 v54, a110
  v_accvgpr_read_b32 v55, a111
  v_mul_f32 v48, v48, v27
  v_mul_f32 v49, v49, v27
  v_mul_f32 v50, v50, v27
  v_mul_f32 v51, v51, v27
  v_mul_f32 v52, v52, v27
  v_mul_f32 v53, v53, v27
  v_mul_f32 v54, v54, v27
  v_mul_f32 v55, v55, v27
  v_mul_f32 v48, v48, v27
  v_mul_f32 v49, v49, v27
  v_mul_f32 v50, v50, v27
  v_mul_f32 v51, v51, v27
  v_mul_f32 v52, v52, v27
  v_mul_f32 v53, v53, v27
  v_mul_f32 v54, v54, v27
  v_mul_f32 v55, v55, v27
  v_accvgpr_write_b32 a104, v48
  v_accvgpr_write_b32 a105, v49
  v_accvgpr_write_b32 a106, v50
  v_accvgpr_write_b32 a107, v51
  v_accvgpr_write_b32 a108, v52
  v_accvgpr_write_b32 a109, v53
  v_accvgpr_write_b32 a110, v54
  v_accvgpr_write_b32 a111, v55
  v_accvgpr_read_b32 v48, a112
  v_accvgpr_read_b32 v49, a113
  v_accvgpr_read_b32 v50, a114
  v_accvgpr_read_b32 v51, a115
  v_accvgpr_read_b32 v52, a116
  v_accvgpr_read_b32 v53, a117
  v_accvgpr_read_b32 v54, a118
  v_accvgpr_read_b32 v55, a119
  v_mul_f32 v48, v48, v27
  v_mul_f32 v49, v49, v27
  v_mul_f32 v50, v50, v27
  v_mul_f32 v51, v51, v27
  v_mul_f32 v52, v52, v27
  v_mul_f32 v53, v53, v27
  v_mul_f32 v54, v54, v27
  v_mul_f32 v55, v55, v27
  v_mul_f32 v48, v48, v27
  v_mul_f32 v49, v49, v27
  v_mul_f32 v50, v50, v27
  v_mul_f32 v51, v51, v27
  v_mul_f32 v52, v52, v27
  v_mul_f32 v53, v53, v27
  v_mul_f32 v54, v54, v27
  v_mul_f32 v55, v55, v27
  v_accvgpr_write_b32 a112, v48
  v_accvgpr_write_b32 a113, v49
  v_accvgpr_write_b32 a114, v50
  v_accvgpr_write_b32 a115, v51
  v_accvgpr_write_b32 a116, v52
  v_accvgpr_write_b32 a117, v53
  v_accvgpr_write_b32 a118, v54
  v_accvgpr_write_b32 a119, v55
  v_accvgpr_read_b32 v48, a120
  v_accvgpr_read_b32 v49, a121
  v_accvgpr_read_b32 v50, a122
  v_accvgpr_read_b32 v51, a123
  v_accvgpr_read_b32 v52, a124
  v_accvgpr_read_b32 v53, a125
  v_accvgpr_read_b32 v54, a126
  v_accvgpr_read_b32 v55, a127
  v_mul_f32 v48, v48, v27
  v_mul_f32 v49, v49, v27
  v_mul_f32 v50, v50, v27
  v_mul_f32 v51, v51, v27
  v_mul_f32 v52, v52, v27
  v_mul_f32 v53, v53, v27
  v_mul_f32 v54, v54, v27
  v_mul_f32 v55, v55, v27
  v_mul_f32 v48, v48, v27
  v_mul_f32 v49, v49, v27
  v_mul_f32 v50, v50, v27
  v_mul_f32 v51, v51, v27
  v_mul_f32 v52, v52, v27
  v_mul_f32 v53, v53, v27
  v_mul_f32 v54, v54, v27
  v_mul_f32 v55, v55, v27
  v_accvgpr_write_b32 a120, v48
  v_accvgpr_write_b32 a121, v49
  v_accvgpr_write_b32 a122, v50
  v_accvgpr_write_b32 a123, v51
  v_accvgpr_write_b32 a124, v52
  v_accvgpr_write_b32 a125, v53
  v_accvgpr_write_b32 a126, v54
  v_accvgpr_write_b32 a127, v55
  s_nop 1
  s_setpc_b64 s[82:83]
attn_kernel_fix52:
  s_nop 15
  v_max3_f32 v26, v112, v113, v114
  v_max3_f32 v27, v115, v116, v117
  v_max3_f32 v26, v26, v118, v119
  v_max3_f32 v27, v27, v120, v121
  v_max3_f32 v26, v26, v122, v123
  v_max3_f32 v27, v27, v124, v125
  v_max3_f32 v26, v26, v126, v127
  v_max_f32 v26, v26, v27
  v_mov_b32 v27, v26
  s_nop 1
  v_permlane32_swap_b32 v26, v27
  v_max_f32 v26, v26, v27
  v_add_f32 v26, 0x42cc0000, v26
  v_max_f32 v26, 0, v26
  v_mul_f32 v27, -0.5, v26
  v_exp_f32 v27, v27
  v_sub_f32 v176, v176, v26
  v_sub_f32 v177, v177, v26
  v_sub_f32 v178, v178, v26
  v_sub_f32 v179, v179, v26
  v_sub_f32 v180, v180, v26
  v_sub_f32 v181, v181, v26
  v_sub_f32 v182, v182, v26
  v_sub_f32 v183, v183, v26
  v_sub_f32 v184, v184, v26
  v_sub_f32 v185, v185, v26
  v_sub_f32 v186, v186, v26
  v_sub_f32 v187, v187, v26
  v_sub_f32 v188, v188, v26
  v_sub_f32 v189, v189, v26
  v_sub_f32 v190, v190, v26
  v_sub_f32 v191, v191, v26
  v_sub_f32 v112, v112, v26
  v_sub_f32 v113, v113, v26
  v_sub_f32 v114, v114, v26
  v_sub_f32 v115, v115, v26
  v_sub_f32 v116, v116, v26
  v_sub_f32 v117, v117, v26
  v_sub_f32 v118, v118, v26
  v_sub_f32 v119, v119, v26
  v_sub_f32 v120, v120, v26
  v_sub_f32 v121, v121, v26
  v_sub_f32 v122, v122, v26
  v_sub_f32 v123, v123, v26
  v_sub_f32 v124, v124, v26
  v_sub_f32 v125, v125, v26
  v_sub_f32 v126, v126, v26
  v_sub_f32 v127, v127, v26
  v_mul_f32 v21, v21, v27
  v_mul_f32 v21, v21, v27
  v_exp_f32 v40, v112
  v_exp_f32 v41, v113
  v_exp_f32 v42, v114
  v_add_f32 v23, v40, v41
  v_exp_f32 v43, v115
  v_cvt_pk_bf16_f32 v152, v40, v41
  v_exp_f32 v44, v116
  v_add_f32 v23, v23, v42
  v_exp_f32 v45, v117
  v_add_f32 v23, v23, v43
  v_cvt_pk_bf16_f32 v153, v42, v43
  v_exp_f32 v46, v118
  v_add_f32 v23, v23, v44
  v_exp_f32 v47, v119
  v_add_f32 v23, v23, v45
  v_cvt_pk_bf16_f32 v154, v44, v45
  v_exp_f32 v40, v120
  v_add_f32 v23, v23, v46
  v_exp_f32 v41, v121
  v_add_f32 v23, v23, v47
  v_cvt_pk_bf16_f32 v155, v46, v47
  v_exp_f32 v42, v122
  v_add_f32 v23, v23, v40
  v_exp_f32 v43, v123
  v_add_f32 v23, v23, v41
  v_cvt_pk_bf16_f32 v156, v40, v41
  v_exp_f32 v44, v124
  v_add_f32 v23, v23, v42
  v_exp_f32 v45, v125
  v_add_f32 v23, v23, v43
  v_cvt_pk_bf16_f32 v157, v42, v43
  v_exp_f32 v46, v126
  v_add_f32 v23, v23, v44
  v_exp_f32 v47, v127
  v_add_f32 v23, v23, v45
  v_cvt_pk_bf16_f32 v158, v44, v45
  v_add_f32 v23, v23, v46
  v_add_f32 v23, v23, v47
  v_cvt_pk_bf16_f32 v159, v46, v47
  v_accvgpr_read_b32 v48, a64
  v_accvgpr_read_b32 v49, a65
  v_accvgpr_read_b32 v50, a66
  v_accvgpr_read_b32 v51, a67
  v_accvgpr_read_b32 v52, a68
  v_accvgpr_read_b32 v53, a69
  v_accvgpr_read_b32 v54, a70
  v_accvgpr_read_b32 v55, a71
  v_mul_f32 v48, v48, v27
  v_mul_f32 v49, v49, v27
  v_mul_f32 v50, v50, v27
  v_mul_f32 v51, v51, v27
  v_mul_f32 v52, v52, v27
  v_mul_f32 v53, v53, v27
  v_mul_f32 v54, v54, v27
  v_mul_f32 v55, v55, v27
  v_mul_f32 v48, v48, v27
  v_mul_f32 v49, v49, v27
  v_mul_f32 v50, v50, v27
  v_mul_f32 v51, v51, v27
  v_mul_f32 v52, v52, v27
  v_mul_f32 v53, v53, v27
  v_mul_f32 v54, v54, v27
  v_mul_f32 v55, v55, v27
  v_accvgpr_write_b32 a64, v48
  v_accvgpr_write_b32 a65, v49
  v_accvgpr_write_b32 a66, v50
  v_accvgpr_write_b32 a67, v51
  v_accvgpr_write_b32 a68, v52
  v_accvgpr_write_b32 a69, v53
  v_accvgpr_write_b32 a70, v54
  v_accvgpr_write_b32 a71, v55
  v_accvgpr_read_b32 v48, a72
  v_accvgpr_read_b32 v49, a73
  v_accvgpr_read_b32 v50, a74
  v_accvgpr_read_b32 v51, a75
  v_accvgpr_read_b32 v52, a76
  v_accvgpr_read_b32 v53, a77
  v_accvgpr_read_b32 v54, a78
  v_accvgpr_read_b32 v55, a79
  v_mul_f32 v48, v48, v27
  v_mul_f32 v49, v49, v27
  v_mul_f32 v50, v50, v27
  v_mul_f32 v51, v51, v27
  v_mul_f32 v52, v52, v27
  v_mul_f32 v53, v53, v27
  v_mul_f32 v54, v54, v27
  v_mul_f32 v55, v55, v27
  v_mul_f32 v48, v48, v27
  v_mul_f32 v49, v49, v27
  v_mul_f32 v50, v50, v27
  v_mul_f32 v51, v51, v27
  v_mul_f32 v52, v52, v27
  v_mul_f32 v53, v53, v27
  v_mul_f32 v54, v54, v27
  v_mul_f32 v55, v55, v27
  v_accvgpr_write_b32 a72, v48
  v_accvgpr_write_b32 a73, v49
  v_accvgpr_write_b32 a74, v50
  v_accvgpr_write_b32 a75, v51
  v_accvgpr_write_b32 a76, v52
  v_accvgpr_write_b32 a77, v53
  v_accvgpr_write_b32 a78, v54
  v_accvgpr_write_b32 a79, v55
  v_accvgpr_read_b32 v48, a80
  v_accvgpr_read_b32 v49, a81
  v_accvgpr_read_b32 v50, a82
  v_accvgpr_read_b32 v51, a83
  v_accvgpr_read_b32 v52, a84
  v_accvgpr_read_b32 v53, a85
  v_accvgpr_read_b32 v54, a86
  v_accvgpr_read_b32 v55, a87
  v_mul_f32 v48, v48, v27
  v_mul_f32 v49, v49, v27
  v_mul_f32 v50, v50, v27
  v_mul_f32 v51, v51, v27
  v_mul_f32 v52, v52, v27
  v_mul_f32 v53, v53, v27
  v_mul_f32 v54, v54, v27
  v_mul_f32 v55, v55, v27
  v_mul_f32 v48, v48, v27
  v_mul_f32 v49, v49, v27
  v_mul_f32 v50, v50, v27
  v_mul_f32 v51, v51, v27
  v_mul_f32 v52, v52, v27
  v_mul_f32 v53, v53, v27
  v_mul_f32 v54, v54, v27
  v_mul_f32 v55, v55, v27
  v_accvgpr_write_b32 a80, v48
  v_accvgpr_write_b32 a81, v49
  v_accvgpr_write_b32 a82, v50
  v_accvgpr_write_b32 a83, v51
  v_accvgpr_write_b32 a84, v52
  v_accvgpr_write_b32 a85, v53
  v_accvgpr_write_b32 a86, v54
  v_accvgpr_write_b32 a87, v55
  v_accvgpr_read_b32 v48, a88
  v_accvgpr_read_b32 v49, a89
  v_accvgpr_read_b32 v50, a90
  v_accvgpr_read_b32 v51, a91
  v_accvgpr_read_b32 v52, a92
  v_accvgpr_read_b32 v53, a93
  v_accvgpr_read_b32 v54, a94
  v_accvgpr_read_b32 v55, a95
  v_mul_f32 v48, v48, v27
  v_mul_f32 v49, v49, v27
  v_mul_f32 v50, v50, v27
  v_mul_f32 v51, v51, v27
  v_mul_f32 v52, v52, v27
  v_mul_f32 v53, v53, v27
  v_mul_f32 v54, v54, v27
  v_mul_f32 v55, v55, v27
  v_mul_f32 v48, v48, v27
  v_mul_f32 v49, v49, v27
  v_mul_f32 v50, v50, v27
  v_mul_f32 v51, v51, v27
  v_mul_f32 v52, v52, v27
  v_mul_f32 v53, v53, v27
  v_mul_f32 v54, v54, v27
  v_mul_f32 v55, v55, v27
  v_accvgpr_write_b32 a88, v48
  v_accvgpr_write_b32 a89, v49
  v_accvgpr_write_b32 a90, v50
  v_accvgpr_write_b32 a91, v51
  v_accvgpr_write_b32 a92, v52
  v_accvgpr_write_b32 a93, v53
  v_accvgpr_write_b32 a94, v54
  v_accvgpr_write_b32 a95, v55
  v_accvgpr_read_b32 v48, a96
  v_accvgpr_read_b32 v49, a97
  v_accvgpr_read_b32 v50, a98
  v_accvgpr_read_b32 v51, a99
  v_accvgpr_read_b32 v52, a100
  v_accvgpr_read_b32 v53, a101
  v_accvgpr_read_b32 v54, a102
  v_accvgpr_read_b32 v55, a103
  v_mul_f32 v48, v48, v27
  v_mul_f32 v49, v49, v27
  v_mul_f32 v50, v50, v27
  v_mul_f32 v51, v51, v27
  v_mul_f32 v52, v52, v27
  v_mul_f32 v53, v53, v27
  v_mul_f32 v54, v54, v27
  v_mul_f32 v55, v55, v27
  v_mul_f32 v48, v48, v27
  v_mul_f32 v49, v49, v27
  v_mul_f32 v50, v50, v27
  v_mul_f32 v51, v51, v27
  v_mul_f32 v52, v52, v27
  v_mul_f32 v53, v53, v27
  v_mul_f32 v54, v54, v27
  v_mul_f32 v55, v55, v27
  v_accvgpr_write_b32 a96, v48
  v_accvgpr_write_b32 a97, v49
  v_accvgpr_write_b32 a98, v50
  v_accvgpr_write_b32 a99, v51
  v_accvgpr_write_b32 a100, v52
  v_accvgpr_write_b32 a101, v53
  v_accvgpr_write_b32 a102, v54
  v_accvgpr_write_b32 a103, v55
  v_accvgpr_read_b32 v48, a104
  v_accvgpr_read_b32 v49, a105
  v_accvgpr_read_b32 v50, a106
  v_accvgpr_read_b32 v51, a107
  v_accvgpr_read_b32 v52, a108
  v_accvgpr_read_b32 v53, a109
  v_accvgpr_read_b32 v54, a110
  v_accvgpr_read_b32 v55, a111
  v_mul_f32 v48, v48, v27
  v_mul_f32 v49, v49, v27
  v_mul_f32 v50, v50, v27
  v_mul_f32 v51, v51, v27
  v_mul_f32 v52, v52, v27
  v_mul_f32 v53, v53, v27
  v_mul_f32 v54, v54, v27
  v_mul_f32 v55, v55, v27
  v_mul_f32 v48, v48, v27
  v_mul_f32 v49, v49, v27
  v_mul_f32 v50, v50, v27
  v_mul_f32 v51, v51, v27
  v_mul_f32 v52, v52, v27
  v_mul_f32 v53, v53, v27
  v_mul_f32 v54, v54, v27
  v_mul_f32 v55, v55, v27
  v_accvgpr_write_b32 a104, v48
  v_accvgpr_write_b32 a105, v49
  v_accvgpr_write_b32 a106, v50
  v_accvgpr_write_b32 a107, v51
  v_accvgpr_write_b32 a108, v52
  v_accvgpr_write_b32 a109, v53
  v_accvgpr_write_b32 a110, v54
  v_accvgpr_write_b32 a111, v55
  v_accvgpr_read_b32 v48, a112
  v_accvgpr_read_b32 v49, a113
  v_accvgpr_read_b32 v50, a114
  v_accvgpr_read_b32 v51, a115
  v_accvgpr_read_b32 v52, a116
  v_accvgpr_read_b32 v53, a117
  v_accvgpr_read_b32 v54, a118
  v_accvgpr_read_b32 v55, a119
  v_mul_f32 v48, v48, v27
  v_mul_f32 v49, v49, v27
  v_mul_f32 v50, v50, v27
  v_mul_f32 v51, v51, v27
  v_mul_f32 v52, v52, v27
  v_mul_f32 v53, v53, v27
  v_mul_f32 v54, v54, v27
  v_mul_f32 v55, v55, v27
  v_mul_f32 v48, v48, v27
  v_mul_f32 v49, v49, v27
  v_mul_f32 v50, v50, v27
  v_mul_f32 v51, v51, v27
  v_mul_f32 v52, v52, v27
  v_mul_f32 v53, v53, v27
  v_mul_f32 v54, v54, v27
  v_mul_f32 v55, v55, v27
  v_accvgpr_write_b32 a112, v48
  v_accvgpr_write_b32 a113, v49
  v_accvgpr_write_b32 a114, v50
  v_accvgpr_write_b32 a115, v51
  v_accvgpr_write_b32 a116, v52
  v_accvgpr_write_b32 a117, v53
  v_accvgpr_write_b32 a118, v54
  v_accvgpr_write_b32 a119, v55
  v_accvgpr_read_b32 v48, a120
  v_accvgpr_read_b32 v49, a121
  v_accvgpr_read_b32 v50, a122
  v_accvgpr_read_b32 v51, a123
  v_accvgpr_read_b32 v52, a124
  v_accvgpr_read_b32 v53, a125
  v_accvgpr_read_b32 v54, a126
  v_accvgpr_read_b32 v55, a127
  v_mul_f32 v48, v48, v27
  v_mul_f32 v49, v49, v27
  v_mul_f32 v50, v50, v27
  v_mul_f32 v51, v51, v27
  v_mul_f32 v52, v52, v27
  v_mul_f32 v53, v53, v27
  v_mul_f32 v54, v54, v27
  v_mul_f32 v55, v55, v27
  v_mul_f32 v48, v48, v27
  v_mul_f32 v49, v49, v27
  v_mul_f32 v50, v50, v27
  v_mul_f32 v51, v51, v27
  v_mul_f32 v52, v52, v27
  v_mul_f32 v53, v53, v27
  v_mul_f32 v54, v54, v27
  v_mul_f32 v55, v55, v27
  v_accvgpr_write_b32 a120, v48
  v_accvgpr_write_b32 a121, v49
  v_accvgpr_write_b32 a122, v50
  v_accvgpr_write_b32 a123, v51
  v_accvgpr_write_b32 a124, v52
  v_accvgpr_write_b32 a125, v53
  v_accvgpr_write_b32 a126, v54
  v_accvgpr_write_b32 a127, v55
  s_nop 1
  s_setpc_b64 s[82:83]
code_end:
.section .rodata,"a"
.p2align 6
.amdhsa_kernel pre_kernel
  .amdhsa_next_free_vgpr 64
  .amdhsa_next_free_sgpr 40
  .amdhsa_accum_offset 64
  .amdhsa_group_segment_fixed_size 0
  .amdhsa_kernarg_size 112
  .amdhsa_user_sgpr_count 2
  .amdhsa_user_sgpr_kernarg_segment_ptr 1
  .amdhsa_system_sgpr_workgroup_id_x 1
.end_amdhsa_kernel
.p2align 6
.amdhsa_kernel attn_kernel
  .amdhsa_next_free_vgpr 512
  .amdhsa_next_free_sgpr 84
  .amdhsa_accum_offset 256
  .amdhsa_group_segment_fixed_size 0
  .amdhsa_kernarg_size 112
  .amdhsa_user_sgpr_count 2
  .amdhsa_user_sgpr_kernarg_segment_ptr 1
  .amdhsa_system_sgpr_workgroup_id_x 1
.end_amdhsa_kernel
```
